```python
import torch

def _softmax(x, axis=-1):
    return torch.softmax(x, dim=axis)

def _gelu(x):
    return torch.nn.functional.gelu(x, approximate='tanh')

def _silu(x):
    return torch.nn.functional.silu(x)

def _sigmoid(x):
    return torch.sigmoid(x)

def _layernorm(x, axis=-1, eps=1e-05):
    m = x.mean(dim=axis, keepdim=True)
    v = x.var(dim=axis, keepdim=True, unbiased=False)
    return (x - m) / torch.sqrt(v + eps)

def _scatter_add(tgt, idx, src, axis=0):
    return tgt.clone().index_add_(axis, idx, src)

def _segment_sum(src, seg, n):
    out = torch.zeros((n,) + src.shape[1:], dtype=src.dtype)
    return out.index_add_(0, seg, src)

def _pad(x, pw):
    flat = tuple((v for pair in reversed(pw) for v in pair))
    return torch.nn.functional.pad(x, flat)
kernel_name = 'recurrent_scan__linear_attn_block__mixer_gmlp__prompt'

def setup_inputs():

    _w = lambda a: (lambda t: t.to(torch.bfloat16) if t.is_floating_point() else t)(torch.as_tensor(a))

    def _A_setup():
        B, S, D = (1, 2048, 512)
        return {'x': _w((lambda *s: torch.randn(*s, dtype=torch.bfloat16) * 0.05)(B, S, D)), 'wqkv': _w((lambda *s: torch.randn(*s, dtype=torch.bfloat16) * 0.05)(D, 3 * D)), 'wo': _w((lambda *s: torch.randn(*s, dtype=torch.bfloat16) * 0.05)(D, D))}
    _A_in = _A_setup()

    def _B_setup():
        B, S, D, F = (1, 2048, 512, 1376)
        Fh = F // 2
        return {'x': _w((lambda *s: torch.randn(*s, dtype=torch.bfloat16) * 0.05)(B, S, D)), 'w_in': _w((lambda *s: torch.randn(*s, dtype=torch.bfloat16) * 0.4)(D, 2 * Fh)), 'w_sp': _w(0.01 * (lambda *s: torch.randn(*s, dtype=torch.bfloat16) * 0.4)(S, S)), 'b_sp': _w(1.0 + 0.01 * (lambda *s: torch.randn(*s, dtype=torch.bfloat16) * 0.05)(S)), 'w_out': _w((lambda *s: torch.randn(*s, dtype=torch.bfloat16) * 0.05)(Fh, D))}
    _B_in = _B_setup()
    return {'A_x': _A_in['x'], 'A_wqkv': _A_in['wqkv'], 'A_wo': _A_in['wo'], 'B_x': _B_in['x'], 'B_w_in': _B_in['w_in'], 'B_w_sp': _B_in['w_sp'], 'B_b_sp': _B_in['b_sp'], 'B_w_out': _B_in['w_out']}

def reference(A_x, A_wqkv, A_wo, B_x, B_w_in, B_w_sp, B_b_sp, B_w_out):

    def _A_ref(x, wqkv, wo):
        B, S, D = x.shape
        H = 32
        Dh = D // H
        qkv = (lambda x, *d: x.permute(*d))((x @ wqkv).reshape(B, S, 3, H, Dh), 2, 0, 3, 1, 4)
        q, k, v = (qkv[0], qkv[1], qkv[2])
        phi = lambda t: torch.where(t > 0, t + 1, torch.exp(t)) + 1e-06
        pq, pk = (phi(q), phi(k))
        kv = torch.einsum('bhsd,bhse->bhde', pk, v)
        z = torch.einsum('bhsd->bhd', pk)
        num = torch.einsum('bhqd,bhde->bhqe', pq, kv)
        den = torch.einsum('bhqd,bhd->bhq', pq, z)[..., None] + 1e-06
        o = num / den
        return (lambda x, *d: x.permute(*d))(o, 0, 2, 1, 3).reshape(B, S, D) @ wo

    def _B_ref(x, w_in, w_sp, b_sp, w_out):
        B, S, D = x.shape
        F = w_in.shape[-1]
        Fh = F // 2
        z = _gelu(torch.einsum('bsd,df->bsf', x, w_in))
        z1 = z[..., :Fh].clone()
        z2 = _layernorm(z[..., Fh:], axis=-1)
        g = torch.einsum('ts,bsf->btf', w_sp, z2) + b_sp[None, :, None]
        return torch.einsum('bsf,fd->bsd', z1 * g, w_out)
    x = A_x
    xn = _layernorm(x, axis=-1)
    s = _A_ref(xn, A_wqkv, A_wo)
    g = _silu(_B_ref(xn, B_w_in, B_w_sp, B_b_sp, B_w_out))
    return x + s * g
```

```asm
; @launch grid=(256,1,1) block=(256,1,1) lds=163840
.amdgcn_target "amdgcn-amd-amdhsa--gfx950"
.text
.globl recurrent_scan__linear_attn_block__mixer_gmlp__prompt_kernel
.p2align 8
.type recurrent_scan__linear_attn_block__mixer_gmlp__prompt_kernel,@function
recurrent_scan__linear_attn_block__mixer_gmlp__prompt_kernel:
KSTART:
  s_cmp_ge_u32 s2, 256
  s_cbranch_scc1 END
  s_load_dwordx16 s[48:63], s[0:1], 0
  s_load_dwordx4 s[64:67], s[0:1], 64
  s_load_dwordx2 s[68:69], s[0:1], 80
  v_and_b32 v1, 63, v0
  v_lshrrev_b32 v204, 6, v0
  s_nop 0
  v_readfirstlane_b32 s44, v204
  v_lshrrev_b32 v205, 3, v1
  v_and_b32 v206, 7, v1
  v_lshrrev_b32 v207, 4, v1
  v_xor_b32 v208, v206, v207
  v_lshlrev_b32 v208, 4, v208
  v_lshl_add_u32 v5, v205, 10, v208
  v_xor_b32_e64 v209, 64, v5
  v_add_u32 v6, 7168, v209
  v_add_u32 v7, 14336, v5
  v_add_u32 v8, 21504, v209
  s_and_b32 s73, s2, 1
  s_bfe_u32 s74, s2, 0x20001
  s_bfe_u32 s3, s2, 0x30003
  s_lshl_b32 s45, s73, 3
  s_add_u32 s45, s45, s3
  s_lshl_b32 s47, s74, 3
  s_add_u32 s47, s47, s3
  s_lshr_b32 s75, s2, 6
  s_lshl_b32 s46, s75, 2
  s_add_u32 s46, s46, s74
  s_lshl_b32 s83, s73, 2
  s_add_u32 s83, s83, s75
  s_lshl_b32 s72, s44, 12
  s_lshl_b32 s90, s45, 2
  s_add_u32 s90, s90, s44
  s_lshl_b32 s77, s90, 15
  v_and_b32 v210, 1, v207
  v_lshlrev_b32 v210, 2, v210
  v_xor_b32 v210, v210, v206
  v_lshlrev_b32 v210, 4, v210
  s_lshl_b32 s73, s44, 5
  v_add_u32_e64 v211, s73, v205
  s_movk_i32 s73, 2752
  v_mad_u32_u24 v14, v211, s73, v210
  v_add_u32 v15, 20992, v14
  v_add_u32 v16, 41984, v14
  v_add_u32 v17, 62976, v14
  s_mov_b32 s84, 0x150A1413
  s_mov_b32 s85, 0x08060300
  s_lshl_b32 s73, s46, 3
  s_lshr_b64 s[84:85], s[84:85], s73
  s_and_b32 s73, s84, 0xff
  s_add_u32 s74, s46, 11
  s_cmp_lt_u32 s46, 8
  s_cselect_b32 s73, s74, s73
  s_lshl_b32 s80, s73, 7
  s_waitcnt lgkmcnt(0)
  s_lshr_b32 s1, s2, 6
  s_add_u32 s0, s1, s45
  s_lshl_b32 s1, s1, 1
  s_add_u32 s1, s1, s3
  s_and_b32 s0, s0, 1
  s_mov_b32 s4, s48
  s_mov_b32 s5, s49
  s_mov_b32 s6, 2097152
  s_mov_b32 s7, 0x20000
  s_add_u32 m0, s72, 0
  s_add_u32 s73, s0, 0
  s_and_b32 s73, s73, 3
  s_mul_i32 s73, s73, 256
  s_add_u32 s73, s73, s77
  buffer_load_dwordx4 v5, s[4:7], s73 offen offset:0 lds
  buffer_load_dwordx4 v6, s[4:7], s73 offen offset:1024 lds
  buffer_load_dwordx4 v7, s[4:7], s73 offen offset:2048 lds
  buffer_load_dwordx4 v8, s[4:7], s73 offen offset:3072 lds
  s_add_u32 m0, s72, 16384
  s_add_u32 s73, s73, 128
  buffer_load_dwordx4 v5, s[4:7], s73 offen offset:0 lds
  buffer_load_dwordx4 v6, s[4:7], s73 offen offset:1024 lds
  buffer_load_dwordx4 v7, s[4:7], s73 offen offset:2048 lds
  buffer_load_dwordx4 v8, s[4:7], s73 offen offset:3072 lds
  s_mov_b32 s28, s56
  s_mov_b32 s29, s57
  s_mov_b32 s30, 1409024
  s_mov_b32 s31, 0x20000
  s_add_u32 m0, s72, 32768
  s_add_u32 s73, s0, 0
  s_and_b32 s73, s73, 3
  s_mul_i32 s73, s73, 352256
  s_add_u32 s73, s73, s80
  buffer_load_dwordx4 v14, s[28:31], s73 offen offset:0 lds
  buffer_load_dwordx4 v15, s[28:31], s73 offen offset:1024 lds
  buffer_load_dwordx4 v16, s[28:31], s73 offen offset:2048 lds
  buffer_load_dwordx4 v17, s[28:31], s73 offen offset:3072 lds
  s_mov_b32 s8, s68
  s_mov_b32 s9, s69
  s_mov_b32 s10, 18874368
  s_mov_b32 s11, 0x20000
  buffer_load_dword v3, off, s[8:11], 0 sc1
  s_getpc_b64 s[92:93]
PC_H:
  s_sub_u32 s92, s92, PC_H-KSTART
  s_subb_u32 s93, s93, 0
  s_mov_b32 s94, CODE_END-KSTART
  s_mov_b32 s95, 0x20000
  s_lshr_b32 s74, s2, 3
  s_lshl_b32 s74, s74, 2
  s_add_u32 s74, s74, s44
  s_lshl_b32 s74, s74, 10
  v_lshlrev_b32 v248, 4, v1
  buffer_load_dword v4, v248, s[92:95], s74 offen
  s_mov_b32 s24, s50
  s_mov_b32 s25, s51
  s_mov_b32 s26, 1572864
  s_mov_b32 s27, 0x20000
  s_cmp_ge_u32 s46, 14
  s_cbranch_scc1 PROG_D
  s_cmp_ge_u32 s46, 12
  s_cbranch_scc1 PROG_C
  s_cmp_ge_u32 s46, 8
  s_cbranch_scc1 PROG_B
PROG_A:
  s_lshl_b32 s73, s46, 7
  s_add_u32 s81, s73, 1024
  s_add_u32 s82, s73, 2048
  s_lshr_b32 s95, s44, 1
  s_and_b32 s96, s44, 1
  v_and_b32 v212, 31, v1
  v_lshrrev_b32_e64 v213, 5, v1
  v_bfe_u32 v214, v1, 1, 3
  v_xor_b32 v214, v214, v213
  v_lshlrev_b32 v214, 4, v214
  v_lshl_add_u32 v214, v212, 7, v214
  s_mul_i32 s74, s95, 8224
  s_lshl_b32 s75, s96, 6
  s_add_u32 s74, s74, s75
  v_xor_b32 v18, s74, v214
  v_xor_b32 v19, 32, v18
  v_xor_b32_e64 v20, 64, v18
  v_xor_b32 v21, 96, v18
  v_mov_b32 v50, 0x3f803f80
  v_mov_b32 v52, 0
  v_mov_b32 v53, 0
  v_mov_b32 v54, 0
  v_mov_b32 v55, 0
  v_lshlrev_b32_e64 v2, 4, v1
  s_add_u32 m0, s72, 49152
  s_add_u32 s73, s0, 1
  s_and_b32 s73, s73, 3
  s_mul_i32 s73, s73, 256
  s_add_u32 s73, s73, s77
  buffer_load_dwordx4 v5, s[4:7], s73 offen offset:0 lds
  buffer_load_dwordx4 v6, s[4:7], s73 offen offset:1024 lds
  buffer_load_dwordx4 v7, s[4:7], s73 offen offset:2048 lds
  buffer_load_dwordx4 v8, s[4:7], s73 offen offset:3072 lds
  v_add_u32 v26, s72, v214
  v_xor_b32 v27, 32, v26
  v_xor_b32 v28, 64, v26
  v_xor_b32 v29, 96, v26
  v_add_u32 v30, 0x10000, v26
  v_add_u32 v22, 0x10000, v18
  v_add_u32 v31, 0x10000, v27
  v_add_u32 v23, 0x10000, v19
  v_add_u32 v32, 0x10000, v28
  v_add_u32 v24, 0x10000, v20
  v_add_u32 v33, 0x10000, v29
  v_add_u32 v25, 0x10000, v21
  s_mov_b32 s32, s58
  s_mov_b32 s33, s59
  s_mov_b32 s34, 8388608
  s_mov_b32 s35, 0x20000
  s_mov_b32 s12, s52
  s_mov_b32 s13, s53
  s_mov_b32 s14, 524288
  s_mov_b32 s15, 0x20000
  s_add_u32 m0, s72, 65536
  s_add_u32 s73, s0, 1
  s_and_b32 s73, s73, 3
  s_mul_i32 s73, s73, 256
  s_add_u32 s73, s73, s77
  s_add_u32 s73, s73, 128
  buffer_load_dwordx4 v5, s[4:7], s73 offen offset:0 lds
  buffer_load_dwordx4 v6, s[4:7], s73 offen offset:1024 lds
  buffer_load_dwordx4 v7, s[4:7], s73 offen offset:2048 lds
  buffer_load_dwordx4 v8, s[4:7], s73 offen offset:3072 lds
  s_mov_b32 s16, s62
  s_mov_b32 s17, s63
  s_mov_b32 s18, 704512
  s_mov_b32 s19, 0x20000
  s_mov_b32 s20, s64
  s_mov_b32 s21, s65
  s_mov_b32 s22, 2097152
  s_mov_b32 s23, 0x20000
  s_mov_b32 s36, s60
  s_mov_b32 s37, s61
  s_mov_b32 s38, 4096
  s_mov_b32 s39, 0x20000
  s_mov_b32 s40, s66
  s_mov_b32 s41, s67
  s_mov_b32 s42, 256
  s_mov_b32 s43, 0x20000
  s_movk_i32 s74, 3072
  v_mad_u32_u24 v9, v211, s74, v210
  v_add_u32 v10, 23552, v9
  v_add_u32 v11, 47104, v9
  s_add_u32 m0, s72, 81920
  s_add_u32 s73, s0, 1
  s_and_b32 s73, s73, 3
  s_mul_i32 s73, s73, 352256
  s_add_u32 s73, s73, s80
  buffer_load_dwordx4 v14, s[28:31], s73 offen offset:0 lds
  buffer_load_dwordx4 v15, s[28:31], s73 offen offset:1024 lds
  buffer_load_dwordx4 v16, s[28:31], s73 offen offset:2048 lds
  buffer_load_dwordx4 v17, s[28:31], s73 offen offset:3072 lds
  v_add_u32 v12, 70656, v9
  s_lshl_b32 s74, s47, 1
  s_add_u32 s74, s74, s95
  s_lshl_b32 s79, s74, 17
  s_lshl_b32 s74, s44, 10
  s_add_u32 s79, s79, s74
  s_xor_b32 s78, s79, 0x20000
  v_bfe_u32 v215, v1, 2, 2
  v_and_b32_e64 v216, 3, v1
  v_bfe_u32 v217, v1, 4, 1
  v_lshlrev_b32_e64 v216, 3, v216
  v_lshl_add_u32 v216, v217, 5, v216
  v_lshl_add_u32 v218, v213, 3, v215
  v_lshl_add_u32 v219, v218, 7, v216
  v_bfe_u32 v220, v1, 3, 1
  v_lshl_add_u32 v219, v220, 6, v219
  s_mul_i32 s74, s96, 4160
  s_lshl_b32 s75, s95, 11
  s_or_b32 s74, s74, s75
  v_xor_b32_e64 v34, s74, v219
  v_xor_b32 v35, 2048, v34
  v_xor_b32 v36, 4096, v34
  v_xor_b32 v37, 6144, v34
  v_add_u32 v38, 0x10000, v34
  v_add_u32 v39, 0x10000, v35
  v_add_u32 v40, 0x10000, v36
  v_add_u32 v41, 0x10000, v37
  s_lshl_b32 s74, s96, 7
  s_add_u32 s74, s74, 131072
  v_lshl_add_u32 v44, v213, 4, s74
  v_lshl_add_u32 v45, v212, 2, s74
  s_lshl_b32 s75, s95, 8
  v_lshl_add_u32 v49, v213, 14, v45
  v_add_u32 v49, s75, v49
  s_lshl_b32 s74, s95, 9
  s_add_u32 s75, s74, 133120
  s_mov_b32 s91, s75
  v_lshl_add_u32 v42, v213, 4, s75
  v_lshl_add_u32 v43, v212, 2, s75
  s_lshl_b32 s75, s44, 9
  s_add_u32 s75, s75, 135168
  v_lshl_add_u32 v48, v1, 2, s75
  s_mul_i32 s74, s44, 2304
  s_add_u32 s74, s74, 137216
  v_mul_u32_u24 v13, 72, v212
  v_lshl_add_u32 v13, v213, 3, v13
  v_add_u32_e64 v13, s74, v13
  v_mul_u32_u24 v46, 72, v218
  v_add3_u32 v46, v46, v216, s74
  v_and_b32 v221, 15, v1
  v_lshlrev_b32 v222, 2, v217
  v_cmp_eq_u32 vcc, v221, v222
  s_nop 1
  v_cndmask_b32 v88, 0, v50, vcc
  v_mov_b32 v89, v88
  v_mov_b32 v90, v88
  v_mov_b32 v91, v88
  s_mov_b32 s84, 0x358637bd
  s_mov_b32 s85, 0x358637bd
  s_mov_b32 s86, 0x3fb8aa3b
  s_mov_b32 s87, 0x3fb8aa3b
  s_or_b32 s99, s2, s44
  s_lshr_b32 s76, s80, 7
  s_sub_u32 s74, s76, 10
  s_mul_i32 s92, s90, 6144
  s_add_u32 s92, s92, 131072
  s_movk_i32 s93, 4096
  v_add_u32_e64 v47, s92, v2
  s_lshr_b32 s75, s74, 1
  s_lshl_b32 s75, s75, 10
  s_add_u32 s92, s92, s75
  s_and_b32 s75, s74, 1
  s_lshl_b32 s75, s75, 3
  s_add_u32 s92, s92, s75
  s_lshl_b32 s76, s76, 1
  s_add_u32 s76, s76, s96
  s_lshl_b32 s75, s76, 17
  s_andn2_b32 s100, s90, 1
  s_lshl_b32 s100, s100, 11
  s_add_u32 s100, s100, s75
  s_add_u32 s100, s100, 9830400
  s_waitcnt vmcnt(18)
  s_barrier
  ds_read_b128 v[156:159], v18 offset:0
  ds_read_b128 v[160:163], v19 offset:0
  ds_read_b128 v[164:167], v18 offset:4096
  ds_read_b128 v[168:171], v19 offset:4096
  ds_read_b128 v[172:175], v18 offset:16384
  ds_read_b128 v[176:179], v19 offset:16384
  ds_read_b128 v[180:183], v18 offset:20480
  ds_read_b128 v[184:187], v19 offset:20480
  ds_read_b128 a[8:11], v20 offset:0
  ds_read_b128 a[12:15], v21 offset:0
  ds_read_b128 a[136:139], v20 offset:4096
  ds_read_b128 a[140:143], v21 offset:4096
  ds_read_b128 a[24:27], v20 offset:16384
  ds_read_b128 a[28:31], v21 offset:16384
  ds_read_b128 a[152:155], v20 offset:20480
  ds_read_b128 a[156:159], v21 offset:20480
  s_add_u32 m0, s72, 98304
  s_add_u32 s73, s0, 2
  s_and_b32 s73, s73, 3
  s_mul_i32 s73, s73, 256
  s_add_u32 s73, s73, s77
  buffer_load_dwordx4 v5, s[4:7], s73 offen offset:0 lds
  buffer_load_dwordx4 v6, s[4:7], s73 offen offset:1024 lds
  buffer_load_dwordx4 v7, s[4:7], s73 offen offset:2048 lds
  buffer_load_dwordx4 v8, s[4:7], s73 offen offset:3072 lds
  s_add_u32 m0, s72, 114688
  s_add_u32 s73, s0, 2
  s_and_b32 s73, s73, 3
  s_mul_i32 s73, s73, 256
  s_add_u32 s73, s73, s77
  s_add_u32 s73, s73, 128
  buffer_load_dwordx4 v5, s[4:7], s73 offen offset:0 lds
  buffer_load_dwordx4 v6, s[4:7], s73 offen offset:1024 lds
  buffer_load_dwordx4 v7, s[4:7], s73 offen offset:2048 lds
  buffer_load_dwordx4 v8, s[4:7], s73 offen offset:3072 lds
  s_waitcnt lgkmcnt(15)
  v_accvgpr_write_b32 a0, v156
  v_accvgpr_write_b32 a1, v157
  v_accvgpr_write_b32 a2, v158
  v_accvgpr_write_b32 a3, v159
  s_waitcnt lgkmcnt(14)
  v_accvgpr_write_b32 a4, v160
  v_accvgpr_write_b32 a5, v161
  v_accvgpr_write_b32 a6, v162
  v_accvgpr_write_b32 a7, v163
  s_waitcnt lgkmcnt(13)
  v_accvgpr_write_b32 a128, v164
  v_accvgpr_write_b32 a129, v165
  v_accvgpr_write_b32 a130, v166
  v_accvgpr_write_b32 a131, v167
  s_waitcnt lgkmcnt(12)
  v_accvgpr_write_b32 a132, v168
  v_accvgpr_write_b32 a133, v169
  v_accvgpr_write_b32 a134, v170
  v_accvgpr_write_b32 a135, v171
  s_waitcnt lgkmcnt(11)
  v_accvgpr_write_b32 a16, v172
  v_accvgpr_write_b32 a17, v173
  v_accvgpr_write_b32 a18, v174
  v_accvgpr_write_b32 a19, v175
  s_waitcnt lgkmcnt(10)
  v_accvgpr_write_b32 a20, v176
  v_accvgpr_write_b32 a21, v177
  v_accvgpr_write_b32 a22, v178
  v_accvgpr_write_b32 a23, v179
  s_waitcnt lgkmcnt(9)
  v_accvgpr_write_b32 a144, v180
  v_accvgpr_write_b32 a145, v181
  v_accvgpr_write_b32 a146, v182
  v_accvgpr_write_b32 a147, v183
  s_waitcnt lgkmcnt(8)
  v_accvgpr_write_b32 a148, v184
  v_accvgpr_write_b32 a149, v185
  v_accvgpr_write_b32 a150, v186
  v_accvgpr_write_b32 a151, v187
  s_waitcnt vmcnt(12) lgkmcnt(0)
  s_barrier
  s_cmp_eq_u32 s99, 0
  s_cbranch_scc1 EPOCH_A
EPOCHR_A:
  ds_read_b64_tr_b16 v[68:69], v34 offset:32768
  ds_read_b64_tr_b16 v[70:71], v34 offset:33280
  ds_read_b64_tr_b16 v[72:73], v35 offset:32768
  ds_read_b64_tr_b16 v[74:75], v35 offset:33280
  ds_read_b64_tr_b16 v[76:77], v36 offset:32768
  ds_read_b64_tr_b16 v[78:79], v36 offset:33280
  s_add_u32 m0, s72, 0
  s_add_u32 s73, s0, 2
  s_and_b32 s73, s73, 3
  s_mul_i32 s73, s73, 352256
  s_add_u32 s73, s73, s80
  buffer_load_dwordx4 v14, s[28:31], s73 offen offset:0 lds
  buffer_load_dwordx4 v15, s[28:31], s73 offen offset:1024 lds
  buffer_load_dwordx4 v16, s[28:31], s73 offen offset:2048 lds
  buffer_load_dwordx4 v17, s[28:31], s73 offen offset:3072 lds
  s_add_u32 m0, s72, 16384
  s_add_u32 s73, s0, 3
  s_and_b32 s73, s73, 3
  s_mul_i32 s73, s73, 256
  s_add_u32 s73, s73, s77
  buffer_load_dwordx4 v5, s[4:7], s73 offen offset:0 lds
  buffer_load_dwordx4 v6, s[4:7], s73 offen offset:1024 lds
  buffer_load_dwordx4 v7, s[4:7], s73 offen offset:2048 lds
  buffer_load_dwordx4 v8, s[4:7], s73 offen offset:3072 lds
  s_waitcnt lgkmcnt(4)
  v_mfma_f32_32x32x16_bf16 v[92:107], v[68:71], a[0:3], 0
  ds_read_b64_tr_b16 v[80:81], v37 offset:32768
  ds_read_b64_tr_b16 v[82:83], v37 offset:33280
  v_mfma_f32_16x16x32_bf16 v[84:87], v[88:91], v[68:71], 0
  ds_read_b128 v[204:207], v18 offset:49152
  ds_read_b128 v[208:211], v19 offset:49152
  ds_read_b128 v[212:215], v18 offset:53248
  v_mfma_f32_32x32x16_bf16 v[108:123], v[68:71], a[128:131], 0
  ds_read_b128 v[216:219], v19 offset:53248
  ds_read_b128 v[220:223], v22 offset:0
  ds_read_b128 v[224:227], v23 offset:0
  s_waitcnt lgkmcnt(10)
  v_mfma_f32_32x32x16_bf16 v[92:107], v[72:75], a[4:7], v[92:107]
  ds_read_b64_tr_b16 v[68:69], v34 offset:40960
  ds_read_b64_tr_b16 v[70:71], v34 offset:41472
  ds_read_b128 v[228:231], v22 offset:4096
  ds_read_b128 v[232:235], v23 offset:4096
  v_mfma_f32_32x32x16_bf16 v[108:123], v[72:75], a[132:135], v[108:123]
  ds_read_b128 a[40:43], v20 offset:49152
  ds_read_b128 a[44:47], v21 offset:49152
  ds_read_b128 a[168:171], v20 offset:53248
  s_waitcnt lgkmcnt(15)
  v_mfma_f32_32x32x16_bf16 v[92:107], v[76:79], a[8:11], v[92:107]
  ds_read_b64_tr_b16 v[72:73], v35 offset:40960
  ds_read_b64_tr_b16 v[74:75], v35 offset:41472
  v_mfma_f32_16x16x32_bf16 v[84:87], v[88:91], v[76:79], v[84:87]
  ds_read_b128 a[172:175], v21 offset:53248
  ds_read_b128 a[56:59], v24 offset:0
  ds_read_b128 a[60:63], v25 offset:0
  v_mfma_f32_32x32x16_bf16 v[108:123], v[76:79], a[136:139], v[108:123]
  ds_read_b128 a[184:187], v24 offset:4096
  ds_read_b128 a[188:191], v25 offset:4096
  s_waitcnt lgkmcnt(15)
  v_mfma_f32_32x32x16_bf16 v[92:107], v[80:83], a[12:15], v[92:107]
  ds_read_b64_tr_b16 v[76:77], v36 offset:40960
  ds_read_b64_tr_b16 v[78:79], v36 offset:41472
  v_accvgpr_write_b32 a32, v204
  v_accvgpr_write_b32 a33, v205
  v_accvgpr_write_b32 a34, v206
  v_accvgpr_write_b32 a35, v207
  v_accvgpr_write_b32 a36, v208
  v_accvgpr_write_b32 a37, v209
  v_accvgpr_write_b32 a38, v210
  v_accvgpr_write_b32 a39, v211
  v_mfma_f32_32x32x16_bf16 v[108:123], v[80:83], a[140:143], v[108:123]
  v_accvgpr_write_b32 a160, v212
  v_accvgpr_write_b32 a161, v213
  v_accvgpr_write_b32 a162, v214
  v_accvgpr_write_b32 a163, v215
  v_accvgpr_write_b32 a164, v216
  v_accvgpr_write_b32 a165, v217
  v_accvgpr_write_b32 a166, v218
  v_accvgpr_write_b32 a167, v219
  s_waitcnt lgkmcnt(14)
  v_mfma_f32_32x32x16_bf16 v[92:107], v[68:71], a[16:19], v[92:107]
  ds_read_b64_tr_b16 v[80:81], v37 offset:40960
  ds_read_b64_tr_b16 v[82:83], v37 offset:41472
  v_mfma_f32_16x16x32_bf16 v[84:87], v[88:91], v[68:71], v[84:87]
  v_accvgpr_write_b32 a48, v220
  v_accvgpr_write_b32 a49, v221
  v_accvgpr_write_b32 a50, v222
  v_accvgpr_write_b32 a51, v223
  v_accvgpr_write_b32 a52, v224
  v_accvgpr_write_b32 a53, v225
  v_accvgpr_write_b32 a54, v226
  v_accvgpr_write_b32 a55, v227
  v_mfma_f32_32x32x16_bf16 v[108:123], v[68:71], a[144:147], v[108:123]
  s_waitcnt lgkmcnt(15)
  v_accvgpr_write_b32 a176, v228
  v_accvgpr_write_b32 a177, v229
  v_accvgpr_write_b32 a178, v230
  v_accvgpr_write_b32 a179, v231
  s_waitcnt lgkmcnt(14)
  v_accvgpr_write_b32 a180, v232
  v_accvgpr_write_b32 a181, v233
  v_accvgpr_write_b32 a182, v234
  v_accvgpr_write_b32 a183, v235
  v_dot2c_f32_bf16 v52, v204, v50
  v_dot2c_f32_bf16 v53, v204, v204
  v_dot2c_f32_bf16 v54, v212, v50
  v_dot2c_f32_bf16 v55, v212, v212
  v_dot2c_f32_bf16 v52, v205, v50
  v_dot2c_f32_bf16 v53, v205, v205
  v_dot2c_f32_bf16 v54, v213, v50
  v_dot2c_f32_bf16 v55, v213, v213
  v_dot2c_f32_bf16 v52, v206, v50
  v_dot2c_f32_bf16 v53, v206, v206
  v_dot2c_f32_bf16 v54, v214, v50
  v_dot2c_f32_bf16 v55, v214, v214
  v_dot2c_f32_bf16 v52, v207, v50
  v_dot2c_f32_bf16 v53, v207, v207
  v_dot2c_f32_bf16 v54, v215, v50
  v_dot2c_f32_bf16 v55, v215, v215
  v_dot2c_f32_bf16 v52, v208, v50
  v_dot2c_f32_bf16 v53, v208, v208
  v_dot2c_f32_bf16 v54, v216, v50
  v_dot2c_f32_bf16 v55, v216, v216
  v_dot2c_f32_bf16 v52, v209, v50
  v_dot2c_f32_bf16 v53, v209, v209
  v_dot2c_f32_bf16 v54, v217, v50
  v_dot2c_f32_bf16 v55, v217, v217
  v_dot2c_f32_bf16 v52, v210, v50
  v_dot2c_f32_bf16 v53, v210, v210
  v_dot2c_f32_bf16 v54, v218, v50
  v_dot2c_f32_bf16 v55, v218, v218
  v_dot2c_f32_bf16 v52, v211, v50
  v_dot2c_f32_bf16 v53, v211, v211
  v_dot2c_f32_bf16 v54, v219, v50
  v_dot2c_f32_bf16 v55, v219, v219
  v_dot2c_f32_bf16 v52, v220, v50
  v_dot2c_f32_bf16 v53, v220, v220
  v_dot2c_f32_bf16 v54, v228, v50
  v_dot2c_f32_bf16 v55, v228, v228
  v_dot2c_f32_bf16 v52, v221, v50
  v_dot2c_f32_bf16 v53, v221, v221
  v_dot2c_f32_bf16 v54, v229, v50
  v_dot2c_f32_bf16 v55, v229, v229
  v_dot2c_f32_bf16 v52, v222, v50
  v_dot2c_f32_bf16 v53, v222, v222
  v_dot2c_f32_bf16 v54, v230, v50
  v_dot2c_f32_bf16 v55, v230, v230
  v_dot2c_f32_bf16 v52, v223, v50
  v_dot2c_f32_bf16 v53, v223, v223
  v_dot2c_f32_bf16 v54, v231, v50
  v_dot2c_f32_bf16 v55, v231, v231
  v_dot2c_f32_bf16 v52, v224, v50
  v_dot2c_f32_bf16 v53, v224, v224
  v_dot2c_f32_bf16 v54, v232, v50
  v_dot2c_f32_bf16 v55, v232, v232
  v_dot2c_f32_bf16 v52, v225, v50
  v_dot2c_f32_bf16 v53, v225, v225
  v_dot2c_f32_bf16 v54, v233, v50
  v_dot2c_f32_bf16 v55, v233, v233
  v_dot2c_f32_bf16 v52, v226, v50
  v_dot2c_f32_bf16 v53, v226, v226
  v_dot2c_f32_bf16 v54, v234, v50
  v_dot2c_f32_bf16 v55, v234, v234
  v_dot2c_f32_bf16 v52, v227, v50
  v_dot2c_f32_bf16 v53, v227, v227
  v_dot2c_f32_bf16 v54, v235, v50
  v_dot2c_f32_bf16 v55, v235, v235
  s_waitcnt vmcnt(8) lgkmcnt(4)
  s_barrier
  v_mfma_f32_32x32x16_bf16 v[92:107], v[72:75], a[20:23], v[92:107]
  ds_read_b64_tr_b16 v[68:69], v38 offset:16384
  ds_read_b64_tr_b16 v[70:71], v38 offset:16896
  ds_read_b128 v[204:207], v22 offset:32768
  ds_read_b128 v[208:211], v23 offset:32768
  s_add_u32 m0, s72, 49152
  s_add_u32 s73, s0, 3
  s_and_b32 s73, s73, 3
  s_mul_i32 s73, s73, 256
  s_add_u32 s73, s73, s77
  s_add_u32 s73, s73, 128
  buffer_load_dwordx4 v5, s[4:7], s73 offen offset:0 lds
  buffer_load_dwordx4 v6, s[4:7], s73 offen offset:1024 lds
  buffer_load_dwordx4 v7, s[4:7], s73 offen offset:2048 lds
  buffer_load_dwordx4 v8, s[4:7], s73 offen offset:3072 lds
  v_mfma_f32_32x32x16_bf16 v[108:123], v[72:75], a[148:151], v[108:123]
  ds_read_b128 v[212:215], v22 offset:36864
  ds_read_b128 v[216:219], v23 offset:36864
  s_waitcnt lgkmcnt(8)
  v_mfma_f32_32x32x16_bf16 v[92:107], v[76:79], a[24:27], v[92:107]
  ds_read_b64_tr_b16 v[72:73], v39 offset:16384
  ds_read_b64_tr_b16 v[74:75], v39 offset:16896
  v_mfma_f32_16x16x32_bf16 v[84:87], v[88:91], v[76:79], v[84:87]
  ds_read_b128 v[220:223], v22 offset:49152
  ds_read_b128 v[224:227], v23 offset:49152
  s_add_u32 m0, s72, 65536
  s_add_u32 s73, s0, 3
  s_and_b32 s73, s73, 3
  s_mul_i32 s73, s73, 352256
  s_add_u32 s73, s73, s80
  buffer_load_dwordx4 v14, s[28:31], s73 offen offset:0 lds
  buffer_load_dwordx4 v15, s[28:31], s73 offen offset:1024 lds
  buffer_load_dwordx4 v16, s[28:31], s73 offen offset:2048 lds
  buffer_load_dwordx4 v17, s[28:31], s73 offen offset:3072 lds
  v_mfma_f32_32x32x16_bf16 v[108:123], v[76:79], a[152:155], v[108:123]
  ds_read_b128 v[228:231], v22 offset:53248
  ds_read_b128 v[232:235], v23 offset:53248
  s_waitcnt lgkmcnt(12)
  v_mfma_f32_32x32x16_bf16 v[92:107], v[80:83], a[28:31], v[92:107]
  ds_read_b64_tr_b16 v[76:77], v40 offset:16384
  ds_read_b64_tr_b16 v[78:79], v40 offset:16896
  ds_read_b128 a[72:75], v24 offset:32768
  ds_read_b128 a[76:79], v25 offset:32768
  v_mfma_f32_32x32x16_bf16 v[108:123], v[80:83], a[156:159], v[108:123]
  ds_read_b128 a[200:203], v24 offset:36864
  ds_read_b128 a[204:207], v25 offset:36864
  s_waitcnt lgkmcnt(15)
  v_mfma_f32_32x32x16_bf16 v[92:107], v[68:71], a[32:35], v[92:107]
  ds_read_b64_tr_b16 v[80:81], v41 offset:16384
  ds_read_b64_tr_b16 v[82:83], v41 offset:16896
  v_mfma_f32_16x16x32_bf16 v[84:87], v[88:91], v[68:71], v[84:87]
  ds_read_b128 a[88:91], v24 offset:49152
  ds_read_b128 a[92:95], v25 offset:49152
  v_mfma_f32_32x32x16_bf16 v[108:123], v[68:71], a[160:163], v[108:123]
  ds_read_b128 a[216:219], v24 offset:53248
  ds_read_b128 a[220:223], v25 offset:53248
  s_waitcnt lgkmcnt(15)
  v_mfma_f32_32x32x16_bf16 v[92:107], v[72:75], a[36:39], v[92:107]
  ds_read_b64_tr_b16 v[68:69], v38 offset:24576
  ds_read_b64_tr_b16 v[70:71], v38 offset:25088
  v_accvgpr_write_b32 a64, v204
  v_accvgpr_write_b32 a65, v205
  v_accvgpr_write_b32 a66, v206
  v_accvgpr_write_b32 a67, v207
  v_mfma_f32_32x32x16_bf16 v[108:123], v[72:75], a[164:167], v[108:123]
  v_accvgpr_write_b32 a68, v208
  v_accvgpr_write_b32 a69, v209
  v_accvgpr_write_b32 a70, v210
  v_accvgpr_write_b32 a71, v211
  v_lshrrev_b32_e64 v244, 3, v1
  v_mul_u32_u24 v244, 3072, v244
  v_add_u32 v5, v244, v5
  s_waitcnt lgkmcnt(12)
  v_mfma_f32_32x32x16_bf16 v[92:107], v[76:79], a[40:43], v[92:107]
  ds_read_b64_tr_b16 v[72:73], v39 offset:24576
  ds_read_b64_tr_b16 v[74:75], v39 offset:25088
  v_mfma_f32_16x16x32_bf16 v[84:87], v[88:91], v[76:79], v[84:87]
  v_accvgpr_write_b32 a192, v212
  v_accvgpr_write_b32 a193, v213
  v_accvgpr_write_b32 a194, v214
  v_accvgpr_write_b32 a195, v215
  v_mfma_f32_32x32x16_bf16 v[108:123], v[76:79], a[168:171], v[108:123]
  v_accvgpr_write_b32 a196, v216
  v_accvgpr_write_b32 a197, v217
  v_accvgpr_write_b32 a198, v218
  v_accvgpr_write_b32 a199, v219
  v_add_u32 v244, 24576, v244
  v_add_u32 v6, v244, v6
  s_waitcnt lgkmcnt(8)
  v_mfma_f32_32x32x16_bf16 v[92:107], v[80:83], a[44:47], v[92:107]
  ds_read_b64_tr_b16 v[76:77], v40 offset:24576
  ds_read_b64_tr_b16 v[78:79], v40 offset:25088
  v_accvgpr_write_b32 a80, v220
  v_accvgpr_write_b32 a81, v221
  v_accvgpr_write_b32 a82, v222
  v_accvgpr_write_b32 a83, v223
  v_mfma_f32_32x32x16_bf16 v[108:123], v[80:83], a[172:175], v[108:123]
  v_accvgpr_write_b32 a84, v224
  v_accvgpr_write_b32 a85, v225
  v_accvgpr_write_b32 a86, v226
  v_accvgpr_write_b32 a87, v227
  v_add_u32 v244, 24576, v244
  v_add_u32 v7, v244, v7
  s_waitcnt lgkmcnt(4)
  v_mfma_f32_32x32x16_bf16 v[92:107], v[68:71], a[48:51], v[92:107]
  ds_read_b64_tr_b16 v[80:81], v41 offset:24576
  ds_read_b64_tr_b16 v[82:83], v41 offset:25088
  v_mfma_f32_16x16x32_bf16 v[84:87], v[88:91], v[68:71], v[84:87]
  v_accvgpr_write_b32 a208, v228
  v_accvgpr_write_b32 a209, v229
  v_accvgpr_write_b32 a210, v230
  v_accvgpr_write_b32 a211, v231
  v_mfma_f32_32x32x16_bf16 v[108:123], v[68:71], a[176:179], v[108:123]
  v_accvgpr_write_b32 a212, v232
  v_accvgpr_write_b32 a213, v233
  v_accvgpr_write_b32 a214, v234
  v_accvgpr_write_b32 a215, v235
  v_add_u32 v244, 24576, v244
  v_add_u32 v8, v244, v8
  v_dot2c_f32_bf16 v52, v204, v50
  v_dot2c_f32_bf16 v53, v204, v204
  v_dot2c_f32_bf16 v54, v212, v50
  v_dot2c_f32_bf16 v55, v212, v212
  v_dot2c_f32_bf16 v52, v205, v50
  v_dot2c_f32_bf16 v53, v205, v205
  v_dot2c_f32_bf16 v54, v213, v50
  v_dot2c_f32_bf16 v55, v213, v213
  v_dot2c_f32_bf16 v52, v206, v50
  v_dot2c_f32_bf16 v53, v206, v206
  v_dot2c_f32_bf16 v54, v214, v50
  v_dot2c_f32_bf16 v55, v214, v214
  v_dot2c_f32_bf16 v52, v207, v50
  v_dot2c_f32_bf16 v53, v207, v207
  v_dot2c_f32_bf16 v54, v215, v50
  v_dot2c_f32_bf16 v55, v215, v215
  v_dot2c_f32_bf16 v52, v208, v50
  v_dot2c_f32_bf16 v53, v208, v208
  v_dot2c_f32_bf16 v54, v216, v50
  v_dot2c_f32_bf16 v55, v216, v216
  v_dot2c_f32_bf16 v52, v209, v50
  v_dot2c_f32_bf16 v53, v209, v209
  v_dot2c_f32_bf16 v54, v217, v50
  v_dot2c_f32_bf16 v55, v217, v217
  v_dot2c_f32_bf16 v52, v210, v50
  v_dot2c_f32_bf16 v53, v210, v210
  v_dot2c_f32_bf16 v54, v218, v50
  v_dot2c_f32_bf16 v55, v218, v218
  v_dot2c_f32_bf16 v52, v211, v50
  v_dot2c_f32_bf16 v53, v211, v211
  v_dot2c_f32_bf16 v54, v219, v50
  v_dot2c_f32_bf16 v55, v219, v219
  v_dot2c_f32_bf16 v52, v220, v50
  v_dot2c_f32_bf16 v53, v220, v220
  v_dot2c_f32_bf16 v54, v228, v50
  v_dot2c_f32_bf16 v55, v228, v228
  v_dot2c_f32_bf16 v52, v221, v50
  v_dot2c_f32_bf16 v53, v221, v221
  v_dot2c_f32_bf16 v54, v229, v50
  v_dot2c_f32_bf16 v55, v229, v229
  v_dot2c_f32_bf16 v52, v222, v50
  v_dot2c_f32_bf16 v53, v222, v222
  v_dot2c_f32_bf16 v54, v230, v50
  v_dot2c_f32_bf16 v55, v230, v230
  v_dot2c_f32_bf16 v52, v223, v50
  v_dot2c_f32_bf16 v53, v223, v223
  v_dot2c_f32_bf16 v54, v231, v50
  v_dot2c_f32_bf16 v55, v231, v231
  v_dot2c_f32_bf16 v52, v224, v50
  v_dot2c_f32_bf16 v53, v224, v224
  v_dot2c_f32_bf16 v54, v232, v50
  v_dot2c_f32_bf16 v55, v232, v232
  v_dot2c_f32_bf16 v52, v225, v50
  v_dot2c_f32_bf16 v53, v225, v225
  v_dot2c_f32_bf16 v54, v233, v50
  v_dot2c_f32_bf16 v55, v233, v233
  v_dot2c_f32_bf16 v52, v226, v50
  v_dot2c_f32_bf16 v53, v226, v226
  v_dot2c_f32_bf16 v54, v234, v50
  v_dot2c_f32_bf16 v55, v234, v234
  v_dot2c_f32_bf16 v52, v227, v50
  v_dot2c_f32_bf16 v53, v227, v227
  v_dot2c_f32_bf16 v54, v235, v50
  v_dot2c_f32_bf16 v55, v235, v235
  s_waitcnt vmcnt(4)
  s_barrier
  s_waitcnt lgkmcnt(4)
  v_mfma_f32_32x32x16_bf16 v[92:107], v[72:75], a[52:55], v[92:107]
  ds_read_b64_tr_b16 v[68:69], v34 offset:0
  ds_read_b64_tr_b16 v[70:71], v34 offset:512
  ds_read_b128 v[204:207], v18 offset:16384
  ds_read_b128 v[208:211], v19 offset:16384
  s_add_u32 m0, s72, 32768
  s_add_u32 s73, s0, 0
  s_and_b32 s73, s73, 3
  s_mul_i32 s73, s73, 393216
  s_add_u32 s73, s73, s81
  buffer_load_dwordx4 v9, s[24:27], s73 offen offset:0 lds
  buffer_load_dwordx4 v10, s[24:27], s73 offen offset:1024 lds
  buffer_load_dwordx4 v11, s[24:27], s73 offen offset:2048 lds
  buffer_load_dwordx4 v12, s[24:27], s73 offen offset:3072 lds
  v_mfma_f32_32x32x16_bf16 v[108:123], v[72:75], a[180:183], v[108:123]
  ds_read_b128 v[212:215], v18 offset:20480
  ds_read_b128 v[216:219], v19 offset:20480
  s_waitcnt lgkmcnt(8)
  v_mfma_f32_32x32x16_bf16 v[92:107], v[76:79], a[56:59], v[92:107]
  ds_read_b64_tr_b16 v[72:73], v35 offset:0
  ds_read_b64_tr_b16 v[74:75], v35 offset:512
  v_mfma_f32_16x16x32_bf16 v[84:87], v[88:91], v[76:79], v[84:87]
  ds_read_b128 v[220:223], v18 offset:49152
  ds_read_b128 v[224:227], v19 offset:49152
  s_add_u32 m0, s72, 98304
  s_add_u32 s73, s0, 1
  s_and_b32 s73, s73, 3
  s_mul_i32 s73, s73, 393216
  s_add_u32 s73, s73, s81
  buffer_load_dwordx4 v9, s[24:27], s73 offen offset:0 lds
  buffer_load_dwordx4 v10, s[24:27], s73 offen offset:1024 lds
  buffer_load_dwordx4 v11, s[24:27], s73 offen offset:2048 lds
  buffer_load_dwordx4 v12, s[24:27], s73 offen offset:3072 lds
  v_mfma_f32_32x32x16_bf16 v[108:123], v[76:79], a[184:187], v[108:123]
  ds_read_b128 v[228:231], v18 offset:53248
  ds_read_b128 v[232:235], v19 offset:53248
  s_waitcnt lgkmcnt(12)
  v_mfma_f32_32x32x16_bf16 v[92:107], v[80:83], a[60:63], v[92:107]
  ds_read_b64_tr_b16 v[76:77], v36 offset:0
  ds_read_b64_tr_b16 v[78:79], v36 offset:512
  ds_read_b128 a[104:107], v20 offset:16384
  ds_read_b128 a[108:111], v21 offset:16384
  s_add_u32 m0, s72, 114688
  s_add_u32 s73, s0, 2
  s_and_b32 s73, s73, 3
  s_mul_i32 s73, s73, 393216
  s_add_u32 s73, s73, s81
  buffer_load_dwordx4 v9, s[24:27], s73 offen offset:0 lds
  buffer_load_dwordx4 v10, s[24:27], s73 offen offset:1024 lds
  buffer_load_dwordx4 v11, s[24:27], s73 offen offset:2048 lds
  buffer_load_dwordx4 v12, s[24:27], s73 offen offset:3072 lds
  v_mfma_f32_32x32x16_bf16 v[108:123], v[80:83], a[188:191], v[108:123]
  ds_read_b128 a[232:235], v20 offset:20480
  ds_read_b128 a[236:239], v21 offset:20480
  s_waitcnt lgkmcnt(15)
  v_mfma_f32_32x32x16_bf16 v[92:107], v[68:71], a[64:67], v[92:107]
  ds_read_b64_tr_b16 v[80:81], v37 offset:0
  ds_read_b64_tr_b16 v[82:83], v37 offset:512
  v_mfma_f32_16x16x32_bf16 v[84:87], v[88:91], v[68:71], v[84:87]
  ds_read_b128 a[120:123], v20 offset:49152
  ds_read_b128 a[124:127], v21 offset:49152
  v_mfma_f32_32x32x16_bf16 v[108:123], v[68:71], a[192:195], v[108:123]
  ds_read_b128 a[248:251], v20 offset:53248
  ds_read_b128 a[252:255], v21 offset:53248
  s_waitcnt lgkmcnt(15)
  v_mfma_f32_32x32x16_bf16 v[92:107], v[72:75], a[68:71], v[92:107]
  ds_read_b64_tr_b16 v[68:69], v34 offset:8192
  ds_read_b64_tr_b16 v[70:71], v34 offset:8704
  v_accvgpr_write_b32 a96, v204
  v_accvgpr_write_b32 a97, v205
  v_accvgpr_write_b32 a98, v206
  v_accvgpr_write_b32 a99, v207
  v_mfma_f32_32x32x16_bf16 v[108:123], v[72:75], a[196:199], v[108:123]
  v_accvgpr_write_b32 a100, v208
  v_accvgpr_write_b32 a101, v209
  v_accvgpr_write_b32 a102, v210
  v_accvgpr_write_b32 a103, v211
  s_waitcnt lgkmcnt(12)
  v_mfma_f32_32x32x16_bf16 v[92:107], v[76:79], a[72:75], v[92:107]
  ds_read_b64_tr_b16 v[72:73], v35 offset:8192
  ds_read_b64_tr_b16 v[74:75], v35 offset:8704
  v_mfma_f32_16x16x32_bf16 v[84:87], v[88:91], v[76:79], v[84:87]
  v_accvgpr_write_b32 a224, v212
  v_accvgpr_write_b32 a225, v213
  v_accvgpr_write_b32 a226, v214
  v_accvgpr_write_b32 a227, v215
  v_mfma_f32_32x32x16_bf16 v[108:123], v[76:79], a[200:203], v[108:123]
  v_accvgpr_write_b32 a228, v216
  v_accvgpr_write_b32 a229, v217
  v_accvgpr_write_b32 a230, v218
  v_accvgpr_write_b32 a231, v219
  s_waitcnt lgkmcnt(8)
  v_mfma_f32_32x32x16_bf16 v[92:107], v[80:83], a[76:79], v[92:107]
  ds_read_b64_tr_b16 v[76:77], v36 offset:8192
  ds_read_b64_tr_b16 v[78:79], v36 offset:8704
  v_accvgpr_write_b32 a112, v220
  v_accvgpr_write_b32 a113, v221
  v_accvgpr_write_b32 a114, v222
  v_accvgpr_write_b32 a115, v223
  v_mfma_f32_32x32x16_bf16 v[108:123], v[80:83], a[204:207], v[108:123]
  v_accvgpr_write_b32 a116, v224
  v_accvgpr_write_b32 a117, v225
  v_accvgpr_write_b32 a118, v226
  v_accvgpr_write_b32 a119, v227
  s_waitcnt lgkmcnt(4)
  v_mfma_f32_32x32x16_bf16 v[92:107], v[68:71], a[80:83], v[92:107]
  ds_read_b64_tr_b16 v[80:81], v37 offset:8192
  ds_read_b64_tr_b16 v[82:83], v37 offset:8704
  v_mfma_f32_16x16x32_bf16 v[84:87], v[88:91], v[68:71], v[84:87]
  v_accvgpr_write_b32 a240, v228
  v_accvgpr_write_b32 a241, v229
  v_accvgpr_write_b32 a242, v230
  v_accvgpr_write_b32 a243, v231
  v_mfma_f32_32x32x16_bf16 v[108:123], v[68:71], a[208:211], v[108:123]
  v_accvgpr_write_b32 a244, v232
  v_accvgpr_write_b32 a245, v233
  v_accvgpr_write_b32 a246, v234
  v_accvgpr_write_b32 a247, v235
  v_dot2c_f32_bf16 v52, v156, v50
  v_dot2c_f32_bf16 v53, v156, v156
  v_dot2c_f32_bf16 v54, v164, v50
  v_dot2c_f32_bf16 v55, v164, v164
  v_dot2c_f32_bf16 v52, v157, v50
  v_dot2c_f32_bf16 v53, v157, v157
  v_dot2c_f32_bf16 v54, v165, v50
  v_dot2c_f32_bf16 v55, v165, v165
  v_dot2c_f32_bf16 v52, v158, v50
  v_dot2c_f32_bf16 v53, v158, v158
  v_dot2c_f32_bf16 v54, v166, v50
  v_dot2c_f32_bf16 v55, v166, v166
  v_dot2c_f32_bf16 v52, v159, v50
  v_dot2c_f32_bf16 v53, v159, v159
  v_dot2c_f32_bf16 v54, v167, v50
  v_dot2c_f32_bf16 v55, v167, v167
  v_dot2c_f32_bf16 v52, v160, v50
  v_dot2c_f32_bf16 v53, v160, v160
  v_dot2c_f32_bf16 v54, v168, v50
  v_dot2c_f32_bf16 v55, v168, v168
  v_dot2c_f32_bf16 v52, v161, v50
  v_dot2c_f32_bf16 v53, v161, v161
  v_dot2c_f32_bf16 v54, v169, v50
  v_dot2c_f32_bf16 v55, v169, v169
  v_dot2c_f32_bf16 v52, v162, v50
  v_dot2c_f32_bf16 v53, v162, v162
  v_dot2c_f32_bf16 v54, v170, v50
  v_dot2c_f32_bf16 v55, v170, v170
  v_dot2c_f32_bf16 v52, v163, v50
  v_dot2c_f32_bf16 v53, v163, v163
  v_dot2c_f32_bf16 v54, v171, v50
  v_dot2c_f32_bf16 v55, v171, v171
  v_dot2c_f32_bf16 v52, v172, v50
  v_dot2c_f32_bf16 v53, v172, v172
  v_dot2c_f32_bf16 v54, v180, v50
  v_dot2c_f32_bf16 v55, v180, v180
  v_dot2c_f32_bf16 v52, v173, v50
  v_dot2c_f32_bf16 v53, v173, v173
  v_dot2c_f32_bf16 v54, v181, v50
  v_dot2c_f32_bf16 v55, v181, v181
  v_dot2c_f32_bf16 v52, v174, v50
  v_dot2c_f32_bf16 v53, v174, v174
  v_dot2c_f32_bf16 v54, v182, v50
  v_dot2c_f32_bf16 v55, v182, v182
  v_dot2c_f32_bf16 v52, v175, v50
  v_dot2c_f32_bf16 v53, v175, v175
  v_dot2c_f32_bf16 v54, v183, v50
  v_dot2c_f32_bf16 v55, v183, v183
  v_dot2c_f32_bf16 v52, v176, v50
  v_dot2c_f32_bf16 v53, v176, v176
  v_dot2c_f32_bf16 v54, v184, v50
  v_dot2c_f32_bf16 v55, v184, v184
  v_dot2c_f32_bf16 v52, v177, v50
  v_dot2c_f32_bf16 v53, v177, v177
  v_dot2c_f32_bf16 v54, v185, v50
  v_dot2c_f32_bf16 v55, v185, v185
  v_dot2c_f32_bf16 v52, v178, v50
  v_dot2c_f32_bf16 v53, v178, v178
  v_dot2c_f32_bf16 v54, v186, v50
  v_dot2c_f32_bf16 v55, v186, v186
  v_dot2c_f32_bf16 v52, v179, v50
  v_dot2c_f32_bf16 v53, v179, v179
  v_dot2c_f32_bf16 v54, v187, v50
  v_dot2c_f32_bf16 v55, v187, v187
  v_dot2c_f32_bf16 v52, v204, v50
  v_dot2c_f32_bf16 v53, v204, v204
  v_dot2c_f32_bf16 v54, v212, v50
  v_dot2c_f32_bf16 v55, v212, v212
  v_dot2c_f32_bf16 v52, v205, v50
  v_dot2c_f32_bf16 v53, v205, v205
  v_dot2c_f32_bf16 v54, v213, v50
  v_dot2c_f32_bf16 v55, v213, v213
  v_dot2c_f32_bf16 v52, v206, v50
  v_dot2c_f32_bf16 v53, v206, v206
  v_dot2c_f32_bf16 v54, v214, v50
  v_dot2c_f32_bf16 v55, v214, v214
  v_dot2c_f32_bf16 v52, v207, v50
  v_dot2c_f32_bf16 v53, v207, v207
  v_dot2c_f32_bf16 v54, v215, v50
  v_dot2c_f32_bf16 v55, v215, v215
  v_dot2c_f32_bf16 v52, v208, v50
  v_dot2c_f32_bf16 v53, v208, v208
  v_dot2c_f32_bf16 v54, v216, v50
  v_dot2c_f32_bf16 v55, v216, v216
  v_dot2c_f32_bf16 v52, v209, v50
  v_dot2c_f32_bf16 v53, v209, v209
  v_dot2c_f32_bf16 v54, v217, v50
  v_dot2c_f32_bf16 v55, v217, v217
  v_dot2c_f32_bf16 v52, v210, v50
  v_dot2c_f32_bf16 v53, v210, v210
  v_dot2c_f32_bf16 v54, v218, v50
  v_dot2c_f32_bf16 v55, v218, v218
  v_dot2c_f32_bf16 v52, v211, v50
  v_dot2c_f32_bf16 v53, v211, v211
  v_dot2c_f32_bf16 v54, v219, v50
  v_dot2c_f32_bf16 v55, v219, v219
  v_dot2c_f32_bf16 v52, v220, v50
  v_dot2c_f32_bf16 v53, v220, v220
  v_dot2c_f32_bf16 v54, v228, v50
  v_dot2c_f32_bf16 v55, v228, v228
  v_dot2c_f32_bf16 v52, v221, v50
  v_dot2c_f32_bf16 v53, v221, v221
  v_dot2c_f32_bf16 v54, v229, v50
  v_dot2c_f32_bf16 v55, v229, v229
  v_dot2c_f32_bf16 v52, v222, v50
  v_dot2c_f32_bf16 v53, v222, v222
  v_dot2c_f32_bf16 v54, v230, v50
  v_dot2c_f32_bf16 v55, v230, v230
  v_dot2c_f32_bf16 v52, v223, v50
  v_dot2c_f32_bf16 v53, v223, v223
  v_dot2c_f32_bf16 v54, v231, v50
  v_dot2c_f32_bf16 v55, v231, v231
  v_dot2c_f32_bf16 v52, v224, v50
  v_dot2c_f32_bf16 v53, v224, v224
  v_dot2c_f32_bf16 v54, v232, v50
  v_dot2c_f32_bf16 v55, v232, v232
  v_dot2c_f32_bf16 v52, v225, v50
  v_dot2c_f32_bf16 v53, v225, v225
  v_dot2c_f32_bf16 v54, v233, v50
  v_dot2c_f32_bf16 v55, v233, v233
  v_dot2c_f32_bf16 v52, v226, v50
  v_dot2c_f32_bf16 v53, v226, v226
  v_dot2c_f32_bf16 v54, v234, v50
  v_dot2c_f32_bf16 v55, v234, v234
  v_dot2c_f32_bf16 v52, v227, v50
  v_dot2c_f32_bf16 v53, v227, v227
  v_dot2c_f32_bf16 v54, v235, v50
  v_dot2c_f32_bf16 v55, v235, v235
  s_waitcnt vmcnt(12)
  s_barrier
  s_waitcnt lgkmcnt(4)
  v_mfma_f32_32x32x16_bf16 v[92:107], v[72:75], a[84:87], v[92:107]
  ds_read_b64_tr_b16 v[68:69], v38 offset:0
  ds_read_b64_tr_b16 v[70:71], v38 offset:512
  s_add_u32 m0, s72, 81920
  s_add_u32 s73, s0, 3
  s_and_b32 s73, s73, 3
  s_mul_i32 s73, s73, 393216
  s_add_u32 s73, s73, s81
  buffer_load_dwordx4 v9, s[24:27], s73 offen offset:0 lds
  buffer_load_dwordx4 v10, s[24:27], s73 offen offset:1024 lds
  buffer_load_dwordx4 v11, s[24:27], s73 offen offset:2048 lds
  buffer_load_dwordx4 v12, s[24:27], s73 offen offset:3072 lds
  v_mfma_f32_32x32x16_bf16 v[108:123], v[72:75], a[212:215], v[108:123]
  s_waitcnt lgkmcnt(4)
  v_mfma_f32_32x32x16_bf16 v[92:107], v[76:79], a[88:91], v[92:107]
  ds_read_b64_tr_b16 v[72:73], v39 offset:0
  ds_read_b64_tr_b16 v[74:75], v39 offset:512
  v_permlane32_swap_b32 v52, v53
  v_permlane32_swap_b32 v54, v55
  v_mfma_f32_16x16x32_bf16 v[84:87], v[88:91], v[76:79], v[84:87]
  s_add_u32 m0, s72, 16384
  s_add_u32 s73, s1, 0
  s_and_b32 s73, s73, 7
  s_mul_i32 s73, s73, 128
  s_add_u32 s73, s73, s79
  buffer_load_dwordx4 v5, s[32:35], s73 offen offset:0 lds
  buffer_load_dwordx4 v6, s[32:35], s73 offen offset:1024 lds
  buffer_load_dwordx4 v7, s[32:35], s73 offen offset:2048 lds
  buffer_load_dwordx4 v8, s[32:35], s73 offen offset:3072 lds
  v_mfma_f32_32x32x16_bf16 v[108:123], v[76:79], a[216:219], v[108:123]
  v_add_f32 v52, v52, v53
  v_add_f32 v54, v54, v55
  ds_write_b32 v48, v52 offset:0
  ds_write_b32 v48, v54 offset:256
  v_xor_b32 v244, 512, v48
  s_waitcnt lgkmcnt(6)
  v_mfma_f32_32x32x16_bf16 v[92:107], v[80:83], a[92:95], v[92:107]
  ds_read_b64_tr_b16 v[76:77], v40 offset:0
  ds_read_b64_tr_b16 v[78:79], v40 offset:512
  s_add_u32 m0, s72, 49152
  s_add_u32 s73, s1, 0
  s_and_b32 s73, s73, 7
  s_mul_i32 s73, s73, 128
  s_add_u32 s73, s73, s78
  buffer_load_dwordx4 v5, s[32:35], s73 offen offset:0 lds
  buffer_load_dwordx4 v6, s[32:35], s73 offen offset:1024 lds
  buffer_load_dwordx4 v7, s[32:35], s73 offen offset:2048 lds
  buffer_load_dwordx4 v8, s[32:35], s73 offen offset:3072 lds
  v_mfma_f32_32x32x16_bf16 v[108:123], v[80:83], a[220:223], v[108:123]
  s_waitcnt lgkmcnt(6)
  v_mfma_f32_32x32x16_bf16 v[92:107], v[68:71], a[96:99], v[92:107]
  ds_read_b64_tr_b16 v[80:81], v41 offset:0
  ds_read_b64_tr_b16 v[82:83], v41 offset:512
  v_mfma_f32_16x16x32_bf16 v[84:87], v[88:91], v[68:71], v[84:87]
  v_mfma_f32_32x32x16_bf16 v[108:123], v[68:71], a[224:227], v[108:123]
  v_bfe_u32 v248, v1, 1, 4
  v_mul_u32_u24 v248, 3072, v248
  v_and_b32 v249, 1, v1
  v_mul_u32_u24 v249, 124, v249
  v_add_u32_e64 v248, v248, v249
  s_lshl_b32 s74, s3, 2
  s_add_u32 s74, s74, s44
  s_mul_i32 s74, s74, 49152
  s_add_u32 s74, s74, s82
  s_mov_b64 exec, 0xffffffff
  buffer_load_dword v4, v248, s[24:27], s74 offen
  s_mov_b64 exec, -1
  s_waitcnt lgkmcnt(6)
  v_mfma_f32_32x32x16_bf16 v[92:107], v[72:75], a[100:103], v[92:107]
  ds_read_b64_tr_b16 v[68:69], v38 offset:8192
  ds_read_b64_tr_b16 v[70:71], v38 offset:8704
  v_mfma_f32_32x32x16_bf16 v[108:123], v[72:75], a[228:231], v[108:123]
  s_waitcnt lgkmcnt(4)
  v_mfma_f32_32x32x16_bf16 v[92:107], v[76:79], a[104:107], v[92:107]
  ds_read_b64_tr_b16 v[72:73], v39 offset:8192
  ds_read_b64_tr_b16 v[74:75], v39 offset:8704
  v_mfma_f32_16x16x32_bf16 v[84:87], v[88:91], v[76:79], v[84:87]
  v_mfma_f32_32x32x16_bf16 v[108:123], v[76:79], a[232:235], v[108:123]
  s_waitcnt lgkmcnt(4)
  v_mfma_f32_32x32x16_bf16 v[92:107], v[80:83], a[108:111], v[92:107]
  ds_read_b64_tr_b16 v[76:77], v40 offset:8192
  ds_read_b64_tr_b16 v[78:79], v40 offset:8704
  v_mfma_f32_32x32x16_bf16 v[108:123], v[80:83], a[236:239], v[108:123]
  s_waitcnt lgkmcnt(4)
  v_mfma_f32_32x32x16_bf16 v[92:107], v[68:71], a[112:115], v[92:107]
  ds_read_b64_tr_b16 v[80:81], v41 offset:8192
  ds_read_b64_tr_b16 v[82:83], v41 offset:8704
  v_mfma_f32_16x16x32_bf16 v[84:87], v[88:91], v[68:71], v[84:87]
  v_mfma_f32_32x32x16_bf16 v[108:123], v[68:71], a[240:243], v[108:123]
  s_waitcnt vmcnt(21)
  s_barrier
  s_waitcnt lgkmcnt(4)
  v_mfma_f32_32x32x16_bf16 v[92:107], v[72:75], a[116:119], v[92:107]
  ds_read_b64_tr_b16 v[68:69], v34 offset:32768
  ds_read_b64_tr_b16 v[70:71], v34 offset:33280
  ds_read_b32 v53, v244 offset:0
  ds_read_b32 v55, v244 offset:256
  s_waitcnt lgkmcnt(1)
  v_add_f32 v52, v52, v53
  s_waitcnt lgkmcnt(0)
  v_add_f32 v54, v54, v55
  v_mov_b32 v53, v52
  v_mov_b32_e64 v55, v54
  v_mfma_f32_16x16x32_bf16 v[84:87], v[88:91], v[76:79], v[84:87]
  v_permlane32_swap_b32 v52, v53
  v_mfma_f32_32x32x16_bf16 v[108:123], v[72:75], a[244:247], v[108:123]
  v_permlane32_swap_b32 v54, v55
  v_mul_f32 v56, 0xbb000000, v52
  v_mul_f32 v62, 0xbb000000, v54
  v_mul_f32 v245, 0x3b000000, v53
  v_mul_f32 v246, 0x3b000000, v55
  v_fma_f32 v245, -v56, v56, v245
  v_fma_f32 v246, -v62, v62, v246
  v_mfma_f32_32x32x16_bf16 v[92:107], v[76:79], a[120:123], v[92:107]
  ds_read_b64_tr_b16 v[72:73], v35 offset:32768
  ds_read_b64_tr_b16 v[74:75], v35 offset:33280
  v_max_f32 v245, 0, v245
  v_max_f32 v246, 0, v246
  v_add_f32 v245, 0x3727c5ac, v245
  v_add_f32 v246, 0x3727c5ac, v246
  v_rsq_f32_e64 v57, v245
  v_mfma_f32_32x32x16_bf16 v[108:123], v[76:79], a[248:251], v[108:123]
  v_rsq_f32 v63, v246
  v_sqrt_f32 v58, v245
  v_sqrt_f32_e64 v64, v246
  v_mul_f32 v59, 0xc0135761, v57
  v_mul_f32 v65, 0xc0135761, v63
  v_mfma_f32_32x32x16_bf16 v[92:107], v[80:83], a[124:127], v[92:107]
  ds_read_b64_tr_b16 v[76:77], v36 offset:32768
  ds_read_b64_tr_b16 v[78:79], v36 offset:33280
  ds_write_b32 v49, v84 offset:0
  v_mul_f32 v245, v57, v57
  v_mul_f32 v246, v63, v63
  v_mul_f32 v52, 0xbdd2d3e8, v57
  v_mul_f32 v54, 0xbdd2d3e8, v63
  v_mul_f32_e64 v60, v245, v52
  v_mfma_f32_32x32x16_bf16 v[108:123], v[80:83], a[252:255], v[108:123]
  v_mul_f32 v66, v246, v54
  v_cmp_gt_u32 vcc, 32, v1
  v_lshlrev_b32 v247, 2, v1
  v_add_u32 v247, s91, v247
  v_cndmask_b32 v245, v57, v56, vcc
  v_cndmask_b32 v246, v63, v62, vcc
  ds_write_b32 v247, v245 offset:0
  ds_write_b32 v247, v246 offset:256
  s_waitcnt lgkmcnt(2)
  s_barrier
  ds_read_b128 v[204:207], v44 offset:0
  ds_read_b128 v[220:223], v44 offset:256
  ds_read_b128 v[208:211], v44 offset:32
  ds_read_b128 v[224:227], v44 offset:288
  ds_read_b128 v[212:215], v44 offset:64
  ds_read_b128 v[228:231], v44 offset:320
  ds_read_b128 v[216:219], v44 offset:96
  ds_read_b128 v[232:235], v44 offset:352
  s_waitcnt lgkmcnt(6)
  v_pk_add_f32 v[204:205], v[204:205], v[220:221] op_sel:[0,0] op_sel_hi:[1,1]
  v_pk_add_f32 v[206:207], v[206:207], v[222:223] op_sel:[0,0] op_sel_hi:[1,1]
  s_waitcnt lgkmcnt(4)
  v_pk_add_f32 v[208:209], v[208:209], v[224:225] op_sel:[0,0] op_sel_hi:[1,1]
  v_pk_add_f32 v[210:211], v[210:211], v[226:227] op_sel:[0,0] op_sel_hi:[1,1]
  s_waitcnt lgkmcnt(2)
  v_pk_add_f32 v[212:213], v[212:213], v[228:229] op_sel:[0,0] op_sel_hi:[1,1]
  v_pk_add_f32 v[214:215], v[214:215], v[230:231] op_sel:[0,0] op_sel_hi:[1,1]
  s_waitcnt lgkmcnt(0)
  v_pk_add_f32 v[216:217], v[216:217], v[232:233] op_sel:[0,0] op_sel_hi:[1,1]
  v_pk_add_f32 v[218:219], v[218:219], v[234:235] op_sel:[0,0] op_sel_hi:[1,1]
  s_buffer_load_dword s71, s[40:43], 0
  v_pk_fma_f32 v[92:93], v[204:205], v[56:57], v[92:93] op_sel:[0,0,0] op_sel_hi:[1,0,1]
  v_pk_fma_f32 v[94:95], v[206:207], v[56:57], v[94:95] op_sel:[0,0,0] op_sel_hi:[1,0,1]
  v_pk_fma_f32 v[96:97], v[208:209], v[56:57], v[96:97] op_sel:[0,0,0] op_sel_hi:[1,0,1]
  v_pk_fma_f32 v[98:99], v[210:211], v[56:57], v[98:99] op_sel:[0,0,0] op_sel_hi:[1,0,1]
  v_pk_mul_f32 v[220:221], v[92:93], v[92:93] op_sel:[0,0] op_sel_hi:[1,1]
  v_pk_mul_f32 v[222:223], v[94:95], v[94:95] op_sel:[0,0] op_sel_hi:[1,1]
  v_pk_mul_f32 v[224:225], v[96:97], v[96:97] op_sel:[0,0] op_sel_hi:[1,1]
  v_pk_mul_f32 v[226:227], v[98:99], v[98:99] op_sel:[0,0] op_sel_hi:[1,1]
  v_pk_fma_f32 v[220:221], v[220:221], v[60:61], v[58:59] op_sel:[0,0,1] op_sel_hi:[1,0,1]
  v_pk_fma_f32 v[222:223], v[222:223], v[60:61], v[58:59] op_sel:[0,0,1] op_sel_hi:[1,0,1]
  v_pk_fma_f32 v[224:225], v[224:225], v[60:61], v[58:59] op_sel:[0,0,1] op_sel_hi:[1,0,1]
  v_pk_fma_f32 v[226:227], v[226:227], v[60:61], v[58:59] op_sel:[0,0,1] op_sel_hi:[1,0,1]
  v_pk_mul_f32 v[220:221], v[220:221], v[92:93] op_sel:[0,0] op_sel_hi:[1,1]
  v_pk_mul_f32 v[222:223], v[222:223], v[94:95] op_sel:[0,0] op_sel_hi:[1,1]
  v_pk_mul_f32 v[224:225], v[224:225], v[96:97] op_sel:[0,0] op_sel_hi:[1,1]
  v_pk_mul_f32 v[226:227], v[226:227], v[98:99] op_sel:[0,0] op_sel_hi:[1,1]
  v_exp_f32 v220, v220
  v_exp_f32 v221, v221
  v_exp_f32 v222, v222
  v_exp_f32 v223, v223
  v_exp_f32 v224, v224
  v_exp_f32 v225, v225
  v_exp_f32 v226, v226
  v_exp_f32 v227, v227
  v_pk_fma_f32 v[220:221], v[220:221], v[58:59], v[58:59] op_sel:[0,0,0] op_sel_hi:[1,0,0]
  v_pk_fma_f32 v[222:223], v[222:223], v[58:59], v[58:59] op_sel:[0,0,0] op_sel_hi:[1,0,0]
  v_pk_fma_f32 v[224:225], v[224:225], v[58:59], v[58:59] op_sel:[0,0,0] op_sel_hi:[1,0,0]
  v_pk_fma_f32 v[226:227], v[226:227], v[58:59], v[58:59] op_sel:[0,0,0] op_sel_hi:[1,0,0]
  v_rcp_f32 v220, v220
  v_rcp_f32 v221, v221
  v_rcp_f32 v222, v222
  v_rcp_f32 v223, v223
  v_rcp_f32 v224, v224
  v_rcp_f32 v225, v225
  v_rcp_f32 v226, v226
  v_rcp_f32 v227, v227
  v_pk_mul_f32 v[92:93], v[92:93], v[220:221] op_sel:[0,0] op_sel_hi:[1,1]
  v_pk_mul_f32 v[94:95], v[94:95], v[222:223] op_sel:[0,0] op_sel_hi:[1,1]
  v_pk_mul_f32 v[96:97], v[96:97], v[224:225] op_sel:[0,0] op_sel_hi:[1,1]
  v_pk_mul_f32 v[98:99], v[98:99], v[226:227] op_sel:[0,0] op_sel_hi:[1,1]
  v_mov_b64 v[188:189], v[92:93]
  v_pk_mul_f32 v[190:191], v[92:93], v[92:93] op_sel:[0,0] op_sel_hi:[1,1]
  v_pk_add_f32 v[188:189], v[188:189], v[94:95] op_sel:[0,0] op_sel_hi:[1,1]
  v_pk_fma_f32 v[190:191], v[94:95], v[94:95], v[190:191] op_sel:[0,0,0] op_sel_hi:[1,1,1]
  v_pk_add_f32 v[188:189], v[188:189], v[96:97] op_sel:[0,0] op_sel_hi:[1,1]
  v_pk_fma_f32 v[190:191], v[96:97], v[96:97], v[190:191] op_sel:[0,0,0] op_sel_hi:[1,1,1]
  v_pk_add_f32 v[188:189], v[188:189], v[98:99] op_sel:[0,0] op_sel_hi:[1,1]
  v_pk_fma_f32 v[190:191], v[98:99], v[98:99], v[190:191] op_sel:[0,0,0] op_sel_hi:[1,1,1]
  v_pk_fma_f32 v[100:101], v[212:213], v[56:57], v[100:101] op_sel:[0,0,0] op_sel_hi:[1,0,1]
  v_pk_fma_f32 v[102:103], v[214:215], v[56:57], v[102:103] op_sel:[0,0,0] op_sel_hi:[1,0,1]
  v_pk_fma_f32 v[104:105], v[216:217], v[56:57], v[104:105] op_sel:[0,0,0] op_sel_hi:[1,0,1]
  v_pk_fma_f32 v[106:107], v[218:219], v[56:57], v[106:107] op_sel:[0,0,0] op_sel_hi:[1,0,1]
  v_pk_mul_f32 v[228:229], v[100:101], v[100:101] op_sel:[0,0] op_sel_hi:[1,1]
  v_pk_mul_f32 v[230:231], v[102:103], v[102:103] op_sel:[0,0] op_sel_hi:[1,1]
  v_pk_mul_f32 v[232:233], v[104:105], v[104:105] op_sel:[0,0] op_sel_hi:[1,1]
  v_pk_mul_f32 v[234:235], v[106:107], v[106:107] op_sel:[0,0] op_sel_hi:[1,1]
  v_pk_fma_f32 v[228:229], v[228:229], v[60:61], v[58:59] op_sel:[0,0,1] op_sel_hi:[1,0,1]
  v_pk_fma_f32 v[230:231], v[230:231], v[60:61], v[58:59] op_sel:[0,0,1] op_sel_hi:[1,0,1]
  v_pk_fma_f32 v[232:233], v[232:233], v[60:61], v[58:59] op_sel:[0,0,1] op_sel_hi:[1,0,1]
  v_pk_fma_f32 v[234:235], v[234:235], v[60:61], v[58:59] op_sel:[0,0,1] op_sel_hi:[1,0,1]
  v_pk_mul_f32 v[228:229], v[228:229], v[100:101] op_sel:[0,0] op_sel_hi:[1,1]
  v_pk_mul_f32 v[230:231], v[230:231], v[102:103] op_sel:[0,0] op_sel_hi:[1,1]
  v_pk_mul_f32 v[232:233], v[232:233], v[104:105] op_sel:[0,0] op_sel_hi:[1,1]
  v_pk_mul_f32 v[234:235], v[234:235], v[106:107] op_sel:[0,0] op_sel_hi:[1,1]
  v_exp_f32 v228, v228
  v_exp_f32 v229, v229
  v_exp_f32 v230, v230
  v_exp_f32 v231, v231
  v_exp_f32 v232, v232
  v_exp_f32 v233, v233
  v_exp_f32 v234, v234
  v_exp_f32_e64 v235, v235
  v_pk_fma_f32 v[228:229], v[228:229], v[58:59], v[58:59] op_sel:[0,0,0] op_sel_hi:[1,0,0]
  v_pk_fma_f32 v[230:231], v[230:231], v[58:59], v[58:59] op_sel:[0,0,0] op_sel_hi:[1,0,0]
  v_pk_fma_f32 v[232:233], v[232:233], v[58:59], v[58:59] op_sel:[0,0,0] op_sel_hi:[1,0,0]
  v_pk_fma_f32 v[234:235], v[234:235], v[58:59], v[58:59] op_sel:[0,0,0] op_sel_hi:[1,0,0]
  v_rcp_f32 v228, v228
  v_rcp_f32 v229, v229
  v_rcp_f32 v230, v230
  v_rcp_f32 v231, v231
  v_rcp_f32 v232, v232
  v_rcp_f32 v233, v233
  v_rcp_f32 v234, v234
  v_rcp_f32 v235, v235
  v_pk_mul_f32 v[100:101], v[100:101], v[228:229] op_sel:[0,0] op_sel_hi:[1,1]
  v_pk_mul_f32 v[102:103], v[102:103], v[230:231] op_sel:[0,0] op_sel_hi:[1,1]
  v_pk_mul_f32 v[104:105], v[104:105], v[232:233] op_sel:[0,0] op_sel_hi:[1,1]
  v_pk_mul_f32 v[106:107], v[106:107], v[234:235] op_sel:[0,0] op_sel_hi:[1,1]
  v_pk_add_f32 v[188:189], v[188:189], v[100:101] op_sel:[0,0] op_sel_hi:[1,1]
  v_pk_fma_f32 v[190:191], v[100:101], v[100:101], v[190:191] op_sel:[0,0,0] op_sel_hi:[1,1,1]
  v_pk_add_f32 v[188:189], v[188:189], v[102:103] op_sel:[0,0] op_sel_hi:[1,1]
  v_pk_fma_f32 v[190:191], v[102:103], v[102:103], v[190:191] op_sel:[0,0,0] op_sel_hi:[1,1,1]
  v_pk_add_f32 v[188:189], v[188:189], v[104:105] op_sel:[0,0] op_sel_hi:[1,1]
  v_pk_fma_f32 v[190:191], v[104:105], v[104:105], v[190:191] op_sel:[0,0,0] op_sel_hi:[1,1,1]
  v_pk_add_f32 v[188:189], v[188:189], v[106:107] op_sel:[0,0] op_sel_hi:[1,1]
  v_pk_fma_f32 v[190:191], v[106:107], v[106:107], v[190:191] op_sel:[0,0,0] op_sel_hi:[1,1,1]
  v_pk_fma_f32 v[108:109], v[204:205], v[62:63], v[108:109] op_sel:[0,0,0] op_sel_hi:[1,0,1]
  v_pk_fma_f32 v[110:111], v[206:207], v[62:63], v[110:111] op_sel:[0,0,0] op_sel_hi:[1,0,1]
  v_pk_fma_f32 v[112:113], v[208:209], v[62:63], v[112:113] op_sel:[0,0,0] op_sel_hi:[1,0,1]
  v_pk_fma_f32 v[114:115], v[210:211], v[62:63], v[114:115] op_sel:[0,0,0] op_sel_hi:[1,0,1]
  v_pk_mul_f32 v[220:221], v[108:109], v[108:109] op_sel:[0,0] op_sel_hi:[1,1]
  v_pk_mul_f32 v[222:223], v[110:111], v[110:111] op_sel:[0,0] op_sel_hi:[1,1]
  v_pk_mul_f32 v[224:225], v[112:113], v[112:113] op_sel:[0,0] op_sel_hi:[1,1]
  v_pk_mul_f32 v[226:227], v[114:115], v[114:115] op_sel:[0,0] op_sel_hi:[1,1]
  v_pk_fma_f32 v[220:221], v[220:221], v[66:67], v[64:65] op_sel:[0,0,1] op_sel_hi:[1,0,1]
  v_pk_fma_f32 v[222:223], v[222:223], v[66:67], v[64:65] op_sel:[0,0,1] op_sel_hi:[1,0,1]
  v_pk_fma_f32 v[224:225], v[224:225], v[66:67], v[64:65] op_sel:[0,0,1] op_sel_hi:[1,0,1]
  v_pk_fma_f32 v[226:227], v[226:227], v[66:67], v[64:65] op_sel:[0,0,1] op_sel_hi:[1,0,1]
  v_pk_mul_f32 v[220:221], v[220:221], v[108:109] op_sel:[0,0] op_sel_hi:[1,1]
  v_pk_mul_f32 v[222:223], v[222:223], v[110:111] op_sel:[0,0] op_sel_hi:[1,1]
  v_pk_mul_f32 v[224:225], v[224:225], v[112:113] op_sel:[0,0] op_sel_hi:[1,1]
  v_pk_mul_f32 v[226:227], v[226:227], v[114:115] op_sel:[0,0] op_sel_hi:[1,1]
  v_exp_f32 v220, v220
  v_exp_f32 v221, v221
  v_exp_f32 v222, v222
  v_exp_f32 v223, v223
  v_exp_f32 v224, v224
  v_exp_f32 v225, v225
  v_exp_f32 v226, v226
  v_exp_f32 v227, v227
  v_pk_fma_f32 v[220:221], v[220:221], v[64:65], v[64:65] op_sel:[0,0,0] op_sel_hi:[1,0,0]
  v_pk_fma_f32 v[222:223], v[222:223], v[64:65], v[64:65] op_sel:[0,0,0] op_sel_hi:[1,0,0]
  v_pk_fma_f32 v[224:225], v[224:225], v[64:65], v[64:65] op_sel:[0,0,0] op_sel_hi:[1,0,0]
  v_pk_fma_f32 v[226:227], v[226:227], v[64:65], v[64:65] op_sel:[0,0,0] op_sel_hi:[1,0,0]
  v_rcp_f32 v220, v220
  v_rcp_f32 v221, v221
  v_rcp_f32 v222, v222
  v_rcp_f32 v223, v223
  v_rcp_f32 v224, v224
  v_rcp_f32 v225, v225
  v_rcp_f32 v226, v226
  v_rcp_f32 v227, v227
  v_pk_mul_f32 v[108:109], v[108:109], v[220:221] op_sel:[0,0] op_sel_hi:[1,1]
  v_pk_mul_f32 v[110:111], v[110:111], v[222:223] op_sel:[0,0] op_sel_hi:[1,1]
  v_pk_mul_f32 v[112:113], v[112:113], v[224:225] op_sel:[0,0] op_sel_hi:[1,1]
  v_pk_mul_f32 v[114:115], v[114:115], v[226:227] op_sel:[0,0] op_sel_hi:[1,1]
  v_mov_b64 v[196:197], v[108:109]
  v_pk_mul_f32 v[198:199], v[108:109], v[108:109] op_sel:[0,0] op_sel_hi:[1,1]
  v_pk_add_f32 v[196:197], v[196:197], v[110:111] op_sel:[0,0] op_sel_hi:[1,1]
  v_pk_fma_f32 v[198:199], v[110:111], v[110:111], v[198:199] op_sel:[0,0,0] op_sel_hi:[1,1,1]
  v_pk_add_f32 v[196:197], v[196:197], v[112:113] op_sel:[0,0] op_sel_hi:[1,1]
  v_pk_fma_f32 v[198:199], v[112:113], v[112:113], v[198:199] op_sel:[0,0,0] op_sel_hi:[1,1,1]
  v_pk_add_f32 v[196:197], v[196:197], v[114:115] op_sel:[0,0] op_sel_hi:[1,1]
  v_pk_fma_f32 v[198:199], v[114:115], v[114:115], v[198:199] op_sel:[0,0,0] op_sel_hi:[1,1,1]
  v_pk_fma_f32 v[116:117], v[212:213], v[62:63], v[116:117] op_sel:[0,0,0] op_sel_hi:[1,0,1]
  v_pk_fma_f32 v[118:119], v[214:215], v[62:63], v[118:119] op_sel:[0,0,0] op_sel_hi:[1,0,1]
  v_pk_fma_f32 v[120:121], v[216:217], v[62:63], v[120:121] op_sel:[0,0,0] op_sel_hi:[1,0,1]
  v_pk_fma_f32 v[122:123], v[218:219], v[62:63], v[122:123] op_sel:[0,0,0] op_sel_hi:[1,0,1]
  v_pk_mul_f32 v[228:229], v[116:117], v[116:117] op_sel:[0,0] op_sel_hi:[1,1]
  v_pk_mul_f32 v[230:231], v[118:119], v[118:119] op_sel:[0,0] op_sel_hi:[1,1]
  v_pk_mul_f32 v[232:233], v[120:121], v[120:121] op_sel:[0,0] op_sel_hi:[1,1]
  v_pk_mul_f32 v[234:235], v[122:123], v[122:123] op_sel:[0,0] op_sel_hi:[1,1]
  v_pk_fma_f32 v[228:229], v[228:229], v[66:67], v[64:65] op_sel:[0,0,1] op_sel_hi:[1,0,1]
  v_pk_fma_f32 v[230:231], v[230:231], v[66:67], v[64:65] op_sel:[0,0,1] op_sel_hi:[1,0,1]
  v_pk_fma_f32 v[232:233], v[232:233], v[66:67], v[64:65] op_sel:[0,0,1] op_sel_hi:[1,0,1]
  v_pk_fma_f32 v[234:235], v[234:235], v[66:67], v[64:65] op_sel:[0,0,1] op_sel_hi:[1,0,1]
  v_pk_mul_f32 v[228:229], v[228:229], v[116:117] op_sel:[0,0] op_sel_hi:[1,1]
  v_pk_mul_f32 v[230:231], v[230:231], v[118:119] op_sel:[0,0] op_sel_hi:[1,1]
  v_pk_mul_f32 v[232:233], v[232:233], v[120:121] op_sel:[0,0] op_sel_hi:[1,1]
  v_pk_mul_f32 v[234:235], v[234:235], v[122:123] op_sel:[0,0] op_sel_hi:[1,1]
  v_exp_f32 v228, v228
  v_exp_f32 v229, v229
  v_exp_f32 v230, v230
  v_exp_f32 v231, v231
  v_exp_f32 v232, v232
  v_exp_f32 v233, v233
  v_exp_f32 v234, v234
  v_exp_f32_e64 v235, v235
  v_pk_fma_f32 v[228:229], v[228:229], v[64:65], v[64:65] op_sel:[0,0,0] op_sel_hi:[1,0,0]
  v_pk_fma_f32 v[230:231], v[230:231], v[64:65], v[64:65] op_sel:[0,0,0] op_sel_hi:[1,0,0]
  v_pk_fma_f32 v[232:233], v[232:233], v[64:65], v[64:65] op_sel:[0,0,0] op_sel_hi:[1,0,0]
  v_pk_fma_f32 v[234:235], v[234:235], v[64:65], v[64:65] op_sel:[0,0,0] op_sel_hi:[1,0,0]
  v_rcp_f32 v228, v228
  v_rcp_f32 v229, v229
  v_rcp_f32 v230, v230
  v_rcp_f32 v231, v231
  v_rcp_f32 v232, v232
  v_rcp_f32 v233, v233
  v_rcp_f32 v234, v234
  v_rcp_f32 v235, v235
  v_pk_mul_f32 v[116:117], v[116:117], v[228:229] op_sel:[0,0] op_sel_hi:[1,1]
  v_pk_mul_f32 v[118:119], v[118:119], v[230:231] op_sel:[0,0] op_sel_hi:[1,1]
  v_pk_mul_f32 v[120:121], v[120:121], v[232:233] op_sel:[0,0] op_sel_hi:[1,1]
  v_pk_mul_f32 v[122:123], v[122:123], v[234:235] op_sel:[0,0] op_sel_hi:[1,1]
  v_pk_add_f32 v[196:197], v[196:197], v[116:117] op_sel:[0,0] op_sel_hi:[1,1]
  v_pk_fma_f32 v[198:199], v[116:117], v[116:117], v[198:199] op_sel:[0,0,0] op_sel_hi:[1,1,1]
  v_pk_add_f32 v[196:197], v[196:197], v[118:119] op_sel:[0,0] op_sel_hi:[1,1]
  v_pk_fma_f32 v[198:199], v[118:119], v[118:119], v[198:199] op_sel:[0,0,0] op_sel_hi:[1,1,1]
  v_pk_add_f32 v[196:197], v[196:197], v[120:121] op_sel:[0,0] op_sel_hi:[1,1]
  v_pk_fma_f32 v[198:199], v[120:121], v[120:121], v[198:199] op_sel:[0,0,0] op_sel_hi:[1,1,1]
  v_pk_add_f32 v[196:197], v[196:197], v[122:123] op_sel:[0,0] op_sel_hi:[1,1]
  v_pk_fma_f32 v[198:199], v[122:123], v[122:123], v[198:199] op_sel:[0,0,0] op_sel_hi:[1,1,1]
  s_waitcnt lgkmcnt(0)
  s_cmp_eq_u32 s71, 0
  s_cbranch_scc1 SLOW_TGA
RET_TGA:
  s_mov_b32 s70, s71
  s_add_u32 m0, s72, 0
  s_add_u32 s73, s1, 1
  s_and_b32 s73, s73, 7
  s_mul_i32 s73, s73, 128
  s_add_u32 s73, s73, s79
  buffer_load_dwordx4 v5, s[32:35], s73 offen offset:0 lds
  buffer_load_dwordx4 v6, s[32:35], s73 offen offset:1024 lds
  buffer_load_dwordx4 v7, s[32:35], s73 offen offset:2048 lds
  buffer_load_dwordx4 v8, s[32:35], s73 offen offset:3072 lds
  v_add_f32 v236, v188, v189
  v_add_f32 v237, v190, v191
  v_add_f32 v238, v196, v197
  v_add_f32 v239, v198, v199
  v_permlane32_swap_b32 v236, v237
  s_nop 0
  v_permlane32_swap_b32 v238, v239
  v_add_f32 v236, v236, v237
  v_add_f32_e64 v238, v238, v239
  ds_write_b32 v48, v236 offset:0
  ds_write_b32 v48, v238 offset:256
  s_lshl_b32 s74, s96, 8
  v_subrev_u32 v240, s74, v48
  v_mov_b32_e64 v243, s71
  s_waitcnt lgkmcnt(0)
  s_barrier
  v_mfma_f32_32x32x16_bf16 v[124:139], a[0:3], v[68:71], 0
  ds_read_b64_tr_b16 v[80:81], v37 offset:32768
  ds_read_b64_tr_b16 v[82:83], v37 offset:33280
  ds_read_b32 v242, v240
  ds_read_b32 v241, v240 offset:512
  s_waitcnt lgkmcnt(0)
  v_add_f32 v242, v242, v241
  buffer_store_dwordx2 v[242:243], v2, s[8:11], s92 offen sc1
  v_mfma_f32_16x16x32_bf16 v[84:87], v[88:91], v[68:71], 0
  v_mfma_f32_32x32x16_bf16 v[140:155], a[128:131], v[68:71], 0
  v_mfma_f32_32x32x16_bf16 v[124:139], a[4:7], v[72:75], v[124:139]
  ds_read_b64_tr_b16 v[68:69], v34 offset:40960
  ds_read_b64_tr_b16 v[70:71], v34 offset:41472
  v_mfma_f32_32x32x16_bf16 v[140:155], a[132:135], v[72:75], v[140:155]
  v_mfma_f32_32x32x16_bf16 v[124:139], a[8:11], v[76:79], v[124:139]
  ds_read_b64_tr_b16 v[72:73], v35 offset:40960
  ds_read_b64_tr_b16 v[74:75], v35 offset:41472
  v_mfma_f32_16x16x32_bf16 v[84:87], v[88:91], v[76:79], v[84:87]
  v_mfma_f32_32x32x16_bf16 v[140:155], a[136:139], v[76:79], v[140:155]
  v_mfma_f32_32x32x16_bf16 v[124:139], a[12:15], v[80:83], v[124:139]
  ds_read_b64_tr_b16 v[76:77], v36 offset:40960
  ds_read_b64_tr_b16 v[78:79], v36 offset:41472
  v_mfma_f32_32x32x16_bf16 v[140:155], a[140:143], v[80:83], v[140:155]
  s_waitcnt lgkmcnt(4)
  v_mfma_f32_32x32x16_bf16 v[124:139], a[16:19], v[68:71], v[124:139]
  ds_read_b64_tr_b16 v[80:81], v37 offset:40960
  ds_read_b64_tr_b16 v[82:83], v37 offset:41472
  v_mfma_f32_16x16x32_bf16 v[84:87], v[88:91], v[68:71], v[84:87]
  v_mfma_f32_32x32x16_bf16 v[140:155], a[144:147], v[68:71], v[140:155]
  s_waitcnt vmcnt(22)
  s_barrier
  s_waitcnt lgkmcnt(4)
  v_mfma_f32_32x32x16_bf16 v[124:139], a[20:23], v[72:75], v[124:139]
  ds_read_b64_tr_b16 v[68:69], v38 offset:32768
  ds_read_b64_tr_b16 v[70:71], v38 offset:33280
  s_add_u32 m0, s72, 65536
  s_add_u32 s73, s1, 1
  s_and_b32 s73, s73, 7
  s_mul_i32 s73, s73, 128
  s_add_u32 s73, s73, s78
  buffer_load_dwordx4 v5, s[32:35], s73 offen offset:0 lds
  buffer_load_dwordx4 v6, s[32:35], s73 offen offset:1024 lds
  buffer_load_dwordx4 v7, s[32:35], s73 offen offset:2048 lds
  buffer_load_dwordx4 v8, s[32:35], s73 offen offset:3072 lds
  v_mfma_f32_32x32x16_bf16 v[140:155], a[148:151], v[72:75], v[140:155]
  s_waitcnt lgkmcnt(4)
  v_mfma_f32_32x32x16_bf16 v[124:139], a[24:27], v[76:79], v[124:139]
  ds_read_b64_tr_b16 v[72:73], v39 offset:32768
  ds_read_b64_tr_b16 v[74:75], v39 offset:33280
  v_mfma_f32_16x16x32_bf16 v[84:87], v[88:91], v[76:79], v[84:87]
  v_mfma_f32_32x32x16_bf16 v[140:155], a[152:155], v[76:79], v[140:155]
  s_waitcnt lgkmcnt(4)
  v_mfma_f32_32x32x16_bf16 v[124:139], a[28:31], v[80:83], v[124:139]
  ds_read_b64_tr_b16 v[76:77], v40 offset:32768
  ds_read_b64_tr_b16 v[78:79], v40 offset:33280
  v_mfma_f32_32x32x16_bf16 v[140:155], a[156:159], v[80:83], v[140:155]
  s_waitcnt lgkmcnt(4)
  v_mfma_f32_32x32x16_bf16 v[124:139], a[32:35], v[68:71], v[124:139]
  ds_read_b64_tr_b16 v[80:81], v41 offset:32768
  ds_read_b64_tr_b16 v[82:83], v41 offset:33280
  v_mfma_f32_16x16x32_bf16 v[84:87], v[88:91], v[68:71], v[84:87]
  v_mfma_f32_32x32x16_bf16 v[140:155], a[160:163], v[68:71], v[140:155]
  s_waitcnt lgkmcnt(4)
  v_mfma_f32_32x32x16_bf16 v[124:139], a[36:39], v[72:75], v[124:139]
  ds_read_b64_tr_b16 v[68:69], v38 offset:40960
  ds_read_b64_tr_b16 v[70:71], v38 offset:41472
  v_mfma_f32_32x32x16_bf16 v[140:155], a[164:167], v[72:75], v[140:155]
  s_waitcnt lgkmcnt(4)
  v_mfma_f32_32x32x16_bf16 v[124:139], a[40:43], v[76:79], v[124:139]
  ds_read_b64_tr_b16 v[72:73], v39 offset:40960
  ds_read_b64_tr_b16 v[74:75], v39 offset:41472
  v_mfma_f32_16x16x32_bf16 v[84:87], v[88:91], v[76:79], v[84:87]
  v_mfma_f32_32x32x16_bf16 v[140:155], a[168:171], v[76:79], v[140:155]
  s_waitcnt lgkmcnt(4)
  v_mfma_f32_32x32x16_bf16 v[124:139], a[44:47], v[80:83], v[124:139]
  ds_read_b64_tr_b16 v[76:77], v40 offset:40960
  ds_read_b64_tr_b16 v[78:79], v40 offset:41472
  v_mfma_f32_32x32x16_bf16 v[140:155], a[172:175], v[80:83], v[140:155]
  s_waitcnt lgkmcnt(4)
  v_mfma_f32_32x32x16_bf16 v[124:139], a[48:51], v[68:71], v[124:139]
  ds_read_b64_tr_b16 v[80:81], v41 offset:40960
  ds_read_b64_tr_b16 v[82:83], v41 offset:41472
  v_mfma_f32_16x16x32_bf16 v[84:87], v[88:91], v[68:71], v[84:87]
  v_mfma_f32_32x32x16_bf16 v[140:155], a[176:179], v[68:71], v[140:155]
  s_waitcnt vmcnt(22)
  s_barrier
  s_waitcnt lgkmcnt(4)
  v_mfma_f32_32x32x16_bf16 v[124:139], a[52:55], v[72:75], v[124:139]
  ds_read_b64_tr_b16 v[68:69], v38 offset:49152
  ds_read_b64_tr_b16 v[70:71], v38 offset:49664
  v_mfma_f32_32x32x16_bf16 v[140:155], a[180:183], v[72:75], v[140:155]
  s_waitcnt lgkmcnt(4)
  v_mfma_f32_32x32x16_bf16 v[124:139], a[56:59], v[76:79], v[124:139]
  ds_read_b64_tr_b16 v[72:73], v39 offset:49152
  ds_read_b64_tr_b16 v[74:75], v39 offset:49664
  v_mfma_f32_16x16x32_bf16 v[84:87], v[88:91], v[76:79], v[84:87]
  v_mfma_f32_32x32x16_bf16 v[140:155], a[184:187], v[76:79], v[140:155]
  s_waitcnt lgkmcnt(4)
  v_mfma_f32_32x32x16_bf16 v[124:139], a[60:63], v[80:83], v[124:139]
  ds_read_b64_tr_b16 v[76:77], v40 offset:49152
  ds_read_b64_tr_b16 v[78:79], v40 offset:49664
  v_mfma_f32_32x32x16_bf16 v[140:155], a[188:191], v[80:83], v[140:155]
  s_waitcnt lgkmcnt(4)
  v_mfma_f32_32x32x16_bf16 v[124:139], a[64:67], v[68:71], v[124:139]
  ds_read_b64_tr_b16 v[80:81], v41 offset:49152
  ds_read_b64_tr_b16 v[82:83], v41 offset:49664
  v_mfma_f32_16x16x32_bf16 v[84:87], v[88:91], v[68:71], v[84:87]
  v_mfma_f32_32x32x16_bf16 v[140:155], a[192:195], v[68:71], v[140:155]
  s_waitcnt lgkmcnt(4)
  v_mfma_f32_32x32x16_bf16 v[124:139], a[68:71], v[72:75], v[124:139]
  ds_read_b64_tr_b16 v[68:69], v38 offset:57344
  ds_read_b64_tr_b16 v[70:71], v38 offset:57856
  v_mfma_f32_32x32x16_bf16 v[140:155], a[196:199], v[72:75], v[140:155]
  s_waitcnt lgkmcnt(4)
  v_mfma_f32_32x32x16_bf16 v[124:139], a[72:75], v[76:79], v[124:139]
  ds_read_b64_tr_b16 v[72:73], v39 offset:57344
  ds_read_b64_tr_b16 v[74:75], v39 offset:57856
  v_mfma_f32_16x16x32_bf16 v[84:87], v[88:91], v[76:79], v[84:87]
  v_mfma_f32_32x32x16_bf16 v[140:155], a[200:203], v[76:79], v[140:155]
  s_waitcnt lgkmcnt(4)
  v_mfma_f32_32x32x16_bf16 v[124:139], a[76:79], v[80:83], v[124:139]
  ds_read_b64_tr_b16 v[76:77], v40 offset:57344
  ds_read_b64_tr_b16 v[78:79], v40 offset:57856
  v_mfma_f32_32x32x16_bf16 v[140:155], a[204:207], v[80:83], v[140:155]
  s_waitcnt lgkmcnt(4)
  v_mfma_f32_32x32x16_bf16 v[124:139], a[80:83], v[68:71], v[124:139]
  ds_read_b64_tr_b16 v[80:81], v41 offset:57344
  ds_read_b64_tr_b16 v[82:83], v41 offset:57856
  v_mfma_f32_16x16x32_bf16 v[84:87], v[88:91], v[68:71], v[84:87]
  s_add_u32 m0, s72, 32768
  s_add_u32 s73, s0, 0
  s_and_b32 s73, s73, 3
  s_mul_i32 s73, s73, 393216
  s_add_u32 s73, s73, s82
  buffer_load_dwordx4 v9, s[24:27], s73 offen offset:0 lds
  buffer_load_dwordx4 v10, s[24:27], s73 offen offset:1024 lds
  buffer_load_dwordx4 v11, s[24:27], s73 offen offset:2048 lds
  buffer_load_dwordx4 v12, s[24:27], s73 offen offset:3072 lds
  v_mfma_f32_32x32x16_bf16 v[140:155], a[208:211], v[68:71], v[140:155]
  s_waitcnt vmcnt(22)
  s_barrier
  s_waitcnt lgkmcnt(4)
  v_mfma_f32_32x32x16_bf16 v[124:139], a[84:87], v[72:75], v[124:139]
  ds_read_b64_tr_b16 v[68:69], v38 offset:16384
  ds_read_b64_tr_b16 v[70:71], v38 offset:16896
  v_mfma_f32_32x32x16_bf16 v[140:155], a[212:215], v[72:75], v[140:155]
  s_waitcnt lgkmcnt(4)
  v_mfma_f32_32x32x16_bf16 v[124:139], a[88:91], v[76:79], v[124:139]
  ds_read_b64_tr_b16 v[72:73], v39 offset:16384
  ds_read_b64_tr_b16 v[74:75], v39 offset:16896
  v_mfma_f32_16x16x32_bf16 v[84:87], v[88:91], v[76:79], v[84:87]
  v_mfma_f32_32x32x16_bf16 v[140:155], a[216:219], v[76:79], v[140:155]
  s_waitcnt lgkmcnt(4)
  v_mfma_f32_32x32x16_bf16 v[124:139], a[92:95], v[80:83], v[124:139]
  ds_read_b64_tr_b16 v[76:77], v40 offset:16384
  ds_read_b64_tr_b16 v[78:79], v40 offset:16896
  v_mfma_f32_32x32x16_bf16 v[140:155], a[220:223], v[80:83], v[140:155]
  s_waitcnt lgkmcnt(4)
  v_mfma_f32_32x32x16_bf16 v[124:139], a[96:99], v[68:71], v[124:139]
  ds_read_b64_tr_b16 v[80:81], v41 offset:16384
  ds_read_b64_tr_b16 v[82:83], v41 offset:16896
  v_mfma_f32_16x16x32_bf16 v[84:87], v[88:91], v[68:71], v[84:87]
  s_add_u32 m0, s72, 98304
  s_add_u32 s73, s0, 1
  s_and_b32 s73, s73, 3
  s_mul_i32 s73, s73, 393216
  s_add_u32 s73, s73, s82
  buffer_load_dwordx4 v9, s[24:27], s73 offen offset:0 lds
  buffer_load_dwordx4 v10, s[24:27], s73 offen offset:1024 lds
  buffer_load_dwordx4 v11, s[24:27], s73 offen offset:2048 lds
  buffer_load_dwordx4 v12, s[24:27], s73 offen offset:3072 lds
  v_mfma_f32_32x32x16_bf16 v[140:155], a[224:227], v[68:71], v[140:155]
  buffer_load_dwordx4 v[14:17], v47, s[8:11], 0 offen offset:0 sc1
  buffer_load_dwordx4 v[18:21], v47, s[8:11], 0 offen offset:1024 sc1
  buffer_load_dwordx4 v[22:25], v47, s[8:11], 0 offen offset:2048 sc1
  buffer_load_dwordx4 v[52:55], v47, s[8:11], 0 offen offset:3072 sc1
  buffer_load_dwordx4 v[248:251], v47, s[8:11], s93 offen offset:0 sc1
  buffer_load_dwordx4 v[252:255], v47, s[8:11], s93 offen offset:1024 sc1
  s_waitcnt lgkmcnt(4)
  v_mfma_f32_32x32x16_bf16 v[124:139], a[100:103], v[72:75], v[124:139]
  ds_read_b64_tr_b16 v[68:69], v38 offset:24576
  ds_read_b64_tr_b16 v[70:71], v38 offset:25088
  v_mfma_f32_32x32x16_bf16 v[140:155], a[228:231], v[72:75], v[140:155]
  s_waitcnt lgkmcnt(4)
  v_mfma_f32_32x32x16_bf16 v[124:139], a[104:107], v[76:79], v[124:139]
  ds_read_b64_tr_b16 v[72:73], v39 offset:24576
  ds_read_b64_tr_b16 v[74:75], v39 offset:25088
  v_mfma_f32_16x16x32_bf16 v[84:87], v[88:91], v[76:79], v[84:87]
  v_mfma_f32_32x32x16_bf16 v[140:155], a[232:235], v[76:79], v[140:155]
  s_waitcnt lgkmcnt(4)
  v_mfma_f32_32x32x16_bf16 v[124:139], a[108:111], v[80:83], v[124:139]
  ds_read_b64_tr_b16 v[76:77], v40 offset:24576
  ds_read_b64_tr_b16 v[78:79], v40 offset:25088
  v_mfma_f32_32x32x16_bf16 v[140:155], a[236:239], v[80:83], v[140:155]
  s_waitcnt lgkmcnt(4)
  v_mfma_f32_32x32x16_bf16 v[124:139], a[112:115], v[68:71], v[124:139]
  ds_read_b64_tr_b16 v[80:81], v41 offset:24576
  ds_read_b64_tr_b16 v[82:83], v41 offset:25088
  v_mfma_f32_16x16x32_bf16 v[84:87], v[88:91], v[68:71], v[84:87]
  v_mfma_f32_32x32x16_bf16 v[140:155], a[240:243], v[68:71], v[140:155]
  s_waitcnt vmcnt(10)
  s_barrier
  s_waitcnt lgkmcnt(4)
  v_mfma_f32_32x32x16_bf16 v[124:139], a[116:119], v[72:75], v[124:139]
  ds_read_b64_tr_b16 v[68:69], v34 offset:32768
  ds_read_b64_tr_b16 v[70:71], v34 offset:33280
  s_waitcnt lgkmcnt(4)
  v_mfma_f32_16x16x32_bf16 v[84:87], v[88:91], v[76:79], v[84:87]
  s_add_u32 m0, s72, 114688
  s_add_u32 s73, s0, 2
  s_and_b32 s73, s73, 3
  s_mul_i32 s73, s73, 393216
  s_add_u32 s73, s73, s82
  buffer_load_dwordx4 v9, s[24:27], s73 offen offset:0 lds
  buffer_load_dwordx4 v10, s[24:27], s73 offen offset:1024 lds
  buffer_load_dwordx4 v11, s[24:27], s73 offen offset:2048 lds
  buffer_load_dwordx4 v12, s[24:27], s73 offen offset:3072 lds
  v_mfma_f32_32x32x16_bf16 v[140:155], a[244:247], v[72:75], v[140:155]
  v_mfma_f32_32x32x16_bf16 v[124:139], a[120:123], v[76:79], v[124:139]
  ds_read_b64_tr_b16 v[72:73], v35 offset:32768
  ds_read_b64_tr_b16 v[74:75], v35 offset:33280
  v_mfma_f32_32x32x16_bf16 v[140:155], a[248:251], v[76:79], v[140:155]
  s_waitcnt lgkmcnt(4)
  v_mfma_f32_32x32x16_bf16 v[124:139], a[124:127], v[80:83], v[124:139]
  ds_read_b64_tr_b16 v[76:77], v36 offset:32768
  ds_read_b64_tr_b16 v[78:79], v36 offset:33280
  ds_write_b32 v49, v84 offset:512
  v_mfma_f32_32x32x16_bf16 v[140:155], a[252:255], v[80:83], v[140:155]
  s_waitcnt lgkmcnt(0)
  s_barrier
  v_mfma_f32_32x32x16_bf16 v[156:171], a[0:3], v[68:71], 0
  ds_read_b64_tr_b16 v[80:81], v37 offset:32768
  ds_read_b64_tr_b16 v[82:83], v37 offset:33280
  v_mfma_f32_16x16x32_bf16 v[84:87], v[88:91], v[68:71], 0
  v_mfma_f32_32x32x16_bf16 v[172:187], a[128:131], v[68:71], 0
  v_mfma_f32_32x32x16_bf16 v[156:171], a[4:7], v[72:75], v[156:171]
  ds_read_b64_tr_b16 v[68:69], v34 offset:40960
  ds_read_b64_tr_b16 v[70:71], v34 offset:41472
  v_mfma_f32_32x32x16_bf16 v[172:187], a[132:135], v[72:75], v[172:187]
  s_waitcnt vmcnt(9)
  v_xor_b32 v15, s71, v15
  v_xor_b32 v17, s71, v17
  s_waitcnt vmcnt(8)
  v_xor_b32 v19, s71, v19
  v_xor_b32 v21, s71, v21
  s_waitcnt vmcnt(7)
  v_xor_b32 v23, s71, v23
  v_xor_b32 v25, s71, v25
  s_waitcnt vmcnt(6)
  v_xor_b32 v53, s71, v53
  v_xor_b32 v55, s71, v55
  s_waitcnt vmcnt(5)
  v_xor_b32 v249, s71, v249
  v_xor_b32 v251, s71, v251
  s_waitcnt vmcnt(4)
  v_xor_b32 v253, s71, v253
  v_xor_b32 v255, s71, v255
  v_or3_b32 v15, v15, v17, v19
  v_or3_b32 v21, v21, v23, v25
  v_or3_b32 v53, v53, v55, v249
  v_or3_b32 v251, v251, v253, v255
  v_or3_b32 v15, v15, v21, v53
  v_or_b32 v15, v15, v251
  v_cmp_ne_u32 vcc, 0, v15
  s_nop 0
  s_cbranch_vccnz SLOW_STA
RET_STA:
  v_mfma_f32_32x32x16_bf16 v[156:171], a[8:11], v[76:79], v[156:171]
  ds_read_b64_tr_b16 v[72:73], v35 offset:40960
  ds_read_b64_tr_b16 v[74:75], v35 offset:41472
  v_add_f32 v14, v14, v16
  v_add_f32 v18, v18, v20
  v_add_f32 v22, v22, v24
  v_add_f32 v52, v52, v54
  v_add_f32_e64 v248, v248, v250
  v_mfma_f32_16x16x32_bf16 v[84:87], v[88:91], v[76:79], v[84:87]
  v_add_f32 v252, v252, v254
  v_add_f32 v14, v14, v18
  v_mfma_f32_32x32x16_bf16 v[172:187], a[136:139], v[76:79], v[172:187]
  v_add_f32 v22, v22, v52
  v_add_f32 v248, v248, v252
  v_add_f32 v14, v14, v22
  v_add_f32 v14, v14, v248
  v_mov_b32 v15, v14
  s_nop 1
  v_permlane32_swap_b32 v14, v15
  s_waitcnt lgkmcnt(4)
  v_mfma_f32_32x32x16_bf16 v[156:171], a[12:15], v[80:83], v[156:171]
  ds_read_b64_tr_b16 v[76:77], v36 offset:40960
  ds_read_b64_tr_b16 v[78:79], v36 offset:41472
  v_mul_f32 v14, 0xbabe82fa, v14
  v_mul_f32 v15, 0x3abe82fa, v15
  v_fma_f32 v15, -v14, v14, v15
  v_max_f32_e64 v15, 0, v15
  v_add_f32 v15, 0x3727c5ac, v15
  v_mfma_f32_32x32x16_bf16 v[172:187], a[140:143], v[80:83], v[172:187]
  v_rsq_f32 v15, v15
  v_cmp_gt_u32 vcc, 32, v1
  v_mul_f32_e64 v14, v14, v15
  s_lshl_b32 s74, s96, 8
  s_add_u32 s74, s74, s91
  v_lshl_add_u32 v16, v1, 2, s74
  s_waitcnt lgkmcnt(4)
  v_mfma_f32_32x32x16_bf16 v[156:171], a[16:19], v[68:71], v[156:171]
  ds_read_b64_tr_b16 v[80:81], v37 offset:40960
  ds_read_b64_tr_b16 v[82:83], v37 offset:41472
  v_cndmask_b32 v14, v15, v14, vcc
  ds_write_b32 v16, v14 offset:1024
  v_mfma_f32_16x16x32_bf16 v[84:87], v[88:91], v[68:71], v[84:87]
  v_mfma_f32_32x32x16_bf16 v[172:187], a[144:147], v[68:71], v[172:187]
  ds_read_b128 a[0:3], v26 offset:16384
  ds_read_b128 a[4:7], v27 offset:16384
  ds_read_b128 a[8:11], v28 offset:16384
  ds_read_b128 a[12:15], v29 offset:16384
  s_waitcnt lgkmcnt(4)
  s_barrier
  s_barrier
  v_mfma_f32_32x32x16_bf16 v[156:171], a[20:23], v[72:75], v[156:171]
  ds_read_b64_tr_b16 v[68:69], v38 offset:32768
  ds_read_b64_tr_b16 v[70:71], v38 offset:33280
  s_add_u32 m0, s72, 81920
  s_add_u32 s73, s0, 3
  s_and_b32 s73, s73, 3
  s_mul_i32 s73, s73, 393216
  s_add_u32 s73, s73, s82
  buffer_load_dwordx4 v9, s[24:27], s73 offen offset:0 lds
  buffer_load_dwordx4 v10, s[24:27], s73 offen offset:1024 lds
  buffer_load_dwordx4 v11, s[24:27], s73 offen offset:2048 lds
  buffer_load_dwordx4 v12, s[24:27], s73 offen offset:3072 lds
  v_mfma_f32_32x32x16_bf16 v[172:187], a[148:151], v[72:75], v[172:187]
  ds_read_b32 v204, v43 offset:1024
  ds_read_b32 v205, v43 offset:1152
  ds_read_b32 v228, v43 offset:1280
  ds_read_b32 v229, v43 offset:1408
  s_waitcnt lgkmcnt(2)
  v_fma_f32 v92, v92, v205, v204
  v_fma_f32 v93, v93, v205, v204
  v_mfma_f32_32x32x16_bf16 v[156:171], a[24:27], v[76:79], v[156:171]
  ds_read_b64_tr_b16 v[72:73], v39 offset:32768
  ds_read_b64_tr_b16 v[74:75], v39 offset:33280
  v_fma_f32 v94, v94, v205, v204
  v_fma_f32 v95, v95, v205, v204
  v_fma_f32 v96, v96, v205, v204
  v_fma_f32 v97, v97, v205, v204
  v_mfma_f32_16x16x32_bf16 v[84:87], v[88:91], v[76:79], v[84:87]
  s_add_u32 m0, s72, 16384
  s_add_u32 s73, s1, 2
  s_and_b32 s73, s73, 7
  s_mul_i32 s73, s73, 128
  s_add_u32 s73, s73, s79
  buffer_load_dwordx4 v5, s[32:35], s73 offen offset:0 lds
  buffer_load_dwordx4 v6, s[32:35], s73 offen offset:1024 lds
  buffer_load_dwordx4 v7, s[32:35], s73 offen offset:2048 lds
  buffer_load_dwordx4 v8, s[32:35], s73 offen offset:3072 lds
  v_mfma_f32_32x32x16_bf16 v[172:187], a[152:155], v[76:79], v[172:187]
  v_fma_f32 v98, v98, v205, v204
  v_fma_f32 v99, v99, v205, v204
  v_fma_f32 v100, v100, v205, v204
  v_fma_f32 v101, v101, v205, v204
  v_fma_f32 v102, v102, v205, v204
  v_fma_f32 v103, v103, v205, v204
  v_mfma_f32_32x32x16_bf16 v[156:171], a[28:31], v[80:83], v[156:171]
  ds_read_b64_tr_b16 v[76:77], v40 offset:32768
  ds_read_b64_tr_b16 v[78:79], v40 offset:33280
  v_fma_f32 v104, v104, v205, v204
  v_fma_f32 v105, v105, v205, v204
  v_fma_f32 v106, v106, v205, v204
  v_fma_f32 v107, v107, v205, v204
  v_mfma_f32_32x32x16_bf16 v[172:187], a[156:159], v[80:83], v[172:187]
  v_cvt_pk_bf16_f32 v208, v92, v93
  v_cvt_pk_bf16_f32 v209, v94, v95
  v_cvt_pk_bf16_f32 v210, v96, v97
  v_cvt_pk_bf16_f32 v211, v98, v99
  v_cvt_pk_bf16_f32 v212, v100, v101
  v_cvt_pk_bf16_f32 v213, v102, v103
  v_mfma_f32_32x32x16_bf16 v[156:171], a[32:35], v[68:71], v[156:171]
  ds_read_b64_tr_b16 v[80:81], v41 offset:32768
  ds_read_b64_tr_b16 v[82:83], v41 offset:33280
  v_cvt_pk_bf16_f32 v214, v104, v105
  v_cvt_pk_bf16_f32 v215, v106, v107
  ds_write_b64 v13, v[208:209] offset:0
  ds_write_b64 v13, v[210:211] offset:16
  v_mfma_f32_16x16x32_bf16 v[84:87], v[88:91], v[68:71], v[84:87]
  ds_write_b64 v13, v[212:213] offset:32
  ds_write_b64 v13, v[214:215] offset:48
  v_mfma_f32_32x32x16_bf16 v[172:187], a[160:163], v[68:71], v[172:187]
  ds_read_b128 a[128:131], v26 offset:49152
  ds_read_b128 a[132:135], v27 offset:49152
  ds_read_b128 a[136:139], v28 offset:49152
  ds_read_b128 a[140:143], v29 offset:49152
  ds_read_b64_tr_b16 v[216:217], v46 offset:0
  ds_read_b64_tr_b16 v[218:219], v46 offset:288
  s_waitcnt lgkmcnt(14)
  v_mfma_f32_32x32x16_bf16 v[156:171], a[36:39], v[72:75], v[156:171]
  ds_read_b64_tr_b16 v[68:69], v38 offset:40960
  ds_read_b64_tr_b16 v[70:71], v38 offset:41472
  ds_read_b64_tr_b16 v[220:221], v46 offset:1152
  ds_read_b64_tr_b16 v[222:223], v46 offset:1440
  s_waitcnt lgkmcnt(4)
  buffer_store_dwordx4 v[216:219], v2, s[8:11], s100 offen offset:0 sc1
  s_waitcnt lgkmcnt(0)
  buffer_store_dwordx4 v[220:223], v2, s[8:11], s100 offen offset:1024 sc1
  v_mfma_f32_32x32x16_bf16 v[172:187], a[164:167], v[72:75], v[172:187]
  v_fma_f32 v108, v108, v229, v228
  v_fma_f32 v109, v109, v229, v228
  v_fma_f32 v110, v110, v229, v228
  v_fma_f32 v111, v111, v229, v228
  v_fma_f32 v112, v112, v229, v228
  v_fma_f32 v113, v113, v229, v228
  v_mfma_f32_32x32x16_bf16 v[156:171], a[40:43], v[76:79], v[156:171]
  ds_read_b64_tr_b16 v[72:73], v39 offset:40960
  ds_read_b64_tr_b16 v[74:75], v39 offset:41472
  v_fma_f32 v114, v114, v229, v228
  v_fma_f32 v115, v115, v229, v228
  v_fma_f32 v116, v116, v229, v228
  v_fma_f32 v117, v117, v229, v228
  v_mfma_f32_16x16x32_bf16 v[84:87], v[88:91], v[76:79], v[84:87]
  s_add_u32 m0, s72, 49152
  s_add_u32 s73, s1, 2
  s_and_b32 s73, s73, 7
  s_mul_i32 s73, s73, 128
  s_add_u32 s73, s73, s78
  buffer_load_dwordx4 v5, s[32:35], s73 offen offset:0 lds
  buffer_load_dwordx4 v6, s[32:35], s73 offen offset:1024 lds
  buffer_load_dwordx4 v7, s[32:35], s73 offen offset:2048 lds
  buffer_load_dwordx4 v8, s[32:35], s73 offen offset:3072 lds
  v_mfma_f32_32x32x16_bf16 v[172:187], a[168:171], v[76:79], v[172:187]
  v_fma_f32 v118, v118, v229, v228
  v_fma_f32 v119, v119, v229, v228
  v_fma_f32 v120, v120, v229, v228
  v_fma_f32 v121, v121, v229, v228
  v_fma_f32 v122, v122, v229, v228
  v_fma_f32 v123, v123, v229, v228
  v_mfma_f32_32x32x16_bf16 v[156:171], a[44:47], v[80:83], v[156:171]
  ds_read_b64_tr_b16 v[76:77], v40 offset:40960
  ds_read_b64_tr_b16 v[78:79], v40 offset:41472
  v_cvt_pk_bf16_f32 v232, v108, v109
  v_cvt_pk_bf16_f32 v233, v110, v111
  v_cvt_pk_bf16_f32 v234, v112, v113
  v_cvt_pk_bf16_f32 v235, v114, v115
  v_mfma_f32_32x32x16_bf16 v[172:187], a[172:175], v[80:83], v[172:187]
  v_cvt_pk_bf16_f32 v236, v116, v117
  v_cvt_pk_bf16_f32 v237, v118, v119
  v_cvt_pk_bf16_f32 v238, v120, v121
  v_cvt_pk_bf16_f32 v239, v122, v123
  ds_write_b64 v13, v[232:233] offset:0
  ds_write_b64 v13, v[234:235] offset:16
  v_mfma_f32_32x32x16_bf16 v[156:171], a[48:51], v[68:71], v[156:171]
  ds_read_b64_tr_b16 v[80:81], v41 offset:40960
  ds_read_b64_tr_b16 v[82:83], v41 offset:41472
  ds_write_b64 v13, v[236:237] offset:32
  ds_write_b64 v13, v[238:239] offset:48
  ds_read_b64_tr_b16 v[240:241], v46 offset:0
  ds_read_b64_tr_b16 v[242:243], v46 offset:288
  v_mfma_f32_16x16x32_bf16 v[84:87], v[88:91], v[68:71], v[84:87]
  ds_read_b64_tr_b16 v[244:245], v46 offset:1152
  ds_read_b64_tr_b16 v[246:247], v46 offset:1440
  v_mfma_f32_32x32x16_bf16 v[172:187], a[176:179], v[68:71], v[172:187]
  s_waitcnt vmcnt(14)
  s_barrier
  s_waitcnt lgkmcnt(2)
  buffer_store_dwordx4 v[240:243], v2, s[8:11], s100 offen offset:2048 sc1
  s_waitcnt lgkmcnt(0)
  buffer_store_dwordx4 v[244:247], v2, s[8:11], s100 offen offset:3072 sc1
  s_nop 0
  ds_read_b32 v244, v45 offset:512
  ds_read_b32 v245, v45 offset:768
  ds_read_b128 v[204:207], v42 offset:0
  v_mfma_f32_32x32x16_bf16 v[156:171], a[52:55], v[72:75], v[156:171]
  ds_read_b64_tr_b16 v[68:69], v38 offset:49152
  ds_read_b64_tr_b16 v[70:71], v38 offset:49664
  s_add_u32 m0, s72, 32768
  s_add_u32 s73, s1, 4
  s_and_b32 s73, s73, 7
  s_mul_i32 s73, s73, 128
  s_add_u32 s73, s73, s79
  buffer_load_dwordx4 v5, s[32:35], s73 offen offset:0 lds
  buffer_load_dwordx4 v6, s[32:35], s73 offen offset:1024 lds
  buffer_load_dwordx4 v7, s[32:35], s73 offen offset:2048 lds
  buffer_load_dwordx4 v8, s[32:35], s73 offen offset:3072 lds
  v_mfma_f32_32x32x16_bf16 v[172:187], a[180:183], v[72:75], v[172:187]
  ds_read_b128 v[212:215], v42 offset:128
  ds_read_b128 v[208:211], v42 offset:32
  ds_read_b128 v[216:219], v42 offset:160
  ds_read_b128 v[220:223], v42 offset:64
  ds_read_b128 v[228:231], v42 offset:192
  ds_read_b128 v[224:227], v42 offset:96
  v_mfma_f32_32x32x16_bf16 v[156:171], a[56:59], v[76:79], v[156:171]
  ds_read_b64_tr_b16 v[72:73], v39 offset:49152
  ds_read_b64_tr_b16 v[74:75], v39 offset:49664
  ds_read_b128 v[232:235], v42 offset:224
  s_waitcnt lgkmcnt(12)
  v_add_f32 v244, v244, v245
  s_waitcnt lgkmcnt(11)
  v_fmac_f32 v124, v204, v244
  v_fmac_f32_e64 v125, v205, v244
  v_mfma_f32_16x16x32_bf16 v[84:87], v[88:91], v[76:79], v[84:87]
  v_fmac_f32 v126, v206, v244
  v_fmac_f32 v127, v207, v244
  v_mfma_f32_32x32x16_bf16 v[172:187], a[184:187], v[76:79], v[172:187]
  ds_read_b128 a[16:19], v26 offset:0
  ds_read_b128 a[20:23], v27 offset:0
  ds_read_b128 a[24:27], v28 offset:0
  ds_read_b128 a[28:31], v29 offset:0
  s_waitcnt lgkmcnt(11)
  v_fmac_f32 v128, v208, v244
  v_fmac_f32_e64 v129, v209, v244
  v_mfma_f32_32x32x16_bf16 v[156:171], a[60:63], v[80:83], v[156:171]
  ds_read_b64_tr_b16 v[76:77], v40 offset:49152
  ds_read_b64_tr_b16 v[78:79], v40 offset:49664
  v_fmac_f32 v130, v210, v244
  v_fmac_f32 v131, v211, v244
  v_fma_f32 v124, v124, v212, s84
  v_fma_f32 v125, v125, v213, s84
  v_mfma_f32_32x32x16_bf16 v[172:187], a[188:191], v[80:83], v[172:187]
  v_fma_f32 v126, v126, v214, s84
  v_fma_f32 v127, v127, v215, s84
  s_waitcnt lgkmcnt(12)
  v_fma_f32 v128, v128, v216, s84
  v_fma_f32 v129, v129, v217, s84
  v_fma_f32 v130, v130, v218, s84
  v_fma_f32 v131, v131, v219, s84
  v_mfma_f32_32x32x16_bf16 v[156:171], a[64:67], v[68:71], v[156:171]
  ds_read_b64_tr_b16 v[80:81], v41 offset:49152
  ds_read_b64_tr_b16 v[82:83], v41 offset:49664
  ds_read_b128 v[204:207], v42 offset:256
  ds_read_b128 v[212:215], v42 offset:384
  ds_read_b128 v[208:211], v42 offset:288
  ds_read_b128 v[216:219], v42 offset:416
  v_mfma_f32_16x16x32_bf16 v[84:87], v[88:91], v[68:71], v[84:87]
  s_waitcnt lgkmcnt(8)
  s_add_u32 m0, s72, 0
  s_add_u32 s73, s1, 3
  s_and_b32 s73, s73, 7
  s_mul_i32 s73, s73, 128
  s_add_u32 s73, s73, s79
  buffer_load_dwordx4 v5, s[32:35], s73 offen offset:0 lds
  buffer_load_dwordx4 v6, s[32:35], s73 offen offset:1024 lds
  buffer_load_dwordx4 v7, s[32:35], s73 offen offset:2048 lds
  buffer_load_dwordx4 v8, s[32:35], s73 offen offset:3072 lds
  v_mfma_f32_32x32x16_bf16 v[172:187], a[192:195], v[68:71], v[172:187]
  v_mul_f32 v236, s86, v124
  v_mul_f32 v237, s86, v125
  v_mul_f32 v238, s86, v126
  v_mul_f32 v239, s86, v127
  v_mul_f32 v240, s86, v128
  v_mul_f32 v241, s86, v129
  v_mfma_f32_32x32x16_bf16 v[156:171], a[68:71], v[72:75], v[156:171]
  ds_read_b64_tr_b16 v[68:69], v38 offset:57344
  ds_read_b64_tr_b16 v[70:71], v38 offset:57856
  v_mul_f32 v242, s86, v130
  v_mul_f32 v243, s86, v131
  v_exp_f32_e64 v236, v236 clamp
  v_mfma_f32_32x32x16_bf16 v[172:187], a[196:199], v[72:75], v[172:187]
  v_exp_f32_e64 v237, v237 clamp
  v_exp_f32_e64 v238, v238 clamp
  v_exp_f32_e64 v239, v239 clamp
  s_waitcnt lgkmcnt(8)
  v_mfma_f32_32x32x16_bf16 v[156:171], a[72:75], v[76:79], v[156:171]
  ds_read_b64_tr_b16 v[72:73], v39 offset:57344
  ds_read_b64_tr_b16 v[74:75], v39 offset:57856
  v_exp_f32_e64 v240, v240 clamp
  v_exp_f32_e64 v241, v241 clamp
  v_mfma_f32_16x16x32_bf16 v[84:87], v[88:91], v[76:79], v[84:87]
  v_exp_f32_e64 v242, v242 clamp
  v_mfma_f32_32x32x16_bf16 v[172:187], a[200:203], v[76:79], v[172:187]
  v_exp_f32_e64 v243, v243 clamp
  v_max_f32 v124, s84, v124
  v_max_f32 v125, s84, v125
  v_max_f32 v126, s84, v126
  v_max_f32 v127, s84, v127
  s_waitcnt lgkmcnt(8)
  v_mfma_f32_32x32x16_bf16 v[156:171], a[76:79], v[80:83], v[156:171]
  ds_read_b64_tr_b16 v[76:77], v40 offset:57344
  ds_read_b64_tr_b16 v[78:79], v40 offset:57856
  v_max_f32 v128, s84, v128
  v_max_f32 v129, s84, v129
  v_max_f32 v130, s84, v130
  v_max_f32 v131, s84, v131
  v_mfma_f32_32x32x16_bf16 v[172:187], a[204:207], v[80:83], v[172:187]
  v_add_f32 v124, v124, v236
  v_add_f32 v125, v125, v237
  v_add_f32 v126, v126, v238
  v_add_f32 v127, v127, v239
  v_add_f32 v128, v128, v240
  v_add_f32_e64 v129, v129, v241
  s_waitcnt vmcnt(8)
  s_lshr_b32 s74, s80, 6
  s_add_u32 s74, s74, s96
  s_lshl_b32 s74, s74, 7
  s_lshr_b32 s75, s90, 1
  s_lshl_b32 s75, s75, 2
  s_add_u32 s74, s74, s75
  s_add_u32 s74, s74, 1536
  v_mov_b32 v3, s71
  s_mov_b64 exec, 1
  buffer_store_dword v3, off, s[8:11], s74 sc1
  s_mov_b64 exec, -1
  s_waitcnt lgkmcnt(4)
  v_mfma_f32_32x32x16_bf16 v[156:171], a[80:83], v[68:71], v[156:171]
  ds_read_b64_tr_b16 v[80:81], v41 offset:57344
  ds_read_b64_tr_b16 v[82:83], v41 offset:57856
  v_add_f32 v130, v130, v242
  v_add_f32 v131, v131, v243
  v_cvt_pk_bf16_f32 v188, v124, v125
  v_cvt_pk_bf16_f32 v189, v126, v127
  v_mfma_f32_16x16x32_bf16 v[84:87], v[88:91], v[68:71], v[84:87]
  v_cvt_pk_bf16_f32 v190, v128, v129
  v_cvt_pk_bf16_f32 v191, v130, v131
  v_mfma_f32_32x32x16_bf16 v[172:187], a[208:211], v[68:71], v[172:187]
  s_barrier
  v_fmac_f32 v132, v220, v244
  v_fmac_f32 v133, v221, v244
  v_fmac_f32 v134, v222, v244
  v_fmac_f32 v135, v223, v244
  v_fmac_f32_e64 v136, v224, v244
  s_waitcnt lgkmcnt(4)
  v_mfma_f32_32x32x16_bf16 v[156:171], a[84:87], v[72:75], v[156:171]
  ds_read_b64_tr_b16 v[68:69], v38 offset:16384
  ds_read_b64_tr_b16 v[70:71], v38 offset:16896
  s_add_u32 m0, s72, 98304
  s_add_u32 s73, s1, 4
  s_and_b32 s73, s73, 7
  s_mul_i32 s73, s73, 128
  s_add_u32 s73, s73, s78
  buffer_load_dwordx4 v5, s[32:35], s73 offen offset:0 lds
  buffer_load_dwordx4 v6, s[32:35], s73 offen offset:1024 lds
  buffer_load_dwordx4 v7, s[32:35], s73 offen offset:2048 lds
  buffer_load_dwordx4 v8, s[32:35], s73 offen offset:3072 lds
  v_mfma_f32_32x32x16_bf16 v[172:187], a[212:215], v[72:75], v[172:187]
  v_fmac_f32 v137, v225, v244
  v_fmac_f32 v138, v226, v244
  v_fmac_f32 v139, v227, v244
  v_fma_f32 v132, v132, v228, s84
  v_fma_f32 v133, v133, v229, s84
  v_fma_f32 v134, v134, v230, s84
  s_waitcnt lgkmcnt(4)
  v_mfma_f32_32x32x16_bf16 v[156:171], a[88:91], v[76:79], v[156:171]
  ds_read_b64_tr_b16 v[72:73], v39 offset:16384
  ds_read_b64_tr_b16 v[74:75], v39 offset:16896
  v_fma_f32 v135, v135, v231, s84
  v_fma_f32 v136, v136, v232, s84
  v_fma_f32 v137, v137, v233, s84
  v_fma_f32 v138, v138, v234, s84
  v_mfma_f32_16x16x32_bf16 v[84:87], v[88:91], v[76:79], v[84:87]
  v_fma_f32 v139, v139, v235, s84
  ds_read_b128 v[220:223], v42 offset:320
  v_mfma_f32_32x32x16_bf16 v[172:187], a[216:219], v[76:79], v[172:187]
  ds_read_b128 a[144:147], v30 offset:0
  ds_read_b128 a[148:151], v31 offset:0
  ds_read_b128 a[152:155], v32 offset:0
  ds_read_b128 a[156:159], v33 offset:0
  ds_read_b128 v[228:231], v42 offset:448
  ds_read_b128 v[224:227], v42 offset:352
  s_waitcnt lgkmcnt(11)
  v_mfma_f32_32x32x16_bf16 v[156:171], a[92:95], v[80:83], v[156:171]
  ds_read_b64_tr_b16 v[76:77], v40 offset:16384
  ds_read_b64_tr_b16 v[78:79], v40 offset:16896
  ds_read_b128 v[232:235], v42 offset:480
  v_mul_f32 v236, s86, v132
  v_mul_f32 v237, s86, v133
  v_mul_f32_e64 v238, s86, v134
  v_mfma_f32_32x32x16_bf16 v[172:187], a[220:223], v[80:83], v[172:187]
  v_mul_f32 v239, s86, v135
  v_mul_f32 v240, s86, v136
  v_mul_f32 v241, s86, v137
  v_mul_f32 v242, s86, v138
  v_mul_f32 v243, s86, v139
  s_waitcnt lgkmcnt(12)
  v_mfma_f32_32x32x16_bf16 v[156:171], a[96:99], v[68:71], v[156:171]
  ds_read_b64_tr_b16 v[80:81], v41 offset:16384
  ds_read_b64_tr_b16 v[82:83], v41 offset:16896
  v_exp_f32_e64 v236, v236 clamp
  v_exp_f32_e64 v237, v237 clamp
  v_mfma_f32_16x16x32_bf16 v[84:87], v[88:91], v[68:71], v[84:87]
  s_waitcnt lgkmcnt(7)
  s_add_u32 m0, s72, 65536
  s_add_u32 s73, s1, 3
  s_and_b32 s73, s73, 7
  s_mul_i32 s73, s73, 128
  s_add_u32 s73, s73, s78
  buffer_load_dwordx4 v5, s[32:35], s73 offen offset:0 lds
  buffer_load_dwordx4 v6, s[32:35], s73 offen offset:1024 lds
  buffer_load_dwordx4 v7, s[32:35], s73 offen offset:2048 lds
  buffer_load_dwordx4 v8, s[32:35], s73 offen offset:3072 lds
  v_mfma_f32_32x32x16_bf16 v[172:187], a[224:227], v[68:71], v[172:187]
  v_exp_f32_e64 v238, v238 clamp
  v_exp_f32_e64 v239, v239 clamp
  v_exp_f32_e64 v240, v240 clamp
  v_mfma_f32_32x32x16_bf16 v[156:171], a[100:103], v[72:75], v[156:171]
  ds_read_b64_tr_b16 v[68:69], v38 offset:24576
  ds_read_b64_tr_b16 v[70:71], v38 offset:25088
  v_exp_f32_e64 v241, v241 clamp
  v_exp_f32_e64 v242, v242 clamp
  v_mfma_f32_32x32x16_bf16 v[172:187], a[228:231], v[72:75], v[172:187]
  v_exp_f32_e64 v243, v243 clamp
  v_max_f32 v132, s84, v132
  v_max_f32 v133, s84, v133
  v_max_f32 v134, s84, v134
  v_max_f32_e64 v135, s84, v135
  s_waitcnt lgkmcnt(5)
  v_mfma_f32_32x32x16_bf16 v[156:171], a[104:107], v[76:79], v[156:171]
  ds_read_b64_tr_b16 v[72:73], v39 offset:24576
  ds_read_b64_tr_b16 v[74:75], v39 offset:25088
  v_max_f32 v136, s84, v136
  v_max_f32 v137, s84, v137
  v_max_f32 v138, s84, v138
  v_max_f32 v139, s84, v139
  v_mfma_f32_16x16x32_bf16 v[84:87], v[88:91], v[76:79], v[84:87]
  v_add_f32 v132, v132, v236
  v_add_f32 v133, v133, v237
  v_mfma_f32_32x32x16_bf16 v[172:187], a[232:235], v[76:79], v[172:187]
  v_add_f32 v134, v134, v238
  v_add_f32 v135, v135, v239
  v_add_f32 v136, v136, v240
  v_add_f32 v137, v137, v241
  v_add_f32 v138, v138, v242
  v_add_f32_e64 v139, v139, v243
  s_waitcnt lgkmcnt(4)
  v_mfma_f32_32x32x16_bf16 v[156:171], a[108:111], v[80:83], v[156:171]
  ds_read_b64_tr_b16 v[76:77], v40 offset:24576
  ds_read_b64_tr_b16 v[78:79], v40 offset:25088
  v_cvt_pk_bf16_f32 v192, v132, v133
  v_cvt_pk_bf16_f32 v193, v134, v135
  v_cvt_pk_bf16_f32 v194, v136, v137
  v_cvt_pk_bf16_f32 v195, v138, v139
  v_mfma_f32_32x32x16_bf16 v[172:187], a[236:239], v[80:83], v[172:187]
  v_fmac_f32 v140, v204, v244
  v_fmac_f32 v141, v205, v244
  v_fmac_f32 v142, v206, v244
  v_fmac_f32 v143, v207, v244
  v_fmac_f32 v144, v208, v244
  v_fmac_f32_e64 v145, v209, v244
  s_waitcnt lgkmcnt(4)
  v_mfma_f32_32x32x16_bf16 v[156:171], a[112:115], v[68:71], v[156:171]
  ds_read_b64_tr_b16 v[80:81], v41 offset:24576
  ds_read_b64_tr_b16 v[82:83], v41 offset:25088
  v_fmac_f32 v146, v210, v244
  v_fmac_f32 v147, v211, v244
  v_fma_f32 v140, v140, v212, s84
  v_fma_f32 v141, v141, v213, s84
  v_mfma_f32_16x16x32_bf16 v[84:87], v[88:91], v[68:71], v[84:87]
  v_fma_f32 v142, v142, v214, s84
  v_fma_f32 v143, v143, v215, s84
  v_mfma_f32_32x32x16_bf16 v[172:187], a[240:243], v[68:71], v[172:187]
  s_barrier
  v_fma_f32 v144, v144, v216, s84
  v_fma_f32 v145, v145, v217, s84
  v_fma_f32 v146, v146, v218, s84
  v_fma_f32 v147, v147, v219, s84
  v_mul_f32_e64 v236, s86, v140
  s_waitcnt lgkmcnt(4)
  v_mfma_f32_32x32x16_bf16 v[156:171], a[116:119], v[72:75], v[156:171]
  v_mul_f32 v237, s86, v141
  v_mul_f32 v238, s86, v142
  v_mul_f32 v239, s86, v143
  v_mul_f32 v240, s86, v144
  v_mul_f32 v241, s86, v145
  v_mul_f32_e64 v242, s86, v146
  s_waitcnt lgkmcnt(2)
  v_mfma_f32_16x16x32_bf16 v[84:87], v[88:91], v[76:79], v[84:87]
  s_add_u32 m0, s72, 114688
  s_add_u32 s73, s1, 5
  s_and_b32 s73, s73, 7
  s_mul_i32 s73, s73, 128
  s_add_u32 s73, s73, s79
  buffer_load_dwordx4 v5, s[32:35], s73 offen offset:0 lds
  buffer_load_dwordx4 v6, s[32:35], s73 offen offset:1024 lds
  buffer_load_dwordx4 v7, s[32:35], s73 offen offset:2048 lds
  buffer_load_dwordx4 v8, s[32:35], s73 offen offset:3072 lds
  v_mfma_f32_32x32x16_bf16 v[172:187], a[244:247], v[72:75], v[172:187]
  v_mul_f32 v243, s86, v147
  v_exp_f32_e64 v236, v236 clamp
  v_exp_f32_e64 v237, v237 clamp
  v_mfma_f32_32x32x16_bf16 v[156:171], a[120:123], v[76:79], v[156:171]
  v_exp_f32_e64 v238, v238 clamp
  v_exp_f32_e64 v239, v239 clamp
  v_exp_f32_e64 v240, v240 clamp
  v_mfma_f32_32x32x16_bf16 v[172:187], a[248:251], v[76:79], v[172:187]
  v_exp_f32_e64 v241, v241 clamp
  v_exp_f32_e64 v242, v242 clamp
  v_exp_f32_e64 v243, v243 clamp
  s_waitcnt lgkmcnt(0)
  v_mfma_f32_32x32x16_bf16 v[156:171], a[124:127], v[80:83], v[156:171]
  ds_write_b32 v49, v84 offset:1024
  v_max_f32 v140, s84, v140
  v_max_f32 v141, s84, v141
  v_max_f32 v142, s84, v142
  v_max_f32 v143, s84, v143
  v_max_f32 v144, s84, v144
  v_mfma_f32_32x32x16_bf16 v[172:187], a[252:255], v[80:83], v[172:187]
  v_max_f32 v145, s84, v145
  v_max_f32 v146, s84, v146
  v_max_f32 v147, s84, v147
  v_add_f32 v140, v140, v236
  v_add_f32 v141, v141, v237
  v_add_f32 v142, v142, v238
  v_add_f32 v143, v143, v239
  v_add_f32 v144, v144, v240
  v_add_f32 v145, v145, v241
  v_add_f32 v146, v146, v242
  v_add_f32_e64 v147, v147, v243
  v_cvt_pk_bf16_f32 v196, v140, v141
  v_cvt_pk_bf16_f32 v197, v142, v143
  v_cvt_pk_bf16_f32 v198, v144, v145
  v_cvt_pk_bf16_f32 v199, v146, v147
  v_fmac_f32 v148, v220, v244
  v_fmac_f32 v149, v221, v244
  v_fmac_f32 v150, v222, v244
  v_fmac_f32 v151, v223, v244
  v_fmac_f32 v152, v224, v244
  v_fmac_f32 v153, v225, v244
  v_fmac_f32 v154, v226, v244
  v_fmac_f32 v155, v227, v244
  v_fma_f32 v148, v148, v228, s84
  v_fma_f32 v149, v149, v229, s84
  v_fma_f32 v150, v150, v230, s84
  v_fma_f32 v151, v151, v231, s84
  v_fma_f32 v152, v152, v232, s84
  v_fma_f32 v153, v153, v233, s84
  v_fma_f32 v154, v154, v234, s84
  v_fma_f32 v155, v155, v235, s84
  v_mul_f32 v236, s86, v148
  v_mul_f32 v237, s86, v149
  v_mul_f32 v238, s86, v150
  v_mul_f32 v239, s86, v151
  v_mul_f32 v240, s86, v152
  v_mul_f32 v241, s86, v153
  v_mul_f32 v242, s86, v154
  v_mul_f32 v243, s86, v155
  v_exp_f32_e64 v236, v236 clamp
  v_exp_f32_e64 v237, v237 clamp
  v_exp_f32_e64 v238, v238 clamp
  v_exp_f32_e64 v239, v239 clamp
  v_exp_f32_e64 v240, v240 clamp
  v_exp_f32_e64 v241, v241 clamp
  v_exp_f32_e64 v242, v242 clamp
  v_exp_f32_e64 v243, v243 clamp
  v_max_f32 v148, s84, v148
  v_max_f32 v149, s84, v149
  v_max_f32 v150, s84, v150
  v_max_f32 v151, s84, v151
  v_max_f32 v152, s84, v152
  v_max_f32 v153, s84, v153
  v_max_f32 v154, s84, v154
  v_max_f32 v155, s84, v155
  v_add_f32 v148, v148, v236
  v_add_f32 v149, v149, v237
  v_add_f32 v150, v150, v238
  v_add_f32 v151, v151, v239
  v_add_f32 v152, v152, v240
  v_add_f32 v153, v153, v241
  v_add_f32 v154, v154, v242
  v_add_f32 v155, v155, v243
  v_cvt_pk_bf16_f32 v200, v148, v149
  v_cvt_pk_bf16_f32 v201, v150, v151
  v_cvt_pk_bf16_f32 v202, v152, v153
  v_cvt_pk_bf16_f32 v203, v154, v155
  s_waitcnt lgkmcnt(0)
  s_barrier
  s_add_u32 m0, s72, 81920
  s_add_u32 s73, s1, 5
  s_and_b32 s73, s73, 7
  s_mul_i32 s73, s73, 128
  s_add_u32 s73, s73, s78
  buffer_load_dwordx4 v5, s[32:35], s73 offen offset:0 lds
  buffer_load_dwordx4 v6, s[32:35], s73 offen offset:1024 lds
  buffer_load_dwordx4 v7, s[32:35], s73 offen offset:2048 lds
  buffer_load_dwordx4 v8, s[32:35], s73 offen offset:3072 lds
  ds_read_b32 v244, v45 offset:1024
  ds_read_b32 v245, v45 offset:1280
  ds_read_b128 v[204:207], v42 offset:0
  ds_read_b128 v[212:215], v42 offset:128
  ds_read_b128 v[208:211], v42 offset:32
  ds_read_b128 v[216:219], v42 offset:160
  ds_read_b128 v[220:223], v42 offset:64
  ds_read_b128 v[228:231], v42 offset:192
  ds_read_b128 v[224:227], v42 offset:96
  ds_read_b128 v[232:235], v42 offset:224
  s_waitcnt lgkmcnt(8)
  v_add_f32 v244, v244, v245
  s_waitcnt lgkmcnt(7)
  v_pk_fma_f32 v[156:157], v[204:205], v[244:245], v[156:157] op_sel:[0,0,0] op_sel_hi:[1,0,1]
  v_pk_fma_f32 v[158:159], v[206:207], v[244:245], v[158:159] op_sel:[0,0,0] op_sel_hi:[1,0,1]
  s_waitcnt lgkmcnt(5)
  v_pk_fma_f32 v[160:161], v[208:209], v[244:245], v[160:161] op_sel:[0,0,0] op_sel_hi:[1,0,1]
  v_pk_fma_f32 v[162:163], v[210:211], v[244:245], v[162:163] op_sel:[0,0,0] op_sel_hi:[1,0,1]
  v_pk_mul_f32 v[156:157], v[156:157], v[212:213] op_sel:[0,0] op_sel_hi:[1,1]
  v_pk_mul_f32 v[158:159], v[158:159], v[214:215] op_sel:[0,0] op_sel_hi:[1,1]
  s_waitcnt lgkmcnt(4)
  v_pk_mul_f32 v[160:161], v[160:161], v[216:217] op_sel:[0,0] op_sel_hi:[1,1]
  v_pk_mul_f32 v[162:163], v[162:163], v[218:219] op_sel:[0,0] op_sel_hi:[1,1]
  ds_read_b128 v[204:207], v42 offset:256
  ds_read_b128 v[212:215], v42 offset:384
  ds_read_b128 v[208:211], v42 offset:288
  ds_read_b128 v[216:219], v42 offset:416
  v_cvt_pk_bf16_f32 v92, v156, v157
  v_cvt_pk_bf16_f32 v93, v158, v159
  v_cvt_pk_bf16_f32 v94, v160, v161
  v_cvt_pk_bf16_f32 v95, v162, v163
  s_waitcnt lgkmcnt(7)
  v_pk_fma_f32 v[164:165], v[220:221], v[244:245], v[164:165] op_sel:[0,0,0] op_sel_hi:[1,0,1]
  v_pk_fma_f32 v[166:167], v[222:223], v[244:245], v[166:167] op_sel:[0,0,0] op_sel_hi:[1,0,1]
  s_waitcnt lgkmcnt(5)
  v_pk_fma_f32 v[168:169], v[224:225], v[244:245], v[168:169] op_sel:[0,0,0] op_sel_hi:[1,0,1]
  v_pk_fma_f32 v[170:171], v[226:227], v[244:245], v[170:171] op_sel:[0,0,0] op_sel_hi:[1,0,1]
  v_pk_mul_f32 v[164:165], v[164:165], v[228:229] op_sel:[0,0] op_sel_hi:[1,1]
  v_pk_mul_f32 v[166:167], v[166:167], v[230:231] op_sel:[0,0] op_sel_hi:[1,1]
  s_waitcnt lgkmcnt(4)
  v_pk_mul_f32 v[168:169], v[168:169], v[232:233] op_sel:[0,0] op_sel_hi:[1,1]
  v_pk_mul_f32 v[170:171], v[170:171], v[234:235] op_sel:[0,0] op_sel_hi:[1,1]
  ds_read_b128 v[220:223], v42 offset:320
  ds_read_b128 v[228:231], v42 offset:448
  ds_read_b128 v[224:227], v42 offset:352
  ds_read_b128 v[232:235], v42 offset:480
  v_cvt_pk_bf16_f32 v96, v164, v165
  v_cvt_pk_bf16_f32 v97, v166, v167
  v_cvt_pk_bf16_f32 v98, v168, v169
  v_cvt_pk_bf16_f32 v99, v170, v171
  s_waitcnt lgkmcnt(7)
  v_pk_fma_f32 v[172:173], v[204:205], v[244:245], v[172:173] op_sel:[0,0,0] op_sel_hi:[1,0,1]
  v_pk_fma_f32 v[174:175], v[206:207], v[244:245], v[174:175] op_sel:[0,0,0] op_sel_hi:[1,0,1]
  s_waitcnt lgkmcnt(5)
  v_pk_fma_f32 v[176:177], v[208:209], v[244:245], v[176:177] op_sel:[0,0,0] op_sel_hi:[1,0,1]
  v_pk_fma_f32 v[178:179], v[210:211], v[244:245], v[178:179] op_sel:[0,0,0] op_sel_hi:[1,0,1]
  v_pk_mul_f32 v[172:173], v[172:173], v[212:213] op_sel:[0,0] op_sel_hi:[1,1]
  v_pk_mul_f32 v[174:175], v[174:175], v[214:215] op_sel:[0,0] op_sel_hi:[1,1]
  s_waitcnt lgkmcnt(4)
  v_pk_mul_f32 v[176:177], v[176:177], v[216:217] op_sel:[0,0] op_sel_hi:[1,1]
  v_pk_mul_f32 v[178:179], v[178:179], v[218:219] op_sel:[0,0] op_sel_hi:[1,1]
  v_cvt_pk_bf16_f32 v100, v172, v173
  v_cvt_pk_bf16_f32 v101, v174, v175
  v_cvt_pk_bf16_f32 v102, v176, v177
  v_cvt_pk_bf16_f32 v103, v178, v179
  s_waitcnt lgkmcnt(3)
  v_pk_fma_f32 v[180:181], v[220:221], v[244:245], v[180:181] op_sel:[0,0,0] op_sel_hi:[1,0,1]
  v_pk_fma_f32 v[182:183], v[222:223], v[244:245], v[182:183] op_sel:[0,0,0] op_sel_hi:[1,0,1]
  s_waitcnt lgkmcnt(1)
  v_pk_fma_f32 v[184:185], v[224:225], v[244:245], v[184:185] op_sel:[0,0,0] op_sel_hi:[1,0,1]
  v_pk_fma_f32 v[186:187], v[226:227], v[244:245], v[186:187] op_sel:[0,0,0] op_sel_hi:[1,0,1]
  v_pk_mul_f32 v[180:181], v[180:181], v[228:229] op_sel:[0,0] op_sel_hi:[1,1]
  v_pk_mul_f32 v[182:183], v[182:183], v[230:231] op_sel:[0,0] op_sel_hi:[1,1]
  s_waitcnt lgkmcnt(0)
  v_pk_mul_f32 v[184:185], v[184:185], v[232:233] op_sel:[0,0] op_sel_hi:[1,1]
  v_pk_mul_f32 v[186:187], v[186:187], v[234:235] op_sel:[0,0] op_sel_hi:[1,1]
  v_cvt_pk_bf16_f32 v104, v180, v181
  v_cvt_pk_bf16_f32 v105, v182, v183
  v_cvt_pk_bf16_f32 v106, v184, v185
  v_cvt_pk_bf16_f32 v107, v186, v187
  s_mov_b32 s88, 0xffff
  s_mov_b32 s89, 0xffff
  v_cndmask_b32 v108, v50, v92, s[88:89]
  v_cndmask_b32 v116, v92, v50, s[88:89]
  v_cndmask_b32 v109, v50, v93, s[88:89]
  v_cndmask_b32 v117, v93, v50, s[88:89]
  v_cndmask_b32 v110, v50, v94, s[88:89]
  v_cndmask_b32 v118, v94, v50, s[88:89]
  v_cndmask_b32 v111, v50, v95, s[88:89]
  v_cndmask_b32 v119, v95, v50, s[88:89]
  v_cndmask_b32 v112, v50, v96, s[88:89]
  v_cndmask_b32 v120, v96, v50, s[88:89]
  v_cndmask_b32 v113, v50, v97, s[88:89]
  v_cndmask_b32 v121, v97, v50, s[88:89]
  v_cndmask_b32 v114, v50, v98, s[88:89]
  v_cndmask_b32 v122, v98, v50, s[88:89]
  v_cndmask_b32 v115, v50, v99, s[88:89]
  v_cndmask_b32 v123, v99, v50, s[88:89]
  v_mfma_f32_32x32x16_bf16 v[124:139], v[188:191], v[108:111], 0
  v_mfma_f32_32x32x16_bf16 v[140:155], v[188:191], v[116:119], 0
  v_mfma_f32_32x32x16_bf16 v[124:139], v[192:195], v[112:115], v[124:139]
  v_mfma_f32_32x32x16_bf16 v[140:155], v[192:195], v[120:123], v[140:155]
  v_cndmask_b32 v204, v50, v100, s[88:89]
  v_cndmask_b32 v212, v100, v50, s[88:89]
  v_cndmask_b32 v205, v50, v101, s[88:89]
  v_cndmask_b32 v213, v101, v50, s[88:89]
  v_cndmask_b32 v206, v50, v102, s[88:89]
  v_cndmask_b32 v214, v102, v50, s[88:89]
  v_cndmask_b32 v207, v50, v103, s[88:89]
  v_cndmask_b32 v215, v103, v50, s[88:89]
  v_cndmask_b32 v208, v50, v104, s[88:89]
  v_cndmask_b32 v216, v104, v50, s[88:89]
  v_cndmask_b32 v209, v50, v105, s[88:89]
  v_cndmask_b32 v217, v105, v50, s[88:89]
  v_cndmask_b32 v210, v50, v106, s[88:89]
  v_cndmask_b32 v218, v106, v50, s[88:89]
  v_cndmask_b32 v211, v50, v107, s[88:89]
  v_cndmask_b32 v219, v107, v50, s[88:89]
  v_mfma_f32_32x32x16_bf16 v[124:139], v[196:199], v[204:207], v[124:139]
  v_mfma_f32_32x32x16_bf16 v[140:155], v[196:199], v[212:215], v[140:155]
  v_mfma_f32_32x32x16_bf16 v[124:139], v[200:203], v[208:211], v[124:139]
  v_mfma_f32_32x32x16_bf16 v[140:155], v[200:203], v[216:219], v[140:155]
  s_add_u32 s73, s72, 147456
  v_add_u32 v224, s73, v2
  s_mul_i32 s73, s95, 2048
  s_lshl_b32 s74, s96, 12
  s_add_u32 s73, s73, s74
  s_add_u32 s73, s73, 147456
  v_add_u32 v225, s73, v2
  s_nop 3
  ds_write_b128 v224, v[124:127] offset:0
  ds_write_b128 v224, v[128:131] offset:1024
  ds_write_b128 v224, v[148:151] offset:2048
  ds_write_b128 v224, v[152:155] offset:3072
  v_mov_b32 v157, s71
  v_mov_b32 v159, s71
  v_mov_b32 v161, s71
  v_mov_b32 v163, s71
  v_mov_b32 v165, s71
  v_mov_b32 v167, s71
  v_mov_b32 v169, s71
  v_mov_b32_e64 v171, s71
  s_lshl_b32 s73, s45, 17
  s_lshl_b32 s74, s46, 14
  s_add_u32 s73, s73, s74
  s_lshl_b32 s74, s96, 13
  s_add_u32 s73, s73, s74
  s_lshl_b32 s74, s95, 12
  s_add_u32 s73, s73, s74
  s_add_u32 s73, s73, 16777216
  s_waitcnt lgkmcnt(0)
  s_barrier
  ds_read_b128 v[92:95], v225 offset:0
  ds_read_b128 v[96:99], v225 offset:1024
  ds_read_b128 v[100:103], v225 offset:8192
  ds_read_b128 v[104:107], v225 offset:9216
  s_waitcnt lgkmcnt(1)
  v_add_f32 v156, v92, v100
  v_add_f32 v158, v93, v101
  v_add_f32 v160, v94, v102
  v_add_f32 v162, v95, v103
  s_waitcnt lgkmcnt(0)
  v_add_f32 v164, v96, v104
  v_add_f32 v166, v97, v105
  v_add_f32 v168, v98, v106
  v_add_f32_e64 v170, v99, v107
  s_cmp_eq_u32 s95, 0
  s_mov_b32 s74, 0xffff8000
  s_cselect_b32 s88, 0x1ffff, s74
  s_mov_b32 s89, s88
  s_mov_b64 exec, s[88:89]
  buffer_store_dwordx4 v[156:159], v2, s[8:11], s73 offen offset:0 sc1
  buffer_store_dwordx4 v[160:163], v2, s[8:11], s73 offen offset:1024 sc1
  buffer_store_dwordx4 v[164:167], v2, s[8:11], s73 offen offset:2048 sc1
  buffer_store_dwordx4 v[168:171], v2, s[8:11], s73 offen offset:3072 sc1
  s_mov_b64 exec, -1
  ds_read_b128 a[32:35], v26 offset:16384
  ds_read_b128 a[36:39], v27 offset:16384
  ds_read_b128 a[40:43], v28 offset:16384
  ds_read_b128 a[44:47], v29 offset:16384
  ds_read_b128 a[160:163], v26 offset:49152
  ds_read_b128 a[164:167], v27 offset:49152
  ds_read_b128 a[168:171], v28 offset:49152
  ds_read_b128 a[172:175], v29 offset:49152
  s_waitcnt vmcnt(21)
  ds_read_b128 a[48:51], v26 offset:0
  ds_read_b128 a[52:55], v27 offset:0
  ds_read_b128 a[56:59], v28 offset:0
  ds_read_b128 a[60:63], v29 offset:0
  s_waitcnt vmcnt(12)
  ds_read_b128 a[176:179], v30 offset:0
  ds_read_b128 a[180:183], v31 offset:0
  ds_read_b128 a[184:187], v32 offset:0
  ds_read_b128 a[188:191], v33 offset:0
  s_waitcnt lgkmcnt(12)
  s_add_u32 m0, s72, 16384
  s_add_u32 s73, s1, 6
  s_and_b32 s73, s73, 7
  s_mul_i32 s73, s73, 128
  s_add_u32 s73, s73, s79
  buffer_load_dwordx4 v5, s[32:35], s73 offen offset:0 lds
  buffer_load_dwordx4 v6, s[32:35], s73 offen offset:1024 lds
  buffer_load_dwordx4 v7, s[32:35], s73 offen offset:2048 lds
  buffer_load_dwordx4 v8, s[32:35], s73 offen offset:3072 lds
  s_waitcnt lgkmcnt(8)
  s_add_u32 m0, s72, 49152
  s_add_u32 s73, s1, 6
  s_and_b32 s73, s73, 7
  s_mul_i32 s73, s73, 128
  s_add_u32 s73, s73, s78
  buffer_load_dwordx4 v5, s[32:35], s73 offen offset:0 lds
  buffer_load_dwordx4 v6, s[32:35], s73 offen offset:1024 lds
  buffer_load_dwordx4 v7, s[32:35], s73 offen offset:2048 lds
  buffer_load_dwordx4 v8, s[32:35], s73 offen offset:3072 lds
  s_waitcnt lgkmcnt(4)
  s_add_u32 m0, s72, 0
  s_add_u32 s73, s1, 7
  s_and_b32 s73, s73, 7
  s_mul_i32 s73, s73, 128
  s_add_u32 s73, s73, s79
  buffer_load_dwordx4 v5, s[32:35], s73 offen offset:0 lds
  buffer_load_dwordx4 v6, s[32:35], s73 offen offset:1024 lds
  buffer_load_dwordx4 v7, s[32:35], s73 offen offset:2048 lds
  buffer_load_dwordx4 v8, s[32:35], s73 offen offset:3072 lds
  s_waitcnt lgkmcnt(0)
  s_add_u32 m0, s72, 65536
  s_add_u32 s73, s1, 7
  s_and_b32 s73, s73, 7
  s_mul_i32 s73, s73, 128
  s_add_u32 s73, s73, s78
  buffer_load_dwordx4 v5, s[32:35], s73 offen offset:0 lds
  buffer_load_dwordx4 v6, s[32:35], s73 offen offset:1024 lds
  buffer_load_dwordx4 v7, s[32:35], s73 offen offset:2048 lds
  buffer_load_dwordx4 v8, s[32:35], s73 offen offset:3072 lds
  s_mul_i32 s91, s83, 3
  s_add_u32 s91, s91, 1
  s_cmp_eq_u32 s83, 7
  s_cselect_b32 s91, 0, s91
  s_cselect_b32 s75, 0, 128
  s_lshl_b32 s74, s91, 7
  s_lshl_b32 s73, s44, 5
  s_add_u32 s74, s74, s73
  s_add_u32 s40, s74, 4224
  s_add_u32 s41, s40, s75
  s_add_u32 s42, s41, s75
  s_buffer_load_dwordx8 s[48:55], s[8:11], s40
  s_buffer_load_dwordx8 s[56:63], s[8:11], s41
  s_buffer_load_dwordx8 s[24:31], s[8:11], s42
  s_waitcnt lgkmcnt(0)
  s_branch PHASE2
PROG_B:
  s_and_b32 s74, s46, 3
  s_lshl_b32 s81, s74, 8
  s_add_u32 s82, s81, 128
  s_lshr_b32 s95, s44, 1
  s_and_b32 s96, s44, 1
  v_and_b32 v212, 31, v1
  v_lshrrev_b32_e64 v213, 5, v1
  v_bfe_u32 v214, v1, 1, 3
  v_xor_b32 v214, v214, v213
  v_lshlrev_b32 v214, 4, v214
  v_lshl_add_u32 v214, v212, 7, v214
  s_mul_i32 s74, s95, 8224
  s_lshl_b32 s75, s96, 6
  s_add_u32 s74, s74, s75
  v_xor_b32 v18, s74, v214
  v_xor_b32 v19, 32, v18
  v_xor_b32_e64 v20, 64, v18
  v_xor_b32 v21, 96, v18
  v_mov_b32 v50, 0x3f803f80
  v_mov_b32 v52, 0
  v_mov_b32 v53, 0
  v_mov_b32 v54, 0
  v_mov_b32 v55, 0
  v_lshlrev_b32_e64 v2, 4, v1
  s_add_u32 m0, s72, 49152
  s_add_u32 s73, s0, 1
  s_and_b32 s73, s73, 3
  s_mul_i32 s73, s73, 256
  s_add_u32 s73, s73, s77
  buffer_load_dwordx4 v5, s[4:7], s73 offen offset:0 lds
  buffer_load_dwordx4 v6, s[4:7], s73 offen offset:1024 lds
  buffer_load_dwordx4 v7, s[4:7], s73 offen offset:2048 lds
  buffer_load_dwordx4 v8, s[4:7], s73 offen offset:3072 lds
  v_add_u32 v26, s72, v214
  v_xor_b32 v27, 32, v26
  v_xor_b32 v28, 64, v26
  v_xor_b32 v29, 96, v26
  v_add_u32 v30, 0x10000, v26
  v_add_u32 v22, 0x10000, v18
  v_add_u32 v31, 0x10000, v27
  v_add_u32 v23, 0x10000, v19
  v_add_u32 v32, 0x10000, v28
  v_add_u32 v24, 0x10000, v20
  v_add_u32 v33, 0x10000, v29
  v_add_u32 v25, 0x10000, v21
  s_mov_b32 s32, s58
  s_mov_b32 s33, s59
  s_mov_b32 s34, 8388608
  s_mov_b32 s35, 0x20000
  s_mov_b32 s12, s52
  s_mov_b32 s13, s53
  s_mov_b32 s14, 524288
  s_mov_b32 s15, 0x20000
  s_add_u32 m0, s72, 65536
  s_add_u32 s73, s0, 1
  s_and_b32 s73, s73, 3
  s_mul_i32 s73, s73, 256
  s_add_u32 s73, s73, s77
  s_add_u32 s73, s73, 128
  buffer_load_dwordx4 v5, s[4:7], s73 offen offset:0 lds
  buffer_load_dwordx4 v6, s[4:7], s73 offen offset:1024 lds
  buffer_load_dwordx4 v7, s[4:7], s73 offen offset:2048 lds
  buffer_load_dwordx4 v8, s[4:7], s73 offen offset:3072 lds
  s_mov_b32 s16, s62
  s_mov_b32 s17, s63
  s_mov_b32 s18, 704512
  s_mov_b32 s19, 0x20000
  s_mov_b32 s20, s64
  s_mov_b32 s21, s65
  s_mov_b32 s22, 2097152
  s_mov_b32 s23, 0x20000
  s_mov_b32 s36, s60
  s_mov_b32 s37, s61
  s_mov_b32 s38, 4096
  s_mov_b32 s39, 0x20000
  s_mov_b32 s40, s66
  s_mov_b32 s41, s67
  s_mov_b32 s42, 256
  s_mov_b32 s43, 0x20000
  s_movk_i32 s74, 3072
  v_mad_u32_u24 v9, v211, s74, v210
  v_add_u32 v10, 23552, v9
  v_add_u32 v11, 47104, v9
  s_add_u32 m0, s72, 81920
  s_add_u32 s73, s0, 1
  s_and_b32 s73, s73, 3
  s_mul_i32 s73, s73, 352256
  s_add_u32 s73, s73, s80
  buffer_load_dwordx4 v14, s[28:31], s73 offen offset:0 lds
  buffer_load_dwordx4 v15, s[28:31], s73 offen offset:1024 lds
  buffer_load_dwordx4 v16, s[28:31], s73 offen offset:2048 lds
  buffer_load_dwordx4 v17, s[28:31], s73 offen offset:3072 lds
  v_add_u32 v12, 70656, v9
  s_lshl_b32 s74, s47, 1
  s_add_u32 s74, s74, s95
  s_lshl_b32 s79, s74, 17
  s_lshl_b32 s74, s44, 10
  s_add_u32 s79, s79, s74
  s_xor_b32 s78, s79, 0x20000
  v_bfe_u32 v215, v1, 2, 2
  v_and_b32_e64 v216, 3, v1
  v_bfe_u32 v217, v1, 4, 1
  v_lshlrev_b32_e64 v216, 3, v216
  v_lshl_add_u32 v216, v217, 5, v216
  v_lshl_add_u32 v218, v213, 3, v215
  v_lshl_add_u32 v219, v218, 7, v216
  v_bfe_u32 v220, v1, 3, 1
  v_lshl_add_u32 v219, v220, 6, v219
  s_mul_i32 s74, s96, 4160
  s_lshl_b32 s75, s95, 11
  s_or_b32 s74, s74, s75
  v_xor_b32_e64 v34, s74, v219
  v_xor_b32 v35, 2048, v34
  v_xor_b32 v36, 4096, v34
  v_xor_b32 v37, 6144, v34
  v_add_u32 v38, 0x10000, v34
  v_add_u32 v39, 0x10000, v35
  v_add_u32 v40, 0x10000, v36
  v_add_u32 v41, 0x10000, v37
  s_lshl_b32 s74, s96, 7
  s_add_u32 s74, s74, 131072
  v_lshl_add_u32 v44, v213, 4, s74
  v_lshl_add_u32 v45, v212, 2, s74
  s_lshl_b32 s75, s95, 8
  v_lshl_add_u32 v49, v213, 14, v45
  v_add_u32 v49, s75, v49
  s_lshl_b32 s74, s95, 9
  s_add_u32 s75, s74, 133120
  s_mov_b32 s91, s75
  v_lshl_add_u32 v42, v213, 4, s75
  v_lshl_add_u32 v43, v212, 2, s75
  s_lshl_b32 s75, s44, 9
  s_add_u32 s75, s75, 135168
  v_lshl_add_u32 v48, v1, 2, s75
  s_mul_i32 s74, s44, 2304
  s_add_u32 s74, s74, 137216
  v_mul_u32_u24 v13, 72, v212
  v_lshl_add_u32 v13, v213, 3, v13
  v_add_u32_e64 v13, s74, v13
  v_mul_u32_u24 v46, 72, v218
  v_add3_u32 v46, v46, v216, s74
  v_and_b32 v221, 15, v1
  v_lshlrev_b32 v222, 2, v217
  v_cmp_eq_u32 vcc, v221, v222
  s_nop 1
  v_cndmask_b32 v88, 0, v50, vcc
  v_mov_b32 v89, v88
  v_mov_b32 v90, v88
  v_mov_b32 v91, v88
  s_mov_b32 s84, 0x358637bd
  s_mov_b32 s85, 0x358637bd
  s_mov_b32 s86, 0x3fb8aa3b
  s_mov_b32 s87, 0x3fb8aa3b
  s_or_b32 s99, s2, s44
  s_lshr_b32 s76, s80, 7
  s_sub_u32 s74, s76, 10
  s_mul_i32 s92, s90, 6144
  s_add_u32 s92, s92, 131072
  s_movk_i32 s93, 4096
  v_add_u32_e64 v47, s92, v2
  s_lshr_b32 s75, s74, 1
  s_lshl_b32 s75, s75, 10
  s_add_u32 s92, s92, s75
  s_and_b32 s75, s74, 1
  s_lshl_b32 s75, s75, 3
  s_add_u32 s92, s92, s75
  s_lshl_b32 s76, s76, 1
  s_add_u32 s76, s76, s96
  s_lshl_b32 s75, s76, 17
  s_andn2_b32 s100, s90, 1
  s_lshl_b32 s100, s100, 11
  s_add_u32 s100, s100, s75
  s_add_u32 s100, s100, 9830400
  s_andn2_b32 s94, s90, 1
  s_mul_i32 s94, s94, 44032
  s_lshl_b32 s75, s76, 11
  s_add_u32 s94, s94, s75
  s_add_u32 s94, s94, 6291456
  s_add_u32 s101, s94, 1024
  s_cmp_le_u32 s76, 21
  s_cselect_b32 s94, s94, 2130706432
  s_cselect_b32 s97, 0, -1
  s_cmp_eq_u32 s76, 20
  s_cselect_b32 s101, s101, 2130706432
  s_cselect_b32 s98, 0, -1
  s_cselect_b32 s100, 2130706432, s100
  s_cmp_eq_u32 s76, 43
  s_cselect_b32 s100, 2130706432, s100
  s_cselect_b32 s97, 0, s97
  s_cselect_b32 s98, 0, s98
  s_waitcnt vmcnt(18)
  s_barrier
  ds_read_b128 v[156:159], v18 offset:0
  ds_read_b128 v[160:163], v19 offset:0
  ds_read_b128 v[164:167], v18 offset:4096
  ds_read_b128 v[168:171], v19 offset:4096
  ds_read_b128 v[172:175], v18 offset:16384
  ds_read_b128 v[176:179], v19 offset:16384
  ds_read_b128 v[180:183], v18 offset:20480
  ds_read_b128 v[184:187], v19 offset:20480
  ds_read_b128 a[8:11], v20 offset:0
  ds_read_b128 a[12:15], v21 offset:0
  ds_read_b128 a[136:139], v20 offset:4096
  ds_read_b128 a[140:143], v21 offset:4096
  ds_read_b128 a[24:27], v20 offset:16384
  ds_read_b128 a[28:31], v21 offset:16384
  ds_read_b128 a[152:155], v20 offset:20480
  ds_read_b128 a[156:159], v21 offset:20480
  s_add_u32 m0, s72, 98304
  s_add_u32 s73, s0, 2
  s_and_b32 s73, s73, 3
  s_mul_i32 s73, s73, 256
  s_add_u32 s73, s73, s77
  buffer_load_dwordx4 v5, s[4:7], s73 offen offset:0 lds
  buffer_load_dwordx4 v6, s[4:7], s73 offen offset:1024 lds
  buffer_load_dwordx4 v7, s[4:7], s73 offen offset:2048 lds
  buffer_load_dwordx4 v8, s[4:7], s73 offen offset:3072 lds
  s_add_u32 m0, s72, 114688
  s_add_u32 s73, s0, 2
  s_and_b32 s73, s73, 3
  s_mul_i32 s73, s73, 256
  s_add_u32 s73, s73, s77
  s_add_u32 s73, s73, 128
  buffer_load_dwordx4 v5, s[4:7], s73 offen offset:0 lds
  buffer_load_dwordx4 v6, s[4:7], s73 offen offset:1024 lds
  buffer_load_dwordx4 v7, s[4:7], s73 offen offset:2048 lds
  buffer_load_dwordx4 v8, s[4:7], s73 offen offset:3072 lds
  s_waitcnt lgkmcnt(15)
  v_accvgpr_write_b32 a0, v156
  v_accvgpr_write_b32 a1, v157
  v_accvgpr_write_b32 a2, v158
  v_accvgpr_write_b32 a3, v159
  s_waitcnt lgkmcnt(14)
  v_accvgpr_write_b32 a4, v160
  v_accvgpr_write_b32 a5, v161
  v_accvgpr_write_b32 a6, v162
  v_accvgpr_write_b32 a7, v163
  s_waitcnt lgkmcnt(13)
  v_accvgpr_write_b32 a128, v164
  v_accvgpr_write_b32 a129, v165
  v_accvgpr_write_b32 a130, v166
  v_accvgpr_write_b32 a131, v167
  s_waitcnt lgkmcnt(12)
  v_accvgpr_write_b32 a132, v168
  v_accvgpr_write_b32 a133, v169
  v_accvgpr_write_b32 a134, v170
  v_accvgpr_write_b32 a135, v171
  s_waitcnt lgkmcnt(11)
  v_accvgpr_write_b32 a16, v172
  v_accvgpr_write_b32 a17, v173
  v_accvgpr_write_b32 a18, v174
  v_accvgpr_write_b32 a19, v175
  s_waitcnt lgkmcnt(10)
  v_accvgpr_write_b32 a20, v176
  v_accvgpr_write_b32 a21, v177
  v_accvgpr_write_b32 a22, v178
  v_accvgpr_write_b32 a23, v179
  s_waitcnt lgkmcnt(9)
  v_accvgpr_write_b32 a144, v180
  v_accvgpr_write_b32 a145, v181
  v_accvgpr_write_b32 a146, v182
  v_accvgpr_write_b32 a147, v183
  s_waitcnt lgkmcnt(8)
  v_accvgpr_write_b32 a148, v184
  v_accvgpr_write_b32 a149, v185
  v_accvgpr_write_b32 a150, v186
  v_accvgpr_write_b32 a151, v187
  s_waitcnt vmcnt(12) lgkmcnt(0)
  s_barrier
  s_cmp_eq_u32 s99, 0
  s_cbranch_scc1 EPOCH_B
EPOCHR_B:
  ds_read_b64_tr_b16 v[68:69], v34 offset:32768
  ds_read_b64_tr_b16 v[70:71], v34 offset:33280
  ds_read_b64_tr_b16 v[72:73], v35 offset:32768
  ds_read_b64_tr_b16 v[74:75], v35 offset:33280
  ds_read_b64_tr_b16 v[76:77], v36 offset:32768
  ds_read_b64_tr_b16 v[78:79], v36 offset:33280
  s_add_u32 m0, s72, 0
  s_add_u32 s73, s0, 2
  s_and_b32 s73, s73, 3
  s_mul_i32 s73, s73, 352256
  s_add_u32 s73, s73, s80
  buffer_load_dwordx4 v14, s[28:31], s73 offen offset:0 lds
  buffer_load_dwordx4 v15, s[28:31], s73 offen offset:1024 lds
  buffer_load_dwordx4 v16, s[28:31], s73 offen offset:2048 lds
  buffer_load_dwordx4 v17, s[28:31], s73 offen offset:3072 lds
  s_add_u32 m0, s72, 16384
  s_add_u32 s73, s0, 3
  s_and_b32 s73, s73, 3
  s_mul_i32 s73, s73, 256
  s_add_u32 s73, s73, s77
  buffer_load_dwordx4 v5, s[4:7], s73 offen offset:0 lds
  buffer_load_dwordx4 v6, s[4:7], s73 offen offset:1024 lds
  buffer_load_dwordx4 v7, s[4:7], s73 offen offset:2048 lds
  buffer_load_dwordx4 v8, s[4:7], s73 offen offset:3072 lds
  s_waitcnt lgkmcnt(4)
  v_mfma_f32_32x32x16_bf16 v[92:107], v[68:71], a[0:3], 0
  ds_read_b64_tr_b16 v[80:81], v37 offset:32768
  ds_read_b64_tr_b16 v[82:83], v37 offset:33280
  v_mfma_f32_16x16x32_bf16 v[84:87], v[88:91], v[68:71], 0
  ds_read_b128 v[204:207], v18 offset:49152
  ds_read_b128 v[208:211], v19 offset:49152
  ds_read_b128 v[212:215], v18 offset:53248
  v_mfma_f32_32x32x16_bf16 v[108:123], v[68:71], a[128:131], 0
  ds_read_b128 v[216:219], v19 offset:53248
  ds_read_b128 v[220:223], v22 offset:0
  ds_read_b128 v[224:227], v23 offset:0
  s_waitcnt lgkmcnt(10)
  v_mfma_f32_32x32x16_bf16 v[92:107], v[72:75], a[4:7], v[92:107]
  ds_read_b64_tr_b16 v[68:69], v34 offset:40960
  ds_read_b64_tr_b16 v[70:71], v34 offset:41472
  ds_read_b128 v[228:231], v22 offset:4096
  ds_read_b128 v[232:235], v23 offset:4096
  v_mfma_f32_32x32x16_bf16 v[108:123], v[72:75], a[132:135], v[108:123]
  ds_read_b128 a[40:43], v20 offset:49152
  ds_read_b128 a[44:47], v21 offset:49152
  ds_read_b128 a[168:171], v20 offset:53248
  s_waitcnt lgkmcnt(15)
  v_mfma_f32_32x32x16_bf16 v[92:107], v[76:79], a[8:11], v[92:107]
  ds_read_b64_tr_b16 v[72:73], v35 offset:40960
  ds_read_b64_tr_b16 v[74:75], v35 offset:41472
  v_mfma_f32_16x16x32_bf16 v[84:87], v[88:91], v[76:79], v[84:87]
  ds_read_b128 a[172:175], v21 offset:53248
  ds_read_b128 a[56:59], v24 offset:0
  ds_read_b128 a[60:63], v25 offset:0
  v_mfma_f32_32x32x16_bf16 v[108:123], v[76:79], a[136:139], v[108:123]
  ds_read_b128 a[184:187], v24 offset:4096
  ds_read_b128 a[188:191], v25 offset:4096
  s_waitcnt lgkmcnt(15)
  v_mfma_f32_32x32x16_bf16 v[92:107], v[80:83], a[12:15], v[92:107]
  ds_read_b64_tr_b16 v[76:77], v36 offset:40960
  ds_read_b64_tr_b16 v[78:79], v36 offset:41472
  v_accvgpr_write_b32 a32, v204
  v_accvgpr_write_b32 a33, v205
  v_accvgpr_write_b32 a34, v206
  v_accvgpr_write_b32 a35, v207
  v_accvgpr_write_b32 a36, v208
  v_accvgpr_write_b32 a37, v209
  v_accvgpr_write_b32 a38, v210
  v_accvgpr_write_b32 a39, v211
  v_mfma_f32_32x32x16_bf16 v[108:123], v[80:83], a[140:143], v[108:123]
  v_accvgpr_write_b32 a160, v212
  v_accvgpr_write_b32 a161, v213
  v_accvgpr_write_b32 a162, v214
  v_accvgpr_write_b32 a163, v215
  v_accvgpr_write_b32 a164, v216
  v_accvgpr_write_b32 a165, v217
  v_accvgpr_write_b32 a166, v218
  v_accvgpr_write_b32 a167, v219
  s_waitcnt lgkmcnt(14)
  v_mfma_f32_32x32x16_bf16 v[92:107], v[68:71], a[16:19], v[92:107]
  ds_read_b64_tr_b16 v[80:81], v37 offset:40960
  ds_read_b64_tr_b16 v[82:83], v37 offset:41472
  v_mfma_f32_16x16x32_bf16 v[84:87], v[88:91], v[68:71], v[84:87]
  v_accvgpr_write_b32 a48, v220
  v_accvgpr_write_b32 a49, v221
  v_accvgpr_write_b32 a50, v222
  v_accvgpr_write_b32 a51, v223
  v_accvgpr_write_b32 a52, v224
  v_accvgpr_write_b32 a53, v225
  v_accvgpr_write_b32 a54, v226
  v_accvgpr_write_b32 a55, v227
  v_mfma_f32_32x32x16_bf16 v[108:123], v[68:71], a[144:147], v[108:123]
  s_waitcnt lgkmcnt(15)
  v_accvgpr_write_b32 a176, v228
  v_accvgpr_write_b32 a177, v229
  v_accvgpr_write_b32 a178, v230
  v_accvgpr_write_b32 a179, v231
  s_waitcnt lgkmcnt(14)
  v_accvgpr_write_b32 a180, v232
  v_accvgpr_write_b32 a181, v233
  v_accvgpr_write_b32 a182, v234
  v_accvgpr_write_b32 a183, v235
  v_dot2c_f32_bf16 v52, v204, v50
  v_dot2c_f32_bf16 v53, v204, v204
  v_dot2c_f32_bf16 v54, v212, v50
  v_dot2c_f32_bf16 v55, v212, v212
  v_dot2c_f32_bf16 v52, v205, v50
  v_dot2c_f32_bf16 v53, v205, v205
  v_dot2c_f32_bf16 v54, v213, v50
  v_dot2c_f32_bf16 v55, v213, v213
  v_dot2c_f32_bf16 v52, v206, v50
  v_dot2c_f32_bf16 v53, v206, v206
  v_dot2c_f32_bf16 v54, v214, v50
  v_dot2c_f32_bf16 v55, v214, v214
  v_dot2c_f32_bf16 v52, v207, v50
  v_dot2c_f32_bf16 v53, v207, v207
  v_dot2c_f32_bf16 v54, v215, v50
  v_dot2c_f32_bf16 v55, v215, v215
  v_dot2c_f32_bf16 v52, v208, v50
  v_dot2c_f32_bf16 v53, v208, v208
  v_dot2c_f32_bf16 v54, v216, v50
  v_dot2c_f32_bf16 v55, v216, v216
  v_dot2c_f32_bf16 v52, v209, v50
  v_dot2c_f32_bf16 v53, v209, v209
  v_dot2c_f32_bf16 v54, v217, v50
  v_dot2c_f32_bf16 v55, v217, v217
  v_dot2c_f32_bf16 v52, v210, v50
  v_dot2c_f32_bf16 v53, v210, v210
  v_dot2c_f32_bf16 v54, v218, v50
  v_dot2c_f32_bf16 v55, v218, v218
  v_dot2c_f32_bf16 v52, v211, v50
  v_dot2c_f32_bf16 v53, v211, v211
  v_dot2c_f32_bf16 v54, v219, v50
  v_dot2c_f32_bf16 v55, v219, v219
  v_dot2c_f32_bf16 v52, v220, v50
  v_dot2c_f32_bf16 v53, v220, v220
  v_dot2c_f32_bf16 v54, v228, v50
  v_dot2c_f32_bf16 v55, v228, v228
  v_dot2c_f32_bf16 v52, v221, v50
  v_dot2c_f32_bf16 v53, v221, v221
  v_dot2c_f32_bf16 v54, v229, v50
  v_dot2c_f32_bf16 v55, v229, v229
  v_dot2c_f32_bf16 v52, v222, v50
  v_dot2c_f32_bf16 v53, v222, v222
  v_dot2c_f32_bf16 v54, v230, v50
  v_dot2c_f32_bf16 v55, v230, v230
  v_dot2c_f32_bf16 v52, v223, v50
  v_dot2c_f32_bf16 v53, v223, v223
  v_dot2c_f32_bf16 v54, v231, v50
  v_dot2c_f32_bf16 v55, v231, v231
  v_dot2c_f32_bf16 v52, v224, v50
  v_dot2c_f32_bf16 v53, v224, v224
  v_dot2c_f32_bf16 v54, v232, v50
  v_dot2c_f32_bf16 v55, v232, v232
  v_dot2c_f32_bf16 v52, v225, v50
  v_dot2c_f32_bf16 v53, v225, v225
  v_dot2c_f32_bf16 v54, v233, v50
  v_dot2c_f32_bf16 v55, v233, v233
  v_dot2c_f32_bf16 v52, v226, v50
  v_dot2c_f32_bf16 v53, v226, v226
  v_dot2c_f32_bf16 v54, v234, v50
  v_dot2c_f32_bf16 v55, v234, v234
  v_dot2c_f32_bf16 v52, v227, v50
  v_dot2c_f32_bf16 v53, v227, v227
  v_dot2c_f32_bf16 v54, v235, v50
  v_dot2c_f32_bf16 v55, v235, v235
  s_waitcnt vmcnt(8) lgkmcnt(4)
  s_barrier
  v_mfma_f32_32x32x16_bf16 v[92:107], v[72:75], a[20:23], v[92:107]
  ds_read_b64_tr_b16 v[68:69], v38 offset:16384
  ds_read_b64_tr_b16 v[70:71], v38 offset:16896
  ds_read_b128 v[204:207], v22 offset:32768
  ds_read_b128 v[208:211], v23 offset:32768
  s_add_u32 m0, s72, 49152
  s_add_u32 s73, s0, 3
  s_and_b32 s73, s73, 3
  s_mul_i32 s73, s73, 256
  s_add_u32 s73, s73, s77
  s_add_u32 s73, s73, 128
  buffer_load_dwordx4 v5, s[4:7], s73 offen offset:0 lds
  buffer_load_dwordx4 v6, s[4:7], s73 offen offset:1024 lds
  buffer_load_dwordx4 v7, s[4:7], s73 offen offset:2048 lds
  buffer_load_dwordx4 v8, s[4:7], s73 offen offset:3072 lds
  v_mfma_f32_32x32x16_bf16 v[108:123], v[72:75], a[148:151], v[108:123]
  ds_read_b128 v[212:215], v22 offset:36864
  ds_read_b128 v[216:219], v23 offset:36864
  s_waitcnt lgkmcnt(8)
  v_mfma_f32_32x32x16_bf16 v[92:107], v[76:79], a[24:27], v[92:107]
  ds_read_b64_tr_b16 v[72:73], v39 offset:16384
  ds_read_b64_tr_b16 v[74:75], v39 offset:16896
  v_mfma_f32_16x16x32_bf16 v[84:87], v[88:91], v[76:79], v[84:87]
  ds_read_b128 v[220:223], v22 offset:49152
  ds_read_b128 v[224:227], v23 offset:49152
  s_add_u32 m0, s72, 65536
  s_add_u32 s73, s0, 3
  s_and_b32 s73, s73, 3
  s_mul_i32 s73, s73, 352256
  s_add_u32 s73, s73, s80
  buffer_load_dwordx4 v14, s[28:31], s73 offen offset:0 lds
  buffer_load_dwordx4 v15, s[28:31], s73 offen offset:1024 lds
  buffer_load_dwordx4 v16, s[28:31], s73 offen offset:2048 lds
  buffer_load_dwordx4 v17, s[28:31], s73 offen offset:3072 lds
  v_mfma_f32_32x32x16_bf16 v[108:123], v[76:79], a[152:155], v[108:123]
  ds_read_b128 v[228:231], v22 offset:53248
  ds_read_b128 v[232:235], v23 offset:53248
  s_waitcnt lgkmcnt(12)
  v_mfma_f32_32x32x16_bf16 v[92:107], v[80:83], a[28:31], v[92:107]
  ds_read_b64_tr_b16 v[76:77], v40 offset:16384
  ds_read_b64_tr_b16 v[78:79], v40 offset:16896
  ds_read_b128 a[72:75], v24 offset:32768
  ds_read_b128 a[76:79], v25 offset:32768
  v_mfma_f32_32x32x16_bf16 v[108:123], v[80:83], a[156:159], v[108:123]
  ds_read_b128 a[200:203], v24 offset:36864
  ds_read_b128 a[204:207], v25 offset:36864
  s_waitcnt lgkmcnt(15)
  v_mfma_f32_32x32x16_bf16 v[92:107], v[68:71], a[32:35], v[92:107]
  ds_read_b64_tr_b16 v[80:81], v41 offset:16384
  ds_read_b64_tr_b16 v[82:83], v41 offset:16896
  v_mfma_f32_16x16x32_bf16 v[84:87], v[88:91], v[68:71], v[84:87]
  ds_read_b128 a[88:91], v24 offset:49152
  ds_read_b128 a[92:95], v25 offset:49152
  v_mfma_f32_32x32x16_bf16 v[108:123], v[68:71], a[160:163], v[108:123]
  ds_read_b128 a[216:219], v24 offset:53248
  ds_read_b128 a[220:223], v25 offset:53248
  s_waitcnt lgkmcnt(15)
  v_mfma_f32_32x32x16_bf16 v[92:107], v[72:75], a[36:39], v[92:107]
  ds_read_b64_tr_b16 v[68:69], v38 offset:24576
  ds_read_b64_tr_b16 v[70:71], v38 offset:25088
  v_accvgpr_write_b32 a64, v204
  v_accvgpr_write_b32 a65, v205
  v_accvgpr_write_b32 a66, v206
  v_accvgpr_write_b32 a67, v207
  v_mfma_f32_32x32x16_bf16 v[108:123], v[72:75], a[164:167], v[108:123]
  v_accvgpr_write_b32 a68, v208
  v_accvgpr_write_b32 a69, v209
  v_accvgpr_write_b32 a70, v210
  v_accvgpr_write_b32 a71, v211
  v_lshrrev_b32_e64 v244, 3, v1
  v_mul_u32_u24 v244, 3072, v244
  v_add_u32 v5, v244, v5
  s_waitcnt lgkmcnt(12)
  v_mfma_f32_32x32x16_bf16 v[92:107], v[76:79], a[40:43], v[92:107]
  ds_read_b64_tr_b16 v[72:73], v39 offset:24576
  ds_read_b64_tr_b16 v[74:75], v39 offset:25088
  v_mfma_f32_16x16x32_bf16 v[84:87], v[88:91], v[76:79], v[84:87]
  v_accvgpr_write_b32 a192, v212
  v_accvgpr_write_b32 a193, v213
  v_accvgpr_write_b32 a194, v214
  v_accvgpr_write_b32 a195, v215
  v_mfma_f32_32x32x16_bf16 v[108:123], v[76:79], a[168:171], v[108:123]
  v_accvgpr_write_b32 a196, v216
  v_accvgpr_write_b32 a197, v217
  v_accvgpr_write_b32 a198, v218
  v_accvgpr_write_b32 a199, v219
  v_add_u32 v244, 24576, v244
  v_add_u32 v6, v244, v6
  s_waitcnt lgkmcnt(8)
  v_mfma_f32_32x32x16_bf16 v[92:107], v[80:83], a[44:47], v[92:107]
  ds_read_b64_tr_b16 v[76:77], v40 offset:24576
  ds_read_b64_tr_b16 v[78:79], v40 offset:25088
  v_accvgpr_write_b32 a80, v220
  v_accvgpr_write_b32 a81, v221
  v_accvgpr_write_b32 a82, v222
  v_accvgpr_write_b32 a83, v223
  v_mfma_f32_32x32x16_bf16 v[108:123], v[80:83], a[172:175], v[108:123]
  v_accvgpr_write_b32 a84, v224
  v_accvgpr_write_b32 a85, v225
  v_accvgpr_write_b32 a86, v226
  v_accvgpr_write_b32 a87, v227
  v_add_u32 v244, 24576, v244
  v_add_u32 v7, v244, v7
  s_waitcnt lgkmcnt(4)
  v_mfma_f32_32x32x16_bf16 v[92:107], v[68:71], a[48:51], v[92:107]
  ds_read_b64_tr_b16 v[80:81], v41 offset:24576
  ds_read_b64_tr_b16 v[82:83], v41 offset:25088
  v_mfma_f32_16x16x32_bf16 v[84:87], v[88:91], v[68:71], v[84:87]
  v_accvgpr_write_b32 a208, v228
  v_accvgpr_write_b32 a209, v229
  v_accvgpr_write_b32 a210, v230
  v_accvgpr_write_b32 a211, v231
  v_mfma_f32_32x32x16_bf16 v[108:123], v[68:71], a[176:179], v[108:123]
  v_accvgpr_write_b32 a212, v232
  v_accvgpr_write_b32 a213, v233
  v_accvgpr_write_b32 a214, v234
  v_accvgpr_write_b32 a215, v235
  v_add_u32 v244, 24576, v244
  v_add_u32 v8, v244, v8
  v_dot2c_f32_bf16 v52, v204, v50
  v_dot2c_f32_bf16 v53, v204, v204
  v_dot2c_f32_bf16 v54, v212, v50
  v_dot2c_f32_bf16 v55, v212, v212
  v_dot2c_f32_bf16 v52, v205, v50
  v_dot2c_f32_bf16 v53, v205, v205
  v_dot2c_f32_bf16 v54, v213, v50
  v_dot2c_f32_bf16 v55, v213, v213
  v_dot2c_f32_bf16 v52, v206, v50
  v_dot2c_f32_bf16 v53, v206, v206
  v_dot2c_f32_bf16 v54, v214, v50
  v_dot2c_f32_bf16 v55, v214, v214
  v_dot2c_f32_bf16 v52, v207, v50
  v_dot2c_f32_bf16 v53, v207, v207
  v_dot2c_f32_bf16 v54, v215, v50
  v_dot2c_f32_bf16 v55, v215, v215
  v_dot2c_f32_bf16 v52, v208, v50
  v_dot2c_f32_bf16 v53, v208, v208
  v_dot2c_f32_bf16 v54, v216, v50
  v_dot2c_f32_bf16 v55, v216, v216
  v_dot2c_f32_bf16 v52, v209, v50
  v_dot2c_f32_bf16 v53, v209, v209
  v_dot2c_f32_bf16 v54, v217, v50
  v_dot2c_f32_bf16 v55, v217, v217
  v_dot2c_f32_bf16 v52, v210, v50
  v_dot2c_f32_bf16 v53, v210, v210
  v_dot2c_f32_bf16 v54, v218, v50
  v_dot2c_f32_bf16 v55, v218, v218
  v_dot2c_f32_bf16 v52, v211, v50
  v_dot2c_f32_bf16 v53, v211, v211
  v_dot2c_f32_bf16 v54, v219, v50
  v_dot2c_f32_bf16 v55, v219, v219
  v_dot2c_f32_bf16 v52, v220, v50
  v_dot2c_f32_bf16 v53, v220, v220
  v_dot2c_f32_bf16 v54, v228, v50
  v_dot2c_f32_bf16 v55, v228, v228
  v_dot2c_f32_bf16 v52, v221, v50
  v_dot2c_f32_bf16 v53, v221, v221
  v_dot2c_f32_bf16 v54, v229, v50
  v_dot2c_f32_bf16 v55, v229, v229
  v_dot2c_f32_bf16 v52, v222, v50
  v_dot2c_f32_bf16 v53, v222, v222
  v_dot2c_f32_bf16 v54, v230, v50
  v_dot2c_f32_bf16 v55, v230, v230
  v_dot2c_f32_bf16 v52, v223, v50
  v_dot2c_f32_bf16 v53, v223, v223
  v_dot2c_f32_bf16 v54, v231, v50
  v_dot2c_f32_bf16 v55, v231, v231
  v_dot2c_f32_bf16 v52, v224, v50
  v_dot2c_f32_bf16 v53, v224, v224
  v_dot2c_f32_bf16 v54, v232, v50
  v_dot2c_f32_bf16 v55, v232, v232
  v_dot2c_f32_bf16 v52, v225, v50
  v_dot2c_f32_bf16 v53, v225, v225
  v_dot2c_f32_bf16 v54, v233, v50
  v_dot2c_f32_bf16 v55, v233, v233
  v_dot2c_f32_bf16 v52, v226, v50
  v_dot2c_f32_bf16 v53, v226, v226
  v_dot2c_f32_bf16 v54, v234, v50
  v_dot2c_f32_bf16 v55, v234, v234
  v_dot2c_f32_bf16 v52, v227, v50
  v_dot2c_f32_bf16 v53, v227, v227
  v_dot2c_f32_bf16 v54, v235, v50
  v_dot2c_f32_bf16 v55, v235, v235
  s_waitcnt vmcnt(4)
  s_barrier
  s_waitcnt lgkmcnt(4)
  v_mfma_f32_32x32x16_bf16 v[92:107], v[72:75], a[52:55], v[92:107]
  ds_read_b64_tr_b16 v[68:69], v34 offset:0
  ds_read_b64_tr_b16 v[70:71], v34 offset:512
  ds_read_b128 v[204:207], v18 offset:16384
  ds_read_b128 v[208:211], v19 offset:16384
  s_add_u32 m0, s72, 32768
  s_add_u32 s73, s0, 0
  s_and_b32 s73, s73, 3
  s_mul_i32 s73, s73, 393216
  s_add_u32 s73, s73, s81
  buffer_load_dwordx4 v9, s[24:27], s73 offen offset:0 lds
  buffer_load_dwordx4 v10, s[24:27], s73 offen offset:1024 lds
  buffer_load_dwordx4 v11, s[24:27], s73 offen offset:2048 lds
  buffer_load_dwordx4 v12, s[24:27], s73 offen offset:3072 lds
  v_mfma_f32_32x32x16_bf16 v[108:123], v[72:75], a[180:183], v[108:123]
  ds_read_b128 v[212:215], v18 offset:20480
  ds_read_b128 v[216:219], v19 offset:20480
  s_waitcnt lgkmcnt(8)
  v_mfma_f32_32x32x16_bf16 v[92:107], v[76:79], a[56:59], v[92:107]
  ds_read_b64_tr_b16 v[72:73], v35 offset:0
  ds_read_b64_tr_b16 v[74:75], v35 offset:512
  v_mfma_f32_16x16x32_bf16 v[84:87], v[88:91], v[76:79], v[84:87]
  ds_read_b128 v[220:223], v18 offset:49152
  ds_read_b128 v[224:227], v19 offset:49152
  s_add_u32 m0, s72, 98304
  s_add_u32 s73, s0, 1
  s_and_b32 s73, s73, 3
  s_mul_i32 s73, s73, 393216
  s_add_u32 s73, s73, s81
  buffer_load_dwordx4 v9, s[24:27], s73 offen offset:0 lds
  buffer_load_dwordx4 v10, s[24:27], s73 offen offset:1024 lds
  buffer_load_dwordx4 v11, s[24:27], s73 offen offset:2048 lds
  buffer_load_dwordx4 v12, s[24:27], s73 offen offset:3072 lds
  v_mfma_f32_32x32x16_bf16 v[108:123], v[76:79], a[184:187], v[108:123]
  ds_read_b128 v[228:231], v18 offset:53248
  ds_read_b128 v[232:235], v19 offset:53248
  s_waitcnt lgkmcnt(12)
  v_mfma_f32_32x32x16_bf16 v[92:107], v[80:83], a[60:63], v[92:107]
  ds_read_b64_tr_b16 v[76:77], v36 offset:0
  ds_read_b64_tr_b16 v[78:79], v36 offset:512
  ds_read_b128 a[104:107], v20 offset:16384
  ds_read_b128 a[108:111], v21 offset:16384
  s_add_u32 m0, s72, 114688
  s_add_u32 s73, s0, 2
  s_and_b32 s73, s73, 3
  s_mul_i32 s73, s73, 393216
  s_add_u32 s73, s73, s81
  buffer_load_dwordx4 v9, s[24:27], s73 offen offset:0 lds
  buffer_load_dwordx4 v10, s[24:27], s73 offen offset:1024 lds
  buffer_load_dwordx4 v11, s[24:27], s73 offen offset:2048 lds
  buffer_load_dwordx4 v12, s[24:27], s73 offen offset:3072 lds
  v_mfma_f32_32x32x16_bf16 v[108:123], v[80:83], a[188:191], v[108:123]
  ds_read_b128 a[232:235], v20 offset:20480
  ds_read_b128 a[236:239], v21 offset:20480
  s_waitcnt lgkmcnt(15)
  v_mfma_f32_32x32x16_bf16 v[92:107], v[68:71], a[64:67], v[92:107]
  ds_read_b64_tr_b16 v[80:81], v37 offset:0
  ds_read_b64_tr_b16 v[82:83], v37 offset:512
  v_mfma_f32_16x16x32_bf16 v[84:87], v[88:91], v[68:71], v[84:87]
  ds_read_b128 a[120:123], v20 offset:49152
  ds_read_b128 a[124:127], v21 offset:49152
  v_mfma_f32_32x32x16_bf16 v[108:123], v[68:71], a[192:195], v[108:123]
  ds_read_b128 a[248:251], v20 offset:53248
  ds_read_b128 a[252:255], v21 offset:53248
  s_waitcnt lgkmcnt(15)
  v_mfma_f32_32x32x16_bf16 v[92:107], v[72:75], a[68:71], v[92:107]
  ds_read_b64_tr_b16 v[68:69], v34 offset:8192
  ds_read_b64_tr_b16 v[70:71], v34 offset:8704
  v_accvgpr_write_b32 a96, v204
  v_accvgpr_write_b32 a97, v205
  v_accvgpr_write_b32 a98, v206
  v_accvgpr_write_b32 a99, v207
  v_mfma_f32_32x32x16_bf16 v[108:123], v[72:75], a[196:199], v[108:123]
  v_accvgpr_write_b32 a100, v208
  v_accvgpr_write_b32 a101, v209
  v_accvgpr_write_b32 a102, v210
  v_accvgpr_write_b32 a103, v211
  s_waitcnt lgkmcnt(12)
  v_mfma_f32_32x32x16_bf16 v[92:107], v[76:79], a[72:75], v[92:107]
  ds_read_b64_tr_b16 v[72:73], v35 offset:8192
  ds_read_b64_tr_b16 v[74:75], v35 offset:8704
  v_mfma_f32_16x16x32_bf16 v[84:87], v[88:91], v[76:79], v[84:87]
  v_accvgpr_write_b32 a224, v212
  v_accvgpr_write_b32 a225, v213
  v_accvgpr_write_b32 a226, v214
  v_accvgpr_write_b32 a227, v215
  v_mfma_f32_32x32x16_bf16 v[108:123], v[76:79], a[200:203], v[108:123]
  v_accvgpr_write_b32 a228, v216
  v_accvgpr_write_b32 a229, v217
  v_accvgpr_write_b32 a230, v218
  v_accvgpr_write_b32 a231, v219
  s_waitcnt lgkmcnt(8)
  v_mfma_f32_32x32x16_bf16 v[92:107], v[80:83], a[76:79], v[92:107]
  ds_read_b64_tr_b16 v[76:77], v36 offset:8192
  ds_read_b64_tr_b16 v[78:79], v36 offset:8704
  v_accvgpr_write_b32 a112, v220
  v_accvgpr_write_b32 a113, v221
  v_accvgpr_write_b32 a114, v222
  v_accvgpr_write_b32 a115, v223
  v_mfma_f32_32x32x16_bf16 v[108:123], v[80:83], a[204:207], v[108:123]
  v_accvgpr_write_b32 a116, v224
  v_accvgpr_write_b32 a117, v225
  v_accvgpr_write_b32 a118, v226
  v_accvgpr_write_b32 a119, v227
  s_waitcnt lgkmcnt(4)
  v_mfma_f32_32x32x16_bf16 v[92:107], v[68:71], a[80:83], v[92:107]
  ds_read_b64_tr_b16 v[80:81], v37 offset:8192
  ds_read_b64_tr_b16 v[82:83], v37 offset:8704
  v_mfma_f32_16x16x32_bf16 v[84:87], v[88:91], v[68:71], v[84:87]
  v_accvgpr_write_b32 a240, v228
  v_accvgpr_write_b32 a241, v229
  v_accvgpr_write_b32 a242, v230
  v_accvgpr_write_b32 a243, v231
  v_mfma_f32_32x32x16_bf16 v[108:123], v[68:71], a[208:211], v[108:123]
  v_accvgpr_write_b32 a244, v232
  v_accvgpr_write_b32 a245, v233
  v_accvgpr_write_b32 a246, v234
  v_accvgpr_write_b32 a247, v235
  v_dot2c_f32_bf16 v52, v156, v50
  v_dot2c_f32_bf16 v53, v156, v156
  v_dot2c_f32_bf16 v54, v164, v50
  v_dot2c_f32_bf16 v55, v164, v164
  v_dot2c_f32_bf16 v52, v157, v50
  v_dot2c_f32_bf16 v53, v157, v157
  v_dot2c_f32_bf16 v54, v165, v50
  v_dot2c_f32_bf16 v55, v165, v165
  v_dot2c_f32_bf16 v52, v158, v50
  v_dot2c_f32_bf16 v53, v158, v158
  v_dot2c_f32_bf16 v54, v166, v50
  v_dot2c_f32_bf16 v55, v166, v166
  v_dot2c_f32_bf16 v52, v159, v50
  v_dot2c_f32_bf16 v53, v159, v159
  v_dot2c_f32_bf16 v54, v167, v50
  v_dot2c_f32_bf16 v55, v167, v167
  v_dot2c_f32_bf16 v52, v160, v50
  v_dot2c_f32_bf16 v53, v160, v160
  v_dot2c_f32_bf16 v54, v168, v50
  v_dot2c_f32_bf16 v55, v168, v168
  v_dot2c_f32_bf16 v52, v161, v50
  v_dot2c_f32_bf16 v53, v161, v161
  v_dot2c_f32_bf16 v54, v169, v50
  v_dot2c_f32_bf16 v55, v169, v169
  v_dot2c_f32_bf16 v52, v162, v50
  v_dot2c_f32_bf16 v53, v162, v162
  v_dot2c_f32_bf16 v54, v170, v50
  v_dot2c_f32_bf16 v55, v170, v170
  v_dot2c_f32_bf16 v52, v163, v50
  v_dot2c_f32_bf16 v53, v163, v163
  v_dot2c_f32_bf16 v54, v171, v50
  v_dot2c_f32_bf16 v55, v171, v171
  v_dot2c_f32_bf16 v52, v172, v50
  v_dot2c_f32_bf16 v53, v172, v172
  v_dot2c_f32_bf16 v54, v180, v50
  v_dot2c_f32_bf16 v55, v180, v180
  v_dot2c_f32_bf16 v52, v173, v50
  v_dot2c_f32_bf16 v53, v173, v173
  v_dot2c_f32_bf16 v54, v181, v50
  v_dot2c_f32_bf16 v55, v181, v181
  v_dot2c_f32_bf16 v52, v174, v50
  v_dot2c_f32_bf16 v53, v174, v174
  v_dot2c_f32_bf16 v54, v182, v50
  v_dot2c_f32_bf16 v55, v182, v182
  v_dot2c_f32_bf16 v52, v175, v50
  v_dot2c_f32_bf16 v53, v175, v175
  v_dot2c_f32_bf16 v54, v183, v50
  v_dot2c_f32_bf16 v55, v183, v183
  v_dot2c_f32_bf16 v52, v176, v50
  v_dot2c_f32_bf16 v53, v176, v176
  v_dot2c_f32_bf16 v54, v184, v50
  v_dot2c_f32_bf16 v55, v184, v184
  v_dot2c_f32_bf16 v52, v177, v50
  v_dot2c_f32_bf16 v53, v177, v177
  v_dot2c_f32_bf16 v54, v185, v50
  v_dot2c_f32_bf16 v55, v185, v185
  v_dot2c_f32_bf16 v52, v178, v50
  v_dot2c_f32_bf16 v53, v178, v178
  v_dot2c_f32_bf16 v54, v186, v50
  v_dot2c_f32_bf16 v55, v186, v186
  v_dot2c_f32_bf16 v52, v179, v50
  v_dot2c_f32_bf16 v53, v179, v179
  v_dot2c_f32_bf16 v54, v187, v50
  v_dot2c_f32_bf16 v55, v187, v187
  v_dot2c_f32_bf16 v52, v204, v50
  v_dot2c_f32_bf16 v53, v204, v204
  v_dot2c_f32_bf16 v54, v212, v50
  v_dot2c_f32_bf16 v55, v212, v212
  v_dot2c_f32_bf16 v52, v205, v50
  v_dot2c_f32_bf16 v53, v205, v205
  v_dot2c_f32_bf16 v54, v213, v50
  v_dot2c_f32_bf16 v55, v213, v213
  v_dot2c_f32_bf16 v52, v206, v50
  v_dot2c_f32_bf16 v53, v206, v206
  v_dot2c_f32_bf16 v54, v214, v50
  v_dot2c_f32_bf16 v55, v214, v214
  v_dot2c_f32_bf16 v52, v207, v50
  v_dot2c_f32_bf16 v53, v207, v207
  v_dot2c_f32_bf16 v54, v215, v50
  v_dot2c_f32_bf16 v55, v215, v215
  v_dot2c_f32_bf16 v52, v208, v50
  v_dot2c_f32_bf16 v53, v208, v208
  v_dot2c_f32_bf16 v54, v216, v50
  v_dot2c_f32_bf16 v55, v216, v216
  v_dot2c_f32_bf16 v52, v209, v50
  v_dot2c_f32_bf16 v53, v209, v209
  v_dot2c_f32_bf16 v54, v217, v50
  v_dot2c_f32_bf16 v55, v217, v217
  v_dot2c_f32_bf16 v52, v210, v50
  v_dot2c_f32_bf16 v53, v210, v210
  v_dot2c_f32_bf16 v54, v218, v50
  v_dot2c_f32_bf16 v55, v218, v218
  v_dot2c_f32_bf16 v52, v211, v50
  v_dot2c_f32_bf16 v53, v211, v211
  v_dot2c_f32_bf16 v54, v219, v50
  v_dot2c_f32_bf16 v55, v219, v219
  v_dot2c_f32_bf16 v52, v220, v50
  v_dot2c_f32_bf16 v53, v220, v220
  v_dot2c_f32_bf16 v54, v228, v50
  v_dot2c_f32_bf16 v55, v228, v228
  v_dot2c_f32_bf16 v52, v221, v50
  v_dot2c_f32_bf16 v53, v221, v221
  v_dot2c_f32_bf16 v54, v229, v50
  v_dot2c_f32_bf16 v55, v229, v229
  v_dot2c_f32_bf16 v52, v222, v50
  v_dot2c_f32_bf16 v53, v222, v222
  v_dot2c_f32_bf16 v54, v230, v50
  v_dot2c_f32_bf16 v55, v230, v230
  v_dot2c_f32_bf16 v52, v223, v50
  v_dot2c_f32_bf16 v53, v223, v223
  v_dot2c_f32_bf16 v54, v231, v50
  v_dot2c_f32_bf16 v55, v231, v231
  v_dot2c_f32_bf16 v52, v224, v50
  v_dot2c_f32_bf16 v53, v224, v224
  v_dot2c_f32_bf16 v54, v232, v50
  v_dot2c_f32_bf16 v55, v232, v232
  v_dot2c_f32_bf16 v52, v225, v50
  v_dot2c_f32_bf16 v53, v225, v225
  v_dot2c_f32_bf16 v54, v233, v50
  v_dot2c_f32_bf16 v55, v233, v233
  v_dot2c_f32_bf16 v52, v226, v50
  v_dot2c_f32_bf16 v53, v226, v226
  v_dot2c_f32_bf16 v54, v234, v50
  v_dot2c_f32_bf16 v55, v234, v234
  v_dot2c_f32_bf16 v52, v227, v50
  v_dot2c_f32_bf16 v53, v227, v227
  v_dot2c_f32_bf16 v54, v235, v50
  v_dot2c_f32_bf16 v55, v235, v235
  s_waitcnt vmcnt(12)
  s_barrier
  s_waitcnt lgkmcnt(4)
  v_mfma_f32_32x32x16_bf16 v[92:107], v[72:75], a[84:87], v[92:107]
  ds_read_b64_tr_b16 v[68:69], v38 offset:0
  ds_read_b64_tr_b16 v[70:71], v38 offset:512
  s_add_u32 m0, s72, 81920
  s_add_u32 s73, s0, 3
  s_and_b32 s73, s73, 3
  s_mul_i32 s73, s73, 393216
  s_add_u32 s73, s73, s81
  buffer_load_dwordx4 v9, s[24:27], s73 offen offset:0 lds
  buffer_load_dwordx4 v10, s[24:27], s73 offen offset:1024 lds
  buffer_load_dwordx4 v11, s[24:27], s73 offen offset:2048 lds
  buffer_load_dwordx4 v12, s[24:27], s73 offen offset:3072 lds
  v_mfma_f32_32x32x16_bf16 v[108:123], v[72:75], a[212:215], v[108:123]
  s_waitcnt lgkmcnt(4)
  v_mfma_f32_32x32x16_bf16 v[92:107], v[76:79], a[88:91], v[92:107]
  ds_read_b64_tr_b16 v[72:73], v39 offset:0
  ds_read_b64_tr_b16 v[74:75], v39 offset:512
  v_permlane32_swap_b32 v52, v53
  v_permlane32_swap_b32 v54, v55
  v_mfma_f32_16x16x32_bf16 v[84:87], v[88:91], v[76:79], v[84:87]
  s_add_u32 m0, s72, 16384
  s_add_u32 s73, s1, 0
  s_and_b32 s73, s73, 7
  s_mul_i32 s73, s73, 128
  s_add_u32 s73, s73, s79
  buffer_load_dwordx4 v5, s[32:35], s73 offen offset:0 lds
  buffer_load_dwordx4 v6, s[32:35], s73 offen offset:1024 lds
  buffer_load_dwordx4 v7, s[32:35], s73 offen offset:2048 lds
  buffer_load_dwordx4 v8, s[32:35], s73 offen offset:3072 lds
  v_mfma_f32_32x32x16_bf16 v[108:123], v[76:79], a[216:219], v[108:123]
  v_add_f32 v52, v52, v53
  v_add_f32 v54, v54, v55
  ds_write_b32 v48, v52 offset:0
  ds_write_b32 v48, v54 offset:256
  v_xor_b32 v244, 512, v48
  s_waitcnt lgkmcnt(6)
  v_mfma_f32_32x32x16_bf16 v[92:107], v[80:83], a[92:95], v[92:107]
  ds_read_b64_tr_b16 v[76:77], v40 offset:0
  ds_read_b64_tr_b16 v[78:79], v40 offset:512
  s_add_u32 m0, s72, 49152
  s_add_u32 s73, s1, 0
  s_and_b32 s73, s73, 7
  s_mul_i32 s73, s73, 128
  s_add_u32 s73, s73, s78
  buffer_load_dwordx4 v5, s[32:35], s73 offen offset:0 lds
  buffer_load_dwordx4 v6, s[32:35], s73 offen offset:1024 lds
  buffer_load_dwordx4 v7, s[32:35], s73 offen offset:2048 lds
  buffer_load_dwordx4 v8, s[32:35], s73 offen offset:3072 lds
  v_mfma_f32_32x32x16_bf16 v[108:123], v[80:83], a[220:223], v[108:123]
  s_waitcnt lgkmcnt(6)
  v_mfma_f32_32x32x16_bf16 v[92:107], v[68:71], a[96:99], v[92:107]
  ds_read_b64_tr_b16 v[80:81], v41 offset:0
  ds_read_b64_tr_b16 v[82:83], v41 offset:512
  v_mfma_f32_16x16x32_bf16 v[84:87], v[88:91], v[68:71], v[84:87]
  v_mfma_f32_32x32x16_bf16 v[108:123], v[68:71], a[224:227], v[108:123]
  v_bfe_u32 v248, v1, 1, 4
  v_mul_u32_u24 v248, 3072, v248
  v_and_b32 v249, 1, v1
  v_mul_u32_u24 v249, 124, v249
  v_add_u32_e64 v248, v248, v249
  s_lshl_b32 s74, s3, 2
  s_add_u32 s74, s74, s44
  s_mul_i32 s74, s74, 49152
  s_add_u32 s74, s74, s82
  s_mov_b64 exec, 0xffffffff
  buffer_load_dword v4, v248, s[24:27], s74 offen
  s_mov_b64 exec, -1
  s_waitcnt lgkmcnt(6)
  v_mfma_f32_32x32x16_bf16 v[92:107], v[72:75], a[100:103], v[92:107]
  ds_read_b64_tr_b16 v[68:69], v38 offset:8192
  ds_read_b64_tr_b16 v[70:71], v38 offset:8704
  v_mfma_f32_32x32x16_bf16 v[108:123], v[72:75], a[228:231], v[108:123]
  s_waitcnt lgkmcnt(4)
  v_mfma_f32_32x32x16_bf16 v[92:107], v[76:79], a[104:107], v[92:107]
  ds_read_b64_tr_b16 v[72:73], v39 offset:8192
  ds_read_b64_tr_b16 v[74:75], v39 offset:8704
  v_mfma_f32_16x16x32_bf16 v[84:87], v[88:91], v[76:79], v[84:87]
  v_mfma_f32_32x32x16_bf16 v[108:123], v[76:79], a[232:235], v[108:123]
  s_waitcnt lgkmcnt(4)
  v_mfma_f32_32x32x16_bf16 v[92:107], v[80:83], a[108:111], v[92:107]
  ds_read_b64_tr_b16 v[76:77], v40 offset:8192
  ds_read_b64_tr_b16 v[78:79], v40 offset:8704
  v_mfma_f32_32x32x16_bf16 v[108:123], v[80:83], a[236:239], v[108:123]
  s_waitcnt lgkmcnt(4)
  v_mfma_f32_32x32x16_bf16 v[92:107], v[68:71], a[112:115], v[92:107]
  ds_read_b64_tr_b16 v[80:81], v41 offset:8192
  ds_read_b64_tr_b16 v[82:83], v41 offset:8704
  v_mfma_f32_16x16x32_bf16 v[84:87], v[88:91], v[68:71], v[84:87]
  v_mfma_f32_32x32x16_bf16 v[108:123], v[68:71], a[240:243], v[108:123]
  s_waitcnt vmcnt(21)
  s_barrier
  s_waitcnt lgkmcnt(4)
  v_mfma_f32_32x32x16_bf16 v[92:107], v[72:75], a[116:119], v[92:107]
  ds_read_b64_tr_b16 v[68:69], v34 offset:32768
  ds_read_b64_tr_b16 v[70:71], v34 offset:33280
  ds_read_b32 v53, v244 offset:0
  ds_read_b32 v55, v244 offset:256
  s_waitcnt lgkmcnt(1)
  v_add_f32 v52, v52, v53
  s_waitcnt lgkmcnt(0)
  v_add_f32 v54, v54, v55
  v_mov_b32 v53, v52
  v_mov_b32_e64 v55, v54
  v_mfma_f32_16x16x32_bf16 v[84:87], v[88:91], v[76:79], v[84:87]
  v_permlane32_swap_b32 v52, v53
  v_mfma_f32_32x32x16_bf16 v[108:123], v[72:75], a[244:247], v[108:123]
  v_permlane32_swap_b32 v54, v55
  v_mul_f32 v56, 0xbb000000, v52
  v_mul_f32 v62, 0xbb000000, v54
  v_mul_f32 v245, 0x3b000000, v53
  v_mul_f32 v246, 0x3b000000, v55
  v_fma_f32 v245, -v56, v56, v245
  v_fma_f32 v246, -v62, v62, v246
  v_mfma_f32_32x32x16_bf16 v[92:107], v[76:79], a[120:123], v[92:107]
  ds_read_b64_tr_b16 v[72:73], v35 offset:32768
  ds_read_b64_tr_b16 v[74:75], v35 offset:33280
  v_max_f32 v245, 0, v245
  v_max_f32 v246, 0, v246
  v_add_f32 v245, 0x3727c5ac, v245
  v_add_f32 v246, 0x3727c5ac, v246
  v_rsq_f32_e64 v57, v245
  v_mfma_f32_32x32x16_bf16 v[108:123], v[76:79], a[248:251], v[108:123]
  v_rsq_f32 v63, v246
  v_sqrt_f32 v58, v245
  v_sqrt_f32_e64 v64, v246
  v_mul_f32 v59, 0xc0135761, v57
  v_mul_f32 v65, 0xc0135761, v63
  v_mfma_f32_32x32x16_bf16 v[92:107], v[80:83], a[124:127], v[92:107]
  ds_read_b64_tr_b16 v[76:77], v36 offset:32768
  ds_read_b64_tr_b16 v[78:79], v36 offset:33280
  ds_write_b32 v49, v84 offset:0
  v_mul_f32 v245, v57, v57
  v_mul_f32 v246, v63, v63
  v_mul_f32 v52, 0xbdd2d3e8, v57
  v_mul_f32 v54, 0xbdd2d3e8, v63
  v_mul_f32_e64 v60, v245, v52
  v_mfma_f32_32x32x16_bf16 v[108:123], v[80:83], a[252:255], v[108:123]
  v_mul_f32_e64 v66, v246, v54
  s_waitcnt lgkmcnt(0)
  s_barrier
  ds_read_b128 v[204:207], v44 offset:0
  ds_read_b128 v[220:223], v44 offset:256
  ds_read_b128 v[208:211], v44 offset:32
  ds_read_b128 v[224:227], v44 offset:288
  ds_read_b128 v[212:215], v44 offset:64
  ds_read_b128 v[228:231], v44 offset:320
  ds_read_b128 v[216:219], v44 offset:96
  ds_read_b128 v[232:235], v44 offset:352
  s_waitcnt lgkmcnt(6)
  v_pk_add_f32 v[204:205], v[204:205], v[220:221] op_sel:[0,0] op_sel_hi:[1,1]
  v_pk_add_f32 v[206:207], v[206:207], v[222:223] op_sel:[0,0] op_sel_hi:[1,1]
  s_waitcnt lgkmcnt(4)
  v_pk_add_f32 v[208:209], v[208:209], v[224:225] op_sel:[0,0] op_sel_hi:[1,1]
  v_pk_add_f32 v[210:211], v[210:211], v[226:227] op_sel:[0,0] op_sel_hi:[1,1]
  s_waitcnt lgkmcnt(2)
  v_pk_add_f32 v[212:213], v[212:213], v[228:229] op_sel:[0,0] op_sel_hi:[1,1]
  v_pk_add_f32 v[214:215], v[214:215], v[230:231] op_sel:[0,0] op_sel_hi:[1,1]
  s_waitcnt lgkmcnt(0)
  v_pk_add_f32 v[216:217], v[216:217], v[232:233] op_sel:[0,0] op_sel_hi:[1,1]
  v_pk_add_f32 v[218:219], v[218:219], v[234:235] op_sel:[0,0] op_sel_hi:[1,1]
  s_buffer_load_dword s71, s[40:43], 0
  v_pk_fma_f32 v[92:93], v[204:205], v[56:57], v[92:93] op_sel:[0,0,0] op_sel_hi:[1,0,1]
  v_pk_fma_f32 v[94:95], v[206:207], v[56:57], v[94:95] op_sel:[0,0,0] op_sel_hi:[1,0,1]
  v_pk_fma_f32 v[96:97], v[208:209], v[56:57], v[96:97] op_sel:[0,0,0] op_sel_hi:[1,0,1]
  v_pk_fma_f32 v[98:99], v[210:211], v[56:57], v[98:99] op_sel:[0,0,0] op_sel_hi:[1,0,1]
  v_pk_mul_f32 v[220:221], v[92:93], v[92:93] op_sel:[0,0] op_sel_hi:[1,1]
  v_pk_mul_f32 v[222:223], v[94:95], v[94:95] op_sel:[0,0] op_sel_hi:[1,1]
  v_pk_mul_f32 v[224:225], v[96:97], v[96:97] op_sel:[0,0] op_sel_hi:[1,1]
  v_pk_mul_f32 v[226:227], v[98:99], v[98:99] op_sel:[0,0] op_sel_hi:[1,1]
  v_pk_fma_f32 v[220:221], v[220:221], v[60:61], v[58:59] op_sel:[0,0,1] op_sel_hi:[1,0,1]
  v_pk_fma_f32 v[222:223], v[222:223], v[60:61], v[58:59] op_sel:[0,0,1] op_sel_hi:[1,0,1]
  v_pk_fma_f32 v[224:225], v[224:225], v[60:61], v[58:59] op_sel:[0,0,1] op_sel_hi:[1,0,1]
  v_pk_fma_f32 v[226:227], v[226:227], v[60:61], v[58:59] op_sel:[0,0,1] op_sel_hi:[1,0,1]
  v_pk_mul_f32 v[220:221], v[220:221], v[92:93] op_sel:[0,0] op_sel_hi:[1,1]
  v_pk_mul_f32 v[222:223], v[222:223], v[94:95] op_sel:[0,0] op_sel_hi:[1,1]
  v_pk_mul_f32 v[224:225], v[224:225], v[96:97] op_sel:[0,0] op_sel_hi:[1,1]
  v_pk_mul_f32 v[226:227], v[226:227], v[98:99] op_sel:[0,0] op_sel_hi:[1,1]
  v_exp_f32 v220, v220
  v_exp_f32 v221, v221
  v_exp_f32 v222, v222
  v_exp_f32 v223, v223
  v_exp_f32 v224, v224
  v_exp_f32 v225, v225
  v_exp_f32 v226, v226
  v_exp_f32 v227, v227
  v_pk_fma_f32 v[220:221], v[220:221], v[58:59], v[58:59] op_sel:[0,0,0] op_sel_hi:[1,0,0]
  v_pk_fma_f32 v[222:223], v[222:223], v[58:59], v[58:59] op_sel:[0,0,0] op_sel_hi:[1,0,0]
  v_pk_fma_f32 v[224:225], v[224:225], v[58:59], v[58:59] op_sel:[0,0,0] op_sel_hi:[1,0,0]
  v_pk_fma_f32 v[226:227], v[226:227], v[58:59], v[58:59] op_sel:[0,0,0] op_sel_hi:[1,0,0]
  v_rcp_f32 v220, v220
  v_rcp_f32 v221, v221
  v_rcp_f32 v222, v222
  v_rcp_f32 v223, v223
  v_rcp_f32 v224, v224
  v_rcp_f32 v225, v225
  v_rcp_f32 v226, v226
  v_rcp_f32 v227, v227
  v_pk_mul_f32 v[92:93], v[92:93], v[220:221] op_sel:[0,0] op_sel_hi:[1,1]
  v_pk_mul_f32 v[94:95], v[94:95], v[222:223] op_sel:[0,0] op_sel_hi:[1,1]
  v_pk_mul_f32 v[96:97], v[96:97], v[224:225] op_sel:[0,0] op_sel_hi:[1,1]
  v_pk_mul_f32 v[98:99], v[98:99], v[226:227] op_sel:[0,0] op_sel_hi:[1,1]
  v_mov_b64 v[188:189], v[92:93]
  v_pk_mul_f32 v[190:191], v[92:93], v[92:93] op_sel:[0,0] op_sel_hi:[1,1]
  v_pk_add_f32 v[188:189], v[188:189], v[94:95] op_sel:[0,0] op_sel_hi:[1,1]
  v_pk_fma_f32 v[190:191], v[94:95], v[94:95], v[190:191] op_sel:[0,0,0] op_sel_hi:[1,1,1]
  v_pk_add_f32 v[188:189], v[188:189], v[96:97] op_sel:[0,0] op_sel_hi:[1,1]
  v_pk_fma_f32 v[190:191], v[96:97], v[96:97], v[190:191] op_sel:[0,0,0] op_sel_hi:[1,1,1]
  v_pk_add_f32 v[188:189], v[188:189], v[98:99] op_sel:[0,0] op_sel_hi:[1,1]
  v_pk_fma_f32 v[190:191], v[98:99], v[98:99], v[190:191] op_sel:[0,0,0] op_sel_hi:[1,1,1]
  v_pk_fma_f32 v[100:101], v[212:213], v[56:57], v[100:101] op_sel:[0,0,0] op_sel_hi:[1,0,1]
  v_pk_fma_f32 v[102:103], v[214:215], v[56:57], v[102:103] op_sel:[0,0,0] op_sel_hi:[1,0,1]
  v_pk_fma_f32 v[104:105], v[216:217], v[56:57], v[104:105] op_sel:[0,0,0] op_sel_hi:[1,0,1]
  v_pk_fma_f32 v[106:107], v[218:219], v[56:57], v[106:107] op_sel:[0,0,0] op_sel_hi:[1,0,1]
  v_pk_mul_f32 v[228:229], v[100:101], v[100:101] op_sel:[0,0] op_sel_hi:[1,1]
  v_pk_mul_f32 v[230:231], v[102:103], v[102:103] op_sel:[0,0] op_sel_hi:[1,1]
  v_pk_mul_f32 v[232:233], v[104:105], v[104:105] op_sel:[0,0] op_sel_hi:[1,1]
  v_pk_mul_f32 v[234:235], v[106:107], v[106:107] op_sel:[0,0] op_sel_hi:[1,1]
  v_pk_fma_f32 v[228:229], v[228:229], v[60:61], v[58:59] op_sel:[0,0,1] op_sel_hi:[1,0,1]
  v_pk_fma_f32 v[230:231], v[230:231], v[60:61], v[58:59] op_sel:[0,0,1] op_sel_hi:[1,0,1]
  v_pk_fma_f32 v[232:233], v[232:233], v[60:61], v[58:59] op_sel:[0,0,1] op_sel_hi:[1,0,1]
  v_pk_fma_f32 v[234:235], v[234:235], v[60:61], v[58:59] op_sel:[0,0,1] op_sel_hi:[1,0,1]
  v_pk_mul_f32 v[228:229], v[228:229], v[100:101] op_sel:[0,0] op_sel_hi:[1,1]
  v_pk_mul_f32 v[230:231], v[230:231], v[102:103] op_sel:[0,0] op_sel_hi:[1,1]
  v_pk_mul_f32 v[232:233], v[232:233], v[104:105] op_sel:[0,0] op_sel_hi:[1,1]
  v_pk_mul_f32 v[234:235], v[234:235], v[106:107] op_sel:[0,0] op_sel_hi:[1,1]
  v_exp_f32 v228, v228
  v_exp_f32 v229, v229
  v_exp_f32 v230, v230
  v_exp_f32 v231, v231
  v_exp_f32 v232, v232
  v_exp_f32 v233, v233
  v_exp_f32 v234, v234
  v_exp_f32_e64 v235, v235
  v_pk_fma_f32 v[228:229], v[228:229], v[58:59], v[58:59] op_sel:[0,0,0] op_sel_hi:[1,0,0]
  v_pk_fma_f32 v[230:231], v[230:231], v[58:59], v[58:59] op_sel:[0,0,0] op_sel_hi:[1,0,0]
  v_pk_fma_f32 v[232:233], v[232:233], v[58:59], v[58:59] op_sel:[0,0,0] op_sel_hi:[1,0,0]
  v_pk_fma_f32 v[234:235], v[234:235], v[58:59], v[58:59] op_sel:[0,0,0] op_sel_hi:[1,0,0]
  v_rcp_f32 v228, v228
  v_rcp_f32 v229, v229
  v_rcp_f32 v230, v230
  v_rcp_f32 v231, v231
  v_rcp_f32 v232, v232
  v_rcp_f32 v233, v233
  v_rcp_f32 v234, v234
  v_rcp_f32 v235, v235
  v_pk_mul_f32 v[100:101], v[100:101], v[228:229] op_sel:[0,0] op_sel_hi:[1,1]
  v_pk_mul_f32 v[102:103], v[102:103], v[230:231] op_sel:[0,0] op_sel_hi:[1,1]
  v_pk_mul_f32 v[104:105], v[104:105], v[232:233] op_sel:[0,0] op_sel_hi:[1,1]
  v_pk_mul_f32 v[106:107], v[106:107], v[234:235] op_sel:[0,0] op_sel_hi:[1,1]
  v_mov_b64 v[192:193], v[100:101]
  v_pk_mul_f32 v[194:195], v[100:101], v[100:101] op_sel:[0,0] op_sel_hi:[1,1]
  v_pk_add_f32 v[192:193], v[192:193], v[102:103] op_sel:[0,0] op_sel_hi:[1,1]
  v_pk_fma_f32 v[194:195], v[102:103], v[102:103], v[194:195] op_sel:[0,0,0] op_sel_hi:[1,1,1]
  v_pk_add_f32 v[192:193], v[192:193], v[104:105] op_sel:[0,0] op_sel_hi:[1,1]
  v_pk_fma_f32 v[194:195], v[104:105], v[104:105], v[194:195] op_sel:[0,0,0] op_sel_hi:[1,1,1]
  v_pk_add_f32 v[192:193], v[192:193], v[106:107] op_sel:[0,0] op_sel_hi:[1,1]
  v_pk_fma_f32 v[194:195], v[106:107], v[106:107], v[194:195] op_sel:[0,0,0] op_sel_hi:[1,1,1]
  v_pk_fma_f32 v[108:109], v[204:205], v[62:63], v[108:109] op_sel:[0,0,0] op_sel_hi:[1,0,1]
  v_pk_fma_f32 v[110:111], v[206:207], v[62:63], v[110:111] op_sel:[0,0,0] op_sel_hi:[1,0,1]
  v_pk_fma_f32 v[112:113], v[208:209], v[62:63], v[112:113] op_sel:[0,0,0] op_sel_hi:[1,0,1]
  v_pk_fma_f32 v[114:115], v[210:211], v[62:63], v[114:115] op_sel:[0,0,0] op_sel_hi:[1,0,1]
  v_pk_mul_f32 v[220:221], v[108:109], v[108:109] op_sel:[0,0] op_sel_hi:[1,1]
  v_pk_mul_f32 v[222:223], v[110:111], v[110:111] op_sel:[0,0] op_sel_hi:[1,1]
  v_pk_mul_f32 v[224:225], v[112:113], v[112:113] op_sel:[0,0] op_sel_hi:[1,1]
  v_pk_mul_f32 v[226:227], v[114:115], v[114:115] op_sel:[0,0] op_sel_hi:[1,1]
  v_pk_fma_f32 v[220:221], v[220:221], v[66:67], v[64:65] op_sel:[0,0,1] op_sel_hi:[1,0,1]
  v_pk_fma_f32 v[222:223], v[222:223], v[66:67], v[64:65] op_sel:[0,0,1] op_sel_hi:[1,0,1]
  v_pk_fma_f32 v[224:225], v[224:225], v[66:67], v[64:65] op_sel:[0,0,1] op_sel_hi:[1,0,1]
  v_pk_fma_f32 v[226:227], v[226:227], v[66:67], v[64:65] op_sel:[0,0,1] op_sel_hi:[1,0,1]
  v_pk_mul_f32 v[220:221], v[220:221], v[108:109] op_sel:[0,0] op_sel_hi:[1,1]
  v_pk_mul_f32 v[222:223], v[222:223], v[110:111] op_sel:[0,0] op_sel_hi:[1,1]
  v_pk_mul_f32 v[224:225], v[224:225], v[112:113] op_sel:[0,0] op_sel_hi:[1,1]
  v_pk_mul_f32 v[226:227], v[226:227], v[114:115] op_sel:[0,0] op_sel_hi:[1,1]
  v_exp_f32 v220, v220
  v_exp_f32 v221, v221
  v_exp_f32 v222, v222
  v_exp_f32 v223, v223
  v_exp_f32 v224, v224
  v_exp_f32 v225, v225
  v_exp_f32 v226, v226
  v_exp_f32_e64 v227, v227
  v_pk_fma_f32 v[220:221], v[220:221], v[64:65], v[64:65] op_sel:[0,0,0] op_sel_hi:[1,0,0]
  v_pk_fma_f32 v[222:223], v[222:223], v[64:65], v[64:65] op_sel:[0,0,0] op_sel_hi:[1,0,0]
  v_pk_fma_f32 v[224:225], v[224:225], v[64:65], v[64:65] op_sel:[0,0,0] op_sel_hi:[1,0,0]
  v_pk_fma_f32 v[226:227], v[226:227], v[64:65], v[64:65] op_sel:[0,0,0] op_sel_hi:[1,0,0]
  v_rcp_f32 v220, v220
  v_rcp_f32 v221, v221
  v_rcp_f32 v222, v222
  v_rcp_f32 v223, v223
  v_rcp_f32 v224, v224
  v_rcp_f32 v225, v225
  v_rcp_f32 v226, v226
  v_rcp_f32 v227, v227
  v_pk_mul_f32 v[108:109], v[108:109], v[220:221] op_sel:[0,0] op_sel_hi:[1,1]
  v_pk_mul_f32 v[110:111], v[110:111], v[222:223] op_sel:[0,0] op_sel_hi:[1,1]
  v_pk_mul_f32 v[112:113], v[112:113], v[224:225] op_sel:[0,0] op_sel_hi:[1,1]
  v_pk_mul_f32 v[114:115], v[114:115], v[226:227] op_sel:[0,0] op_sel_hi:[1,1]
  v_mov_b64 v[196:197], v[108:109]
  v_pk_mul_f32 v[198:199], v[108:109], v[108:109] op_sel:[0,0] op_sel_hi:[1,1]
  v_pk_add_f32 v[196:197], v[196:197], v[110:111] op_sel:[0,0] op_sel_hi:[1,1]
  v_pk_fma_f32 v[198:199], v[110:111], v[110:111], v[198:199] op_sel:[0,0,0] op_sel_hi:[1,1,1]
  v_pk_add_f32 v[196:197], v[196:197], v[112:113] op_sel:[0,0] op_sel_hi:[1,1]
  v_pk_fma_f32 v[198:199], v[112:113], v[112:113], v[198:199] op_sel:[0,0,0] op_sel_hi:[1,1,1]
  v_pk_add_f32 v[196:197], v[196:197], v[114:115] op_sel:[0,0] op_sel_hi:[1,1]
  v_pk_fma_f32 v[198:199], v[114:115], v[114:115], v[198:199] op_sel:[0,0,0] op_sel_hi:[1,1,1]
  v_pk_fma_f32 v[116:117], v[212:213], v[62:63], v[116:117] op_sel:[0,0,0] op_sel_hi:[1,0,1]
  v_pk_fma_f32 v[118:119], v[214:215], v[62:63], v[118:119] op_sel:[0,0,0] op_sel_hi:[1,0,1]
  v_pk_fma_f32 v[120:121], v[216:217], v[62:63], v[120:121] op_sel:[0,0,0] op_sel_hi:[1,0,1]
  v_pk_fma_f32 v[122:123], v[218:219], v[62:63], v[122:123] op_sel:[0,0,0] op_sel_hi:[1,0,1]
  v_pk_mul_f32 v[228:229], v[116:117], v[116:117] op_sel:[0,0] op_sel_hi:[1,1]
  v_pk_mul_f32 v[230:231], v[118:119], v[118:119] op_sel:[0,0] op_sel_hi:[1,1]
  v_pk_mul_f32 v[232:233], v[120:121], v[120:121] op_sel:[0,0] op_sel_hi:[1,1]
  v_pk_mul_f32 v[234:235], v[122:123], v[122:123] op_sel:[0,0] op_sel_hi:[1,1]
  v_pk_fma_f32 v[228:229], v[228:229], v[66:67], v[64:65] op_sel:[0,0,1] op_sel_hi:[1,0,1]
  v_pk_fma_f32 v[230:231], v[230:231], v[66:67], v[64:65] op_sel:[0,0,1] op_sel_hi:[1,0,1]
  v_pk_fma_f32 v[232:233], v[232:233], v[66:67], v[64:65] op_sel:[0,0,1] op_sel_hi:[1,0,1]
  v_pk_fma_f32 v[234:235], v[234:235], v[66:67], v[64:65] op_sel:[0,0,1] op_sel_hi:[1,0,1]
  v_pk_mul_f32 v[228:229], v[228:229], v[116:117] op_sel:[0,0] op_sel_hi:[1,1]
  v_pk_mul_f32 v[230:231], v[230:231], v[118:119] op_sel:[0,0] op_sel_hi:[1,1]
  v_pk_mul_f32 v[232:233], v[232:233], v[120:121] op_sel:[0,0] op_sel_hi:[1,1]
  v_pk_mul_f32 v[234:235], v[234:235], v[122:123] op_sel:[0,0] op_sel_hi:[1,1]
  v_exp_f32 v228, v228
  v_exp_f32 v229, v229
  v_exp_f32 v230, v230
  v_exp_f32 v231, v231
  v_exp_f32 v232, v232
  v_exp_f32 v233, v233
  v_exp_f32 v234, v234
  v_exp_f32_e64 v235, v235
  v_pk_fma_f32 v[228:229], v[228:229], v[64:65], v[64:65] op_sel:[0,0,0] op_sel_hi:[1,0,0]
  v_pk_fma_f32 v[230:231], v[230:231], v[64:65], v[64:65] op_sel:[0,0,0] op_sel_hi:[1,0,0]
  v_pk_fma_f32 v[232:233], v[232:233], v[64:65], v[64:65] op_sel:[0,0,0] op_sel_hi:[1,0,0]
  v_pk_fma_f32 v[234:235], v[234:235], v[64:65], v[64:65] op_sel:[0,0,0] op_sel_hi:[1,0,0]
  v_rcp_f32 v228, v228
  v_rcp_f32 v229, v229
  v_rcp_f32 v230, v230
  v_rcp_f32 v231, v231
  v_rcp_f32 v232, v232
  v_rcp_f32 v233, v233
  v_rcp_f32 v234, v234
  v_rcp_f32 v235, v235
  v_pk_mul_f32 v[116:117], v[116:117], v[228:229] op_sel:[0,0] op_sel_hi:[1,1]
  v_pk_mul_f32 v[118:119], v[118:119], v[230:231] op_sel:[0,0] op_sel_hi:[1,1]
  v_pk_mul_f32 v[120:121], v[120:121], v[232:233] op_sel:[0,0] op_sel_hi:[1,1]
  v_pk_mul_f32 v[122:123], v[122:123], v[234:235] op_sel:[0,0] op_sel_hi:[1,1]
  v_mov_b64 v[200:201], v[116:117]
  v_pk_mul_f32 v[202:203], v[116:117], v[116:117] op_sel:[0,0] op_sel_hi:[1,1]
  v_pk_add_f32 v[200:201], v[200:201], v[118:119] op_sel:[0,0] op_sel_hi:[1,1]
  v_pk_fma_f32 v[202:203], v[118:119], v[118:119], v[202:203] op_sel:[0,0,0] op_sel_hi:[1,1,1]
  v_pk_add_f32 v[200:201], v[200:201], v[120:121] op_sel:[0,0] op_sel_hi:[1,1]
  v_pk_fma_f32 v[202:203], v[120:121], v[120:121], v[202:203] op_sel:[0,0,0] op_sel_hi:[1,1,1]
  v_pk_add_f32 v[200:201], v[200:201], v[122:123] op_sel:[0,0] op_sel_hi:[1,1]
  v_pk_fma_f32 v[202:203], v[122:123], v[122:123], v[202:203] op_sel:[0,0,0] op_sel_hi:[1,1,1]
  s_waitcnt lgkmcnt(0)
  s_cmp_eq_u32 s71, 0
  s_cbranch_scc1 SLOW_TGB
RET_TGB:
  s_mov_b32 s70, s71
  s_add_u32 m0, s72, 0
  s_add_u32 s73, s1, 1
  s_and_b32 s73, s73, 7
  s_mul_i32 s73, s73, 128
  s_add_u32 s73, s73, s79
  buffer_load_dwordx4 v5, s[32:35], s73 offen offset:0 lds
  buffer_load_dwordx4 v6, s[32:35], s73 offen offset:1024 lds
  buffer_load_dwordx4 v7, s[32:35], s73 offen offset:2048 lds
  buffer_load_dwordx4 v8, s[32:35], s73 offen offset:3072 lds
  v_add_f32 v188, v188, v189
  v_add_f32 v190, v190, v191
  v_add_f32 v192, v192, v193
  v_add_f32 v194, v194, v195
  v_and_b32 v188, s97, v188
  v_and_b32 v190, s97, v190
  v_and_b32 v192, s98, v192
  v_and_b32 v194, s98, v194
  v_add_f32 v236, v188, v192
  v_add_f32 v237, v190, v194
  v_add_f32 v196, v196, v197
  v_add_f32 v198, v198, v199
  v_add_f32 v200, v200, v201
  v_add_f32 v202, v202, v203
  v_and_b32 v196, s97, v196
  v_and_b32 v198, s97, v198
  v_and_b32 v200, s98, v200
  v_and_b32 v202, s98, v202
  v_add_f32 v238, v196, v200
  v_add_f32 v239, v198, v202
  v_permlane32_swap_b32 v236, v237
  s_nop 0
  v_permlane32_swap_b32 v238, v239
  v_add_f32 v236, v236, v237
  v_add_f32 v238, v238, v239
  ds_write_b32 v48, v236 offset:0
  ds_write_b32 v48, v238 offset:256
  s_lshl_b32 s74, s96, 8
  v_subrev_u32 v240, s74, v48
  v_mov_b32_e64 v243, s71
  s_waitcnt lgkmcnt(0)
  s_barrier
  v_mfma_f32_32x32x16_bf16 v[124:139], v[68:71], a[0:3], 0
  ds_read_b64_tr_b16 v[80:81], v37 offset:32768
  ds_read_b64_tr_b16 v[82:83], v37 offset:33280
  ds_read_b32 v242, v240
  ds_read_b32 v241, v240 offset:512
  s_waitcnt lgkmcnt(0)
  v_add_f32 v242, v242, v241
  buffer_store_dwordx2 v[242:243], v2, s[8:11], s92 offen sc1
  v_mfma_f32_16x16x32_bf16 v[84:87], v[88:91], v[68:71], 0
  v_cvt_pk_bf16_f32 v188, v92, v93
  v_cvt_pk_bf16_f32 v189, v94, v95
  v_mfma_f32_32x32x16_bf16 v[140:155], v[68:71], a[128:131], 0
  v_cvt_pk_bf16_f32 v190, v96, v97
  v_cvt_pk_bf16_f32 v191, v98, v99
  buffer_store_dwordx4 v[188:191], v2, s[8:11], s94 offen sc1
  v_cvt_pk_bf16_f32 v192, v100, v101
  v_cvt_pk_bf16_f32 v193, v102, v103
  v_cvt_pk_bf16_f32 v194, v104, v105
  v_mfma_f32_32x32x16_bf16 v[124:139], v[72:75], a[4:7], v[124:139]
  ds_read_b64_tr_b16 v[68:69], v34 offset:40960
  ds_read_b64_tr_b16 v[70:71], v34 offset:41472
  v_cvt_pk_bf16_f32 v195, v106, v107
  buffer_store_dwordx4 v[192:195], v2, s[8:11], s101 offen sc1
  v_cvt_pk_bf16_f32 v196, v108, v109
  v_cvt_pk_bf16_f32 v197, v110, v111
  v_mfma_f32_32x32x16_bf16 v[140:155], v[72:75], a[132:135], v[140:155]
  v_cvt_pk_bf16_f32 v198, v112, v113
  v_cvt_pk_bf16_f32 v199, v114, v115
  s_add_u32 s94, s94, 44032
  buffer_store_dwordx4 v[196:199], v2, s[8:11], s94 offen sc1
  v_cvt_pk_bf16_f32 v200, v116, v117
  v_cvt_pk_bf16_f32 v201, v118, v119
  v_mfma_f32_32x32x16_bf16 v[124:139], v[76:79], a[8:11], v[124:139]
  ds_read_b64_tr_b16 v[72:73], v35 offset:40960
  ds_read_b64_tr_b16 v[74:75], v35 offset:41472
  v_cvt_pk_bf16_f32 v202, v120, v121
  v_cvt_pk_bf16_f32 v203, v122, v123
  s_add_u32 s101, s101, 44032
  buffer_store_dwordx4 v[200:203], v2, s[8:11], s101 offen sc1
  v_mfma_f32_16x16x32_bf16 v[84:87], v[88:91], v[76:79], v[84:87]
  v_mfma_f32_32x32x16_bf16 v[140:155], v[76:79], a[136:139], v[140:155]
  v_mfma_f32_32x32x16_bf16 v[124:139], v[80:83], a[12:15], v[124:139]
  ds_read_b64_tr_b16 v[76:77], v36 offset:40960
  ds_read_b64_tr_b16 v[78:79], v36 offset:41472
  v_mfma_f32_32x32x16_bf16 v[140:155], v[80:83], a[140:143], v[140:155]
  s_waitcnt lgkmcnt(4)
  v_mfma_f32_32x32x16_bf16 v[124:139], v[68:71], a[16:19], v[124:139]
  ds_read_b64_tr_b16 v[80:81], v37 offset:40960
  ds_read_b64_tr_b16 v[82:83], v37 offset:41472
  v_mfma_f32_16x16x32_bf16 v[84:87], v[88:91], v[68:71], v[84:87]
  v_mfma_f32_32x32x16_bf16 v[140:155], v[68:71], a[144:147], v[140:155]
  s_waitcnt vmcnt(26)
  s_barrier
  s_waitcnt lgkmcnt(4)
  v_mfma_f32_32x32x16_bf16 v[124:139], v[72:75], a[20:23], v[124:139]
  ds_read_b64_tr_b16 v[68:69], v38 offset:32768
  ds_read_b64_tr_b16 v[70:71], v38 offset:33280
  s_add_u32 m0, s72, 65536
  s_add_u32 s73, s1, 1
  s_and_b32 s73, s73, 7
  s_mul_i32 s73, s73, 128
  s_add_u32 s73, s73, s78
  buffer_load_dwordx4 v5, s[32:35], s73 offen offset:0 lds
  buffer_load_dwordx4 v6, s[32:35], s73 offen offset:1024 lds
  buffer_load_dwordx4 v7, s[32:35], s73 offen offset:2048 lds
  buffer_load_dwordx4 v8, s[32:35], s73 offen offset:3072 lds
  v_mfma_f32_32x32x16_bf16 v[140:155], v[72:75], a[148:151], v[140:155]
  s_waitcnt lgkmcnt(4)
  v_mfma_f32_32x32x16_bf16 v[124:139], v[76:79], a[24:27], v[124:139]
  ds_read_b64_tr_b16 v[72:73], v39 offset:32768
  ds_read_b64_tr_b16 v[74:75], v39 offset:33280
  v_mfma_f32_16x16x32_bf16 v[84:87], v[88:91], v[76:79], v[84:87]
  v_mfma_f32_32x32x16_bf16 v[140:155], v[76:79], a[152:155], v[140:155]
  s_waitcnt lgkmcnt(4)
  v_mfma_f32_32x32x16_bf16 v[124:139], v[80:83], a[28:31], v[124:139]
  ds_read_b64_tr_b16 v[76:77], v40 offset:32768
  ds_read_b64_tr_b16 v[78:79], v40 offset:33280
  v_mfma_f32_32x32x16_bf16 v[140:155], v[80:83], a[156:159], v[140:155]
  s_waitcnt lgkmcnt(4)
  v_mfma_f32_32x32x16_bf16 v[124:139], v[68:71], a[32:35], v[124:139]
  ds_read_b64_tr_b16 v[80:81], v41 offset:32768
  ds_read_b64_tr_b16 v[82:83], v41 offset:33280
  v_mfma_f32_16x16x32_bf16 v[84:87], v[88:91], v[68:71], v[84:87]
  v_mfma_f32_32x32x16_bf16 v[140:155], v[68:71], a[160:163], v[140:155]
  s_waitcnt lgkmcnt(4)
  v_mfma_f32_32x32x16_bf16 v[124:139], v[72:75], a[36:39], v[124:139]
  ds_read_b64_tr_b16 v[68:69], v38 offset:40960
  ds_read_b64_tr_b16 v[70:71], v38 offset:41472
  v_mfma_f32_32x32x16_bf16 v[140:155], v[72:75], a[164:167], v[140:155]
  s_waitcnt lgkmcnt(4)
  v_mfma_f32_32x32x16_bf16 v[124:139], v[76:79], a[40:43], v[124:139]
  ds_read_b64_tr_b16 v[72:73], v39 offset:40960
  ds_read_b64_tr_b16 v[74:75], v39 offset:41472
  v_mfma_f32_16x16x32_bf16 v[84:87], v[88:91], v[76:79], v[84:87]
  v_mfma_f32_32x32x16_bf16 v[140:155], v[76:79], a[168:171], v[140:155]
  s_waitcnt lgkmcnt(4)
  v_mfma_f32_32x32x16_bf16 v[124:139], v[80:83], a[44:47], v[124:139]
  ds_read_b64_tr_b16 v[76:77], v40 offset:40960
  ds_read_b64_tr_b16 v[78:79], v40 offset:41472
  v_mfma_f32_32x32x16_bf16 v[140:155], v[80:83], a[172:175], v[140:155]
  s_waitcnt lgkmcnt(4)
  v_mfma_f32_32x32x16_bf16 v[124:139], v[68:71], a[48:51], v[124:139]
  ds_read_b64_tr_b16 v[80:81], v41 offset:40960
  ds_read_b64_tr_b16 v[82:83], v41 offset:41472
  v_mfma_f32_16x16x32_bf16 v[84:87], v[88:91], v[68:71], v[84:87]
  v_mfma_f32_32x32x16_bf16 v[140:155], v[68:71], a[176:179], v[140:155]
  s_waitcnt vmcnt(26)
  s_barrier
  s_waitcnt lgkmcnt(4)
  v_mfma_f32_32x32x16_bf16 v[124:139], v[72:75], a[52:55], v[124:139]
  ds_read_b64_tr_b16 v[68:69], v38 offset:49152
  ds_read_b64_tr_b16 v[70:71], v38 offset:49664
  v_mfma_f32_32x32x16_bf16 v[140:155], v[72:75], a[180:183], v[140:155]
  s_waitcnt lgkmcnt(4)
  v_mfma_f32_32x32x16_bf16 v[124:139], v[76:79], a[56:59], v[124:139]
  ds_read_b64_tr_b16 v[72:73], v39 offset:49152
  ds_read_b64_tr_b16 v[74:75], v39 offset:49664
  v_mfma_f32_16x16x32_bf16 v[84:87], v[88:91], v[76:79], v[84:87]
  v_mfma_f32_32x32x16_bf16 v[140:155], v[76:79], a[184:187], v[140:155]
  s_waitcnt lgkmcnt(4)
  v_mfma_f32_32x32x16_bf16 v[124:139], v[80:83], a[60:63], v[124:139]
  ds_read_b64_tr_b16 v[76:77], v40 offset:49152
  ds_read_b64_tr_b16 v[78:79], v40 offset:49664
  v_mfma_f32_32x32x16_bf16 v[140:155], v[80:83], a[188:191], v[140:155]
  s_waitcnt lgkmcnt(4)
  v_mfma_f32_32x32x16_bf16 v[124:139], v[68:71], a[64:67], v[124:139]
  ds_read_b64_tr_b16 v[80:81], v41 offset:49152
  ds_read_b64_tr_b16 v[82:83], v41 offset:49664
  v_mfma_f32_16x16x32_bf16 v[84:87], v[88:91], v[68:71], v[84:87]
  v_mfma_f32_32x32x16_bf16 v[140:155], v[68:71], a[192:195], v[140:155]
  s_waitcnt lgkmcnt(4)
  v_mfma_f32_32x32x16_bf16 v[124:139], v[72:75], a[68:71], v[124:139]
  ds_read_b64_tr_b16 v[68:69], v38 offset:57344
  ds_read_b64_tr_b16 v[70:71], v38 offset:57856
  v_mfma_f32_32x32x16_bf16 v[140:155], v[72:75], a[196:199], v[140:155]
  s_waitcnt lgkmcnt(4)
  v_mfma_f32_32x32x16_bf16 v[124:139], v[76:79], a[72:75], v[124:139]
  ds_read_b64_tr_b16 v[72:73], v39 offset:57344
  ds_read_b64_tr_b16 v[74:75], v39 offset:57856
  v_mfma_f32_16x16x32_bf16 v[84:87], v[88:91], v[76:79], v[84:87]
  v_mfma_f32_32x32x16_bf16 v[140:155], v[76:79], a[200:203], v[140:155]
  s_waitcnt lgkmcnt(4)
  v_mfma_f32_32x32x16_bf16 v[124:139], v[80:83], a[76:79], v[124:139]
  ds_read_b64_tr_b16 v[76:77], v40 offset:57344
  ds_read_b64_tr_b16 v[78:79], v40 offset:57856
  v_mfma_f32_32x32x16_bf16 v[140:155], v[80:83], a[204:207], v[140:155]
  s_waitcnt lgkmcnt(4)
  v_mfma_f32_32x32x16_bf16 v[124:139], v[68:71], a[80:83], v[124:139]
  ds_read_b64_tr_b16 v[80:81], v41 offset:57344
  ds_read_b64_tr_b16 v[82:83], v41 offset:57856
  v_mfma_f32_16x16x32_bf16 v[84:87], v[88:91], v[68:71], v[84:87]
  s_add_u32 m0, s72, 32768
  s_add_u32 s73, s0, 0
  s_and_b32 s73, s73, 3
  s_mul_i32 s73, s73, 393216
  s_add_u32 s73, s73, s82
  buffer_load_dwordx4 v9, s[24:27], s73 offen offset:0 lds
  buffer_load_dwordx4 v10, s[24:27], s73 offen offset:1024 lds
  buffer_load_dwordx4 v11, s[24:27], s73 offen offset:2048 lds
  buffer_load_dwordx4 v12, s[24:27], s73 offen offset:3072 lds
  v_mfma_f32_32x32x16_bf16 v[140:155], v[68:71], a[208:211], v[140:155]
  s_waitcnt vmcnt(26)
  s_barrier
  s_waitcnt lgkmcnt(4)
  v_mfma_f32_32x32x16_bf16 v[124:139], v[72:75], a[84:87], v[124:139]
  ds_read_b64_tr_b16 v[68:69], v38 offset:16384
  ds_read_b64_tr_b16 v[70:71], v38 offset:16896
  v_mfma_f32_32x32x16_bf16 v[140:155], v[72:75], a[212:215], v[140:155]
  s_waitcnt lgkmcnt(4)
  v_mfma_f32_32x32x16_bf16 v[124:139], v[76:79], a[88:91], v[124:139]
  ds_read_b64_tr_b16 v[72:73], v39 offset:16384
  ds_read_b64_tr_b16 v[74:75], v39 offset:16896
  v_mfma_f32_16x16x32_bf16 v[84:87], v[88:91], v[76:79], v[84:87]
  v_mfma_f32_32x32x16_bf16 v[140:155], v[76:79], a[216:219], v[140:155]
  s_waitcnt lgkmcnt(4)
  v_mfma_f32_32x32x16_bf16 v[124:139], v[80:83], a[92:95], v[124:139]
  ds_read_b64_tr_b16 v[76:77], v40 offset:16384
  ds_read_b64_tr_b16 v[78:79], v40 offset:16896
  v_mfma_f32_32x32x16_bf16 v[140:155], v[80:83], a[220:223], v[140:155]
  s_waitcnt lgkmcnt(4)
  v_mfma_f32_32x32x16_bf16 v[124:139], v[68:71], a[96:99], v[124:139]
  ds_read_b64_tr_b16 v[80:81], v41 offset:16384
  ds_read_b64_tr_b16 v[82:83], v41 offset:16896
  v_mfma_f32_16x16x32_bf16 v[84:87], v[88:91], v[68:71], v[84:87]
  s_add_u32 m0, s72, 98304
  s_add_u32 s73, s0, 1
  s_and_b32 s73, s73, 3
  s_mul_i32 s73, s73, 393216
  s_add_u32 s73, s73, s82
  buffer_load_dwordx4 v9, s[24:27], s73 offen offset:0 lds
  buffer_load_dwordx4 v10, s[24:27], s73 offen offset:1024 lds
  buffer_load_dwordx4 v11, s[24:27], s73 offen offset:2048 lds
  buffer_load_dwordx4 v12, s[24:27], s73 offen offset:3072 lds
  v_mfma_f32_32x32x16_bf16 v[140:155], v[68:71], a[224:227], v[140:155]
  buffer_load_dwordx4 v[14:17], v47, s[8:11], 0 offen offset:0 sc1
  buffer_load_dwordx4 v[18:21], v47, s[8:11], 0 offen offset:1024 sc1
  buffer_load_dwordx4 v[22:25], v47, s[8:11], 0 offen offset:2048 sc1
  buffer_load_dwordx4 v[52:55], v47, s[8:11], 0 offen offset:3072 sc1
  buffer_load_dwordx4 v[248:251], v47, s[8:11], s93 offen offset:0 sc1
  buffer_load_dwordx4 v[252:255], v47, s[8:11], s93 offen offset:1024 sc1
  s_waitcnt lgkmcnt(4)
  v_mfma_f32_32x32x16_bf16 v[124:139], v[72:75], a[100:103], v[124:139]
  ds_read_b64_tr_b16 v[68:69], v38 offset:24576
  ds_read_b64_tr_b16 v[70:71], v38 offset:25088
  v_mfma_f32_32x32x16_bf16 v[140:155], v[72:75], a[228:231], v[140:155]
  s_waitcnt lgkmcnt(4)
  v_mfma_f32_32x32x16_bf16 v[124:139], v[76:79], a[104:107], v[124:139]
  ds_read_b64_tr_b16 v[72:73], v39 offset:24576
  ds_read_b64_tr_b16 v[74:75], v39 offset:25088
  v_mfma_f32_16x16x32_bf16 v[84:87], v[88:91], v[76:79], v[84:87]
  v_mfma_f32_32x32x16_bf16 v[140:155], v[76:79], a[232:235], v[140:155]
  s_waitcnt lgkmcnt(4)
  v_mfma_f32_32x32x16_bf16 v[124:139], v[80:83], a[108:111], v[124:139]
  ds_read_b64_tr_b16 v[76:77], v40 offset:24576
  ds_read_b64_tr_b16 v[78:79], v40 offset:25088
  v_mfma_f32_32x32x16_bf16 v[140:155], v[80:83], a[236:239], v[140:155]
  s_waitcnt lgkmcnt(4)
  v_mfma_f32_32x32x16_bf16 v[124:139], v[68:71], a[112:115], v[124:139]
  ds_read_b64_tr_b16 v[80:81], v41 offset:24576
  ds_read_b64_tr_b16 v[82:83], v41 offset:25088
  v_mfma_f32_16x16x32_bf16 v[84:87], v[88:91], v[68:71], v[84:87]
  v_mfma_f32_32x32x16_bf16 v[140:155], v[68:71], a[240:243], v[140:155]
  s_waitcnt vmcnt(10)
  s_barrier
  s_waitcnt lgkmcnt(4)
  v_mfma_f32_32x32x16_bf16 v[124:139], v[72:75], a[116:119], v[124:139]
  ds_read_b64_tr_b16 v[68:69], v34 offset:32768
  ds_read_b64_tr_b16 v[70:71], v34 offset:33280
  s_waitcnt lgkmcnt(4)
  v_mfma_f32_16x16x32_bf16 v[84:87], v[88:91], v[76:79], v[84:87]
  s_add_u32 m0, s72, 114688
  s_add_u32 s73, s0, 2
  s_and_b32 s73, s73, 3
  s_mul_i32 s73, s73, 393216
  s_add_u32 s73, s73, s82
  buffer_load_dwordx4 v9, s[24:27], s73 offen offset:0 lds
  buffer_load_dwordx4 v10, s[24:27], s73 offen offset:1024 lds
  buffer_load_dwordx4 v11, s[24:27], s73 offen offset:2048 lds
  buffer_load_dwordx4 v12, s[24:27], s73 offen offset:3072 lds
  v_mfma_f32_32x32x16_bf16 v[140:155], v[72:75], a[244:247], v[140:155]
  v_mfma_f32_32x32x16_bf16 v[124:139], v[76:79], a[120:123], v[124:139]
  ds_read_b64_tr_b16 v[72:73], v35 offset:32768
  ds_read_b64_tr_b16 v[74:75], v35 offset:33280
  v_mfma_f32_32x32x16_bf16 v[140:155], v[76:79], a[248:251], v[140:155]
  s_waitcnt lgkmcnt(4)
  v_mfma_f32_32x32x16_bf16 v[124:139], v[80:83], a[124:127], v[124:139]
  ds_read_b64_tr_b16 v[76:77], v36 offset:32768
  ds_read_b64_tr_b16 v[78:79], v36 offset:33280
  ds_write_b32 v49, v84 offset:512
  v_mfma_f32_32x32x16_bf16 v[140:155], v[80:83], a[252:255], v[140:155]
  s_waitcnt lgkmcnt(0)
  s_barrier
  s_andn2_b32 s94, s90, 1
  s_mul_i32 s94, s94, 32768
  s_lshl_b32 s74, s81, 5
  s_add_u32 s94, s94, s74
  s_lshl_b32 s74, s96, 11
  s_add_u32 s94, s94, s74
  s_add_u32 s94, s94, 2097152
  s_add_u32 s101, s94, 32768
  v_mfma_f32_32x32x16_bf16 v[156:171], v[68:71], a[0:3], 0
  ds_read_b64_tr_b16 v[80:81], v37 offset:32768
  ds_read_b64_tr_b16 v[82:83], v37 offset:33280
  v_mfma_f32_16x16x32_bf16 v[84:87], v[88:91], v[68:71], 0
  v_mfma_f32_32x32x16_bf16 v[172:187], v[68:71], a[128:131], 0
  v_mfma_f32_32x32x16_bf16 v[156:171], v[72:75], a[4:7], v[156:171]
  ds_read_b64_tr_b16 v[68:69], v34 offset:40960
  ds_read_b64_tr_b16 v[70:71], v34 offset:41472
  v_mfma_f32_32x32x16_bf16 v[172:187], v[72:75], a[132:135], v[172:187]
  s_waitcnt vmcnt(9)
  v_xor_b32 v15, s71, v15
  v_xor_b32 v17, s71, v17
  s_waitcnt vmcnt(8)
  v_xor_b32 v19, s71, v19
  v_xor_b32 v21, s71, v21
  s_waitcnt vmcnt(7)
  v_xor_b32 v23, s71, v23
  v_xor_b32 v25, s71, v25
  s_waitcnt vmcnt(6)
  v_xor_b32 v53, s71, v53
  v_xor_b32 v55, s71, v55
  s_waitcnt vmcnt(5)
  v_xor_b32 v249, s71, v249
  v_xor_b32 v251, s71, v251
  s_waitcnt vmcnt(4)
  v_xor_b32 v253, s71, v253
  v_xor_b32_e64 v255, s71, v255
  v_or3_b32 v15, v15, v17, v19
  v_or3_b32 v21, v21, v23, v25
  v_or3_b32 v53, v53, v55, v249
  v_or3_b32 v251, v251, v253, v255
  v_or3_b32 v15, v15, v21, v53
  v_or_b32 v15, v15, v251
  v_cmp_ne_u32 vcc, 0, v15
  s_nop 0
  s_cbranch_vccnz SLOW_STB
RET_STB:
  v_mfma_f32_32x32x16_bf16 v[156:171], v[76:79], a[8:11], v[156:171]
  ds_read_b64_tr_b16 v[72:73], v35 offset:40960
  ds_read_b64_tr_b16 v[74:75], v35 offset:41472
  v_add_f32 v14, v14, v16
  v_add_f32 v18, v18, v20
  v_add_f32 v22, v22, v24
  v_add_f32 v52, v52, v54
  v_add_f32_e64 v248, v248, v250
  v_mfma_f32_16x16x32_bf16 v[84:87], v[88:91], v[76:79], v[84:87]
  v_add_f32 v252, v252, v254
  v_add_f32 v14, v14, v18
  v_mfma_f32_32x32x16_bf16 v[172:187], v[76:79], a[136:139], v[172:187]
  v_add_f32 v22, v22, v52
  v_add_f32 v248, v248, v252
  v_add_f32 v14, v14, v22
  v_add_f32 v14, v14, v248
  v_mov_b32 v15, v14
  s_nop 1
  v_permlane32_swap_b32 v14, v15
  s_waitcnt lgkmcnt(4)
  v_mfma_f32_32x32x16_bf16 v[156:171], v[80:83], a[12:15], v[156:171]
  ds_read_b64_tr_b16 v[76:77], v36 offset:40960
  ds_read_b64_tr_b16 v[78:79], v36 offset:41472
  v_mul_f32 v14, 0xbabe82fa, v14
  v_mul_f32 v15, 0x3abe82fa, v15
  v_fma_f32 v15, -v14, v14, v15
  v_max_f32_e64 v15, 0, v15
  v_add_f32 v15, 0x3727c5ac, v15
  v_mfma_f32_32x32x16_bf16 v[172:187], v[80:83], a[140:143], v[172:187]
  v_rsq_f32 v15, v15
  v_cmp_gt_u32 vcc, 32, v1
  v_mul_f32_e64 v14, v14, v15
  s_lshl_b32 s74, s96, 8
  s_add_u32 s74, s74, s91
  v_lshl_add_u32 v16, v1, 2, s74
  s_waitcnt lgkmcnt(4)
  v_mfma_f32_32x32x16_bf16 v[156:171], v[68:71], a[16:19], v[156:171]
  ds_read_b64_tr_b16 v[80:81], v37 offset:40960
  ds_read_b64_tr_b16 v[82:83], v37 offset:41472
  v_cndmask_b32 v14, v15, v14, vcc
  ds_write_b32 v16, v14 offset:1024
  v_mfma_f32_16x16x32_bf16 v[84:87], v[88:91], v[68:71], v[84:87]
  v_mfma_f32_32x32x16_bf16 v[172:187], v[68:71], a[144:147], v[172:187]
  ds_read_b128 a[0:3], v26 offset:16384
  ds_read_b128 a[4:7], v27 offset:16384
  ds_read_b128 a[8:11], v28 offset:16384
  ds_read_b128 a[12:15], v29 offset:16384
  s_waitcnt lgkmcnt(4)
  s_barrier
  s_barrier
  v_mfma_f32_32x32x16_bf16 v[156:171], v[72:75], a[20:23], v[156:171]
  ds_read_b64_tr_b16 v[68:69], v38 offset:32768
  ds_read_b64_tr_b16 v[70:71], v38 offset:33280
  s_add_u32 m0, s72, 81920
  s_add_u32 s73, s0, 3
  s_and_b32 s73, s73, 3
  s_mul_i32 s73, s73, 393216
  s_add_u32 s73, s73, s82
  buffer_load_dwordx4 v9, s[24:27], s73 offen offset:0 lds
  buffer_load_dwordx4 v10, s[24:27], s73 offen offset:1024 lds
  buffer_load_dwordx4 v11, s[24:27], s73 offen offset:2048 lds
  buffer_load_dwordx4 v12, s[24:27], s73 offen offset:3072 lds
  v_mfma_f32_32x32x16_bf16 v[172:187], v[72:75], a[148:151], v[172:187]
  ds_read_b32 v204, v43 offset:1024
  ds_read_b32 v205, v43 offset:1152
  ds_read_b32 v228, v43 offset:1280
  ds_read_b32 v229, v43 offset:1408
  s_waitcnt lgkmcnt(2)
  v_fma_f32 v92, v92, v205, v204
  v_fma_f32 v93, v93, v205, v204
  v_mfma_f32_32x32x16_bf16 v[156:171], v[76:79], a[24:27], v[156:171]
  ds_read_b64_tr_b16 v[72:73], v39 offset:32768
  ds_read_b64_tr_b16 v[74:75], v39 offset:33280
  v_fma_f32 v94, v94, v205, v204
  v_fma_f32 v95, v95, v205, v204
  v_fma_f32 v96, v96, v205, v204
  v_fma_f32 v97, v97, v205, v204
  v_mfma_f32_16x16x32_bf16 v[84:87], v[88:91], v[76:79], v[84:87]
  s_add_u32 m0, s72, 16384
  s_add_u32 s73, s1, 2
  s_and_b32 s73, s73, 7
  s_mul_i32 s73, s73, 128
  s_add_u32 s73, s73, s79
  buffer_load_dwordx4 v5, s[32:35], s73 offen offset:0 lds
  buffer_load_dwordx4 v6, s[32:35], s73 offen offset:1024 lds
  buffer_load_dwordx4 v7, s[32:35], s73 offen offset:2048 lds
  buffer_load_dwordx4 v8, s[32:35], s73 offen offset:3072 lds
  v_mfma_f32_32x32x16_bf16 v[172:187], v[76:79], a[152:155], v[172:187]
  v_fma_f32 v98, v98, v205, v204
  v_fma_f32 v99, v99, v205, v204
  v_fma_f32 v100, v100, v205, v204
  v_fma_f32 v101, v101, v205, v204
  v_fma_f32 v102, v102, v205, v204
  v_fma_f32 v103, v103, v205, v204
  v_mfma_f32_32x32x16_bf16 v[156:171], v[80:83], a[28:31], v[156:171]
  ds_read_b64_tr_b16 v[76:77], v40 offset:32768
  ds_read_b64_tr_b16 v[78:79], v40 offset:33280
  v_fma_f32 v104, v104, v205, v204
  v_fma_f32 v105, v105, v205, v204
  v_fma_f32 v106, v106, v205, v204
  v_fma_f32 v107, v107, v205, v204
  v_mfma_f32_32x32x16_bf16 v[172:187], v[80:83], a[156:159], v[172:187]
  v_cvt_pk_bf16_f32 v208, v92, v93
  v_cvt_pk_bf16_f32 v209, v94, v95
  v_cvt_pk_bf16_f32 v210, v96, v97
  v_cvt_pk_bf16_f32 v211, v98, v99
  v_cvt_pk_bf16_f32 v212, v100, v101
  v_cvt_pk_bf16_f32 v213, v102, v103
  v_mfma_f32_32x32x16_bf16 v[156:171], v[68:71], a[32:35], v[156:171]
  ds_read_b64_tr_b16 v[80:81], v41 offset:32768
  ds_read_b64_tr_b16 v[82:83], v41 offset:33280
  v_cvt_pk_bf16_f32 v214, v104, v105
  v_cvt_pk_bf16_f32 v215, v106, v107
  ds_write_b64 v13, v[208:209] offset:0
  ds_write_b64 v13, v[210:211] offset:16
  v_mfma_f32_16x16x32_bf16 v[84:87], v[88:91], v[68:71], v[84:87]
  ds_write_b64 v13, v[212:213] offset:32
  ds_write_b64 v13, v[214:215] offset:48
  v_mfma_f32_32x32x16_bf16 v[172:187], v[68:71], a[160:163], v[172:187]
  ds_read_b128 a[128:131], v26 offset:49152
  ds_read_b128 a[132:135], v27 offset:49152
  ds_read_b128 a[136:139], v28 offset:49152
  ds_read_b128 a[140:143], v29 offset:49152
  ds_read_b64_tr_b16 v[216:217], v46 offset:0
  ds_read_b64_tr_b16 v[218:219], v46 offset:288
  s_waitcnt lgkmcnt(14)
  v_mfma_f32_32x32x16_bf16 v[156:171], v[72:75], a[36:39], v[156:171]
  ds_read_b64_tr_b16 v[68:69], v38 offset:40960
  ds_read_b64_tr_b16 v[70:71], v38 offset:41472
  ds_read_b64_tr_b16 v[220:221], v46 offset:1152
  ds_read_b64_tr_b16 v[222:223], v46 offset:1440
  s_waitcnt lgkmcnt(4)
  buffer_store_dwordx4 v[216:219], v2, s[8:11], s100 offen offset:0 sc1
  s_waitcnt lgkmcnt(0)
  buffer_store_dwordx4 v[220:223], v2, s[8:11], s100 offen offset:1024 sc1
  v_mfma_f32_32x32x16_bf16 v[172:187], v[72:75], a[164:167], v[172:187]
  v_fma_f32 v108, v108, v229, v228
  v_fma_f32 v109, v109, v229, v228
  v_fma_f32 v110, v110, v229, v228
  v_fma_f32 v111, v111, v229, v228
  v_fma_f32 v112, v112, v229, v228
  v_fma_f32 v113, v113, v229, v228
  v_mfma_f32_32x32x16_bf16 v[156:171], v[76:79], a[40:43], v[156:171]
  ds_read_b64_tr_b16 v[72:73], v39 offset:40960
  ds_read_b64_tr_b16 v[74:75], v39 offset:41472
  v_fma_f32 v114, v114, v229, v228
  v_fma_f32 v115, v115, v229, v228
  v_fma_f32 v116, v116, v229, v228
  v_fma_f32 v117, v117, v229, v228
  v_mfma_f32_16x16x32_bf16 v[84:87], v[88:91], v[76:79], v[84:87]
  s_add_u32 m0, s72, 49152
  s_add_u32 s73, s1, 2
  s_and_b32 s73, s73, 7
  s_mul_i32 s73, s73, 128
  s_add_u32 s73, s73, s78
  buffer_load_dwordx4 v5, s[32:35], s73 offen offset:0 lds
  buffer_load_dwordx4 v6, s[32:35], s73 offen offset:1024 lds
  buffer_load_dwordx4 v7, s[32:35], s73 offen offset:2048 lds
  buffer_load_dwordx4 v8, s[32:35], s73 offen offset:3072 lds
  v_mfma_f32_32x32x16_bf16 v[172:187], v[76:79], a[168:171], v[172:187]
  v_fma_f32 v118, v118, v229, v228
  v_fma_f32 v119, v119, v229, v228
  v_fma_f32 v120, v120, v229, v228
  v_fma_f32 v121, v121, v229, v228
  v_fma_f32 v122, v122, v229, v228
  v_fma_f32 v123, v123, v229, v228
  v_mfma_f32_32x32x16_bf16 v[156:171], v[80:83], a[44:47], v[156:171]
  ds_read_b64_tr_b16 v[76:77], v40 offset:40960
  ds_read_b64_tr_b16 v[78:79], v40 offset:41472
  v_cvt_pk_bf16_f32 v232, v108, v109
  v_cvt_pk_bf16_f32 v233, v110, v111
  v_cvt_pk_bf16_f32 v234, v112, v113
  v_cvt_pk_bf16_f32 v235, v114, v115
  v_mfma_f32_32x32x16_bf16 v[172:187], v[80:83], a[172:175], v[172:187]
  v_cvt_pk_bf16_f32 v236, v116, v117
  v_cvt_pk_bf16_f32 v237, v118, v119
  v_cvt_pk_bf16_f32 v238, v120, v121
  v_cvt_pk_bf16_f32 v239, v122, v123
  ds_write_b64 v13, v[232:233] offset:0
  ds_write_b64 v13, v[234:235] offset:16
  v_mfma_f32_32x32x16_bf16 v[156:171], v[68:71], a[48:51], v[156:171]
  ds_read_b64_tr_b16 v[80:81], v41 offset:40960
  ds_read_b64_tr_b16 v[82:83], v41 offset:41472
  ds_write_b64 v13, v[236:237] offset:32
  ds_write_b64 v13, v[238:239] offset:48
  ds_read_b64_tr_b16 v[240:241], v46 offset:0
  ds_read_b64_tr_b16 v[242:243], v46 offset:288
  v_mfma_f32_16x16x32_bf16 v[84:87], v[88:91], v[68:71], v[84:87]
  ds_read_b64_tr_b16 v[244:245], v46 offset:1152
  ds_read_b64_tr_b16 v[246:247], v46 offset:1440
  v_mfma_f32_32x32x16_bf16 v[172:187], v[68:71], a[176:179], v[172:187]
  s_waitcnt vmcnt(14)
  s_barrier
  s_waitcnt lgkmcnt(2)
  buffer_store_dwordx4 v[240:243], v2, s[8:11], s100 offen offset:2048 sc1
  s_waitcnt lgkmcnt(0)
  buffer_store_dwordx4 v[244:247], v2, s[8:11], s100 offen offset:3072 sc1
  ds_read_b128 v[204:207], v44 offset:512
  ds_read_b128 v[220:223], v44 offset:768
  ds_read_b128 v[208:211], v44 offset:544
  v_mfma_f32_32x32x16_bf16 v[156:171], v[72:75], a[52:55], v[156:171]
  ds_read_b64_tr_b16 v[68:69], v38 offset:49152
  ds_read_b64_tr_b16 v[70:71], v38 offset:49664
  s_add_u32 m0, s72, 32768
  s_add_u32 s73, s1, 4
  s_and_b32 s73, s73, 7
  s_mul_i32 s73, s73, 128
  s_add_u32 s73, s73, s79
  buffer_load_dwordx4 v5, s[32:35], s73 offen offset:0 lds
  buffer_load_dwordx4 v6, s[32:35], s73 offen offset:1024 lds
  buffer_load_dwordx4 v7, s[32:35], s73 offen offset:2048 lds
  buffer_load_dwordx4 v8, s[32:35], s73 offen offset:3072 lds
  v_mfma_f32_32x32x16_bf16 v[172:187], v[72:75], a[180:183], v[172:187]
  ds_read_b128 v[224:227], v44 offset:800
  ds_read_b128 v[212:215], v44 offset:576
  ds_read_b128 v[228:231], v44 offset:832
  ds_read_b128 v[216:219], v44 offset:608
  ds_read_b128 v[232:235], v44 offset:864
  s_waitcnt lgkmcnt(8)
  v_add_f32_e64 v204, v204, v220
  v_mfma_f32_32x32x16_bf16 v[156:171], v[76:79], a[56:59], v[156:171]
  ds_read_b64_tr_b16 v[72:73], v39 offset:49152
  ds_read_b64_tr_b16 v[74:75], v39 offset:49664
  v_add_f32 v205, v205, v221
  v_add_f32 v206, v206, v222
  v_add_f32 v207, v207, v223
  s_waitcnt lgkmcnt(6)
  v_add_f32_e64 v208, v208, v224
  v_mfma_f32_16x16x32_bf16 v[84:87], v[88:91], v[76:79], v[84:87]
  v_add_f32 v209, v209, v225
  v_add_f32 v210, v210, v226
  v_mfma_f32_32x32x16_bf16 v[172:187], v[76:79], a[184:187], v[172:187]
  ds_read_b128 a[16:19], v26 offset:0
  ds_read_b128 a[20:23], v27 offset:0
  ds_read_b128 a[24:27], v28 offset:0
  ds_read_b128 a[28:31], v29 offset:0
  v_add_f32 v211, v211, v227
  s_waitcnt lgkmcnt(8)
  v_add_f32_e64 v212, v212, v228
  v_mfma_f32_32x32x16_bf16 v[156:171], v[80:83], a[60:63], v[156:171]
  ds_read_b64_tr_b16 v[76:77], v40 offset:49152
  ds_read_b64_tr_b16 v[78:79], v40 offset:49664
  v_add_f32 v213, v213, v229
  v_add_f32 v214, v214, v230
  v_add_f32 v215, v215, v231
  s_waitcnt lgkmcnt(8)
  v_add_f32_e64 v216, v216, v232
  v_mfma_f32_32x32x16_bf16 v[172:187], v[80:83], a[188:191], v[172:187]
  v_add_f32 v217, v217, v233
  v_add_f32 v218, v218, v234
  v_add_f32 v219, v219, v235
  v_fmac_f32 v124, v204, v56
  v_fmac_f32 v125, v205, v56
  v_fmac_f32 v126, v206, v56
  v_mfma_f32_32x32x16_bf16 v[156:171], v[68:71], a[64:67], v[156:171]
  ds_read_b64_tr_b16 v[80:81], v41 offset:49152
  ds_read_b64_tr_b16 v[82:83], v41 offset:49664
  v_fmac_f32 v127, v207, v56
  v_fmac_f32 v128, v208, v56
  v_fmac_f32 v129, v209, v56
  v_fmac_f32 v130, v210, v56
  v_mfma_f32_16x16x32_bf16 v[84:87], v[88:91], v[68:71], v[84:87]
  s_waitcnt lgkmcnt(4)
  s_add_u32 m0, s72, 0
  s_add_u32 s73, s1, 3
  s_and_b32 s73, s73, 7
  s_mul_i32 s73, s73, 128
  s_add_u32 s73, s73, s79
  buffer_load_dwordx4 v5, s[32:35], s73 offen offset:0 lds
  buffer_load_dwordx4 v6, s[32:35], s73 offen offset:1024 lds
  buffer_load_dwordx4 v7, s[32:35], s73 offen offset:2048 lds
  buffer_load_dwordx4 v8, s[32:35], s73 offen offset:3072 lds
  v_mfma_f32_32x32x16_bf16 v[172:187], v[68:71], a[192:195], v[172:187]
  v_fmac_f32 v131, v211, v56
  v_fma_f32 v124, v124, v57, s84
  v_fma_f32 v125, v125, v57, s84
  v_fma_f32 v126, v126, v57, s84
  v_fma_f32 v127, v127, v57, s84
  v_fma_f32 v128, v128, v57, s84
  v_mfma_f32_32x32x16_bf16 v[156:171], v[72:75], a[68:71], v[156:171]
  ds_read_b64_tr_b16 v[68:69], v38 offset:57344
  ds_read_b64_tr_b16 v[70:71], v38 offset:57856
  v_fma_f32 v129, v129, v57, s84
  v_fma_f32 v130, v130, v57, s84
  v_fma_f32 v131, v131, v57, s84
  v_mul_f32_e64 v220, s86, v124
  v_mfma_f32_32x32x16_bf16 v[172:187], v[72:75], a[196:199], v[172:187]
  v_mul_f32 v221, s86, v125
  v_mul_f32 v222, s86, v126
  v_mul_f32 v223, s86, v127
  v_mul_f32 v224, s86, v128
  v_mul_f32 v225, s86, v129
  v_mul_f32_e64 v226, s86, v130
  s_waitcnt lgkmcnt(4)
  v_mfma_f32_32x32x16_bf16 v[156:171], v[76:79], a[72:75], v[156:171]
  ds_read_b64_tr_b16 v[72:73], v39 offset:57344
  ds_read_b64_tr_b16 v[74:75], v39 offset:57856
  v_mul_f32_e64 v227, s86, v131
  v_exp_f32_e64 v220, v220 clamp
  v_mfma_f32_16x16x32_bf16 v[84:87], v[88:91], v[76:79], v[84:87]
  v_exp_f32_e64 v221, v221 clamp
  v_mfma_f32_32x32x16_bf16 v[172:187], v[76:79], a[200:203], v[172:187]
  v_exp_f32_e64 v222, v222 clamp
  v_exp_f32_e64 v223, v223 clamp
  v_exp_f32_e64 v224, v224 clamp
  s_waitcnt lgkmcnt(4)
  v_mfma_f32_32x32x16_bf16 v[156:171], v[80:83], a[76:79], v[156:171]
  ds_read_b64_tr_b16 v[76:77], v40 offset:57344
  ds_read_b64_tr_b16 v[78:79], v40 offset:57856
  v_exp_f32_e64 v225, v225 clamp
  v_exp_f32_e64 v226, v226 clamp
  v_mfma_f32_32x32x16_bf16 v[172:187], v[80:83], a[204:207], v[172:187]
  v_exp_f32_e64 v227, v227 clamp
  v_max_f32 v124, s84, v124
  v_max_f32 v125, s84, v125
  v_max_f32 v126, s84, v126
  v_max_f32 v127, s84, v127
  s_waitcnt vmcnt(8)
  s_lshr_b32 s74, s80, 6
  s_add_u32 s74, s74, s96
  s_lshl_b32 s74, s74, 7
  s_lshr_b32 s75, s90, 1
  s_lshl_b32 s75, s75, 2
  s_add_u32 s74, s74, s75
  s_add_u32 s74, s74, 1536
  v_mov_b32 v3, s71
  s_mov_b64 exec, 1
  buffer_store_dword v3, off, s[8:11], s74 sc1
  s_mov_b64 exec, -1
  s_waitcnt lgkmcnt(4)
  v_mfma_f32_32x32x16_bf16 v[156:171], v[68:71], a[80:83], v[156:171]
  ds_read_b64_tr_b16 v[80:81], v41 offset:57344
  ds_read_b64_tr_b16 v[82:83], v41 offset:57856
  v_max_f32 v128, s84, v128
  v_max_f32 v129, s84, v129
  v_max_f32 v130, s84, v130
  v_max_f32 v131, s84, v131
  v_mfma_f32_16x16x32_bf16 v[84:87], v[88:91], v[68:71], v[84:87]
  v_add_f32 v124, v124, v220
  v_add_f32 v125, v125, v221
  v_mfma_f32_32x32x16_bf16 v[172:187], v[68:71], a[208:211], v[172:187]
  s_barrier
  v_add_f32 v126, v126, v222
  v_add_f32 v127, v127, v223
  v_add_f32 v128, v128, v224
  v_add_f32 v129, v129, v225
  v_add_f32_e64 v130, v130, v226
  s_waitcnt lgkmcnt(4)
  v_mfma_f32_32x32x16_bf16 v[156:171], v[72:75], a[84:87], v[156:171]
  ds_read_b64_tr_b16 v[68:69], v38 offset:16384
  ds_read_b64_tr_b16 v[70:71], v38 offset:16896
  s_add_u32 m0, s72, 98304
  s_add_u32 s73, s1, 4
  s_and_b32 s73, s73, 7
  s_mul_i32 s73, s73, 128
  s_add_u32 s73, s73, s78
  buffer_load_dwordx4 v5, s[32:35], s73 offen offset:0 lds
  buffer_load_dwordx4 v6, s[32:35], s73 offen offset:1024 lds
  buffer_load_dwordx4 v7, s[32:35], s73 offen offset:2048 lds
  buffer_load_dwordx4 v8, s[32:35], s73 offen offset:3072 lds
  v_mfma_f32_32x32x16_bf16 v[172:187], v[72:75], a[212:215], v[172:187]
  v_add_f32 v131, v131, v227
  v_cvt_pk_bf16_f32 v188, v124, v125
  v_cvt_pk_bf16_f32 v189, v126, v127
  v_cvt_pk_bf16_f32 v190, v128, v129
  v_cvt_pk_bf16_f32 v191, v130, v131
  buffer_store_dwordx4 v[188:191], v2, s[8:11], s94 offen offset:0 sc1
  s_waitcnt lgkmcnt(4)
  v_mfma_f32_32x32x16_bf16 v[156:171], v[76:79], a[88:91], v[156:171]
  ds_read_b64_tr_b16 v[72:73], v39 offset:16384
  ds_read_b64_tr_b16 v[74:75], v39 offset:16896
  v_fmac_f32 v132, v212, v56
  v_fmac_f32 v133, v213, v56
  v_fmac_f32 v134, v214, v56
  v_fmac_f32_e64 v135, v215, v56
  v_mfma_f32_16x16x32_bf16 v[84:87], v[88:91], v[76:79], v[84:87]
  v_fmac_f32 v136, v216, v56
  v_fmac_f32 v137, v217, v56
  v_mfma_f32_32x32x16_bf16 v[172:187], v[76:79], a[216:219], v[172:187]
  ds_read_b128 a[144:147], v30 offset:0
  ds_read_b128 a[148:151], v31 offset:0
  ds_read_b128 a[152:155], v32 offset:0
  ds_read_b128 a[156:159], v33 offset:0
  v_fmac_f32 v138, v218, v56
  v_fmac_f32_e64 v139, v219, v56
  s_waitcnt lgkmcnt(8)
  v_mfma_f32_32x32x16_bf16 v[156:171], v[80:83], a[92:95], v[156:171]
  ds_read_b64_tr_b16 v[76:77], v40 offset:16384
  ds_read_b64_tr_b16 v[78:79], v40 offset:16896
  v_fma_f32 v132, v132, v57, s84
  v_fma_f32 v133, v133, v57, s84
  v_fma_f32 v134, v134, v57, s84
  v_fma_f32 v135, v135, v57, s84
  v_mfma_f32_32x32x16_bf16 v[172:187], v[80:83], a[220:223], v[172:187]
  v_fma_f32 v136, v136, v57, s84
  v_fma_f32 v137, v137, v57, s84
  v_fma_f32 v138, v138, v57, s84
  v_fma_f32 v139, v139, v57, s84
  v_mul_f32 v228, s86, v132
  v_mul_f32_e64 v229, s86, v133
  s_waitcnt lgkmcnt(8)
  v_mfma_f32_32x32x16_bf16 v[156:171], v[68:71], a[96:99], v[156:171]
  ds_read_b64_tr_b16 v[80:81], v41 offset:16384
  ds_read_b64_tr_b16 v[82:83], v41 offset:16896
  v_mul_f32 v230, s86, v134
  v_mul_f32 v231, s86, v135
  v_mul_f32 v232, s86, v136
  v_mul_f32 v233, s86, v137
  v_mfma_f32_16x16x32_bf16 v[84:87], v[88:91], v[68:71], v[84:87]
  s_waitcnt lgkmcnt(4)
  s_add_u32 m0, s72, 65536
  s_add_u32 s73, s1, 3
  s_and_b32 s73, s73, 7
  s_mul_i32 s73, s73, 128
  s_add_u32 s73, s73, s78
  buffer_load_dwordx4 v5, s[32:35], s73 offen offset:0 lds
  buffer_load_dwordx4 v6, s[32:35], s73 offen offset:1024 lds
  buffer_load_dwordx4 v7, s[32:35], s73 offen offset:2048 lds
  buffer_load_dwordx4 v8, s[32:35], s73 offen offset:3072 lds
  v_mfma_f32_32x32x16_bf16 v[172:187], v[68:71], a[224:227], v[172:187]
  v_mul_f32 v234, s86, v138
  v_mul_f32 v235, s86, v139
  v_exp_f32_e64 v228, v228 clamp
  v_exp_f32_e64 v229, v229 clamp
  v_mfma_f32_32x32x16_bf16 v[156:171], v[72:75], a[100:103], v[156:171]
  ds_read_b64_tr_b16 v[68:69], v38 offset:24576
  ds_read_b64_tr_b16 v[70:71], v38 offset:25088
  v_exp_f32_e64 v230, v230 clamp
  v_exp_f32_e64 v231, v231 clamp
  v_mfma_f32_32x32x16_bf16 v[172:187], v[72:75], a[228:231], v[172:187]
  v_exp_f32_e64 v232, v232 clamp
  v_exp_f32_e64 v233, v233 clamp
  v_exp_f32_e64 v234, v234 clamp
  s_waitcnt lgkmcnt(4)
  v_mfma_f32_32x32x16_bf16 v[156:171], v[76:79], a[104:107], v[156:171]
  ds_read_b64_tr_b16 v[72:73], v39 offset:24576
  ds_read_b64_tr_b16 v[74:75], v39 offset:25088
  v_exp_f32_e64 v235, v235 clamp
  v_max_f32 v132, s84, v132
  v_max_f32_e64 v133, s84, v133
  v_mfma_f32_16x16x32_bf16 v[84:87], v[88:91], v[76:79], v[84:87]
  v_max_f32 v134, s84, v134
  v_max_f32 v135, s84, v135
  v_mfma_f32_32x32x16_bf16 v[172:187], v[76:79], a[232:235], v[172:187]
  v_max_f32 v136, s84, v136
  v_max_f32 v137, s84, v137
  v_max_f32 v138, s84, v138
  v_max_f32 v139, s84, v139
  v_add_f32 v132, v132, v228
  v_add_f32_e64 v133, v133, v229
  s_waitcnt lgkmcnt(4)
  v_mfma_f32_32x32x16_bf16 v[156:171], v[80:83], a[108:111], v[156:171]
  ds_read_b64_tr_b16 v[76:77], v40 offset:24576
  ds_read_b64_tr_b16 v[78:79], v40 offset:25088
  v_add_f32 v134, v134, v230
  v_add_f32 v135, v135, v231
  v_add_f32 v136, v136, v232
  v_add_f32 v137, v137, v233
  v_mfma_f32_32x32x16_bf16 v[172:187], v[80:83], a[236:239], v[172:187]
  v_add_f32 v138, v138, v234
  v_add_f32 v139, v139, v235
  v_cvt_pk_bf16_f32 v192, v132, v133
  v_cvt_pk_bf16_f32 v193, v134, v135
  v_cvt_pk_bf16_f32 v194, v136, v137
  v_cvt_pk_bf16_f32 v195, v138, v139
  s_waitcnt lgkmcnt(4)
  v_mfma_f32_32x32x16_bf16 v[156:171], v[68:71], a[112:115], v[156:171]
  ds_read_b64_tr_b16 v[80:81], v41 offset:24576
  ds_read_b64_tr_b16 v[82:83], v41 offset:25088
  buffer_store_dwordx4 v[192:195], v2, s[8:11], s94 offen offset:1024 sc1
  v_fmac_f32 v140, v204, v62
  v_fmac_f32 v141, v205, v62
  v_fmac_f32 v142, v206, v62
  v_mfma_f32_16x16x32_bf16 v[84:87], v[88:91], v[68:71], v[84:87]
  v_fmac_f32 v143, v207, v62
  v_fmac_f32 v144, v208, v62
  v_mfma_f32_32x32x16_bf16 v[172:187], v[68:71], a[240:243], v[172:187]
  s_barrier
  v_fmac_f32 v145, v209, v62
  v_fmac_f32 v146, v210, v62
  v_fmac_f32 v147, v211, v62
  v_fma_f32 v140, v140, v63, s84
  v_fma_f32 v141, v141, v63, s84
  s_waitcnt lgkmcnt(4)
  v_mfma_f32_32x32x16_bf16 v[156:171], v[72:75], a[116:119], v[156:171]
  v_fma_f32 v142, v142, v63, s84
  v_fma_f32 v143, v143, v63, s84
  v_fma_f32 v144, v144, v63, s84
  v_fma_f32 v145, v145, v63, s84
  v_fma_f32 v146, v146, v63, s84
  v_fma_f32 v147, v147, v63, s84
  s_waitcnt lgkmcnt(2)
  v_mfma_f32_16x16x32_bf16 v[84:87], v[88:91], v[76:79], v[84:87]
  s_add_u32 m0, s72, 114688
  s_add_u32 s73, s1, 5
  s_and_b32 s73, s73, 7
  s_mul_i32 s73, s73, 128
  s_add_u32 s73, s73, s79
  buffer_load_dwordx4 v5, s[32:35], s73 offen offset:0 lds
  buffer_load_dwordx4 v6, s[32:35], s73 offen offset:1024 lds
  buffer_load_dwordx4 v7, s[32:35], s73 offen offset:2048 lds
  buffer_load_dwordx4 v8, s[32:35], s73 offen offset:3072 lds
  v_mfma_f32_32x32x16_bf16 v[172:187], v[72:75], a[244:247], v[172:187]
  v_mul_f32 v220, s86, v140
  v_mul_f32 v221, s86, v141
  v_mul_f32 v222, s86, v142
  v_mul_f32 v223, s86, v143
  v_mul_f32 v224, s86, v144
  v_mul_f32_e64 v225, s86, v145
  v_mfma_f32_32x32x16_bf16 v[156:171], v[76:79], a[120:123], v[156:171]
  v_mul_f32 v226, s86, v146
  v_mul_f32 v227, s86, v147
  v_exp_f32_e64 v220, v220 clamp
  v_exp_f32_e64 v221, v221 clamp
  v_mfma_f32_32x32x16_bf16 v[172:187], v[76:79], a[248:251], v[172:187]
  v_exp_f32_e64 v222, v222 clamp
  v_exp_f32_e64 v223, v223 clamp
  v_exp_f32_e64 v224, v224 clamp
  s_waitcnt lgkmcnt(0)
  v_mfma_f32_32x32x16_bf16 v[156:171], v[80:83], a[124:127], v[156:171]
  ds_write_b32 v49, v84 offset:1024
  v_exp_f32_e64 v225, v225 clamp
  v_exp_f32_e64 v226, v226 clamp
  v_mfma_f32_32x32x16_bf16 v[172:187], v[80:83], a[252:255], v[172:187]
  v_exp_f32_e64 v227, v227 clamp
  v_max_f32 v140, s84, v140
  v_max_f32 v141, s84, v141
  v_max_f32 v142, s84, v142
  v_max_f32 v143, s84, v143
  v_max_f32 v144, s84, v144
  v_max_f32 v145, s84, v145
  v_max_f32 v146, s84, v146
  v_max_f32 v147, s84, v147
  v_add_f32 v140, v140, v220
  v_add_f32 v141, v141, v221
  v_add_f32 v142, v142, v222
  v_add_f32 v143, v143, v223
  v_add_f32 v144, v144, v224
  v_add_f32 v145, v145, v225
  v_add_f32 v146, v146, v226
  v_add_f32_e64 v147, v147, v227
  v_cvt_pk_bf16_f32 v196, v140, v141
  v_cvt_pk_bf16_f32 v197, v142, v143
  v_cvt_pk_bf16_f32 v198, v144, v145
  v_cvt_pk_bf16_f32 v199, v146, v147
  buffer_store_dwordx4 v[196:199], v2, s[8:11], s101 offen offset:0 sc1
  v_fmac_f32 v148, v212, v62
  v_fmac_f32 v149, v213, v62
  v_fmac_f32 v150, v214, v62
  v_fmac_f32 v151, v215, v62
  v_fmac_f32 v152, v216, v62
  v_fmac_f32 v153, v217, v62
  v_fmac_f32 v154, v218, v62
  v_fmac_f32 v155, v219, v62
  v_fma_f32 v148, v148, v63, s84
  v_fma_f32 v149, v149, v63, s84
  v_fma_f32 v150, v150, v63, s84
  v_fma_f32 v151, v151, v63, s84
  v_fma_f32 v152, v152, v63, s84
  v_fma_f32 v153, v153, v63, s84
  v_fma_f32 v154, v154, v63, s84
  v_fma_f32 v155, v155, v63, s84
  v_mul_f32 v228, s86, v148
  v_mul_f32 v229, s86, v149
  v_mul_f32 v230, s86, v150
  v_mul_f32 v231, s86, v151
  v_mul_f32 v232, s86, v152
  v_mul_f32 v233, s86, v153
  v_mul_f32 v234, s86, v154
  v_mul_f32 v235, s86, v155
  v_exp_f32_e64 v228, v228 clamp
  v_exp_f32_e64 v229, v229 clamp
  v_exp_f32_e64 v230, v230 clamp
  v_exp_f32_e64 v231, v231 clamp
  v_exp_f32_e64 v232, v232 clamp
  v_exp_f32_e64 v233, v233 clamp
  v_exp_f32_e64 v234, v234 clamp
  v_exp_f32_e64 v235, v235 clamp
  v_max_f32 v148, s84, v148
  v_max_f32 v149, s84, v149
  v_max_f32 v150, s84, v150
  v_max_f32 v151, s84, v151
  v_max_f32 v152, s84, v152
  v_max_f32 v153, s84, v153
  v_max_f32 v154, s84, v154
  v_max_f32 v155, s84, v155
  v_add_f32 v148, v148, v228
  v_add_f32 v149, v149, v229
  v_add_f32 v150, v150, v230
  v_add_f32 v151, v151, v231
  v_add_f32 v152, v152, v232
  v_add_f32 v153, v153, v233
  v_add_f32 v154, v154, v234
  v_add_f32 v155, v155, v235
  v_cvt_pk_bf16_f32 v200, v148, v149
  v_cvt_pk_bf16_f32 v201, v150, v151
  v_cvt_pk_bf16_f32 v202, v152, v153
  v_cvt_pk_bf16_f32 v203, v154, v155
  buffer_store_dwordx4 v[200:203], v2, s[8:11], s101 offen offset:1024 sc1
  s_waitcnt lgkmcnt(0)
  s_barrier
  s_add_u32 m0, s72, 81920
  s_add_u32 s73, s1, 5
  s_and_b32 s73, s73, 7
  s_mul_i32 s73, s73, 128
  s_add_u32 s73, s73, s78
  buffer_load_dwordx4 v5, s[32:35], s73 offen offset:0 lds
  buffer_load_dwordx4 v6, s[32:35], s73 offen offset:1024 lds
  buffer_load_dwordx4 v7, s[32:35], s73 offen offset:2048 lds
  buffer_load_dwordx4 v8, s[32:35], s73 offen offset:3072 lds
  s_add_u32 s94, s94, 4096
  s_add_u32 s101, s101, 4096
  ds_read_b128 v[204:207], v44 offset:1024
  ds_read_b128 v[220:223], v44 offset:1280
  ds_read_b128 v[208:211], v44 offset:1056
  ds_read_b128 v[224:227], v44 offset:1312
  ds_read_b128 v[212:215], v44 offset:1088
  ds_read_b128 v[228:231], v44 offset:1344
  ds_read_b128 v[216:219], v44 offset:1120
  ds_read_b128 v[232:235], v44 offset:1376
  s_waitcnt lgkmcnt(6)
  v_pk_add_f32 v[204:205], v[204:205], v[220:221] op_sel:[0,0] op_sel_hi:[1,1]
  v_pk_add_f32 v[206:207], v[206:207], v[222:223] op_sel:[0,0] op_sel_hi:[1,1]
  s_waitcnt lgkmcnt(4)
  v_pk_add_f32 v[208:209], v[208:209], v[224:225] op_sel:[0,0] op_sel_hi:[1,1]
  v_pk_add_f32 v[210:211], v[210:211], v[226:227] op_sel:[0,0] op_sel_hi:[1,1]
  s_waitcnt lgkmcnt(2)
  v_pk_add_f32 v[212:213], v[212:213], v[228:229] op_sel:[0,0] op_sel_hi:[1,1]
  v_pk_add_f32 v[214:215], v[214:215], v[230:231] op_sel:[0,0] op_sel_hi:[1,1]
  s_waitcnt lgkmcnt(0)
  v_pk_add_f32 v[216:217], v[216:217], v[232:233] op_sel:[0,0] op_sel_hi:[1,1]
  v_pk_add_f32 v[218:219], v[218:219], v[234:235] op_sel:[0,0] op_sel_hi:[1,1]
  v_pk_fma_f32 v[156:157], v[204:205], v[56:57], v[156:157] op_sel:[0,0,0] op_sel_hi:[1,0,1]
  v_pk_fma_f32 v[158:159], v[206:207], v[56:57], v[158:159] op_sel:[0,0,0] op_sel_hi:[1,0,1]
  v_pk_fma_f32 v[160:161], v[208:209], v[56:57], v[160:161] op_sel:[0,0,0] op_sel_hi:[1,0,1]
  v_pk_fma_f32 v[162:163], v[210:211], v[56:57], v[162:163] op_sel:[0,0,0] op_sel_hi:[1,0,1]
  v_pk_fma_f32 v[156:157], v[156:157], v[56:57], s[84:85] op_sel:[0,1,0] op_sel_hi:[1,1,1]
  v_pk_fma_f32 v[158:159], v[158:159], v[56:57], s[84:85] op_sel:[0,1,0] op_sel_hi:[1,1,1]
  v_pk_fma_f32 v[160:161], v[160:161], v[56:57], s[84:85] op_sel:[0,1,0] op_sel_hi:[1,1,1]
  v_pk_fma_f32 v[162:163], v[162:163], v[56:57], s[84:85] op_sel:[0,1,0] op_sel_hi:[1,1,1]
  v_pk_mul_f32 v[220:221], v[156:157], s[86:87] op_sel:[0,0] op_sel_hi:[1,1]
  v_pk_mul_f32 v[222:223], v[158:159], s[86:87] op_sel:[0,0] op_sel_hi:[1,1]
  v_pk_mul_f32 v[224:225], v[160:161], s[86:87] op_sel:[0,0] op_sel_hi:[1,1]
  v_pk_mul_f32 v[226:227], v[162:163], s[86:87] op_sel:[0,0] op_sel_hi:[1,1]
  v_exp_f32_e64 v220, v220 clamp
  v_exp_f32_e64 v221, v221 clamp
  v_exp_f32_e64 v222, v222 clamp
  v_exp_f32_e64 v223, v223 clamp
  v_exp_f32_e64 v224, v224 clamp
  v_exp_f32_e64 v225, v225 clamp
  v_exp_f32_e64 v226, v226 clamp
  v_exp_f32_e64 v227, v227 clamp
  v_max_f32 v156, s84, v156
  v_max_f32 v157, s84, v157
  v_max_f32 v158, s84, v158
  v_max_f32 v159, s84, v159
  v_max_f32 v160, s84, v160
  v_max_f32 v161, s84, v161
  v_max_f32 v162, s84, v162
  v_max_f32_e64 v163, s84, v163
  v_pk_add_f32 v[156:157], v[156:157], v[220:221] op_sel:[0,0] op_sel_hi:[1,1]
  v_pk_add_f32 v[158:159], v[158:159], v[222:223] op_sel:[0,0] op_sel_hi:[1,1]
  v_pk_add_f32 v[160:161], v[160:161], v[224:225] op_sel:[0,0] op_sel_hi:[1,1]
  v_pk_add_f32 v[162:163], v[162:163], v[226:227] op_sel:[0,0] op_sel_hi:[1,1]
  v_cvt_pk_bf16_f32 v188, v156, v157
  v_cvt_pk_bf16_f32 v189, v158, v159
  v_cvt_pk_bf16_f32 v190, v160, v161
  v_cvt_pk_bf16_f32 v191, v162, v163
  buffer_store_dwordx4 v[188:191], v2, s[8:11], s94 offen offset:0 sc1
  v_pk_fma_f32 v[164:165], v[212:213], v[56:57], v[164:165] op_sel:[0,0,0] op_sel_hi:[1,0,1]
  v_pk_fma_f32 v[166:167], v[214:215], v[56:57], v[166:167] op_sel:[0,0,0] op_sel_hi:[1,0,1]
  v_pk_fma_f32 v[168:169], v[216:217], v[56:57], v[168:169] op_sel:[0,0,0] op_sel_hi:[1,0,1]
  v_pk_fma_f32 v[170:171], v[218:219], v[56:57], v[170:171] op_sel:[0,0,0] op_sel_hi:[1,0,1]
  v_pk_fma_f32 v[164:165], v[164:165], v[56:57], s[84:85] op_sel:[0,1,0] op_sel_hi:[1,1,1]
  v_pk_fma_f32 v[166:167], v[166:167], v[56:57], s[84:85] op_sel:[0,1,0] op_sel_hi:[1,1,1]
  v_pk_fma_f32 v[168:169], v[168:169], v[56:57], s[84:85] op_sel:[0,1,0] op_sel_hi:[1,1,1]
  v_pk_fma_f32 v[170:171], v[170:171], v[56:57], s[84:85] op_sel:[0,1,0] op_sel_hi:[1,1,1]
  v_pk_mul_f32 v[228:229], v[164:165], s[86:87] op_sel:[0,0] op_sel_hi:[1,1]
  v_pk_mul_f32 v[230:231], v[166:167], s[86:87] op_sel:[0,0] op_sel_hi:[1,1]
  v_pk_mul_f32 v[232:233], v[168:169], s[86:87] op_sel:[0,0] op_sel_hi:[1,1]
  v_pk_mul_f32 v[234:235], v[170:171], s[86:87] op_sel:[0,0] op_sel_hi:[1,1]
  v_exp_f32_e64 v228, v228 clamp
  v_exp_f32_e64 v229, v229 clamp
  v_exp_f32_e64 v230, v230 clamp
  v_exp_f32_e64 v231, v231 clamp
  v_exp_f32_e64 v232, v232 clamp
  v_exp_f32_e64 v233, v233 clamp
  v_exp_f32_e64 v234, v234 clamp
  v_exp_f32_e64 v235, v235 clamp
  v_max_f32 v164, s84, v164
  v_max_f32 v165, s84, v165
  v_max_f32 v166, s84, v166
  v_max_f32 v167, s84, v167
  v_max_f32 v168, s84, v168
  v_max_f32 v169, s84, v169
  v_max_f32 v170, s84, v170
  v_max_f32 v171, s84, v171
  v_pk_add_f32 v[164:165], v[164:165], v[228:229] op_sel:[0,0] op_sel_hi:[1,1]
  v_pk_add_f32 v[166:167], v[166:167], v[230:231] op_sel:[0,0] op_sel_hi:[1,1]
  v_pk_add_f32 v[168:169], v[168:169], v[232:233] op_sel:[0,0] op_sel_hi:[1,1]
  v_pk_add_f32 v[170:171], v[170:171], v[234:235] op_sel:[0,0] op_sel_hi:[1,1]
  v_cvt_pk_bf16_f32 v192, v164, v165
  v_cvt_pk_bf16_f32 v193, v166, v167
  v_cvt_pk_bf16_f32 v194, v168, v169
  v_cvt_pk_bf16_f32 v195, v170, v171
  buffer_store_dwordx4 v[192:195], v2, s[8:11], s94 offen offset:1024 sc1
  v_pk_fma_f32 v[172:173], v[204:205], v[62:63], v[172:173] op_sel:[0,0,0] op_sel_hi:[1,0,1]
  v_pk_fma_f32 v[174:175], v[206:207], v[62:63], v[174:175] op_sel:[0,0,0] op_sel_hi:[1,0,1]
  v_pk_fma_f32 v[176:177], v[208:209], v[62:63], v[176:177] op_sel:[0,0,0] op_sel_hi:[1,0,1]
  v_pk_fma_f32 v[178:179], v[210:211], v[62:63], v[178:179] op_sel:[0,0,0] op_sel_hi:[1,0,1]
  v_pk_fma_f32 v[172:173], v[172:173], v[62:63], s[84:85] op_sel:[0,1,0] op_sel_hi:[1,1,1]
  v_pk_fma_f32 v[174:175], v[174:175], v[62:63], s[84:85] op_sel:[0,1,0] op_sel_hi:[1,1,1]
  v_pk_fma_f32 v[176:177], v[176:177], v[62:63], s[84:85] op_sel:[0,1,0] op_sel_hi:[1,1,1]
  v_pk_fma_f32 v[178:179], v[178:179], v[62:63], s[84:85] op_sel:[0,1,0] op_sel_hi:[1,1,1]
  v_pk_mul_f32 v[220:221], v[172:173], s[86:87] op_sel:[0,0] op_sel_hi:[1,1]
  v_pk_mul_f32 v[222:223], v[174:175], s[86:87] op_sel:[0,0] op_sel_hi:[1,1]
  v_pk_mul_f32 v[224:225], v[176:177], s[86:87] op_sel:[0,0] op_sel_hi:[1,1]
  v_pk_mul_f32 v[226:227], v[178:179], s[86:87] op_sel:[0,0] op_sel_hi:[1,1]
  v_exp_f32_e64 v220, v220 clamp
  v_exp_f32_e64 v221, v221 clamp
  v_exp_f32_e64 v222, v222 clamp
  v_exp_f32_e64 v223, v223 clamp
  v_exp_f32_e64 v224, v224 clamp
  v_exp_f32_e64 v225, v225 clamp
  v_exp_f32_e64 v226, v226 clamp
  v_exp_f32_e64 v227, v227 clamp
  v_max_f32 v172, s84, v172
  v_max_f32 v173, s84, v173
  v_max_f32 v174, s84, v174
  v_max_f32 v175, s84, v175
  v_max_f32 v176, s84, v176
  v_max_f32 v177, s84, v177
  v_max_f32 v178, s84, v178
  v_max_f32 v179, s84, v179
  v_pk_add_f32 v[172:173], v[172:173], v[220:221] op_sel:[0,0] op_sel_hi:[1,1]
  v_pk_add_f32 v[174:175], v[174:175], v[222:223] op_sel:[0,0] op_sel_hi:[1,1]
  v_pk_add_f32 v[176:177], v[176:177], v[224:225] op_sel:[0,0] op_sel_hi:[1,1]
  v_pk_add_f32 v[178:179], v[178:179], v[226:227] op_sel:[0,0] op_sel_hi:[1,1]
  v_cvt_pk_bf16_f32 v196, v172, v173
  v_cvt_pk_bf16_f32 v197, v174, v175
  v_cvt_pk_bf16_f32 v198, v176, v177
  v_cvt_pk_bf16_f32 v199, v178, v179
  buffer_store_dwordx4 v[196:199], v2, s[8:11], s101 offen offset:0 sc1
  v_pk_fma_f32 v[180:181], v[212:213], v[62:63], v[180:181] op_sel:[0,0,0] op_sel_hi:[1,0,1]
  v_pk_fma_f32 v[182:183], v[214:215], v[62:63], v[182:183] op_sel:[0,0,0] op_sel_hi:[1,0,1]
  v_pk_fma_f32 v[184:185], v[216:217], v[62:63], v[184:185] op_sel:[0,0,0] op_sel_hi:[1,0,1]
  v_pk_fma_f32 v[186:187], v[218:219], v[62:63], v[186:187] op_sel:[0,0,0] op_sel_hi:[1,0,1]
  v_pk_fma_f32 v[180:181], v[180:181], v[62:63], s[84:85] op_sel:[0,1,0] op_sel_hi:[1,1,1]
  v_pk_fma_f32 v[182:183], v[182:183], v[62:63], s[84:85] op_sel:[0,1,0] op_sel_hi:[1,1,1]
  v_pk_fma_f32 v[184:185], v[184:185], v[62:63], s[84:85] op_sel:[0,1,0] op_sel_hi:[1,1,1]
  v_pk_fma_f32 v[186:187], v[186:187], v[62:63], s[84:85] op_sel:[0,1,0] op_sel_hi:[1,1,1]
  v_pk_mul_f32 v[228:229], v[180:181], s[86:87] op_sel:[0,0] op_sel_hi:[1,1]
  v_pk_mul_f32 v[230:231], v[182:183], s[86:87] op_sel:[0,0] op_sel_hi:[1,1]
  v_pk_mul_f32 v[232:233], v[184:185], s[86:87] op_sel:[0,0] op_sel_hi:[1,1]
  v_pk_mul_f32 v[234:235], v[186:187], s[86:87] op_sel:[0,0] op_sel_hi:[1,1]
  v_exp_f32_e64 v228, v228 clamp
  v_exp_f32_e64 v229, v229 clamp
  v_exp_f32_e64 v230, v230 clamp
  v_exp_f32_e64 v231, v231 clamp
  v_exp_f32_e64 v232, v232 clamp
  v_exp_f32_e64 v233, v233 clamp
  v_exp_f32_e64 v234, v234 clamp
  v_exp_f32_e64 v235, v235 clamp
  v_max_f32 v180, s84, v180
  v_max_f32 v181, s84, v181
  v_max_f32 v182, s84, v182
  v_max_f32 v183, s84, v183
  v_max_f32 v184, s84, v184
  v_max_f32 v185, s84, v185
  v_max_f32 v186, s84, v186
  v_max_f32 v187, s84, v187
  v_pk_add_f32 v[180:181], v[180:181], v[228:229] op_sel:[0,0] op_sel_hi:[1,1]
  v_pk_add_f32 v[182:183], v[182:183], v[230:231] op_sel:[0,0] op_sel_hi:[1,1]
  v_pk_add_f32 v[184:185], v[184:185], v[232:233] op_sel:[0,0] op_sel_hi:[1,1]
  v_pk_add_f32 v[186:187], v[186:187], v[234:235] op_sel:[0,0] op_sel_hi:[1,1]
  v_cvt_pk_bf16_f32 v200, v180, v181
  v_cvt_pk_bf16_f32 v201, v182, v183
  v_cvt_pk_bf16_f32 v202, v184, v185
  v_cvt_pk_bf16_f32 v203, v186, v187
  buffer_store_dwordx4 v[200:203], v2, s[8:11], s101 offen offset:1024 sc1
  s_barrier
  ds_read_b128 a[32:35], v26 offset:16384
  ds_read_b128 a[36:39], v27 offset:16384
  ds_read_b128 a[40:43], v28 offset:16384
  ds_read_b128 a[44:47], v29 offset:16384
  ds_read_b128 a[160:163], v26 offset:49152
  ds_read_b128 a[164:167], v27 offset:49152
  ds_read_b128 a[168:171], v28 offset:49152
  ds_read_b128 a[172:175], v29 offset:49152
  s_waitcnt vmcnt(25)
  ds_read_b128 a[48:51], v26 offset:0
  ds_read_b128 a[52:55], v27 offset:0
  ds_read_b128 a[56:59], v28 offset:0
  ds_read_b128 a[60:63], v29 offset:0
  s_waitcnt vmcnt(15)
  ds_read_b128 a[176:179], v30 offset:0
  ds_read_b128 a[180:183], v31 offset:0
  ds_read_b128 a[184:187], v32 offset:0
  ds_read_b128 a[188:191], v33 offset:0
  s_waitcnt lgkmcnt(12)
  s_add_u32 m0, s72, 16384
  s_add_u32 s73, s1, 6
  s_and_b32 s73, s73, 7
  s_mul_i32 s73, s73, 128
  s_add_u32 s73, s73, s79
  buffer_load_dwordx4 v5, s[32:35], s73 offen offset:0 lds
  buffer_load_dwordx4 v6, s[32:35], s73 offen offset:1024 lds
  buffer_load_dwordx4 v7, s[32:35], s73 offen offset:2048 lds
  buffer_load_dwordx4 v8, s[32:35], s73 offen offset:3072 lds
  s_waitcnt lgkmcnt(8)
  s_add_u32 m0, s72, 49152
  s_add_u32 s73, s1, 6
  s_and_b32 s73, s73, 7
  s_mul_i32 s73, s73, 128
  s_add_u32 s73, s73, s78
  buffer_load_dwordx4 v5, s[32:35], s73 offen offset:0 lds
  buffer_load_dwordx4 v6, s[32:35], s73 offen offset:1024 lds
  buffer_load_dwordx4 v7, s[32:35], s73 offen offset:2048 lds
  buffer_load_dwordx4 v8, s[32:35], s73 offen offset:3072 lds
  s_waitcnt lgkmcnt(4)
  s_add_u32 m0, s72, 0
  s_add_u32 s73, s1, 7
  s_and_b32 s73, s73, 7
  s_mul_i32 s73, s73, 128
  s_add_u32 s73, s73, s79
  buffer_load_dwordx4 v5, s[32:35], s73 offen offset:0 lds
  buffer_load_dwordx4 v6, s[32:35], s73 offen offset:1024 lds
  buffer_load_dwordx4 v7, s[32:35], s73 offen offset:2048 lds
  buffer_load_dwordx4 v8, s[32:35], s73 offen offset:3072 lds
  s_waitcnt lgkmcnt(0)
  s_add_u32 m0, s72, 65536
  s_add_u32 s73, s1, 7
  s_and_b32 s73, s73, 7
  s_mul_i32 s73, s73, 128
  s_add_u32 s73, s73, s78
  buffer_load_dwordx4 v5, s[32:35], s73 offen offset:0 lds
  buffer_load_dwordx4 v6, s[32:35], s73 offen offset:1024 lds
  buffer_load_dwordx4 v7, s[32:35], s73 offen offset:2048 lds
  buffer_load_dwordx4 v8, s[32:35], s73 offen offset:3072 lds
  s_mul_i32 s91, s83, 3
  s_add_u32 s91, s91, 1
  s_cmp_eq_u32 s83, 7
  s_cselect_b32 s91, 0, s91
  s_cselect_b32 s75, 0, 128
  s_lshl_b32 s74, s91, 7
  s_lshl_b32 s73, s44, 5
  s_add_u32 s74, s74, s73
  s_add_u32 s40, s74, 4224
  s_add_u32 s41, s40, s75
  s_add_u32 s42, s41, s75
  s_buffer_load_dwordx8 s[48:55], s[8:11], s40
  s_buffer_load_dwordx8 s[56:63], s[8:11], s41
  s_buffer_load_dwordx8 s[24:31], s[8:11], s42
  s_waitcnt lgkmcnt(0)
  s_branch PHASE2
PROG_D:
  s_add_u32 s81, s80, 128
  s_add_u32 s82, s80, 256
  s_lshr_b32 s95, s44, 1
  s_and_b32 s96, s44, 1
  v_and_b32 v212, 31, v1
  v_lshrrev_b32_e64 v213, 5, v1
  v_bfe_u32 v214, v1, 1, 3
  v_xor_b32 v214, v214, v213
  v_lshlrev_b32 v214, 4, v214
  v_lshl_add_u32 v214, v212, 7, v214
  s_mul_i32 s74, s95, 8224
  s_lshl_b32 s75, s96, 6
  s_add_u32 s74, s74, s75
  v_xor_b32 v18, s74, v214
  v_xor_b32 v19, 32, v18
  v_xor_b32_e64 v20, 64, v18
  v_xor_b32 v21, 96, v18
  v_mov_b32 v50, 0x3f803f80
  v_mov_b32 v52, 0
  v_mov_b32 v53, 0
  v_mov_b32 v54, 0
  v_mov_b32 v55, 0
  s_mov_b32 s32, s58
  s_mov_b32 s33, s59
  s_mov_b32 s34, 8388608
  s_mov_b32 s35, 0x20000
  v_lshlrev_b32 v248, 7, v1
  s_and_b32 s74, s46, 1
  s_lshl_b32 s74, s74, 4
  s_add_u32 s74, s74, s45
  s_lshl_b32 s74, s74, 2
  s_add_u32 s74, s74, s44
  s_lshl_b32 s74, s74, 16
  s_add_u32 s74, s74, 0
  buffer_load_dword v4, v248, s[32:35], s74 offen
  s_add_u32 s74, s74, 8192
  buffer_load_dword v4, v248, s[32:35], s74 offen
  s_add_u32 s74, s74, 8192
  v_lshlrev_b32_e64 v2, 4, v1
  s_add_u32 m0, s72, 49152
  s_add_u32 s73, s0, 1
  s_and_b32 s73, s73, 3
  s_mul_i32 s73, s73, 256
  s_add_u32 s73, s73, s77
  buffer_load_dwordx4 v5, s[4:7], s73 offen offset:0 lds
  buffer_load_dwordx4 v6, s[4:7], s73 offen offset:1024 lds
  buffer_load_dwordx4 v7, s[4:7], s73 offen offset:2048 lds
  buffer_load_dwordx4 v8, s[4:7], s73 offen offset:3072 lds
  v_add_u32 v26, s72, v214
  v_xor_b32 v27, 32, v26
  v_xor_b32 v28, 64, v26
  v_xor_b32 v29, 96, v26
  v_add_u32 v30, 0x10000, v26
  v_add_u32 v22, 0x10000, v18
  v_add_u32 v31, 0x10000, v27
  v_add_u32 v23, 0x10000, v19
  v_add_u32 v32, 0x10000, v28
  v_add_u32 v24, 0x10000, v20
  v_add_u32 v33, 0x10000, v29
  v_add_u32 v25, 0x10000, v21
  s_mov_b32 s32, s58
  s_mov_b32 s33, s59
  s_mov_b32 s34, 8388608
  s_mov_b32 s35, 0x20000
  s_mov_b32 s12, s52
  s_mov_b32 s13, s53
  s_mov_b32 s14, 524288
  s_mov_b32 s15, 0x20000
  s_add_u32 m0, s72, 65536
  s_add_u32 s73, s0, 1
  s_and_b32 s73, s73, 3
  s_mul_i32 s73, s73, 256
  s_add_u32 s73, s73, s77
  s_add_u32 s73, s73, 128
  buffer_load_dwordx4 v5, s[4:7], s73 offen offset:0 lds
  buffer_load_dwordx4 v6, s[4:7], s73 offen offset:1024 lds
  buffer_load_dwordx4 v7, s[4:7], s73 offen offset:2048 lds
  buffer_load_dwordx4 v8, s[4:7], s73 offen offset:3072 lds
  s_mov_b32 s16, s62
  s_mov_b32 s17, s63
  s_mov_b32 s18, 704512
  s_mov_b32 s19, 0x20000
  s_mov_b32 s20, s64
  s_mov_b32 s21, s65
  s_mov_b32 s22, 2097152
  s_mov_b32 s23, 0x20000
  s_mov_b32 s36, s60
  s_mov_b32 s37, s61
  s_mov_b32 s38, 4096
  s_mov_b32 s39, 0x20000
  s_mov_b32 s40, s66
  s_mov_b32 s41, s67
  s_mov_b32 s42, 256
  s_mov_b32 s43, 0x20000
  s_lshl_b32 s74, s47, 1
  s_add_u32 s74, s74, s95
  s_lshl_b32 s79, s74, 17
  s_lshl_b32 s74, s44, 10
  s_add_u32 m0, s72, 81920
  s_add_u32 s73, s0, 1
  s_and_b32 s73, s73, 3
  s_mul_i32 s73, s73, 352256
  s_add_u32 s73, s73, s80
  buffer_load_dwordx4 v14, s[28:31], s73 offen offset:0 lds
  buffer_load_dwordx4 v15, s[28:31], s73 offen offset:1024 lds
  buffer_load_dwordx4 v16, s[28:31], s73 offen offset:2048 lds
  buffer_load_dwordx4 v17, s[28:31], s73 offen offset:3072 lds
  s_add_u32 s79, s79, s74
  s_xor_b32 s78, s79, 0x20000
  v_bfe_u32 v215, v1, 2, 2
  v_and_b32 v216, 3, v1
  v_bfe_u32 v217, v1, 4, 1
  v_lshlrev_b32_e64 v216, 3, v216
  v_lshl_add_u32 v216, v217, 5, v216
  v_lshl_add_u32 v218, v213, 3, v215
  v_lshl_add_u32 v219, v218, 7, v216
  v_bfe_u32 v220, v1, 3, 1
  v_lshl_add_u32 v219, v220, 6, v219
  s_mul_i32 s74, s96, 4160
  s_lshl_b32 s75, s95, 11
  s_or_b32 s74, s74, s75
  v_xor_b32_e64 v34, s74, v219
  v_xor_b32 v35, 2048, v34
  v_xor_b32 v36, 4096, v34
  v_xor_b32 v37, 6144, v34
  v_add_u32 v38, 0x10000, v34
  v_add_u32 v39, 0x10000, v35
  v_add_u32 v40, 0x10000, v36
  v_add_u32 v41, 0x10000, v37
  s_lshl_b32 s74, s96, 7
  s_add_u32 s74, s74, 131072
  v_lshl_add_u32 v44, v213, 4, s74
  v_lshl_add_u32 v45, v212, 2, s74
  s_lshl_b32 s75, s95, 8
  v_lshl_add_u32 v49, v213, 14, v45
  v_add_u32 v49, s75, v49
  s_lshl_b32 s74, s95, 9
  s_add_u32 s75, s74, 133120
  s_mov_b32 s91, s75
  v_lshl_add_u32 v42, v213, 4, s75
  v_lshl_add_u32 v43, v212, 2, s75
  s_lshl_b32 s75, s44, 9
  s_add_u32 s75, s75, 135168
  v_lshl_add_u32 v48, v1, 2, s75
  s_mul_i32 s74, s44, 2304
  s_add_u32 s74, s74, 137216
  v_mul_u32_u24 v13, 72, v212
  v_lshl_add_u32 v13, v213, 3, v13
  v_add_u32_e64 v13, s74, v13
  v_mul_u32_u24 v46, 72, v218
  v_add3_u32 v46, v46, v216, s74
  v_and_b32 v221, 15, v1
  v_lshlrev_b32 v222, 2, v217
  v_cmp_eq_u32 vcc, v221, v222
  s_nop 1
  v_cndmask_b32 v88, 0, v50, vcc
  v_mov_b32 v89, v88
  v_mov_b32 v90, v88
  v_mov_b32 v91, v88
  s_mov_b32 s84, 0x358637bd
  s_mov_b32 s85, 0x358637bd
  s_mov_b32 s86, 0x3fb8aa3b
  s_mov_b32 s87, 0x3fb8aa3b
  s_or_b32 s99, s2, s44
  s_waitcnt vmcnt(20)
  s_barrier
  ds_read_b128 v[156:159], v18 offset:0
  ds_read_b128 v[160:163], v19 offset:0
  ds_read_b128 v[164:167], v18 offset:4096
  ds_read_b128 v[168:171], v19 offset:4096
  ds_read_b128 v[172:175], v18 offset:16384
  ds_read_b128 v[176:179], v19 offset:16384
  ds_read_b128 v[180:183], v18 offset:20480
  ds_read_b128 v[184:187], v19 offset:20480
  ds_read_b128 a[8:11], v20 offset:0
  ds_read_b128 a[12:15], v21 offset:0
  ds_read_b128 a[136:139], v20 offset:4096
  ds_read_b128 a[140:143], v21 offset:4096
  ds_read_b128 a[24:27], v20 offset:16384
  ds_read_b128 a[28:31], v21 offset:16384
  ds_read_b128 a[152:155], v20 offset:20480
  ds_read_b128 a[156:159], v21 offset:20480
  s_add_u32 m0, s72, 98304
  s_add_u32 s73, s0, 2
  s_and_b32 s73, s73, 3
  s_mul_i32 s73, s73, 256
  s_add_u32 s73, s73, s77
  buffer_load_dwordx4 v5, s[4:7], s73 offen offset:0 lds
  buffer_load_dwordx4 v6, s[4:7], s73 offen offset:1024 lds
  buffer_load_dwordx4 v7, s[4:7], s73 offen offset:2048 lds
  buffer_load_dwordx4 v8, s[4:7], s73 offen offset:3072 lds
  s_add_u32 m0, s72, 114688
  s_add_u32 s73, s0, 2
  s_and_b32 s73, s73, 3
  s_mul_i32 s73, s73, 256
  s_add_u32 s73, s73, s77
  s_add_u32 s73, s73, 128
  buffer_load_dwordx4 v5, s[4:7], s73 offen offset:0 lds
  buffer_load_dwordx4 v6, s[4:7], s73 offen offset:1024 lds
  buffer_load_dwordx4 v7, s[4:7], s73 offen offset:2048 lds
  buffer_load_dwordx4 v8, s[4:7], s73 offen offset:3072 lds
  s_waitcnt lgkmcnt(15)
  v_accvgpr_write_b32 a0, v156
  v_accvgpr_write_b32 a1, v157
  v_accvgpr_write_b32 a2, v158
  v_accvgpr_write_b32 a3, v159
  s_waitcnt lgkmcnt(14)
  v_accvgpr_write_b32 a4, v160
  v_accvgpr_write_b32 a5, v161
  v_accvgpr_write_b32 a6, v162
  v_accvgpr_write_b32 a7, v163
  s_waitcnt lgkmcnt(13)
  v_accvgpr_write_b32 a128, v164
  v_accvgpr_write_b32 a129, v165
  v_accvgpr_write_b32 a130, v166
  v_accvgpr_write_b32 a131, v167
  s_waitcnt lgkmcnt(12)
  v_accvgpr_write_b32 a132, v168
  v_accvgpr_write_b32 a133, v169
  v_accvgpr_write_b32 a134, v170
  v_accvgpr_write_b32 a135, v171
  s_waitcnt lgkmcnt(11)
  v_accvgpr_write_b32 a16, v172
  v_accvgpr_write_b32 a17, v173
  v_accvgpr_write_b32 a18, v174
  v_accvgpr_write_b32 a19, v175
  s_waitcnt lgkmcnt(10)
  v_accvgpr_write_b32 a20, v176
  v_accvgpr_write_b32 a21, v177
  v_accvgpr_write_b32 a22, v178
  v_accvgpr_write_b32 a23, v179
  s_waitcnt lgkmcnt(9)
  v_accvgpr_write_b32 a144, v180
  v_accvgpr_write_b32 a145, v181
  v_accvgpr_write_b32 a146, v182
  v_accvgpr_write_b32 a147, v183
  s_waitcnt lgkmcnt(8)
  v_accvgpr_write_b32 a148, v184
  v_accvgpr_write_b32 a149, v185
  v_accvgpr_write_b32 a150, v186
  v_accvgpr_write_b32 a151, v187
  s_waitcnt vmcnt(12) lgkmcnt(0)
  s_barrier
  s_cmp_eq_u32 s99, 0
  s_cbranch_scc1 EPOCH_D
EPOCHR_D:
  ds_read_b64_tr_b16 v[68:69], v34 offset:32768
  ds_read_b64_tr_b16 v[70:71], v34 offset:33280
  ds_read_b64_tr_b16 v[72:73], v35 offset:32768
  ds_read_b64_tr_b16 v[74:75], v35 offset:33280
  ds_read_b64_tr_b16 v[76:77], v36 offset:32768
  ds_read_b64_tr_b16 v[78:79], v36 offset:33280
  s_add_u32 m0, s72, 0
  s_add_u32 s73, s0, 2
  s_and_b32 s73, s73, 3
  s_mul_i32 s73, s73, 352256
  s_add_u32 s73, s73, s80
  buffer_load_dwordx4 v14, s[28:31], s73 offen offset:0 lds
  buffer_load_dwordx4 v15, s[28:31], s73 offen offset:1024 lds
  buffer_load_dwordx4 v16, s[28:31], s73 offen offset:2048 lds
  buffer_load_dwordx4 v17, s[28:31], s73 offen offset:3072 lds
  s_add_u32 m0, s72, 16384
  s_add_u32 s73, s0, 3
  s_and_b32 s73, s73, 3
  s_mul_i32 s73, s73, 256
  s_add_u32 s73, s73, s77
  buffer_load_dwordx4 v5, s[4:7], s73 offen offset:0 lds
  buffer_load_dwordx4 v6, s[4:7], s73 offen offset:1024 lds
  buffer_load_dwordx4 v7, s[4:7], s73 offen offset:2048 lds
  buffer_load_dwordx4 v8, s[4:7], s73 offen offset:3072 lds
  s_waitcnt lgkmcnt(4)
  v_mfma_f32_32x32x16_bf16 v[92:107], v[68:71], a[0:3], 0
  ds_read_b64_tr_b16 v[80:81], v37 offset:32768
  ds_read_b64_tr_b16 v[82:83], v37 offset:33280
  v_mfma_f32_16x16x32_bf16 v[84:87], v[88:91], v[68:71], 0
  ds_read_b128 v[204:207], v18 offset:49152
  ds_read_b128 v[208:211], v19 offset:49152
  ds_read_b128 v[212:215], v18 offset:53248
  v_mfma_f32_32x32x16_bf16 v[108:123], v[68:71], a[128:131], 0
  ds_read_b128 v[216:219], v19 offset:53248
  ds_read_b128 v[220:223], v22 offset:0
  ds_read_b128 v[224:227], v23 offset:0
  s_waitcnt lgkmcnt(10)
  v_mfma_f32_32x32x16_bf16 v[92:107], v[72:75], a[4:7], v[92:107]
  ds_read_b64_tr_b16 v[68:69], v34 offset:40960
  ds_read_b64_tr_b16 v[70:71], v34 offset:41472
  ds_read_b128 v[228:231], v22 offset:4096
  ds_read_b128 v[232:235], v23 offset:4096
  v_mfma_f32_32x32x16_bf16 v[108:123], v[72:75], a[132:135], v[108:123]
  ds_read_b128 a[40:43], v20 offset:49152
  ds_read_b128 a[44:47], v21 offset:49152
  ds_read_b128 a[168:171], v20 offset:53248
  s_waitcnt lgkmcnt(15)
  v_mfma_f32_32x32x16_bf16 v[92:107], v[76:79], a[8:11], v[92:107]
  ds_read_b64_tr_b16 v[72:73], v35 offset:40960
  ds_read_b64_tr_b16 v[74:75], v35 offset:41472
  v_mfma_f32_16x16x32_bf16 v[84:87], v[88:91], v[76:79], v[84:87]
  ds_read_b128 a[172:175], v21 offset:53248
  ds_read_b128 a[56:59], v24 offset:0
  ds_read_b128 a[60:63], v25 offset:0
  v_mfma_f32_32x32x16_bf16 v[108:123], v[76:79], a[136:139], v[108:123]
  ds_read_b128 a[184:187], v24 offset:4096
  ds_read_b128 a[188:191], v25 offset:4096
  s_waitcnt lgkmcnt(15)
  v_mfma_f32_32x32x16_bf16 v[92:107], v[80:83], a[12:15], v[92:107]
  ds_read_b64_tr_b16 v[76:77], v36 offset:40960
  ds_read_b64_tr_b16 v[78:79], v36 offset:41472
  v_accvgpr_write_b32 a32, v204
  v_accvgpr_write_b32 a33, v205
  v_accvgpr_write_b32 a34, v206
  v_accvgpr_write_b32 a35, v207
  v_accvgpr_write_b32 a36, v208
  v_accvgpr_write_b32 a37, v209
  v_accvgpr_write_b32 a38, v210
  v_accvgpr_write_b32 a39, v211
  v_mfma_f32_32x32x16_bf16 v[108:123], v[80:83], a[140:143], v[108:123]
  v_accvgpr_write_b32 a160, v212
  v_accvgpr_write_b32 a161, v213
  v_accvgpr_write_b32 a162, v214
  v_accvgpr_write_b32 a163, v215
  v_accvgpr_write_b32 a164, v216
  v_accvgpr_write_b32 a165, v217
  v_accvgpr_write_b32 a166, v218
  v_accvgpr_write_b32 a167, v219
  s_waitcnt lgkmcnt(14)
  v_mfma_f32_32x32x16_bf16 v[92:107], v[68:71], a[16:19], v[92:107]
  ds_read_b64_tr_b16 v[80:81], v37 offset:40960
  ds_read_b64_tr_b16 v[82:83], v37 offset:41472
  v_mfma_f32_16x16x32_bf16 v[84:87], v[88:91], v[68:71], v[84:87]
  v_accvgpr_write_b32 a48, v220
  v_accvgpr_write_b32 a49, v221
  v_accvgpr_write_b32 a50, v222
  v_accvgpr_write_b32 a51, v223
  v_accvgpr_write_b32 a52, v224
  v_accvgpr_write_b32 a53, v225
  v_accvgpr_write_b32 a54, v226
  v_accvgpr_write_b32 a55, v227
  v_mfma_f32_32x32x16_bf16 v[108:123], v[68:71], a[144:147], v[108:123]
  s_waitcnt lgkmcnt(15)
  v_accvgpr_write_b32 a176, v228
  v_accvgpr_write_b32 a177, v229
  v_accvgpr_write_b32 a178, v230
  v_accvgpr_write_b32 a179, v231
  s_waitcnt lgkmcnt(14)
  v_accvgpr_write_b32 a180, v232
  v_accvgpr_write_b32 a181, v233
  v_accvgpr_write_b32 a182, v234
  v_accvgpr_write_b32 a183, v235
  v_dot2c_f32_bf16 v52, v204, v50
  v_dot2c_f32_bf16 v53, v204, v204
  v_dot2c_f32_bf16 v54, v212, v50
  v_dot2c_f32_bf16 v55, v212, v212
  v_dot2c_f32_bf16 v52, v205, v50
  v_dot2c_f32_bf16 v53, v205, v205
  v_dot2c_f32_bf16 v54, v213, v50
  v_dot2c_f32_bf16 v55, v213, v213
  v_dot2c_f32_bf16 v52, v206, v50
  v_dot2c_f32_bf16 v53, v206, v206
  v_dot2c_f32_bf16 v54, v214, v50
  v_dot2c_f32_bf16 v55, v214, v214
  v_dot2c_f32_bf16 v52, v207, v50
  v_dot2c_f32_bf16 v53, v207, v207
  v_dot2c_f32_bf16 v54, v215, v50
  v_dot2c_f32_bf16 v55, v215, v215
  v_dot2c_f32_bf16 v52, v208, v50
  v_dot2c_f32_bf16 v53, v208, v208
  v_dot2c_f32_bf16 v54, v216, v50
  v_dot2c_f32_bf16 v55, v216, v216
  v_dot2c_f32_bf16 v52, v209, v50
  v_dot2c_f32_bf16 v53, v209, v209
  v_dot2c_f32_bf16 v54, v217, v50
  v_dot2c_f32_bf16 v55, v217, v217
  v_dot2c_f32_bf16 v52, v210, v50
  v_dot2c_f32_bf16 v53, v210, v210
  v_dot2c_f32_bf16 v54, v218, v50
  v_dot2c_f32_bf16 v55, v218, v218
  v_dot2c_f32_bf16 v52, v211, v50
  v_dot2c_f32_bf16 v53, v211, v211
  v_dot2c_f32_bf16 v54, v219, v50
  v_dot2c_f32_bf16 v55, v219, v219
  v_dot2c_f32_bf16 v52, v220, v50
  v_dot2c_f32_bf16 v53, v220, v220
  v_dot2c_f32_bf16 v54, v228, v50
  v_dot2c_f32_bf16 v55, v228, v228
  v_dot2c_f32_bf16 v52, v221, v50
  v_dot2c_f32_bf16 v53, v221, v221
  v_dot2c_f32_bf16 v54, v229, v50
  v_dot2c_f32_bf16 v55, v229, v229
  v_dot2c_f32_bf16 v52, v222, v50
  v_dot2c_f32_bf16 v53, v222, v222
  v_dot2c_f32_bf16 v54, v230, v50
  v_dot2c_f32_bf16 v55, v230, v230
  v_dot2c_f32_bf16 v52, v223, v50
  v_dot2c_f32_bf16 v53, v223, v223
  v_dot2c_f32_bf16 v54, v231, v50
  v_dot2c_f32_bf16 v55, v231, v231
  v_dot2c_f32_bf16 v52, v224, v50
  v_dot2c_f32_bf16 v53, v224, v224
  v_dot2c_f32_bf16 v54, v232, v50
  v_dot2c_f32_bf16 v55, v232, v232
  v_dot2c_f32_bf16 v52, v225, v50
  v_dot2c_f32_bf16 v53, v225, v225
  v_dot2c_f32_bf16 v54, v233, v50
  v_dot2c_f32_bf16 v55, v233, v233
  v_dot2c_f32_bf16 v52, v226, v50
  v_dot2c_f32_bf16 v53, v226, v226
  v_dot2c_f32_bf16 v54, v234, v50
  v_dot2c_f32_bf16 v55, v234, v234
  v_dot2c_f32_bf16 v52, v227, v50
  v_dot2c_f32_bf16 v53, v227, v227
  v_dot2c_f32_bf16 v54, v235, v50
  v_dot2c_f32_bf16 v55, v235, v235
  s_waitcnt vmcnt(8) lgkmcnt(4)
  s_barrier
  v_mfma_f32_32x32x16_bf16 v[92:107], v[72:75], a[20:23], v[92:107]
  ds_read_b64_tr_b16 v[68:69], v38 offset:16384
  ds_read_b64_tr_b16 v[70:71], v38 offset:16896
  ds_read_b128 v[204:207], v22 offset:32768
  ds_read_b128 v[208:211], v23 offset:32768
  s_add_u32 m0, s72, 49152
  s_add_u32 s73, s0, 3
  s_and_b32 s73, s73, 3
  s_mul_i32 s73, s73, 256
  s_add_u32 s73, s73, s77
  s_add_u32 s73, s73, 128
  buffer_load_dwordx4 v5, s[4:7], s73 offen offset:0 lds
  buffer_load_dwordx4 v6, s[4:7], s73 offen offset:1024 lds
  buffer_load_dwordx4 v7, s[4:7], s73 offen offset:2048 lds
  buffer_load_dwordx4 v8, s[4:7], s73 offen offset:3072 lds
  v_mfma_f32_32x32x16_bf16 v[108:123], v[72:75], a[148:151], v[108:123]
  ds_read_b128 v[212:215], v22 offset:36864
  ds_read_b128 v[216:219], v23 offset:36864
  s_waitcnt lgkmcnt(8)
  v_mfma_f32_32x32x16_bf16 v[92:107], v[76:79], a[24:27], v[92:107]
  ds_read_b64_tr_b16 v[72:73], v39 offset:16384
  ds_read_b64_tr_b16 v[74:75], v39 offset:16896
  v_mfma_f32_16x16x32_bf16 v[84:87], v[88:91], v[76:79], v[84:87]
  ds_read_b128 v[220:223], v22 offset:49152
  ds_read_b128 v[224:227], v23 offset:49152
  s_add_u32 m0, s72, 65536
  s_add_u32 s73, s0, 3
  s_and_b32 s73, s73, 3
  s_mul_i32 s73, s73, 352256
  s_add_u32 s73, s73, s80
  buffer_load_dwordx4 v14, s[28:31], s73 offen offset:0 lds
  buffer_load_dwordx4 v15, s[28:31], s73 offen offset:1024 lds
  buffer_load_dwordx4 v16, s[28:31], s73 offen offset:2048 lds
  buffer_load_dwordx4 v17, s[28:31], s73 offen offset:3072 lds
  v_mfma_f32_32x32x16_bf16 v[108:123], v[76:79], a[152:155], v[108:123]
  ds_read_b128 v[228:231], v22 offset:53248
  ds_read_b128 v[232:235], v23 offset:53248
  s_waitcnt lgkmcnt(12)
  v_mfma_f32_32x32x16_bf16 v[92:107], v[80:83], a[28:31], v[92:107]
  ds_read_b64_tr_b16 v[76:77], v40 offset:16384
  ds_read_b64_tr_b16 v[78:79], v40 offset:16896
  ds_read_b128 a[72:75], v24 offset:32768
  ds_read_b128 a[76:79], v25 offset:32768
  v_mfma_f32_32x32x16_bf16 v[108:123], v[80:83], a[156:159], v[108:123]
  ds_read_b128 a[200:203], v24 offset:36864
  ds_read_b128 a[204:207], v25 offset:36864
  s_waitcnt lgkmcnt(15)
  v_mfma_f32_32x32x16_bf16 v[92:107], v[68:71], a[32:35], v[92:107]
  ds_read_b64_tr_b16 v[80:81], v41 offset:16384
  ds_read_b64_tr_b16 v[82:83], v41 offset:16896
  v_mfma_f32_16x16x32_bf16 v[84:87], v[88:91], v[68:71], v[84:87]
  ds_read_b128 a[88:91], v24 offset:49152
  ds_read_b128 a[92:95], v25 offset:49152
  v_mfma_f32_32x32x16_bf16 v[108:123], v[68:71], a[160:163], v[108:123]
  ds_read_b128 a[216:219], v24 offset:53248
  ds_read_b128 a[220:223], v25 offset:53248
  s_waitcnt lgkmcnt(15)
  v_mfma_f32_32x32x16_bf16 v[92:107], v[72:75], a[36:39], v[92:107]
  ds_read_b64_tr_b16 v[68:69], v38 offset:24576
  ds_read_b64_tr_b16 v[70:71], v38 offset:25088
  v_accvgpr_write_b32 a64, v204
  v_accvgpr_write_b32 a65, v205
  v_accvgpr_write_b32 a66, v206
  v_accvgpr_write_b32 a67, v207
  v_mfma_f32_32x32x16_bf16 v[108:123], v[72:75], a[164:167], v[108:123]
  v_accvgpr_write_b32 a68, v208
  v_accvgpr_write_b32 a69, v209
  v_accvgpr_write_b32 a70, v210
  v_accvgpr_write_b32 a71, v211
  v_lshrrev_b32 v244, 3, v1
  v_mul_u32_u24 v244, 3072, v244
  v_add_u32 v5, v244, v5
  s_waitcnt lgkmcnt(12)
  v_mfma_f32_32x32x16_bf16 v[92:107], v[76:79], a[40:43], v[92:107]
  ds_read_b64_tr_b16 v[72:73], v39 offset:24576
  ds_read_b64_tr_b16 v[74:75], v39 offset:25088
  v_mfma_f32_16x16x32_bf16 v[84:87], v[88:91], v[76:79], v[84:87]
  v_accvgpr_write_b32 a192, v212
  v_accvgpr_write_b32 a193, v213
  v_accvgpr_write_b32 a194, v214
  v_accvgpr_write_b32 a195, v215
  v_mfma_f32_32x32x16_bf16 v[108:123], v[76:79], a[168:171], v[108:123]
  v_accvgpr_write_b32 a196, v216
  v_accvgpr_write_b32 a197, v217
  v_accvgpr_write_b32 a198, v218
  v_accvgpr_write_b32 a199, v219
  v_add_u32 v244, 24576, v244
  v_add_u32 v6, v244, v6
  s_waitcnt lgkmcnt(8)
  v_mfma_f32_32x32x16_bf16 v[92:107], v[80:83], a[44:47], v[92:107]
  ds_read_b64_tr_b16 v[76:77], v40 offset:24576
  ds_read_b64_tr_b16 v[78:79], v40 offset:25088
  v_accvgpr_write_b32 a80, v220
  v_accvgpr_write_b32 a81, v221
  v_accvgpr_write_b32 a82, v222
  v_accvgpr_write_b32 a83, v223
  v_mfma_f32_32x32x16_bf16 v[108:123], v[80:83], a[172:175], v[108:123]
  v_accvgpr_write_b32 a84, v224
  v_accvgpr_write_b32 a85, v225
  v_accvgpr_write_b32 a86, v226
  v_accvgpr_write_b32 a87, v227
  v_add_u32 v244, 24576, v244
  v_add_u32 v7, v244, v7
  s_waitcnt lgkmcnt(4)
  v_mfma_f32_32x32x16_bf16 v[92:107], v[68:71], a[48:51], v[92:107]
  ds_read_b64_tr_b16 v[80:81], v41 offset:24576
  ds_read_b64_tr_b16 v[82:83], v41 offset:25088
  v_mfma_f32_16x16x32_bf16 v[84:87], v[88:91], v[68:71], v[84:87]
  v_accvgpr_write_b32 a208, v228
  v_accvgpr_write_b32 a209, v229
  v_accvgpr_write_b32 a210, v230
  v_accvgpr_write_b32 a211, v231
  v_mfma_f32_32x32x16_bf16 v[108:123], v[68:71], a[176:179], v[108:123]
  v_accvgpr_write_b32 a212, v232
  v_accvgpr_write_b32 a213, v233
  v_accvgpr_write_b32 a214, v234
  v_accvgpr_write_b32 a215, v235
  v_add_u32 v244, 24576, v244
  v_add_u32 v8, v244, v8
  v_dot2c_f32_bf16 v52, v204, v50
  v_dot2c_f32_bf16 v53, v204, v204
  v_dot2c_f32_bf16 v54, v212, v50
  v_dot2c_f32_bf16 v55, v212, v212
  v_dot2c_f32_bf16 v52, v205, v50
  v_dot2c_f32_bf16 v53, v205, v205
  v_dot2c_f32_bf16 v54, v213, v50
  v_dot2c_f32_bf16 v55, v213, v213
  v_dot2c_f32_bf16 v52, v206, v50
  v_dot2c_f32_bf16 v53, v206, v206
  v_dot2c_f32_bf16 v54, v214, v50
  v_dot2c_f32_bf16 v55, v214, v214
  v_dot2c_f32_bf16 v52, v207, v50
  v_dot2c_f32_bf16 v53, v207, v207
  v_dot2c_f32_bf16 v54, v215, v50
  v_dot2c_f32_bf16 v55, v215, v215
  v_dot2c_f32_bf16 v52, v208, v50
  v_dot2c_f32_bf16 v53, v208, v208
  v_dot2c_f32_bf16 v54, v216, v50
  v_dot2c_f32_bf16 v55, v216, v216
  v_dot2c_f32_bf16 v52, v209, v50
  v_dot2c_f32_bf16 v53, v209, v209
  v_dot2c_f32_bf16 v54, v217, v50
  v_dot2c_f32_bf16 v55, v217, v217
  v_dot2c_f32_bf16 v52, v210, v50
  v_dot2c_f32_bf16 v53, v210, v210
  v_dot2c_f32_bf16 v54, v218, v50
  v_dot2c_f32_bf16 v55, v218, v218
  v_dot2c_f32_bf16 v52, v211, v50
  v_dot2c_f32_bf16 v53, v211, v211
  v_dot2c_f32_bf16 v54, v219, v50
  v_dot2c_f32_bf16 v55, v219, v219
  v_dot2c_f32_bf16 v52, v220, v50
  v_dot2c_f32_bf16 v53, v220, v220
  v_dot2c_f32_bf16 v54, v228, v50
  v_dot2c_f32_bf16 v55, v228, v228
  v_dot2c_f32_bf16 v52, v221, v50
  v_dot2c_f32_bf16 v53, v221, v221
  v_dot2c_f32_bf16 v54, v229, v50
  v_dot2c_f32_bf16 v55, v229, v229
  v_dot2c_f32_bf16 v52, v222, v50
  v_dot2c_f32_bf16 v53, v222, v222
  v_dot2c_f32_bf16 v54, v230, v50
  v_dot2c_f32_bf16 v55, v230, v230
  v_dot2c_f32_bf16 v52, v223, v50
  v_dot2c_f32_bf16 v53, v223, v223
  v_dot2c_f32_bf16 v54, v231, v50
  v_dot2c_f32_bf16 v55, v231, v231
  v_dot2c_f32_bf16 v52, v224, v50
  v_dot2c_f32_bf16 v53, v224, v224
  v_dot2c_f32_bf16 v54, v232, v50
  v_dot2c_f32_bf16 v55, v232, v232
  v_dot2c_f32_bf16 v52, v225, v50
  v_dot2c_f32_bf16 v53, v225, v225
  v_dot2c_f32_bf16 v54, v233, v50
  v_dot2c_f32_bf16 v55, v233, v233
  v_dot2c_f32_bf16 v52, v226, v50
  v_dot2c_f32_bf16 v53, v226, v226
  v_dot2c_f32_bf16 v54, v234, v50
  v_dot2c_f32_bf16 v55, v234, v234
  v_dot2c_f32_bf16 v52, v227, v50
  v_dot2c_f32_bf16 v53, v227, v227
  v_dot2c_f32_bf16 v54, v235, v50
  v_dot2c_f32_bf16 v55, v235, v235
  s_waitcnt vmcnt(4)
  s_barrier
  s_waitcnt lgkmcnt(4)
  v_mfma_f32_32x32x16_bf16 v[92:107], v[72:75], a[52:55], v[92:107]
  ds_read_b64_tr_b16 v[68:69], v34 offset:0
  ds_read_b64_tr_b16 v[70:71], v34 offset:512
  ds_read_b128 v[204:207], v18 offset:16384
  ds_read_b128 v[208:211], v19 offset:16384
  s_add_u32 m0, s72, 32768
  s_add_u32 s73, s0, 0
  s_and_b32 s73, s73, 3
  s_mul_i32 s73, s73, 352256
  s_add_u32 s73, s73, s81
  buffer_load_dwordx4 v14, s[28:31], s73 offen offset:0 lds
  buffer_load_dwordx4 v15, s[28:31], s73 offen offset:1024 lds
  buffer_load_dwordx4 v16, s[28:31], s73 offen offset:2048 lds
  buffer_load_dwordx4 v17, s[28:31], s73 offen offset:3072 lds
  v_mfma_f32_32x32x16_bf16 v[108:123], v[72:75], a[180:183], v[108:123]
  ds_read_b128 v[212:215], v18 offset:20480
  ds_read_b128 v[216:219], v19 offset:20480
  s_waitcnt lgkmcnt(8)
  v_mfma_f32_32x32x16_bf16 v[92:107], v[76:79], a[56:59], v[92:107]
  ds_read_b64_tr_b16 v[72:73], v35 offset:0
  ds_read_b64_tr_b16 v[74:75], v35 offset:512
  v_mfma_f32_16x16x32_bf16 v[84:87], v[88:91], v[76:79], v[84:87]
  ds_read_b128 v[220:223], v18 offset:49152
  ds_read_b128 v[224:227], v19 offset:49152
  s_add_u32 m0, s72, 98304
  s_add_u32 s73, s0, 1
  s_and_b32 s73, s73, 3
  s_mul_i32 s73, s73, 352256
  s_add_u32 s73, s73, s81
  buffer_load_dwordx4 v14, s[28:31], s73 offen offset:0 lds
  buffer_load_dwordx4 v15, s[28:31], s73 offen offset:1024 lds
  buffer_load_dwordx4 v16, s[28:31], s73 offen offset:2048 lds
  buffer_load_dwordx4 v17, s[28:31], s73 offen offset:3072 lds
  v_mfma_f32_32x32x16_bf16 v[108:123], v[76:79], a[184:187], v[108:123]
  ds_read_b128 v[228:231], v18 offset:53248
  ds_read_b128 v[232:235], v19 offset:53248
  s_waitcnt lgkmcnt(12)
  v_mfma_f32_32x32x16_bf16 v[92:107], v[80:83], a[60:63], v[92:107]
  ds_read_b64_tr_b16 v[76:77], v36 offset:0
  ds_read_b64_tr_b16 v[78:79], v36 offset:512
  ds_read_b128 a[104:107], v20 offset:16384
  ds_read_b128 a[108:111], v21 offset:16384
  s_add_u32 m0, s72, 114688
  s_add_u32 s73, s0, 2
  s_and_b32 s73, s73, 3
  s_mul_i32 s73, s73, 352256
  s_add_u32 s73, s73, s81
  buffer_load_dwordx4 v14, s[28:31], s73 offen offset:0 lds
  buffer_load_dwordx4 v15, s[28:31], s73 offen offset:1024 lds
  buffer_load_dwordx4 v16, s[28:31], s73 offen offset:2048 lds
  buffer_load_dwordx4 v17, s[28:31], s73 offen offset:3072 lds
  v_mfma_f32_32x32x16_bf16 v[108:123], v[80:83], a[188:191], v[108:123]
  ds_read_b128 a[232:235], v20 offset:20480
  ds_read_b128 a[236:239], v21 offset:20480
  s_waitcnt lgkmcnt(15)
  v_mfma_f32_32x32x16_bf16 v[92:107], v[68:71], a[64:67], v[92:107]
  ds_read_b64_tr_b16 v[80:81], v37 offset:0
  ds_read_b64_tr_b16 v[82:83], v37 offset:512
  v_mfma_f32_16x16x32_bf16 v[84:87], v[88:91], v[68:71], v[84:87]
  ds_read_b128 a[120:123], v20 offset:49152
  ds_read_b128 a[124:127], v21 offset:49152
  v_mfma_f32_32x32x16_bf16 v[108:123], v[68:71], a[192:195], v[108:123]
  ds_read_b128 a[248:251], v20 offset:53248
  ds_read_b128 a[252:255], v21 offset:53248
  s_waitcnt lgkmcnt(15)
  v_mfma_f32_32x32x16_bf16 v[92:107], v[72:75], a[68:71], v[92:107]
  ds_read_b64_tr_b16 v[68:69], v34 offset:8192
  ds_read_b64_tr_b16 v[70:71], v34 offset:8704
  v_accvgpr_write_b32 a96, v204
  v_accvgpr_write_b32 a97, v205
  v_accvgpr_write_b32 a98, v206
  v_accvgpr_write_b32 a99, v207
  v_mfma_f32_32x32x16_bf16 v[108:123], v[72:75], a[196:199], v[108:123]
  v_accvgpr_write_b32 a100, v208
  v_accvgpr_write_b32 a101, v209
  v_accvgpr_write_b32 a102, v210
  v_accvgpr_write_b32 a103, v211
  s_waitcnt lgkmcnt(12)
  v_mfma_f32_32x32x16_bf16 v[92:107], v[76:79], a[72:75], v[92:107]
  ds_read_b64_tr_b16 v[72:73], v35 offset:8192
  ds_read_b64_tr_b16 v[74:75], v35 offset:8704
  v_mfma_f32_16x16x32_bf16 v[84:87], v[88:91], v[76:79], v[84:87]
  v_accvgpr_write_b32 a224, v212
  v_accvgpr_write_b32 a225, v213
  v_accvgpr_write_b32 a226, v214
  v_accvgpr_write_b32 a227, v215
  v_mfma_f32_32x32x16_bf16 v[108:123], v[76:79], a[200:203], v[108:123]
  v_accvgpr_write_b32 a228, v216
  v_accvgpr_write_b32 a229, v217
  v_accvgpr_write_b32 a230, v218
  v_accvgpr_write_b32 a231, v219
  s_waitcnt lgkmcnt(8)
  v_mfma_f32_32x32x16_bf16 v[92:107], v[80:83], a[76:79], v[92:107]
  ds_read_b64_tr_b16 v[76:77], v36 offset:8192
  ds_read_b64_tr_b16 v[78:79], v36 offset:8704
  v_accvgpr_write_b32 a112, v220
  v_accvgpr_write_b32 a113, v221
  v_accvgpr_write_b32 a114, v222
  v_accvgpr_write_b32 a115, v223
  v_mfma_f32_32x32x16_bf16 v[108:123], v[80:83], a[204:207], v[108:123]
  v_accvgpr_write_b32 a116, v224
  v_accvgpr_write_b32 a117, v225
  v_accvgpr_write_b32 a118, v226
  v_accvgpr_write_b32 a119, v227
  s_waitcnt lgkmcnt(4)
  v_mfma_f32_32x32x16_bf16 v[92:107], v[68:71], a[80:83], v[92:107]
  ds_read_b64_tr_b16 v[80:81], v37 offset:8192
  ds_read_b64_tr_b16 v[82:83], v37 offset:8704
  v_mfma_f32_16x16x32_bf16 v[84:87], v[88:91], v[68:71], v[84:87]
  v_accvgpr_write_b32 a240, v228
  v_accvgpr_write_b32 a241, v229
  v_accvgpr_write_b32 a242, v230
  v_accvgpr_write_b32 a243, v231
  v_mfma_f32_32x32x16_bf16 v[108:123], v[68:71], a[208:211], v[108:123]
  v_accvgpr_write_b32 a244, v232
  v_accvgpr_write_b32 a245, v233
  v_accvgpr_write_b32 a246, v234
  v_accvgpr_write_b32 a247, v235
  v_dot2c_f32_bf16 v52, v156, v50
  v_dot2c_f32_bf16 v53, v156, v156
  v_dot2c_f32_bf16 v54, v164, v50
  v_dot2c_f32_bf16 v55, v164, v164
  v_dot2c_f32_bf16 v52, v157, v50
  v_dot2c_f32_bf16 v53, v157, v157
  v_dot2c_f32_bf16 v54, v165, v50
  v_dot2c_f32_bf16 v55, v165, v165
  v_dot2c_f32_bf16 v52, v158, v50
  v_dot2c_f32_bf16 v53, v158, v158
  v_dot2c_f32_bf16 v54, v166, v50
  v_dot2c_f32_bf16 v55, v166, v166
  v_dot2c_f32_bf16 v52, v159, v50
  v_dot2c_f32_bf16 v53, v159, v159
  v_dot2c_f32_bf16 v54, v167, v50
  v_dot2c_f32_bf16 v55, v167, v167
  v_dot2c_f32_bf16 v52, v160, v50
  v_dot2c_f32_bf16 v53, v160, v160
  v_dot2c_f32_bf16 v54, v168, v50
  v_dot2c_f32_bf16 v55, v168, v168
  v_dot2c_f32_bf16 v52, v161, v50
  v_dot2c_f32_bf16 v53, v161, v161
  v_dot2c_f32_bf16 v54, v169, v50
  v_dot2c_f32_bf16 v55, v169, v169
  v_dot2c_f32_bf16 v52, v162, v50
  v_dot2c_f32_bf16 v53, v162, v162
  v_dot2c_f32_bf16 v54, v170, v50
  v_dot2c_f32_bf16 v55, v170, v170
  v_dot2c_f32_bf16 v52, v163, v50
  v_dot2c_f32_bf16 v53, v163, v163
  v_dot2c_f32_bf16 v54, v171, v50
  v_dot2c_f32_bf16 v55, v171, v171
  v_dot2c_f32_bf16 v52, v172, v50
  v_dot2c_f32_bf16 v53, v172, v172
  v_dot2c_f32_bf16 v54, v180, v50
  v_dot2c_f32_bf16 v55, v180, v180
  v_dot2c_f32_bf16 v52, v173, v50
  v_dot2c_f32_bf16 v53, v173, v173
  v_dot2c_f32_bf16 v54, v181, v50
  v_dot2c_f32_bf16 v55, v181, v181
  v_dot2c_f32_bf16 v52, v174, v50
  v_dot2c_f32_bf16 v53, v174, v174
  v_dot2c_f32_bf16 v54, v182, v50
  v_dot2c_f32_bf16 v55, v182, v182
  v_dot2c_f32_bf16 v52, v175, v50
  v_dot2c_f32_bf16 v53, v175, v175
  v_dot2c_f32_bf16 v54, v183, v50
  v_dot2c_f32_bf16 v55, v183, v183
  v_dot2c_f32_bf16 v52, v176, v50
  v_dot2c_f32_bf16 v53, v176, v176
  v_dot2c_f32_bf16 v54, v184, v50
  v_dot2c_f32_bf16 v55, v184, v184
  v_dot2c_f32_bf16 v52, v177, v50
  v_dot2c_f32_bf16 v53, v177, v177
  v_dot2c_f32_bf16 v54, v185, v50
  v_dot2c_f32_bf16 v55, v185, v185
  v_dot2c_f32_bf16 v52, v178, v50
  v_dot2c_f32_bf16 v53, v178, v178
  v_dot2c_f32_bf16 v54, v186, v50
  v_dot2c_f32_bf16 v55, v186, v186
  v_dot2c_f32_bf16 v52, v179, v50
  v_dot2c_f32_bf16 v53, v179, v179
  v_dot2c_f32_bf16 v54, v187, v50
  v_dot2c_f32_bf16 v55, v187, v187
  v_dot2c_f32_bf16 v52, v204, v50
  v_dot2c_f32_bf16 v53, v204, v204
  v_dot2c_f32_bf16 v54, v212, v50
  v_dot2c_f32_bf16 v55, v212, v212
  v_dot2c_f32_bf16 v52, v205, v50
  v_dot2c_f32_bf16 v53, v205, v205
  v_dot2c_f32_bf16 v54, v213, v50
  v_dot2c_f32_bf16 v55, v213, v213
  v_dot2c_f32_bf16 v52, v206, v50
  v_dot2c_f32_bf16 v53, v206, v206
  v_dot2c_f32_bf16 v54, v214, v50
  v_dot2c_f32_bf16 v55, v214, v214
  v_dot2c_f32_bf16 v52, v207, v50
  v_dot2c_f32_bf16 v53, v207, v207
  v_dot2c_f32_bf16 v54, v215, v50
  v_dot2c_f32_bf16 v55, v215, v215
  v_dot2c_f32_bf16 v52, v208, v50
  v_dot2c_f32_bf16 v53, v208, v208
  v_dot2c_f32_bf16 v54, v216, v50
  v_dot2c_f32_bf16 v55, v216, v216
  v_dot2c_f32_bf16 v52, v209, v50
  v_dot2c_f32_bf16 v53, v209, v209
  v_dot2c_f32_bf16 v54, v217, v50
  v_dot2c_f32_bf16 v55, v217, v217
  v_dot2c_f32_bf16 v52, v210, v50
  v_dot2c_f32_bf16 v53, v210, v210
  v_dot2c_f32_bf16 v54, v218, v50
  v_dot2c_f32_bf16 v55, v218, v218
  v_dot2c_f32_bf16 v52, v211, v50
  v_dot2c_f32_bf16 v53, v211, v211
  v_dot2c_f32_bf16 v54, v219, v50
  v_dot2c_f32_bf16 v55, v219, v219
  v_dot2c_f32_bf16 v52, v220, v50
  v_dot2c_f32_bf16 v53, v220, v220
  v_dot2c_f32_bf16 v54, v228, v50
  v_dot2c_f32_bf16 v55, v228, v228
  v_dot2c_f32_bf16 v52, v221, v50
  v_dot2c_f32_bf16 v53, v221, v221
  v_dot2c_f32_bf16 v54, v229, v50
  v_dot2c_f32_bf16 v55, v229, v229
  v_dot2c_f32_bf16 v52, v222, v50
  v_dot2c_f32_bf16 v53, v222, v222
  v_dot2c_f32_bf16 v54, v230, v50
  v_dot2c_f32_bf16 v55, v230, v230
  v_dot2c_f32_bf16 v52, v223, v50
  v_dot2c_f32_bf16 v53, v223, v223
  v_dot2c_f32_bf16 v54, v231, v50
  v_dot2c_f32_bf16 v55, v231, v231
  v_dot2c_f32_bf16 v52, v224, v50
  v_dot2c_f32_bf16 v53, v224, v224
  v_dot2c_f32_bf16 v54, v232, v50
  v_dot2c_f32_bf16 v55, v232, v232
  v_dot2c_f32_bf16 v52, v225, v50
  v_dot2c_f32_bf16 v53, v225, v225
  v_dot2c_f32_bf16 v54, v233, v50
  v_dot2c_f32_bf16 v55, v233, v233
  v_dot2c_f32_bf16 v52, v226, v50
  v_dot2c_f32_bf16 v53, v226, v226
  v_dot2c_f32_bf16 v54, v234, v50
  v_dot2c_f32_bf16 v55, v234, v234
  v_dot2c_f32_bf16 v52, v227, v50
  v_dot2c_f32_bf16 v53, v227, v227
  v_dot2c_f32_bf16 v54, v235, v50
  v_dot2c_f32_bf16 v55, v235, v235
  s_waitcnt vmcnt(12)
  s_barrier
  s_waitcnt lgkmcnt(4)
  v_mfma_f32_32x32x16_bf16 v[92:107], v[72:75], a[84:87], v[92:107]
  ds_read_b64_tr_b16 v[68:69], v38 offset:0
  ds_read_b64_tr_b16 v[70:71], v38 offset:512
  s_add_u32 m0, s72, 81920
  s_add_u32 s73, s0, 3
  s_and_b32 s73, s73, 3
  s_mul_i32 s73, s73, 352256
  s_add_u32 s73, s73, s81
  buffer_load_dwordx4 v14, s[28:31], s73 offen offset:0 lds
  buffer_load_dwordx4 v15, s[28:31], s73 offen offset:1024 lds
  buffer_load_dwordx4 v16, s[28:31], s73 offen offset:2048 lds
  buffer_load_dwordx4 v17, s[28:31], s73 offen offset:3072 lds
  v_mfma_f32_32x32x16_bf16 v[108:123], v[72:75], a[212:215], v[108:123]
  s_waitcnt lgkmcnt(4)
  v_mfma_f32_32x32x16_bf16 v[92:107], v[76:79], a[88:91], v[92:107]
  ds_read_b64_tr_b16 v[72:73], v39 offset:0
  ds_read_b64_tr_b16 v[74:75], v39 offset:512
  v_permlane32_swap_b32 v52, v53
  v_permlane32_swap_b32 v54, v55
  v_mfma_f32_16x16x32_bf16 v[84:87], v[88:91], v[76:79], v[84:87]
  s_add_u32 m0, s72, 16384
  s_add_u32 s73, s1, 0
  s_and_b32 s73, s73, 7
  s_mul_i32 s73, s73, 128
  s_add_u32 s73, s73, s79
  buffer_load_dwordx4 v5, s[32:35], s73 offen offset:0 lds
  buffer_load_dwordx4 v6, s[32:35], s73 offen offset:1024 lds
  buffer_load_dwordx4 v7, s[32:35], s73 offen offset:2048 lds
  buffer_load_dwordx4 v8, s[32:35], s73 offen offset:3072 lds
  v_mfma_f32_32x32x16_bf16 v[108:123], v[76:79], a[216:219], v[108:123]
  v_add_f32 v52, v52, v53
  v_add_f32 v54, v54, v55
  ds_write_b32 v48, v52 offset:0
  ds_write_b32 v48, v54 offset:256
  v_xor_b32 v244, 512, v48
  s_waitcnt lgkmcnt(6)
  v_mfma_f32_32x32x16_bf16 v[92:107], v[80:83], a[92:95], v[92:107]
  ds_read_b64_tr_b16 v[76:77], v40 offset:0
  ds_read_b64_tr_b16 v[78:79], v40 offset:512
  s_add_u32 m0, s72, 49152
  s_add_u32 s73, s1, 0
  s_and_b32 s73, s73, 7
  s_mul_i32 s73, s73, 128
  s_add_u32 s73, s73, s78
  buffer_load_dwordx4 v5, s[32:35], s73 offen offset:0 lds
  buffer_load_dwordx4 v6, s[32:35], s73 offen offset:1024 lds
  buffer_load_dwordx4 v7, s[32:35], s73 offen offset:2048 lds
  buffer_load_dwordx4 v8, s[32:35], s73 offen offset:3072 lds
  v_mfma_f32_32x32x16_bf16 v[108:123], v[80:83], a[220:223], v[108:123]
  s_waitcnt lgkmcnt(6)
  v_mfma_f32_32x32x16_bf16 v[92:107], v[68:71], a[96:99], v[92:107]
  ds_read_b64_tr_b16 v[80:81], v41 offset:0
  ds_read_b64_tr_b16 v[82:83], v41 offset:512
  v_mfma_f32_16x16x32_bf16 v[84:87], v[88:91], v[68:71], v[84:87]
  v_mfma_f32_32x32x16_bf16 v[108:123], v[68:71], a[224:227], v[108:123]
  v_lshlrev_b32_e64 v248, 7, v1
  s_and_b32 s74, s2, 63
  s_lshl_b32 s74, s74, 2
  s_add_u32 s74, s74, s44
  s_mul_i32 s76, s74, 2816
  s_lshl_b32 s74, s74, 11
  s_mov_b64 exec, 0xffff
  buffer_load_dword v4, v248, s[12:15], s74 offen
  s_mov_b64 exec, 0x3fffff
  buffer_load_dword v4, v248, s[16:19], s76 offen
  s_mov_b64 exec, -1
  s_waitcnt lgkmcnt(6)
  v_mfma_f32_32x32x16_bf16 v[92:107], v[72:75], a[100:103], v[92:107]
  ds_read_b64_tr_b16 v[68:69], v38 offset:8192
  ds_read_b64_tr_b16 v[70:71], v38 offset:8704
  v_mfma_f32_32x32x16_bf16 v[108:123], v[72:75], a[228:231], v[108:123]
  s_waitcnt lgkmcnt(4)
  v_mfma_f32_32x32x16_bf16 v[92:107], v[76:79], a[104:107], v[92:107]
  ds_read_b64_tr_b16 v[72:73], v39 offset:8192
  ds_read_b64_tr_b16 v[74:75], v39 offset:8704
  v_mfma_f32_16x16x32_bf16 v[84:87], v[88:91], v[76:79], v[84:87]
  v_mfma_f32_32x32x16_bf16 v[108:123], v[76:79], a[232:235], v[108:123]
  s_waitcnt lgkmcnt(4)
  v_mfma_f32_32x32x16_bf16 v[92:107], v[80:83], a[108:111], v[92:107]
  ds_read_b64_tr_b16 v[76:77], v40 offset:8192
  ds_read_b64_tr_b16 v[78:79], v40 offset:8704
  v_mfma_f32_32x32x16_bf16 v[108:123], v[80:83], a[236:239], v[108:123]
  s_waitcnt lgkmcnt(4)
  v_mfma_f32_32x32x16_bf16 v[92:107], v[68:71], a[112:115], v[92:107]
  ds_read_b64_tr_b16 v[80:81], v41 offset:8192
  ds_read_b64_tr_b16 v[82:83], v41 offset:8704
  v_mfma_f32_16x16x32_bf16 v[84:87], v[88:91], v[68:71], v[84:87]
  v_mfma_f32_32x32x16_bf16 v[108:123], v[68:71], a[240:243], v[108:123]
  s_waitcnt vmcnt(22)
  s_barrier
  s_waitcnt lgkmcnt(4)
  v_mfma_f32_32x32x16_bf16 v[92:107], v[72:75], a[116:119], v[92:107]
  ds_read_b64_tr_b16 v[68:69], v34 offset:32768
  ds_read_b64_tr_b16 v[70:71], v34 offset:33280
  ds_read_b32 v53, v244 offset:0
  ds_read_b32 v55, v244 offset:256
  s_waitcnt lgkmcnt(1)
  v_add_f32 v52, v52, v53
  s_waitcnt lgkmcnt(0)
  v_add_f32 v54, v54, v55
  v_mov_b32 v53, v52
  v_mov_b32_e64 v55, v54
  v_mfma_f32_16x16x32_bf16 v[84:87], v[88:91], v[76:79], v[84:87]
  v_permlane32_swap_b32 v52, v53
  v_mfma_f32_32x32x16_bf16 v[108:123], v[72:75], a[244:247], v[108:123]
  v_permlane32_swap_b32 v54, v55
  v_mul_f32 v56, 0xbb000000, v52
  v_mul_f32 v62, 0xbb000000, v54
  v_mul_f32 v245, 0x3b000000, v53
  v_mul_f32 v246, 0x3b000000, v55
  v_fma_f32 v245, -v56, v56, v245
  v_fma_f32 v246, -v62, v62, v246
  v_mfma_f32_32x32x16_bf16 v[92:107], v[76:79], a[120:123], v[92:107]
  ds_read_b64_tr_b16 v[72:73], v35 offset:32768
  ds_read_b64_tr_b16 v[74:75], v35 offset:33280
  v_max_f32 v245, 0, v245
  v_max_f32 v246, 0, v246
  v_add_f32 v245, 0x3727c5ac, v245
  v_add_f32 v246, 0x3727c5ac, v246
  v_rsq_f32_e64 v57, v245
  v_mfma_f32_32x32x16_bf16 v[108:123], v[76:79], a[248:251], v[108:123]
  v_rsq_f32 v63, v246
  v_sqrt_f32 v58, v245
  v_sqrt_f32_e64 v64, v246
  v_mul_f32 v59, 0xc0135761, v57
  v_mul_f32 v65, 0xc0135761, v63
  v_mfma_f32_32x32x16_bf16 v[92:107], v[80:83], a[124:127], v[92:107]
  ds_read_b64_tr_b16 v[76:77], v36 offset:32768
  ds_read_b64_tr_b16 v[78:79], v36 offset:33280
  ds_write_b32 v49, v84 offset:0
  v_mul_f32 v245, v57, v57
  v_mul_f32 v246, v63, v63
  v_mul_f32 v52, 0xbdd2d3e8, v57
  v_mul_f32 v54, 0xbdd2d3e8, v63
  v_mul_f32_e64 v60, v245, v52
  v_mfma_f32_32x32x16_bf16 v[108:123], v[80:83], a[252:255], v[108:123]
  v_mul_f32 v66, v246, v54
  s_waitcnt lgkmcnt(0)
  s_barrier
  s_add_u32 m0, s72, 0
  s_add_u32 s73, s1, 1
  s_and_b32 s73, s73, 7
  s_mul_i32 s73, s73, 128
  s_add_u32 s73, s73, s79
  buffer_load_dwordx4 v5, s[32:35], s73 offen offset:0 lds
  buffer_load_dwordx4 v6, s[32:35], s73 offen offset:1024 lds
  buffer_load_dwordx4 v7, s[32:35], s73 offen offset:2048 lds
  buffer_load_dwordx4 v8, s[32:35], s73 offen offset:3072 lds
  s_andn2_b32 s94, s90, 1
  s_mul_i32 s94, s94, 44032
  s_lshl_b32 s74, s80, 5
  s_add_u32 s94, s94, s74
  s_lshl_b32 s74, s96, 11
  s_add_u32 s94, s94, s74
  s_add_u32 s94, s94, 6291456
  s_add_u32 s101, s94, 44032
  v_mfma_f32_32x32x16_bf16 v[124:139], v[68:71], a[0:3], 0
  ds_read_b64_tr_b16 v[80:81], v37 offset:32768
  ds_read_b64_tr_b16 v[82:83], v37 offset:33280
  ds_read_b128 v[204:207], v44 offset:0
  ds_read_b128 v[220:223], v44 offset:256
  ds_read_b128 v[208:211], v44 offset:32
  ds_read_b128 v[224:227], v44 offset:288
  ds_read_b128 v[212:215], v44 offset:64
  v_mfma_f32_16x16x32_bf16 v[84:87], v[88:91], v[68:71], 0
  ds_read_b128 v[228:231], v44 offset:320
  ds_read_b128 v[216:219], v44 offset:96
  v_mfma_f32_32x32x16_bf16 v[140:155], v[68:71], a[128:131], 0
  ds_read_b128 v[232:235], v44 offset:352
  s_waitcnt lgkmcnt(6)
  v_add_f32 v204, v204, v220
  v_add_f32 v205, v205, v221
  v_add_f32 v206, v206, v222
  v_add_f32 v207, v207, v223
  s_waitcnt lgkmcnt(4)
  v_add_f32 v208, v208, v224
  v_add_f32 v209, v209, v225
  v_mfma_f32_32x32x16_bf16 v[124:139], v[72:75], a[4:7], v[124:139]
  ds_read_b64_tr_b16 v[68:69], v34 offset:40960
  ds_read_b64_tr_b16 v[70:71], v34 offset:41472
  v_add_f32 v210, v210, v226
  v_add_f32 v211, v211, v227
  s_waitcnt lgkmcnt(4)
  v_add_f32 v212, v212, v228
  v_add_f32 v213, v213, v229
  v_add_f32 v214, v214, v230
  v_mfma_f32_32x32x16_bf16 v[140:155], v[72:75], a[132:135], v[140:155]
  v_add_f32 v215, v215, v231
  s_waitcnt lgkmcnt(2)
  v_add_f32 v216, v216, v232
  v_add_f32 v217, v217, v233
  v_add_f32 v218, v218, v234
  v_add_f32 v219, v219, v235
  v_fmac_f32 v92, v204, v56
  v_fmac_f32 v93, v205, v56
  v_mfma_f32_32x32x16_bf16 v[124:139], v[76:79], a[8:11], v[124:139]
  ds_read_b64_tr_b16 v[72:73], v35 offset:40960
  ds_read_b64_tr_b16 v[74:75], v35 offset:41472
  v_fmac_f32 v94, v206, v56
  v_fmac_f32 v95, v207, v56
  v_fmac_f32 v96, v208, v56
  v_fmac_f32 v97, v209, v56
  v_fmac_f32_e64 v98, v210, v56
  v_mfma_f32_16x16x32_bf16 v[84:87], v[88:91], v[76:79], v[84:87]
  v_fmac_f32 v99, v211, v56
  v_mul_f32 v220, v92, v92
  v_mfma_f32_32x32x16_bf16 v[140:155], v[76:79], a[136:139], v[140:155]
  v_mul_f32 v221, v93, v93
  v_mul_f32 v222, v94, v94
  v_mul_f32 v223, v95, v95
  v_mul_f32 v224, v96, v96
  v_mul_f32 v225, v97, v97
  v_mul_f32 v226, v98, v98
  v_mul_f32_e64 v227, v99, v99
  v_mfma_f32_32x32x16_bf16 v[124:139], v[80:83], a[12:15], v[124:139]
  ds_read_b64_tr_b16 v[76:77], v36 offset:40960
  ds_read_b64_tr_b16 v[78:79], v36 offset:41472
  v_fma_f32 v220, v220, v60, v59
  v_fma_f32 v221, v221, v60, v59
  v_fma_f32 v222, v222, v60, v59
  v_fma_f32 v223, v223, v60, v59
  v_fma_f32 v224, v224, v60, v59
  v_mfma_f32_32x32x16_bf16 v[140:155], v[80:83], a[140:143], v[140:155]
  v_fma_f32 v225, v225, v60, v59
  v_fma_f32 v226, v226, v60, v59
  v_fma_f32 v227, v227, v60, v59
  v_mul_f32 v220, v220, v92
  v_mul_f32 v221, v221, v93
  v_mul_f32 v222, v222, v94
  v_mul_f32_e64 v223, v223, v95
  s_waitcnt lgkmcnt(4)
  v_mfma_f32_32x32x16_bf16 v[124:139], v[68:71], a[16:19], v[124:139]
  ds_read_b64_tr_b16 v[80:81], v37 offset:40960
  ds_read_b64_tr_b16 v[82:83], v37 offset:41472
  v_mul_f32 v224, v224, v96
  v_mul_f32 v225, v225, v97
  v_mul_f32 v226, v226, v98
  v_mul_f32 v227, v227, v99
  v_mfma_f32_16x16x32_bf16 v[84:87], v[88:91], v[68:71], v[84:87]
  v_exp_f32_e64 v220, v220
  v_mfma_f32_32x32x16_bf16 v[140:155], v[68:71], a[144:147], v[140:155]
  s_waitcnt vmcnt(22)
  s_barrier
  v_exp_f32 v221, v221
  v_exp_f32 v222, v222
  v_exp_f32 v223, v223
  s_waitcnt lgkmcnt(4)
  v_mfma_f32_32x32x16_bf16 v[124:139], v[72:75], a[20:23], v[124:139]
  ds_read_b64_tr_b16 v[68:69], v38 offset:32768
  ds_read_b64_tr_b16 v[70:71], v38 offset:33280
  s_add_u32 m0, s72, 65536
  s_add_u32 s73, s1, 1
  s_and_b32 s73, s73, 7
  s_mul_i32 s73, s73, 128
  s_add_u32 s73, s73, s78
  buffer_load_dwordx4 v5, s[32:35], s73 offen offset:0 lds
  buffer_load_dwordx4 v6, s[32:35], s73 offen offset:1024 lds
  buffer_load_dwordx4 v7, s[32:35], s73 offen offset:2048 lds
  buffer_load_dwordx4 v8, s[32:35], s73 offen offset:3072 lds
  v_mfma_f32_32x32x16_bf16 v[140:155], v[72:75], a[148:151], v[140:155]
  v_exp_f32 v224, v224
  v_exp_f32 v225, v225
  v_exp_f32_e64 v226, v226
  s_waitcnt lgkmcnt(4)
  v_mfma_f32_32x32x16_bf16 v[124:139], v[76:79], a[24:27], v[124:139]
  ds_read_b64_tr_b16 v[72:73], v39 offset:32768
  ds_read_b64_tr_b16 v[74:75], v39 offset:33280
  v_exp_f32_e64 v227, v227
  v_fma_f32 v220, v220, v58, v58
  v_fma_f32 v221, v221, v58, v58
  v_fma_f32 v222, v222, v58, v58
  v_mfma_f32_16x16x32_bf16 v[84:87], v[88:91], v[76:79], v[84:87]
  v_fma_f32 v223, v223, v58, v58
  v_fma_f32 v224, v224, v58, v58
  v_mfma_f32_32x32x16_bf16 v[140:155], v[76:79], a[152:155], v[140:155]
  v_fma_f32 v225, v225, v58, v58
  v_fma_f32 v226, v226, v58, v58
  v_fma_f32 v227, v227, v58, v58
  v_rcp_f32 v220, v220
  v_rcp_f32_e64 v221, v221
  s_waitcnt lgkmcnt(4)
  v_mfma_f32_32x32x16_bf16 v[124:139], v[80:83], a[28:31], v[124:139]
  ds_read_b64_tr_b16 v[76:77], v40 offset:32768
  ds_read_b64_tr_b16 v[78:79], v40 offset:33280
  v_rcp_f32 v222, v222
  v_rcp_f32 v223, v223
  v_mfma_f32_32x32x16_bf16 v[140:155], v[80:83], a[156:159], v[140:155]
  v_rcp_f32 v224, v224
  v_rcp_f32 v225, v225
  v_rcp_f32 v226, v226
  s_waitcnt lgkmcnt(4)
  v_mfma_f32_32x32x16_bf16 v[124:139], v[68:71], a[32:35], v[124:139]
  ds_read_b64_tr_b16 v[80:81], v41 offset:32768
  ds_read_b64_tr_b16 v[82:83], v41 offset:33280
  v_rcp_f32 v227, v227
  v_mul_f32 v92, v92, v220
  v_mul_f32 v93, v93, v221
  v_mul_f32 v94, v94, v222
  v_mfma_f32_16x16x32_bf16 v[84:87], v[88:91], v[68:71], v[84:87]
  v_mul_f32 v95, v95, v223
  v_mul_f32 v96, v96, v224
  v_mfma_f32_32x32x16_bf16 v[140:155], v[68:71], a[160:163], v[140:155]
  v_mul_f32 v97, v97, v225
  v_mul_f32 v98, v98, v226
  v_mul_f32_e64 v99, v99, v227
  v_cvt_pk_bf16_f32 v188, v92, v93
  v_cvt_pk_bf16_f32 v189, v94, v95
  v_cvt_pk_bf16_f32 v190, v96, v97
  v_cvt_pk_bf16_f32 v191, v98, v99
  s_waitcnt lgkmcnt(4)
  v_mfma_f32_32x32x16_bf16 v[124:139], v[72:75], a[36:39], v[124:139]
  ds_read_b64_tr_b16 v[68:69], v38 offset:40960
  ds_read_b64_tr_b16 v[70:71], v38 offset:41472
  buffer_store_dwordx4 v[188:191], v2, s[8:11], s94 offen offset:0 sc1
  v_fmac_f32 v100, v212, v56
  v_fmac_f32 v101, v213, v56
  v_fmac_f32 v102, v214, v56
  v_fmac_f32_e64 v103, v215, v56
  v_mfma_f32_32x32x16_bf16 v[140:155], v[72:75], a[164:167], v[140:155]
  v_fmac_f32 v104, v216, v56
  v_fmac_f32 v105, v217, v56
  v_fmac_f32 v106, v218, v56
  v_fmac_f32 v107, v219, v56
  v_mul_f32 v228, v100, v100
  v_mul_f32 v229, v101, v101
  v_mul_f32 v230, v102, v102
  s_waitcnt lgkmcnt(4)
  v_mfma_f32_32x32x16_bf16 v[124:139], v[76:79], a[40:43], v[124:139]
  ds_read_b64_tr_b16 v[72:73], v39 offset:40960
  ds_read_b64_tr_b16 v[74:75], v39 offset:41472
  v_mul_f32 v231, v103, v103
  v_mul_f32 v232, v104, v104
  v_mul_f32 v233, v105, v105
  v_mul_f32 v234, v106, v106
  v_mul_f32_e64 v235, v107, v107
  v_mfma_f32_16x16x32_bf16 v[84:87], v[88:91], v[76:79], v[84:87]
  v_fma_f32 v228, v228, v60, v59
  v_fma_f32 v229, v229, v60, v59
  v_mfma_f32_32x32x16_bf16 v[140:155], v[76:79], a[168:171], v[140:155]
  v_fma_f32 v230, v230, v60, v59
  v_fma_f32 v231, v231, v60, v59
  v_fma_f32 v232, v232, v60, v59
  v_fma_f32 v233, v233, v60, v59
  v_fma_f32 v234, v234, v60, v59
  v_fma_f32 v235, v235, v60, v59
  v_mul_f32 v228, v228, v100
  s_waitcnt lgkmcnt(4)
  v_mfma_f32_32x32x16_bf16 v[124:139], v[80:83], a[44:47], v[124:139]
  ds_read_b64_tr_b16 v[76:77], v40 offset:40960
  ds_read_b64_tr_b16 v[78:79], v40 offset:41472
  v_mul_f32 v229, v229, v101
  v_mul_f32 v230, v230, v102
  v_mul_f32 v231, v231, v103
  v_mul_f32 v232, v232, v104
  v_mul_f32_e64 v233, v233, v105
  v_mfma_f32_32x32x16_bf16 v[140:155], v[80:83], a[172:175], v[140:155]
  v_mul_f32 v234, v234, v106
  v_mul_f32 v235, v235, v107
  v_exp_f32 v228, v228
  v_exp_f32_e64 v229, v229
  s_waitcnt lgkmcnt(4)
  v_mfma_f32_32x32x16_bf16 v[124:139], v[68:71], a[48:51], v[124:139]
  ds_read_b64_tr_b16 v[80:81], v41 offset:40960
  ds_read_b64_tr_b16 v[82:83], v41 offset:41472
  v_exp_f32 v230, v230
  v_exp_f32 v231, v231
  v_mfma_f32_16x16x32_bf16 v[84:87], v[88:91], v[68:71], v[84:87]
  v_exp_f32_e64 v232, v232
  v_mfma_f32_32x32x16_bf16 v[140:155], v[68:71], a[176:179], v[140:155]
  s_waitcnt vmcnt(23)
  s_barrier
  v_exp_f32 v233, v233
  v_exp_f32 v234, v234
  v_exp_f32 v235, v235
  s_waitcnt lgkmcnt(4)
  v_mfma_f32_32x32x16_bf16 v[124:139], v[72:75], a[52:55], v[124:139]
  ds_read_b64_tr_b16 v[68:69], v38 offset:49152
  ds_read_b64_tr_b16 v[70:71], v38 offset:49664
  s_add_u32 m0, s72, 32768
  s_add_u32 s73, s1, 4
  s_and_b32 s73, s73, 7
  s_mul_i32 s73, s73, 128
  s_add_u32 s73, s73, s79
  buffer_load_dwordx4 v5, s[32:35], s73 offen offset:0 lds
  buffer_load_dwordx4 v6, s[32:35], s73 offen offset:1024 lds
  buffer_load_dwordx4 v7, s[32:35], s73 offen offset:2048 lds
  buffer_load_dwordx4 v8, s[32:35], s73 offen offset:3072 lds
  v_mfma_f32_32x32x16_bf16 v[140:155], v[72:75], a[180:183], v[140:155]
  v_fma_f32 v228, v228, v58, v58
  v_fma_f32 v229, v229, v58, v58
  v_fma_f32 v230, v230, v58, v58
  v_fma_f32 v231, v231, v58, v58
  v_fma_f32 v232, v232, v58, v58
  v_fma_f32 v233, v233, v58, v58
  v_fma_f32 v234, v234, v58, v58
  s_waitcnt lgkmcnt(4)
  v_mfma_f32_32x32x16_bf16 v[124:139], v[76:79], a[56:59], v[124:139]
  ds_read_b64_tr_b16 v[72:73], v39 offset:49152
  ds_read_b64_tr_b16 v[74:75], v39 offset:49664
  v_fma_f32 v235, v235, v58, v58
  v_rcp_f32 v228, v228
  v_rcp_f32 v229, v229
  v_mfma_f32_16x16x32_bf16 v[84:87], v[88:91], v[76:79], v[84:87]
  v_rcp_f32_e64 v230, v230
  v_mfma_f32_32x32x16_bf16 v[140:155], v[76:79], a[184:187], v[140:155]
  v_rcp_f32 v231, v231
  v_rcp_f32 v232, v232
  v_rcp_f32 v233, v233
  s_waitcnt lgkmcnt(4)
  v_mfma_f32_32x32x16_bf16 v[124:139], v[80:83], a[60:63], v[124:139]
  ds_read_b64_tr_b16 v[76:77], v40 offset:49152
  ds_read_b64_tr_b16 v[78:79], v40 offset:49664
  v_rcp_f32 v234, v234
  v_rcp_f32 v235, v235
  v_mul_f32_e64 v100, v100, v228
  v_mfma_f32_32x32x16_bf16 v[140:155], v[80:83], a[188:191], v[140:155]
  v_mul_f32 v101, v101, v229
  v_mul_f32 v102, v102, v230
  v_mul_f32 v103, v103, v231
  v_mul_f32 v104, v104, v232
  v_mul_f32 v105, v105, v233
  v_mul_f32 v106, v106, v234
  v_mul_f32 v107, v107, v235
  s_waitcnt lgkmcnt(4)
  v_mfma_f32_32x32x16_bf16 v[124:139], v[68:71], a[64:67], v[124:139]
  ds_read_b64_tr_b16 v[80:81], v41 offset:49152
  ds_read_b64_tr_b16 v[82:83], v41 offset:49664
  v_cvt_pk_bf16_f32 v192, v100, v101
  v_cvt_pk_bf16_f32 v193, v102, v103
  v_cvt_pk_bf16_f32 v194, v104, v105
  v_cvt_pk_bf16_f32 v195, v106, v107
  buffer_store_dwordx4 v[192:195], v2, s[8:11], s94 offen offset:1024 sc1
  v_mfma_f32_16x16x32_bf16 v[84:87], v[88:91], v[68:71], v[84:87]
  v_fmac_f32 v108, v204, v62
  v_fmac_f32 v109, v205, v62
  v_mfma_f32_32x32x16_bf16 v[140:155], v[68:71], a[192:195], v[140:155]
  v_fmac_f32 v110, v206, v62
  v_fmac_f32 v111, v207, v62
  v_fmac_f32 v112, v208, v62
  v_fmac_f32 v113, v209, v62
  v_fmac_f32 v114, v210, v62
  v_fmac_f32 v115, v211, v62
  v_mul_f32 v220, v108, v108
  s_waitcnt lgkmcnt(4)
  v_mfma_f32_32x32x16_bf16 v[124:139], v[72:75], a[68:71], v[124:139]
  ds_read_b64_tr_b16 v[68:69], v38 offset:57344
  ds_read_b64_tr_b16 v[70:71], v38 offset:57856
  v_mul_f32 v221, v109, v109
  v_mul_f32 v222, v110, v110
  v_mul_f32 v223, v111, v111
  v_mul_f32 v224, v112, v112
  v_mul_f32_e64 v225, v113, v113
  v_mfma_f32_32x32x16_bf16 v[140:155], v[72:75], a[196:199], v[140:155]
  v_mul_f32 v226, v114, v114
  v_mul_f32 v227, v115, v115
  v_fma_f32 v220, v220, v66, v65
  v_fma_f32 v221, v221, v66, v65
  v_fma_f32 v222, v222, v66, v65
  v_fma_f32 v223, v223, v66, v65
  v_fma_f32 v224, v224, v66, v65
  s_waitcnt lgkmcnt(4)
  v_mfma_f32_32x32x16_bf16 v[124:139], v[76:79], a[72:75], v[124:139]
  ds_read_b64_tr_b16 v[72:73], v39 offset:57344
  ds_read_b64_tr_b16 v[74:75], v39 offset:57856
  v_fma_f32 v225, v225, v66, v65
  v_fma_f32 v226, v226, v66, v65
  v_fma_f32 v227, v227, v66, v65
  v_mul_f32 v220, v220, v108
  v_mul_f32_e64 v221, v221, v109
  v_mfma_f32_16x16x32_bf16 v[84:87], v[88:91], v[76:79], v[84:87]
  v_mul_f32 v222, v222, v110
  v_mul_f32 v223, v223, v111
  v_mfma_f32_32x32x16_bf16 v[140:155], v[76:79], a[200:203], v[140:155]
  v_mul_f32 v224, v224, v112
  v_mul_f32 v225, v225, v113
  v_mul_f32 v226, v226, v114
  v_mul_f32 v227, v227, v115
  v_exp_f32 v220, v220
  s_waitcnt lgkmcnt(4)
  v_mfma_f32_32x32x16_bf16 v[124:139], v[80:83], a[76:79], v[124:139]
  ds_read_b64_tr_b16 v[76:77], v40 offset:57344
  ds_read_b64_tr_b16 v[78:79], v40 offset:57856
  v_exp_f32 v221, v221
  v_exp_f32 v222, v222
  v_mfma_f32_32x32x16_bf16 v[140:155], v[80:83], a[204:207], v[140:155]
  v_exp_f32 v223, v223
  v_exp_f32 v224, v224
  v_exp_f32 v225, v225
  s_waitcnt lgkmcnt(4)
  v_mfma_f32_32x32x16_bf16 v[124:139], v[68:71], a[80:83], v[124:139]
  ds_read_b64_tr_b16 v[80:81], v41 offset:57344
  ds_read_b64_tr_b16 v[82:83], v41 offset:57856
  v_exp_f32 v226, v226
  v_exp_f32 v227, v227
  v_fma_f32 v220, v220, v64, v64
  v_mfma_f32_16x16x32_bf16 v[84:87], v[88:91], v[68:71], v[84:87]
  v_fma_f32 v221, v221, v64, v64
  v_fma_f32 v222, v222, v64, v64
  v_mfma_f32_32x32x16_bf16 v[140:155], v[68:71], a[208:211], v[140:155]
  s_waitcnt vmcnt(24)
  s_barrier
  v_fma_f32 v223, v223, v64, v64
  v_fma_f32 v224, v224, v64, v64
  v_fma_f32 v225, v225, v64, v64
  v_fma_f32 v226, v226, v64, v64
  v_fma_f32 v227, v227, v64, v64
  s_waitcnt lgkmcnt(4)
  v_mfma_f32_32x32x16_bf16 v[124:139], v[72:75], a[84:87], v[124:139]
  ds_read_b64_tr_b16 v[68:69], v38 offset:16384
  ds_read_b64_tr_b16 v[70:71], v38 offset:16896
  s_add_u32 m0, s72, 98304
  s_add_u32 s73, s1, 4
  s_and_b32 s73, s73, 7
  s_mul_i32 s73, s73, 128
  s_add_u32 s73, s73, s78
  buffer_load_dwordx4 v5, s[32:35], s73 offen offset:0 lds
  buffer_load_dwordx4 v6, s[32:35], s73 offen offset:1024 lds
  buffer_load_dwordx4 v7, s[32:35], s73 offen offset:2048 lds
  buffer_load_dwordx4 v8, s[32:35], s73 offen offset:3072 lds
  v_mfma_f32_32x32x16_bf16 v[140:155], v[72:75], a[212:215], v[140:155]
  v_rcp_f32 v220, v220
  v_rcp_f32 v221, v221
  v_rcp_f32 v222, v222
  s_waitcnt lgkmcnt(4)
  v_mfma_f32_32x32x16_bf16 v[124:139], v[76:79], a[88:91], v[124:139]
  ds_read_b64_tr_b16 v[72:73], v39 offset:16384
  ds_read_b64_tr_b16 v[74:75], v39 offset:16896
  v_rcp_f32 v223, v223
  v_rcp_f32 v224, v224
  v_mfma_f32_16x16x32_bf16 v[84:87], v[88:91], v[76:79], v[84:87]
  v_rcp_f32_e64 v225, v225
  v_mfma_f32_32x32x16_bf16 v[140:155], v[76:79], a[216:219], v[140:155]
  v_rcp_f32 v226, v226
  v_rcp_f32 v227, v227
  v_mul_f32 v108, v108, v220
  v_mul_f32 v109, v109, v221
  v_mul_f32 v110, v110, v222
  s_waitcnt lgkmcnt(4)
  v_mfma_f32_32x32x16_bf16 v[124:139], v[80:83], a[92:95], v[124:139]
  ds_read_b64_tr_b16 v[76:77], v40 offset:16384
  ds_read_b64_tr_b16 v[78:79], v40 offset:16896
  v_mul_f32 v111, v111, v223
  v_mul_f32 v112, v112, v224
  v_mul_f32 v113, v113, v225
  v_mul_f32 v114, v114, v226
  v_mul_f32_e64 v115, v115, v227
  v_mfma_f32_32x32x16_bf16 v[140:155], v[80:83], a[220:223], v[140:155]
  v_cvt_pk_bf16_f32 v196, v108, v109
  v_cvt_pk_bf16_f32 v197, v110, v111
  v_cvt_pk_bf16_f32 v198, v112, v113
  v_cvt_pk_bf16_f32 v199, v114, v115
  buffer_store_dwordx4 v[196:199], v2, s[8:11], s101 offen offset:0 sc1
  v_fmac_f32 v116, v212, v62
  v_fmac_f32_e64 v117, v213, v62
  s_waitcnt lgkmcnt(4)
  v_mfma_f32_32x32x16_bf16 v[124:139], v[68:71], a[96:99], v[124:139]
  ds_read_b64_tr_b16 v[80:81], v41 offset:16384
  ds_read_b64_tr_b16 v[82:83], v41 offset:16896
  v_fmac_f32 v118, v214, v62
  v_fmac_f32 v119, v215, v62
  v_fmac_f32 v120, v216, v62
  v_fmac_f32 v121, v217, v62
  v_fmac_f32_e64 v122, v218, v62
  v_mfma_f32_16x16x32_bf16 v[84:87], v[88:91], v[68:71], v[84:87]
  v_fmac_f32 v123, v219, v62
  v_mul_f32 v228, v116, v116
  v_mfma_f32_32x32x16_bf16 v[140:155], v[68:71], a[224:227], v[140:155]
  v_mul_f32 v229, v117, v117
  v_mul_f32 v230, v118, v118
  v_mul_f32 v231, v119, v119
  v_mul_f32 v232, v120, v120
  v_mul_f32 v233, v121, v121
  v_mul_f32 v234, v122, v122
  v_mul_f32 v235, v123, v123
  s_waitcnt lgkmcnt(4)
  v_mfma_f32_32x32x16_bf16 v[124:139], v[72:75], a[100:103], v[124:139]
  ds_read_b64_tr_b16 v[68:69], v38 offset:24576
  ds_read_b64_tr_b16 v[70:71], v38 offset:25088
  v_fma_f32 v228, v228, v66, v65
  v_fma_f32 v229, v229, v66, v65
  v_fma_f32 v230, v230, v66, v65
  v_fma_f32 v231, v231, v66, v65
  v_fma_f32 v232, v232, v66, v65
  v_mfma_f32_32x32x16_bf16 v[140:155], v[72:75], a[228:231], v[140:155]
  v_fma_f32 v233, v233, v66, v65
  v_fma_f32 v234, v234, v66, v65
  v_fma_f32 v235, v235, v66, v65
  v_mul_f32 v228, v228, v116
  v_mul_f32 v229, v229, v117
  v_mul_f32 v230, v230, v118
  v_mul_f32_e64 v231, v231, v119
  s_waitcnt lgkmcnt(4)
  v_mfma_f32_32x32x16_bf16 v[124:139], v[76:79], a[104:107], v[124:139]
  ds_read_b64_tr_b16 v[72:73], v39 offset:24576
  ds_read_b64_tr_b16 v[74:75], v39 offset:25088
  v_mul_f32 v232, v232, v120
  v_mul_f32 v233, v233, v121
  v_mul_f32 v234, v234, v122
  v_mul_f32 v235, v235, v123
  v_mfma_f32_16x16x32_bf16 v[84:87], v[88:91], v[76:79], v[84:87]
  v_exp_f32_e64 v228, v228
  v_mfma_f32_32x32x16_bf16 v[140:155], v[76:79], a[232:235], v[140:155]
  v_exp_f32 v229, v229
  v_exp_f32 v230, v230
  v_exp_f32 v231, v231
  s_waitcnt lgkmcnt(4)
  v_mfma_f32_32x32x16_bf16 v[124:139], v[80:83], a[108:111], v[124:139]
  ds_read_b64_tr_b16 v[76:77], v40 offset:24576
  ds_read_b64_tr_b16 v[78:79], v40 offset:25088
  v_exp_f32 v232, v232
  v_exp_f32 v233, v233
  v_mfma_f32_32x32x16_bf16 v[140:155], v[80:83], a[236:239], v[140:155]
  v_exp_f32 v234, v234
  v_exp_f32 v235, v235
  v_fma_f32 v228, v228, v64, v64
  v_fma_f32 v229, v229, v64, v64
  v_fma_f32 v230, v230, v64, v64
  s_waitcnt lgkmcnt(4)
  v_mfma_f32_32x32x16_bf16 v[124:139], v[68:71], a[112:115], v[124:139]
  ds_read_b64_tr_b16 v[80:81], v41 offset:24576
  ds_read_b64_tr_b16 v[82:83], v41 offset:25088
  v_fma_f32 v231, v231, v64, v64
  v_fma_f32 v232, v232, v64, v64
  v_fma_f32 v233, v233, v64, v64
  v_fma_f32 v234, v234, v64, v64
  v_fma_f32 v235, v235, v64, v64
  v_mfma_f32_16x16x32_bf16 v[84:87], v[88:91], v[68:71], v[84:87]
  v_rcp_f32 v228, v228
  v_mfma_f32_32x32x16_bf16 v[140:155], v[68:71], a[240:243], v[140:155]
  v_rcp_f32 v229, v229
  v_rcp_f32 v230, v230
  v_rcp_f32 v231, v231
  s_waitcnt lgkmcnt(4)
  v_mfma_f32_32x32x16_bf16 v[124:139], v[72:75], a[116:119], v[124:139]
  v_rcp_f32 v232, v232
  v_rcp_f32 v233, v233
  v_rcp_f32 v234, v234
  s_waitcnt lgkmcnt(2)
  v_mfma_f32_16x16x32_bf16 v[84:87], v[88:91], v[76:79], v[84:87]
  v_rcp_f32_e64 v235, v235
  v_mfma_f32_32x32x16_bf16 v[140:155], v[72:75], a[244:247], v[140:155]
  v_mul_f32 v116, v116, v228
  v_mul_f32 v117, v117, v229
  v_mul_f32 v118, v118, v230
  v_mul_f32 v119, v119, v231
  v_mul_f32 v120, v120, v232
  v_mul_f32 v121, v121, v233
  v_mul_f32_e64 v122, v122, v234
  v_mfma_f32_32x32x16_bf16 v[124:139], v[76:79], a[120:123], v[124:139]
  v_mul_f32_e64 v123, v123, v235
  v_cvt_pk_bf16_f32 v200, v116, v117
  v_cvt_pk_bf16_f32 v201, v118, v119
  v_cvt_pk_bf16_f32 v202, v120, v121
  v_cvt_pk_bf16_f32 v203, v122, v123
  buffer_store_dwordx4 v[200:203], v2, s[8:11], s101 offen offset:1024 sc1
  v_mfma_f32_32x32x16_bf16 v[140:155], v[76:79], a[248:251], v[140:155]
  s_waitcnt lgkmcnt(0)
  v_mfma_f32_32x32x16_bf16 v[124:139], v[80:83], a[124:127], v[124:139]
  ds_write_b32 v49, v84 offset:512
  v_mfma_f32_32x32x16_bf16 v[140:155], v[80:83], a[252:255], v[140:155]
  s_waitcnt lgkmcnt(0)
  s_barrier
  s_add_u32 m0, s72, 114688
  s_add_u32 s73, s1, 5
  s_and_b32 s73, s73, 7
  s_mul_i32 s73, s73, 128
  s_add_u32 s73, s73, s79
  buffer_load_dwordx4 v5, s[32:35], s73 offen offset:0 lds
  buffer_load_dwordx4 v6, s[32:35], s73 offen offset:1024 lds
  buffer_load_dwordx4 v7, s[32:35], s73 offen offset:2048 lds
  buffer_load_dwordx4 v8, s[32:35], s73 offen offset:3072 lds
  s_waitcnt vmcnt(30)
  ds_read_b128 a[0:3], v26 offset:16384
  ds_read_b128 a[4:7], v27 offset:16384
  ds_read_b128 a[8:11], v28 offset:16384
  ds_read_b128 a[12:15], v29 offset:16384
  s_waitcnt vmcnt(26)
  ds_read_b128 a[128:131], v26 offset:49152
  ds_read_b128 a[132:135], v27 offset:49152
  ds_read_b128 a[136:139], v28 offset:49152
  ds_read_b128 a[140:143], v29 offset:49152
  s_waitcnt vmcnt(20)
  ds_read_b128 a[16:19], v26 offset:0
  ds_read_b128 a[20:23], v27 offset:0
  ds_read_b128 a[24:27], v28 offset:0
  ds_read_b128 a[28:31], v29 offset:0
  s_waitcnt vmcnt(16)
  ds_read_b128 a[144:147], v30 offset:0
  ds_read_b128 a[148:151], v31 offset:0
  ds_read_b128 a[152:155], v32 offset:0
  ds_read_b128 a[156:159], v33 offset:0
  s_waitcnt lgkmcnt(12)
  s_add_u32 m0, s72, 16384
  s_add_u32 s73, s1, 2
  s_and_b32 s73, s73, 7
  s_mul_i32 s73, s73, 128
  s_add_u32 s73, s73, s79
  buffer_load_dwordx4 v5, s[32:35], s73 offen offset:0 lds
  buffer_load_dwordx4 v6, s[32:35], s73 offen offset:1024 lds
  buffer_load_dwordx4 v7, s[32:35], s73 offen offset:2048 lds
  buffer_load_dwordx4 v8, s[32:35], s73 offen offset:3072 lds
  s_waitcnt lgkmcnt(8)
  s_add_u32 m0, s72, 49152
  s_add_u32 s73, s1, 2
  s_and_b32 s73, s73, 7
  s_mul_i32 s73, s73, 128
  s_add_u32 s73, s73, s78
  buffer_load_dwordx4 v5, s[32:35], s73 offen offset:0 lds
  buffer_load_dwordx4 v6, s[32:35], s73 offen offset:1024 lds
  buffer_load_dwordx4 v7, s[32:35], s73 offen offset:2048 lds
  buffer_load_dwordx4 v8, s[32:35], s73 offen offset:3072 lds
  s_waitcnt lgkmcnt(4)
  s_add_u32 m0, s72, 0
  s_add_u32 s73, s1, 3
  s_and_b32 s73, s73, 7
  s_mul_i32 s73, s73, 128
  s_add_u32 s73, s73, s79
  buffer_load_dwordx4 v5, s[32:35], s73 offen offset:0 lds
  buffer_load_dwordx4 v6, s[32:35], s73 offen offset:1024 lds
  buffer_load_dwordx4 v7, s[32:35], s73 offen offset:2048 lds
  buffer_load_dwordx4 v8, s[32:35], s73 offen offset:3072 lds
  s_waitcnt lgkmcnt(0)
  s_add_u32 m0, s72, 65536
  s_add_u32 s73, s1, 3
  s_and_b32 s73, s73, 7
  s_mul_i32 s73, s73, 128
  s_add_u32 s73, s73, s78
  buffer_load_dwordx4 v5, s[32:35], s73 offen offset:0 lds
  buffer_load_dwordx4 v6, s[32:35], s73 offen offset:1024 lds
  buffer_load_dwordx4 v7, s[32:35], s73 offen offset:2048 lds
  buffer_load_dwordx4 v8, s[32:35], s73 offen offset:3072 lds
  s_add_u32 m0, s72, 81920
  s_add_u32 s73, s1, 5
  s_and_b32 s73, s73, 7
  s_mul_i32 s73, s73, 128
  s_add_u32 s73, s73, s78
  buffer_load_dwordx4 v5, s[32:35], s73 offen offset:0 lds
  buffer_load_dwordx4 v6, s[32:35], s73 offen offset:1024 lds
  buffer_load_dwordx4 v7, s[32:35], s73 offen offset:2048 lds
  buffer_load_dwordx4 v8, s[32:35], s73 offen offset:3072 lds
  s_add_u32 s94, s94, 4096
  s_add_u32 s101, s101, 4096
  s_buffer_load_dword s71, s[40:43], 0
  ds_read_b128 v[204:207], v44 offset:512
  ds_read_b128 v[220:223], v44 offset:768
  ds_read_b128 v[208:211], v44 offset:544
  ds_read_b128 v[224:227], v44 offset:800
  ds_read_b128 v[212:215], v44 offset:576
  ds_read_b128 v[228:231], v44 offset:832
  ds_read_b128 v[216:219], v44 offset:608
  ds_read_b128 v[232:235], v44 offset:864
  s_waitcnt lgkmcnt(6)
  v_pk_add_f32 v[204:205], v[204:205], v[220:221] op_sel:[0,0] op_sel_hi:[1,1]
  v_pk_add_f32 v[206:207], v[206:207], v[222:223] op_sel:[0,0] op_sel_hi:[1,1]
  s_waitcnt lgkmcnt(4)
  v_pk_add_f32 v[208:209], v[208:209], v[224:225] op_sel:[0,0] op_sel_hi:[1,1]
  v_pk_add_f32 v[210:211], v[210:211], v[226:227] op_sel:[0,0] op_sel_hi:[1,1]
  s_waitcnt lgkmcnt(2)
  v_pk_add_f32 v[212:213], v[212:213], v[228:229] op_sel:[0,0] op_sel_hi:[1,1]
  v_pk_add_f32 v[214:215], v[214:215], v[230:231] op_sel:[0,0] op_sel_hi:[1,1]
  s_waitcnt lgkmcnt(0)
  v_pk_add_f32 v[216:217], v[216:217], v[232:233] op_sel:[0,0] op_sel_hi:[1,1]
  v_pk_add_f32 v[218:219], v[218:219], v[234:235] op_sel:[0,0] op_sel_hi:[1,1]
  v_pk_fma_f32 v[124:125], v[204:205], v[56:57], v[124:125] op_sel:[0,0,0] op_sel_hi:[1,0,1]
  v_pk_fma_f32 v[126:127], v[206:207], v[56:57], v[126:127] op_sel:[0,0,0] op_sel_hi:[1,0,1]
  v_pk_fma_f32 v[128:129], v[208:209], v[56:57], v[128:129] op_sel:[0,0,0] op_sel_hi:[1,0,1]
  v_pk_fma_f32 v[130:131], v[210:211], v[56:57], v[130:131] op_sel:[0,0,0] op_sel_hi:[1,0,1]
  v_pk_mul_f32 v[220:221], v[124:125], v[124:125] op_sel:[0,0] op_sel_hi:[1,1]
  v_pk_mul_f32 v[222:223], v[126:127], v[126:127] op_sel:[0,0] op_sel_hi:[1,1]
  v_pk_mul_f32 v[224:225], v[128:129], v[128:129] op_sel:[0,0] op_sel_hi:[1,1]
  v_pk_mul_f32 v[226:227], v[130:131], v[130:131] op_sel:[0,0] op_sel_hi:[1,1]
  v_pk_fma_f32 v[220:221], v[220:221], v[60:61], v[58:59] op_sel:[0,0,1] op_sel_hi:[1,0,1]
  v_pk_fma_f32 v[222:223], v[222:223], v[60:61], v[58:59] op_sel:[0,0,1] op_sel_hi:[1,0,1]
  v_pk_fma_f32 v[224:225], v[224:225], v[60:61], v[58:59] op_sel:[0,0,1] op_sel_hi:[1,0,1]
  v_pk_fma_f32 v[226:227], v[226:227], v[60:61], v[58:59] op_sel:[0,0,1] op_sel_hi:[1,0,1]
  v_pk_mul_f32 v[220:221], v[220:221], v[124:125] op_sel:[0,0] op_sel_hi:[1,1]
  v_pk_mul_f32 v[222:223], v[222:223], v[126:127] op_sel:[0,0] op_sel_hi:[1,1]
  v_pk_mul_f32 v[224:225], v[224:225], v[128:129] op_sel:[0,0] op_sel_hi:[1,1]
  v_pk_mul_f32 v[226:227], v[226:227], v[130:131] op_sel:[0,0] op_sel_hi:[1,1]
  v_exp_f32 v220, v220
  v_exp_f32 v221, v221
  v_exp_f32 v222, v222
  v_exp_f32 v223, v223
  v_exp_f32 v224, v224
  v_exp_f32 v225, v225
  v_exp_f32 v226, v226
  v_exp_f32 v227, v227
  v_pk_fma_f32 v[220:221], v[220:221], v[58:59], v[58:59] op_sel:[0,0,0] op_sel_hi:[1,0,0]
  v_pk_fma_f32 v[222:223], v[222:223], v[58:59], v[58:59] op_sel:[0,0,0] op_sel_hi:[1,0,0]
  v_pk_fma_f32 v[224:225], v[224:225], v[58:59], v[58:59] op_sel:[0,0,0] op_sel_hi:[1,0,0]
  v_pk_fma_f32 v[226:227], v[226:227], v[58:59], v[58:59] op_sel:[0,0,0] op_sel_hi:[1,0,0]
  v_rcp_f32 v220, v220
  v_rcp_f32 v221, v221
  v_rcp_f32 v222, v222
  v_rcp_f32 v223, v223
  v_rcp_f32 v224, v224
  v_rcp_f32 v225, v225
  v_rcp_f32 v226, v226
  v_rcp_f32 v227, v227
  v_pk_mul_f32 v[124:125], v[124:125], v[220:221] op_sel:[0,0] op_sel_hi:[1,1]
  v_pk_mul_f32 v[126:127], v[126:127], v[222:223] op_sel:[0,0] op_sel_hi:[1,1]
  v_pk_mul_f32 v[128:129], v[128:129], v[224:225] op_sel:[0,0] op_sel_hi:[1,1]
  v_pk_mul_f32 v[130:131], v[130:131], v[226:227] op_sel:[0,0] op_sel_hi:[1,1]
  v_cvt_pk_bf16_f32 v188, v124, v125
  v_cvt_pk_bf16_f32 v189, v126, v127
  v_cvt_pk_bf16_f32 v190, v128, v129
  v_cvt_pk_bf16_f32 v191, v130, v131
  buffer_store_dwordx4 v[188:191], v2, s[8:11], s94 offen offset:0 sc1
  v_pk_fma_f32 v[132:133], v[212:213], v[56:57], v[132:133] op_sel:[0,0,0] op_sel_hi:[1,0,1]
  v_pk_fma_f32 v[134:135], v[214:215], v[56:57], v[134:135] op_sel:[0,0,0] op_sel_hi:[1,0,1]
  v_pk_fma_f32 v[136:137], v[216:217], v[56:57], v[136:137] op_sel:[0,0,0] op_sel_hi:[1,0,1]
  v_pk_fma_f32 v[138:139], v[218:219], v[56:57], v[138:139] op_sel:[0,0,0] op_sel_hi:[1,0,1]
  v_pk_mul_f32 v[228:229], v[132:133], v[132:133] op_sel:[0,0] op_sel_hi:[1,1]
  v_pk_mul_f32 v[230:231], v[134:135], v[134:135] op_sel:[0,0] op_sel_hi:[1,1]
  v_pk_mul_f32 v[232:233], v[136:137], v[136:137] op_sel:[0,0] op_sel_hi:[1,1]
  v_pk_mul_f32 v[234:235], v[138:139], v[138:139] op_sel:[0,0] op_sel_hi:[1,1]
  v_pk_fma_f32 v[228:229], v[228:229], v[60:61], v[58:59] op_sel:[0,0,1] op_sel_hi:[1,0,1]
  v_pk_fma_f32 v[230:231], v[230:231], v[60:61], v[58:59] op_sel:[0,0,1] op_sel_hi:[1,0,1]
  v_pk_fma_f32 v[232:233], v[232:233], v[60:61], v[58:59] op_sel:[0,0,1] op_sel_hi:[1,0,1]
  v_pk_fma_f32 v[234:235], v[234:235], v[60:61], v[58:59] op_sel:[0,0,1] op_sel_hi:[1,0,1]
  v_pk_mul_f32 v[228:229], v[228:229], v[132:133] op_sel:[0,0] op_sel_hi:[1,1]
  v_pk_mul_f32 v[230:231], v[230:231], v[134:135] op_sel:[0,0] op_sel_hi:[1,1]
  v_pk_mul_f32 v[232:233], v[232:233], v[136:137] op_sel:[0,0] op_sel_hi:[1,1]
  v_pk_mul_f32 v[234:235], v[234:235], v[138:139] op_sel:[0,0] op_sel_hi:[1,1]
  v_exp_f32 v228, v228
  v_exp_f32 v229, v229
  v_exp_f32 v230, v230
  v_exp_f32 v231, v231
  v_exp_f32 v232, v232
  v_exp_f32 v233, v233
  v_exp_f32 v234, v234
  v_exp_f32 v235, v235
  v_pk_fma_f32 v[228:229], v[228:229], v[58:59], v[58:59] op_sel:[0,0,0] op_sel_hi:[1,0,0]
  v_pk_fma_f32 v[230:231], v[230:231], v[58:59], v[58:59] op_sel:[0,0,0] op_sel_hi:[1,0,0]
  v_pk_fma_f32 v[232:233], v[232:233], v[58:59], v[58:59] op_sel:[0,0,0] op_sel_hi:[1,0,0]
  v_pk_fma_f32 v[234:235], v[234:235], v[58:59], v[58:59] op_sel:[0,0,0] op_sel_hi:[1,0,0]
  v_rcp_f32 v228, v228
  v_rcp_f32 v229, v229
  v_rcp_f32 v230, v230
  v_rcp_f32 v231, v231
  v_rcp_f32 v232, v232
  v_rcp_f32 v233, v233
  v_rcp_f32 v234, v234
  v_rcp_f32 v235, v235
  v_pk_mul_f32 v[132:133], v[132:133], v[228:229] op_sel:[0,0] op_sel_hi:[1,1]
  v_pk_mul_f32 v[134:135], v[134:135], v[230:231] op_sel:[0,0] op_sel_hi:[1,1]
  v_pk_mul_f32 v[136:137], v[136:137], v[232:233] op_sel:[0,0] op_sel_hi:[1,1]
  v_pk_mul_f32 v[138:139], v[138:139], v[234:235] op_sel:[0,0] op_sel_hi:[1,1]
  v_cvt_pk_bf16_f32 v192, v132, v133
  v_cvt_pk_bf16_f32 v193, v134, v135
  v_cvt_pk_bf16_f32 v194, v136, v137
  v_cvt_pk_bf16_f32 v195, v138, v139
  buffer_store_dwordx4 v[192:195], v2, s[8:11], s94 offen offset:1024 sc1
  v_pk_fma_f32 v[140:141], v[204:205], v[62:63], v[140:141] op_sel:[0,0,0] op_sel_hi:[1,0,1]
  v_pk_fma_f32 v[142:143], v[206:207], v[62:63], v[142:143] op_sel:[0,0,0] op_sel_hi:[1,0,1]
  v_pk_fma_f32 v[144:145], v[208:209], v[62:63], v[144:145] op_sel:[0,0,0] op_sel_hi:[1,0,1]
  v_pk_fma_f32 v[146:147], v[210:211], v[62:63], v[146:147] op_sel:[0,0,0] op_sel_hi:[1,0,1]
  v_pk_mul_f32 v[220:221], v[140:141], v[140:141] op_sel:[0,0] op_sel_hi:[1,1]
  v_pk_mul_f32 v[222:223], v[142:143], v[142:143] op_sel:[0,0] op_sel_hi:[1,1]
  v_pk_mul_f32 v[224:225], v[144:145], v[144:145] op_sel:[0,0] op_sel_hi:[1,1]
  v_pk_mul_f32 v[226:227], v[146:147], v[146:147] op_sel:[0,0] op_sel_hi:[1,1]
  v_pk_fma_f32 v[220:221], v[220:221], v[66:67], v[64:65] op_sel:[0,0,1] op_sel_hi:[1,0,1]
  v_pk_fma_f32 v[222:223], v[222:223], v[66:67], v[64:65] op_sel:[0,0,1] op_sel_hi:[1,0,1]
  v_pk_fma_f32 v[224:225], v[224:225], v[66:67], v[64:65] op_sel:[0,0,1] op_sel_hi:[1,0,1]
  v_pk_fma_f32 v[226:227], v[226:227], v[66:67], v[64:65] op_sel:[0,0,1] op_sel_hi:[1,0,1]
  v_pk_mul_f32 v[220:221], v[220:221], v[140:141] op_sel:[0,0] op_sel_hi:[1,1]
  v_pk_mul_f32 v[222:223], v[222:223], v[142:143] op_sel:[0,0] op_sel_hi:[1,1]
  v_pk_mul_f32 v[224:225], v[224:225], v[144:145] op_sel:[0,0] op_sel_hi:[1,1]
  v_pk_mul_f32 v[226:227], v[226:227], v[146:147] op_sel:[0,0] op_sel_hi:[1,1]
  v_exp_f32 v220, v220
  v_exp_f32 v221, v221
  v_exp_f32 v222, v222
  v_exp_f32 v223, v223
  v_exp_f32 v224, v224
  v_exp_f32 v225, v225
  v_exp_f32 v226, v226
  v_exp_f32 v227, v227
  v_pk_fma_f32 v[220:221], v[220:221], v[64:65], v[64:65] op_sel:[0,0,0] op_sel_hi:[1,0,0]
  v_pk_fma_f32 v[222:223], v[222:223], v[64:65], v[64:65] op_sel:[0,0,0] op_sel_hi:[1,0,0]
  v_pk_fma_f32 v[224:225], v[224:225], v[64:65], v[64:65] op_sel:[0,0,0] op_sel_hi:[1,0,0]
  v_pk_fma_f32 v[226:227], v[226:227], v[64:65], v[64:65] op_sel:[0,0,0] op_sel_hi:[1,0,0]
  v_rcp_f32 v220, v220
  v_rcp_f32 v221, v221
  v_rcp_f32 v222, v222
  v_rcp_f32 v223, v223
  v_rcp_f32 v224, v224
  v_rcp_f32 v225, v225
  v_rcp_f32 v226, v226
  v_rcp_f32 v227, v227
  v_pk_mul_f32 v[140:141], v[140:141], v[220:221] op_sel:[0,0] op_sel_hi:[1,1]
  v_pk_mul_f32 v[142:143], v[142:143], v[222:223] op_sel:[0,0] op_sel_hi:[1,1]
  v_pk_mul_f32 v[144:145], v[144:145], v[224:225] op_sel:[0,0] op_sel_hi:[1,1]
  v_pk_mul_f32 v[146:147], v[146:147], v[226:227] op_sel:[0,0] op_sel_hi:[1,1]
  v_cvt_pk_bf16_f32 v196, v140, v141
  v_cvt_pk_bf16_f32 v197, v142, v143
  v_cvt_pk_bf16_f32 v198, v144, v145
  v_cvt_pk_bf16_f32 v199, v146, v147
  buffer_store_dwordx4 v[196:199], v2, s[8:11], s101 offen offset:0 sc1
  v_pk_fma_f32 v[148:149], v[212:213], v[62:63], v[148:149] op_sel:[0,0,0] op_sel_hi:[1,0,1]
  v_pk_fma_f32 v[150:151], v[214:215], v[62:63], v[150:151] op_sel:[0,0,0] op_sel_hi:[1,0,1]
  v_pk_fma_f32 v[152:153], v[216:217], v[62:63], v[152:153] op_sel:[0,0,0] op_sel_hi:[1,0,1]
  v_pk_fma_f32 v[154:155], v[218:219], v[62:63], v[154:155] op_sel:[0,0,0] op_sel_hi:[1,0,1]
  v_pk_mul_f32 v[228:229], v[148:149], v[148:149] op_sel:[0,0] op_sel_hi:[1,1]
  v_pk_mul_f32 v[230:231], v[150:151], v[150:151] op_sel:[0,0] op_sel_hi:[1,1]
  v_pk_mul_f32 v[232:233], v[152:153], v[152:153] op_sel:[0,0] op_sel_hi:[1,1]
  v_pk_mul_f32 v[234:235], v[154:155], v[154:155] op_sel:[0,0] op_sel_hi:[1,1]
  v_pk_fma_f32 v[228:229], v[228:229], v[66:67], v[64:65] op_sel:[0,0,1] op_sel_hi:[1,0,1]
  v_pk_fma_f32 v[230:231], v[230:231], v[66:67], v[64:65] op_sel:[0,0,1] op_sel_hi:[1,0,1]
  v_pk_fma_f32 v[232:233], v[232:233], v[66:67], v[64:65] op_sel:[0,0,1] op_sel_hi:[1,0,1]
  v_pk_fma_f32 v[234:235], v[234:235], v[66:67], v[64:65] op_sel:[0,0,1] op_sel_hi:[1,0,1]
  v_pk_mul_f32 v[228:229], v[228:229], v[148:149] op_sel:[0,0] op_sel_hi:[1,1]
  v_pk_mul_f32 v[230:231], v[230:231], v[150:151] op_sel:[0,0] op_sel_hi:[1,1]
  v_pk_mul_f32 v[232:233], v[232:233], v[152:153] op_sel:[0,0] op_sel_hi:[1,1]
  v_pk_mul_f32 v[234:235], v[234:235], v[154:155] op_sel:[0,0] op_sel_hi:[1,1]
  v_exp_f32 v228, v228
  v_exp_f32 v229, v229
  v_exp_f32 v230, v230
  v_exp_f32 v231, v231
  v_exp_f32 v232, v232
  v_exp_f32 v233, v233
  v_exp_f32 v234, v234
  v_exp_f32 v235, v235
  v_pk_fma_f32 v[228:229], v[228:229], v[64:65], v[64:65] op_sel:[0,0,0] op_sel_hi:[1,0,0]
  v_pk_fma_f32 v[230:231], v[230:231], v[64:65], v[64:65] op_sel:[0,0,0] op_sel_hi:[1,0,0]
  v_pk_fma_f32 v[232:233], v[232:233], v[64:65], v[64:65] op_sel:[0,0,0] op_sel_hi:[1,0,0]
  v_pk_fma_f32 v[234:235], v[234:235], v[64:65], v[64:65] op_sel:[0,0,0] op_sel_hi:[1,0,0]
  v_rcp_f32 v228, v228
  v_rcp_f32 v229, v229
  v_rcp_f32 v230, v230
  v_rcp_f32 v231, v231
  v_rcp_f32 v232, v232
  v_rcp_f32 v233, v233
  v_rcp_f32 v234, v234
  v_rcp_f32 v235, v235
  v_pk_mul_f32 v[148:149], v[148:149], v[228:229] op_sel:[0,0] op_sel_hi:[1,1]
  v_pk_mul_f32 v[150:151], v[150:151], v[230:231] op_sel:[0,0] op_sel_hi:[1,1]
  v_pk_mul_f32 v[152:153], v[152:153], v[232:233] op_sel:[0,0] op_sel_hi:[1,1]
  v_pk_mul_f32 v[154:155], v[154:155], v[234:235] op_sel:[0,0] op_sel_hi:[1,1]
  v_cvt_pk_bf16_f32 v200, v148, v149
  v_cvt_pk_bf16_f32 v201, v150, v151
  v_cvt_pk_bf16_f32 v202, v152, v153
  v_cvt_pk_bf16_f32 v203, v154, v155
  buffer_store_dwordx4 v[200:203], v2, s[8:11], s101 offen offset:1024 sc1
  s_cmp_eq_u32 s71, 0
  s_cbranch_scc1 SLOW_TGD
RET_TGD:
  s_mov_b32 s70, s71
  s_barrier
  s_waitcnt vmcnt(20)
  ds_read_b128 a[32:35], v26 offset:16384
  ds_read_b128 a[36:39], v27 offset:16384
  ds_read_b128 a[40:43], v28 offset:16384
  ds_read_b128 a[44:47], v29 offset:16384
  s_waitcnt vmcnt(16)
  ds_read_b128 a[160:163], v26 offset:49152
  ds_read_b128 a[164:167], v27 offset:49152
  ds_read_b128 a[168:171], v28 offset:49152
  ds_read_b128 a[172:175], v29 offset:49152
  s_waitcnt vmcnt(12)
  ds_read_b128 a[48:51], v26 offset:0
  ds_read_b128 a[52:55], v27 offset:0
  ds_read_b128 a[56:59], v28 offset:0
  ds_read_b128 a[60:63], v29 offset:0
  s_waitcnt vmcnt(8)
  ds_read_b128 a[176:179], v30 offset:0
  ds_read_b128 a[180:183], v31 offset:0
  ds_read_b128 a[184:187], v32 offset:0
  ds_read_b128 a[188:191], v33 offset:0
  s_waitcnt lgkmcnt(12)
  s_add_u32 m0, s72, 16384
  s_add_u32 s73, s1, 6
  s_and_b32 s73, s73, 7
  s_mul_i32 s73, s73, 128
  s_add_u32 s73, s73, s79
  buffer_load_dwordx4 v5, s[32:35], s73 offen offset:0 lds
  buffer_load_dwordx4 v6, s[32:35], s73 offen offset:1024 lds
  buffer_load_dwordx4 v7, s[32:35], s73 offen offset:2048 lds
  buffer_load_dwordx4 v8, s[32:35], s73 offen offset:3072 lds
  s_waitcnt lgkmcnt(8)
  s_add_u32 m0, s72, 49152
  s_add_u32 s73, s1, 6
  s_and_b32 s73, s73, 7
  s_mul_i32 s73, s73, 128
  s_add_u32 s73, s73, s78
  buffer_load_dwordx4 v5, s[32:35], s73 offen offset:0 lds
  buffer_load_dwordx4 v6, s[32:35], s73 offen offset:1024 lds
  buffer_load_dwordx4 v7, s[32:35], s73 offen offset:2048 lds
  buffer_load_dwordx4 v8, s[32:35], s73 offen offset:3072 lds
  s_waitcnt lgkmcnt(4)
  s_add_u32 m0, s72, 0
  s_add_u32 s73, s1, 7
  s_and_b32 s73, s73, 7
  s_mul_i32 s73, s73, 128
  s_add_u32 s73, s73, s79
  buffer_load_dwordx4 v5, s[32:35], s73 offen offset:0 lds
  buffer_load_dwordx4 v6, s[32:35], s73 offen offset:1024 lds
  buffer_load_dwordx4 v7, s[32:35], s73 offen offset:2048 lds
  buffer_load_dwordx4 v8, s[32:35], s73 offen offset:3072 lds
  s_waitcnt lgkmcnt(0)
  s_add_u32 m0, s72, 65536
  s_add_u32 s73, s1, 7
  s_and_b32 s73, s73, 7
  s_mul_i32 s73, s73, 128
  s_add_u32 s73, s73, s78
  buffer_load_dwordx4 v5, s[32:35], s73 offen offset:0 lds
  buffer_load_dwordx4 v6, s[32:35], s73 offen offset:1024 lds
  buffer_load_dwordx4 v7, s[32:35], s73 offen offset:2048 lds
  buffer_load_dwordx4 v8, s[32:35], s73 offen offset:3072 lds
  s_mul_i32 s91, s83, 3
  s_add_u32 s91, s91, 1
  s_cmp_eq_u32 s83, 7
  s_cselect_b32 s91, 0, s91
  s_cselect_b32 s75, 0, 128
  s_lshl_b32 s74, s91, 7
  s_lshl_b32 s73, s44, 5
  s_add_u32 s74, s74, s73
  s_add_u32 s40, s74, 4224
  s_add_u32 s41, s40, s75
  s_add_u32 s42, s41, s75
  s_buffer_load_dwordx8 s[48:55], s[8:11], s40
  s_buffer_load_dwordx8 s[56:63], s[8:11], s41
  s_buffer_load_dwordx8 s[24:31], s[8:11], s42
  s_waitcnt lgkmcnt(0)
  s_cmp_eq_u32 s83, 7
  s_cbranch_scc1 LIGHT
  s_branch PHASE2
PROG_C:
  s_add_u32 s81, s80, 128
  s_add_u32 s82, s80, 256
  s_lshr_b32 s95, s44, 1
  s_and_b32 s96, s44, 1
  v_and_b32 v212, 31, v1
  v_lshrrev_b32 v213, 5, v1
  v_bfe_u32 v214, v1, 1, 3
  v_xor_b32 v214, v214, v213
  v_lshlrev_b32 v214, 4, v214
  v_lshl_add_u32 v214, v212, 7, v214
  s_mul_i32 s74, s95, 8224
  s_lshl_b32 s75, s96, 6
  s_add_u32 s74, s74, s75
  v_xor_b32 v18, s74, v214
  v_xor_b32 v19, 32, v18
  v_xor_b32_e64 v20, 64, v18
  v_xor_b32 v21, 96, v18
  v_mov_b32 v50, 0x3f803f80
  v_mov_b32 v52, 0
  v_mov_b32 v53, 0
  v_mov_b32 v54, 0
  v_mov_b32 v55, 0
  v_lshlrev_b32_e64 v2, 4, v1
  s_add_u32 m0, s72, 49152
  s_add_u32 s73, s0, 1
  s_and_b32 s73, s73, 3
  s_mul_i32 s73, s73, 256
  s_add_u32 s73, s73, s77
  buffer_load_dwordx4 v5, s[4:7], s73 offen offset:0 lds
  buffer_load_dwordx4 v6, s[4:7], s73 offen offset:1024 lds
  buffer_load_dwordx4 v7, s[4:7], s73 offen offset:2048 lds
  buffer_load_dwordx4 v8, s[4:7], s73 offen offset:3072 lds
  v_add_u32 v26, s72, v214
  v_xor_b32 v27, 32, v26
  v_xor_b32 v28, 64, v26
  v_xor_b32 v29, 96, v26
  v_add_u32 v30, 0x10000, v26
  v_add_u32 v22, 0x10000, v18
  v_add_u32 v31, 0x10000, v27
  v_add_u32 v23, 0x10000, v19
  v_add_u32 v32, 0x10000, v28
  v_add_u32 v24, 0x10000, v20
  v_add_u32 v33, 0x10000, v29
  v_add_u32 v25, 0x10000, v21
  s_mov_b32 s32, s58
  s_mov_b32 s33, s59
  s_mov_b32 s34, 8388608
  s_mov_b32 s35, 0x20000
  s_mov_b32 s12, s52
  s_mov_b32 s13, s53
  s_mov_b32 s14, 524288
  s_mov_b32 s15, 0x20000
  s_add_u32 m0, s72, 65536
  s_add_u32 s73, s0, 1
  s_and_b32 s73, s73, 3
  s_mul_i32 s73, s73, 256
  s_add_u32 s73, s73, s77
  s_add_u32 s73, s73, 128
  buffer_load_dwordx4 v5, s[4:7], s73 offen offset:0 lds
  buffer_load_dwordx4 v6, s[4:7], s73 offen offset:1024 lds
  buffer_load_dwordx4 v7, s[4:7], s73 offen offset:2048 lds
  buffer_load_dwordx4 v8, s[4:7], s73 offen offset:3072 lds
  s_mov_b32 s16, s62
  s_mov_b32 s17, s63
  s_mov_b32 s18, 704512
  s_mov_b32 s19, 0x20000
  s_mov_b32 s20, s64
  s_mov_b32 s21, s65
  s_mov_b32 s22, 2097152
  s_mov_b32 s23, 0x20000
  s_mov_b32 s36, s60
  s_mov_b32 s37, s61
  s_mov_b32 s38, 4096
  s_mov_b32 s39, 0x20000
  s_mov_b32 s40, s66
  s_mov_b32 s41, s67
  s_mov_b32 s42, 256
  s_mov_b32 s43, 0x20000
  s_lshl_b32 s74, s47, 1
  s_add_u32 s74, s74, s95
  s_lshl_b32 s79, s74, 17
  s_lshl_b32 s74, s44, 10
  s_add_u32 m0, s72, 81920
  s_add_u32 s73, s0, 1
  s_and_b32 s73, s73, 3
  s_mul_i32 s73, s73, 352256
  s_add_u32 s73, s73, s80
  buffer_load_dwordx4 v14, s[28:31], s73 offen offset:0 lds
  buffer_load_dwordx4 v15, s[28:31], s73 offen offset:1024 lds
  buffer_load_dwordx4 v16, s[28:31], s73 offen offset:2048 lds
  buffer_load_dwordx4 v17, s[28:31], s73 offen offset:3072 lds
  s_add_u32 s79, s79, s74
  s_xor_b32 s78, s79, 0x20000
  v_bfe_u32 v215, v1, 2, 2
  v_and_b32 v216, 3, v1
  v_bfe_u32 v217, v1, 4, 1
  v_lshlrev_b32_e64 v216, 3, v216
  v_lshl_add_u32 v216, v217, 5, v216
  v_lshl_add_u32 v218, v213, 3, v215
  v_lshl_add_u32 v219, v218, 7, v216
  v_bfe_u32 v220, v1, 3, 1
  v_lshl_add_u32 v219, v220, 6, v219
  s_mul_i32 s74, s96, 4160
  s_lshl_b32 s75, s95, 11
  s_or_b32 s74, s74, s75
  v_xor_b32_e64 v34, s74, v219
  v_xor_b32 v35, 2048, v34
  v_xor_b32 v36, 4096, v34
  v_xor_b32 v37, 6144, v34
  v_add_u32 v38, 0x10000, v34
  v_add_u32 v39, 0x10000, v35
  v_add_u32 v40, 0x10000, v36
  v_add_u32 v41, 0x10000, v37
  s_lshl_b32 s74, s96, 7
  s_add_u32 s74, s74, 131072
  v_lshl_add_u32 v44, v213, 4, s74
  v_lshl_add_u32 v45, v212, 2, s74
  s_lshl_b32 s75, s95, 8
  v_lshl_add_u32 v49, v213, 14, v45
  v_add_u32 v49, s75, v49
  s_lshl_b32 s74, s95, 9
  s_add_u32 s75, s74, 133120
  s_mov_b32 s91, s75
  v_lshl_add_u32 v42, v213, 4, s75
  v_lshl_add_u32 v43, v212, 2, s75
  s_lshl_b32 s75, s44, 9
  s_add_u32 s75, s75, 135168
  v_lshl_add_u32 v48, v1, 2, s75
  s_mul_i32 s74, s44, 2304
  s_add_u32 s74, s74, 137216
  v_mul_u32_u24 v13, 72, v212
  v_lshl_add_u32 v13, v213, 3, v13
  v_add_u32_e64 v13, s74, v13
  v_mul_u32_u24 v46, 72, v218
  v_add3_u32 v46, v46, v216, s74
  v_and_b32 v221, 15, v1
  v_lshlrev_b32 v222, 2, v217
  v_cmp_eq_u32 vcc, v221, v222
  s_nop 1
  v_cndmask_b32 v88, 0, v50, vcc
  v_mov_b32 v89, v88
  v_mov_b32 v90, v88
  v_mov_b32 v91, v88
  s_mov_b32 s84, 0x358637bd
  s_mov_b32 s85, 0x358637bd
  s_mov_b32 s86, 0x3fb8aa3b
  s_mov_b32 s87, 0x3fb8aa3b
  s_or_b32 s99, s2, s44
  s_waitcnt vmcnt(18)
  s_barrier
  ds_read_b128 v[156:159], v18 offset:0
  ds_read_b128 v[160:163], v19 offset:0
  ds_read_b128 v[164:167], v18 offset:4096
  ds_read_b128 v[168:171], v19 offset:4096
  ds_read_b128 v[172:175], v18 offset:16384
  ds_read_b128 v[176:179], v19 offset:16384
  ds_read_b128 v[180:183], v18 offset:20480
  ds_read_b128 v[184:187], v19 offset:20480
  ds_read_b128 a[8:11], v20 offset:0
  ds_read_b128 a[12:15], v21 offset:0
  ds_read_b128 a[136:139], v20 offset:4096
  ds_read_b128 a[140:143], v21 offset:4096
  ds_read_b128 a[24:27], v20 offset:16384
  ds_read_b128 a[28:31], v21 offset:16384
  ds_read_b128 a[152:155], v20 offset:20480
  ds_read_b128 a[156:159], v21 offset:20480
  s_add_u32 m0, s72, 98304
  s_add_u32 s73, s0, 2
  s_and_b32 s73, s73, 3
  s_mul_i32 s73, s73, 256
  s_add_u32 s73, s73, s77
  buffer_load_dwordx4 v5, s[4:7], s73 offen offset:0 lds
  buffer_load_dwordx4 v6, s[4:7], s73 offen offset:1024 lds
  buffer_load_dwordx4 v7, s[4:7], s73 offen offset:2048 lds
  buffer_load_dwordx4 v8, s[4:7], s73 offen offset:3072 lds
  s_add_u32 m0, s72, 114688
  s_add_u32 s73, s0, 2
  s_and_b32 s73, s73, 3
  s_mul_i32 s73, s73, 256
  s_add_u32 s73, s73, s77
  s_add_u32 s73, s73, 128
  buffer_load_dwordx4 v5, s[4:7], s73 offen offset:0 lds
  buffer_load_dwordx4 v6, s[4:7], s73 offen offset:1024 lds
  buffer_load_dwordx4 v7, s[4:7], s73 offen offset:2048 lds
  buffer_load_dwordx4 v8, s[4:7], s73 offen offset:3072 lds
  s_waitcnt lgkmcnt(15)
  v_accvgpr_write_b32 a0, v156
  v_accvgpr_write_b32 a1, v157
  v_accvgpr_write_b32 a2, v158
  v_accvgpr_write_b32 a3, v159
  s_waitcnt lgkmcnt(14)
  v_accvgpr_write_b32 a4, v160
  v_accvgpr_write_b32 a5, v161
  v_accvgpr_write_b32 a6, v162
  v_accvgpr_write_b32 a7, v163
  s_waitcnt lgkmcnt(13)
  v_accvgpr_write_b32 a128, v164
  v_accvgpr_write_b32 a129, v165
  v_accvgpr_write_b32 a130, v166
  v_accvgpr_write_b32 a131, v167
  s_waitcnt lgkmcnt(12)
  v_accvgpr_write_b32 a132, v168
  v_accvgpr_write_b32 a133, v169
  v_accvgpr_write_b32 a134, v170
  v_accvgpr_write_b32 a135, v171
  s_waitcnt lgkmcnt(11)
  v_accvgpr_write_b32 a16, v172
  v_accvgpr_write_b32 a17, v173
  v_accvgpr_write_b32 a18, v174
  v_accvgpr_write_b32 a19, v175
  s_waitcnt lgkmcnt(10)
  v_accvgpr_write_b32 a20, v176
  v_accvgpr_write_b32 a21, v177
  v_accvgpr_write_b32 a22, v178
  v_accvgpr_write_b32 a23, v179
  s_waitcnt lgkmcnt(9)
  v_accvgpr_write_b32 a144, v180
  v_accvgpr_write_b32 a145, v181
  v_accvgpr_write_b32 a146, v182
  v_accvgpr_write_b32 a147, v183
  s_waitcnt lgkmcnt(8)
  v_accvgpr_write_b32 a148, v184
  v_accvgpr_write_b32 a149, v185
  v_accvgpr_write_b32 a150, v186
  v_accvgpr_write_b32 a151, v187
  s_waitcnt vmcnt(12) lgkmcnt(0)
  s_barrier
  s_cmp_eq_u32 s99, 0
  s_cbranch_scc1 EPOCH_C
EPOCHR_C:
  ds_read_b64_tr_b16 v[68:69], v34 offset:32768
  ds_read_b64_tr_b16 v[70:71], v34 offset:33280
  ds_read_b64_tr_b16 v[72:73], v35 offset:32768
  ds_read_b64_tr_b16 v[74:75], v35 offset:33280
  ds_read_b64_tr_b16 v[76:77], v36 offset:32768
  ds_read_b64_tr_b16 v[78:79], v36 offset:33280
  s_add_u32 m0, s72, 0
  s_add_u32 s73, s0, 2
  s_and_b32 s73, s73, 3
  s_mul_i32 s73, s73, 352256
  s_add_u32 s73, s73, s80
  buffer_load_dwordx4 v14, s[28:31], s73 offen offset:0 lds
  buffer_load_dwordx4 v15, s[28:31], s73 offen offset:1024 lds
  buffer_load_dwordx4 v16, s[28:31], s73 offen offset:2048 lds
  buffer_load_dwordx4 v17, s[28:31], s73 offen offset:3072 lds
  s_add_u32 m0, s72, 16384
  s_add_u32 s73, s0, 3
  s_and_b32 s73, s73, 3
  s_mul_i32 s73, s73, 256
  s_add_u32 s73, s73, s77
  buffer_load_dwordx4 v5, s[4:7], s73 offen offset:0 lds
  buffer_load_dwordx4 v6, s[4:7], s73 offen offset:1024 lds
  buffer_load_dwordx4 v7, s[4:7], s73 offen offset:2048 lds
  buffer_load_dwordx4 v8, s[4:7], s73 offen offset:3072 lds
  s_waitcnt lgkmcnt(4)
  v_mfma_f32_32x32x16_bf16 v[92:107], v[68:71], a[0:3], 0
  ds_read_b64_tr_b16 v[80:81], v37 offset:32768
  ds_read_b64_tr_b16 v[82:83], v37 offset:33280
  v_mfma_f32_16x16x32_bf16 v[84:87], v[88:91], v[68:71], 0
  ds_read_b128 v[204:207], v18 offset:49152
  ds_read_b128 v[208:211], v19 offset:49152
  ds_read_b128 v[212:215], v18 offset:53248
  v_mfma_f32_32x32x16_bf16 v[108:123], v[68:71], a[128:131], 0
  ds_read_b128 v[216:219], v19 offset:53248
  ds_read_b128 v[220:223], v22 offset:0
  ds_read_b128 v[224:227], v23 offset:0
  s_waitcnt lgkmcnt(10)
  v_mfma_f32_32x32x16_bf16 v[92:107], v[72:75], a[4:7], v[92:107]
  ds_read_b64_tr_b16 v[68:69], v34 offset:40960
  ds_read_b64_tr_b16 v[70:71], v34 offset:41472
  ds_read_b128 v[228:231], v22 offset:4096
  ds_read_b128 v[232:235], v23 offset:4096
  v_mfma_f32_32x32x16_bf16 v[108:123], v[72:75], a[132:135], v[108:123]
  ds_read_b128 a[40:43], v20 offset:49152
  ds_read_b128 a[44:47], v21 offset:49152
  ds_read_b128 a[168:171], v20 offset:53248
  s_waitcnt lgkmcnt(15)
  v_mfma_f32_32x32x16_bf16 v[92:107], v[76:79], a[8:11], v[92:107]
  ds_read_b64_tr_b16 v[72:73], v35 offset:40960
  ds_read_b64_tr_b16 v[74:75], v35 offset:41472
  v_mfma_f32_16x16x32_bf16 v[84:87], v[88:91], v[76:79], v[84:87]
  ds_read_b128 a[172:175], v21 offset:53248
  ds_read_b128 a[56:59], v24 offset:0
  ds_read_b128 a[60:63], v25 offset:0
  v_mfma_f32_32x32x16_bf16 v[108:123], v[76:79], a[136:139], v[108:123]
  ds_read_b128 a[184:187], v24 offset:4096
  ds_read_b128 a[188:191], v25 offset:4096
  s_waitcnt lgkmcnt(15)
  v_mfma_f32_32x32x16_bf16 v[92:107], v[80:83], a[12:15], v[92:107]
  ds_read_b64_tr_b16 v[76:77], v36 offset:40960
  ds_read_b64_tr_b16 v[78:79], v36 offset:41472
  v_accvgpr_write_b32 a32, v204
  v_accvgpr_write_b32 a33, v205
  v_accvgpr_write_b32 a34, v206
  v_accvgpr_write_b32 a35, v207
  v_accvgpr_write_b32 a36, v208
  v_accvgpr_write_b32 a37, v209
  v_accvgpr_write_b32 a38, v210
  v_accvgpr_write_b32 a39, v211
  v_mfma_f32_32x32x16_bf16 v[108:123], v[80:83], a[140:143], v[108:123]
  v_accvgpr_write_b32 a160, v212
  v_accvgpr_write_b32 a161, v213
  v_accvgpr_write_b32 a162, v214
  v_accvgpr_write_b32 a163, v215
  v_accvgpr_write_b32 a164, v216
  v_accvgpr_write_b32 a165, v217
  v_accvgpr_write_b32 a166, v218
  v_accvgpr_write_b32 a167, v219
  s_waitcnt lgkmcnt(14)
  v_mfma_f32_32x32x16_bf16 v[92:107], v[68:71], a[16:19], v[92:107]
  ds_read_b64_tr_b16 v[80:81], v37 offset:40960
  ds_read_b64_tr_b16 v[82:83], v37 offset:41472
  v_mfma_f32_16x16x32_bf16 v[84:87], v[88:91], v[68:71], v[84:87]
  v_accvgpr_write_b32 a48, v220
  v_accvgpr_write_b32 a49, v221
  v_accvgpr_write_b32 a50, v222
  v_accvgpr_write_b32 a51, v223
  v_accvgpr_write_b32 a52, v224
  v_accvgpr_write_b32 a53, v225
  v_accvgpr_write_b32 a54, v226
  v_accvgpr_write_b32 a55, v227
  v_mfma_f32_32x32x16_bf16 v[108:123], v[68:71], a[144:147], v[108:123]
  s_waitcnt lgkmcnt(15)
  v_accvgpr_write_b32 a176, v228
  v_accvgpr_write_b32 a177, v229
  v_accvgpr_write_b32 a178, v230
  v_accvgpr_write_b32 a179, v231
  s_waitcnt lgkmcnt(14)
  v_accvgpr_write_b32 a180, v232
  v_accvgpr_write_b32 a181, v233
  v_accvgpr_write_b32 a182, v234
  v_accvgpr_write_b32 a183, v235
  v_dot2c_f32_bf16 v52, v204, v50
  v_dot2c_f32_bf16 v53, v204, v204
  v_dot2c_f32_bf16 v54, v212, v50
  v_dot2c_f32_bf16 v55, v212, v212
  v_dot2c_f32_bf16 v52, v205, v50
  v_dot2c_f32_bf16 v53, v205, v205
  v_dot2c_f32_bf16 v54, v213, v50
  v_dot2c_f32_bf16 v55, v213, v213
  v_dot2c_f32_bf16 v52, v206, v50
  v_dot2c_f32_bf16 v53, v206, v206
  v_dot2c_f32_bf16 v54, v214, v50
  v_dot2c_f32_bf16 v55, v214, v214
  v_dot2c_f32_bf16 v52, v207, v50
  v_dot2c_f32_bf16 v53, v207, v207
  v_dot2c_f32_bf16 v54, v215, v50
  v_dot2c_f32_bf16 v55, v215, v215
  v_dot2c_f32_bf16 v52, v208, v50
  v_dot2c_f32_bf16 v53, v208, v208
  v_dot2c_f32_bf16 v54, v216, v50
  v_dot2c_f32_bf16 v55, v216, v216
  v_dot2c_f32_bf16 v52, v209, v50
  v_dot2c_f32_bf16 v53, v209, v209
  v_dot2c_f32_bf16 v54, v217, v50
  v_dot2c_f32_bf16 v55, v217, v217
  v_dot2c_f32_bf16 v52, v210, v50
  v_dot2c_f32_bf16 v53, v210, v210
  v_dot2c_f32_bf16 v54, v218, v50
  v_dot2c_f32_bf16 v55, v218, v218
  v_dot2c_f32_bf16 v52, v211, v50
  v_dot2c_f32_bf16 v53, v211, v211
  v_dot2c_f32_bf16 v54, v219, v50
  v_dot2c_f32_bf16 v55, v219, v219
  v_dot2c_f32_bf16 v52, v220, v50
  v_dot2c_f32_bf16 v53, v220, v220
  v_dot2c_f32_bf16 v54, v228, v50
  v_dot2c_f32_bf16 v55, v228, v228
  v_dot2c_f32_bf16 v52, v221, v50
  v_dot2c_f32_bf16 v53, v221, v221
  v_dot2c_f32_bf16 v54, v229, v50
  v_dot2c_f32_bf16 v55, v229, v229
  v_dot2c_f32_bf16 v52, v222, v50
  v_dot2c_f32_bf16 v53, v222, v222
  v_dot2c_f32_bf16 v54, v230, v50
  v_dot2c_f32_bf16 v55, v230, v230
  v_dot2c_f32_bf16 v52, v223, v50
  v_dot2c_f32_bf16 v53, v223, v223
  v_dot2c_f32_bf16 v54, v231, v50
  v_dot2c_f32_bf16 v55, v231, v231
  v_dot2c_f32_bf16 v52, v224, v50
  v_dot2c_f32_bf16 v53, v224, v224
  v_dot2c_f32_bf16 v54, v232, v50
  v_dot2c_f32_bf16 v55, v232, v232
  v_dot2c_f32_bf16 v52, v225, v50
  v_dot2c_f32_bf16 v53, v225, v225
  v_dot2c_f32_bf16 v54, v233, v50
  v_dot2c_f32_bf16 v55, v233, v233
  v_dot2c_f32_bf16 v52, v226, v50
  v_dot2c_f32_bf16 v53, v226, v226
  v_dot2c_f32_bf16 v54, v234, v50
  v_dot2c_f32_bf16 v55, v234, v234
  v_dot2c_f32_bf16 v52, v227, v50
  v_dot2c_f32_bf16 v53, v227, v227
  v_dot2c_f32_bf16 v54, v235, v50
  v_dot2c_f32_bf16 v55, v235, v235
  s_waitcnt vmcnt(8) lgkmcnt(4)
  s_barrier
  v_mfma_f32_32x32x16_bf16 v[92:107], v[72:75], a[20:23], v[92:107]
  ds_read_b64_tr_b16 v[68:69], v38 offset:16384
  ds_read_b64_tr_b16 v[70:71], v38 offset:16896
  ds_read_b128 v[204:207], v22 offset:32768
  ds_read_b128 v[208:211], v23 offset:32768
  s_add_u32 m0, s72, 49152
  s_add_u32 s73, s0, 3
  s_and_b32 s73, s73, 3
  s_mul_i32 s73, s73, 256
  s_add_u32 s73, s73, s77
  s_add_u32 s73, s73, 128
  buffer_load_dwordx4 v5, s[4:7], s73 offen offset:0 lds
  buffer_load_dwordx4 v6, s[4:7], s73 offen offset:1024 lds
  buffer_load_dwordx4 v7, s[4:7], s73 offen offset:2048 lds
  buffer_load_dwordx4 v8, s[4:7], s73 offen offset:3072 lds
  v_mfma_f32_32x32x16_bf16 v[108:123], v[72:75], a[148:151], v[108:123]
  ds_read_b128 v[212:215], v22 offset:36864
  ds_read_b128 v[216:219], v23 offset:36864
  s_waitcnt lgkmcnt(8)
  v_mfma_f32_32x32x16_bf16 v[92:107], v[76:79], a[24:27], v[92:107]
  ds_read_b64_tr_b16 v[72:73], v39 offset:16384
  ds_read_b64_tr_b16 v[74:75], v39 offset:16896
  v_mfma_f32_16x16x32_bf16 v[84:87], v[88:91], v[76:79], v[84:87]
  ds_read_b128 v[220:223], v22 offset:49152
  ds_read_b128 v[224:227], v23 offset:49152
  s_add_u32 m0, s72, 65536
  s_add_u32 s73, s0, 3
  s_and_b32 s73, s73, 3
  s_mul_i32 s73, s73, 352256
  s_add_u32 s73, s73, s80
  buffer_load_dwordx4 v14, s[28:31], s73 offen offset:0 lds
  buffer_load_dwordx4 v15, s[28:31], s73 offen offset:1024 lds
  buffer_load_dwordx4 v16, s[28:31], s73 offen offset:2048 lds
  buffer_load_dwordx4 v17, s[28:31], s73 offen offset:3072 lds
  v_mfma_f32_32x32x16_bf16 v[108:123], v[76:79], a[152:155], v[108:123]
  ds_read_b128 v[228:231], v22 offset:53248
  ds_read_b128 v[232:235], v23 offset:53248
  s_waitcnt lgkmcnt(12)
  v_mfma_f32_32x32x16_bf16 v[92:107], v[80:83], a[28:31], v[92:107]
  ds_read_b64_tr_b16 v[76:77], v40 offset:16384
  ds_read_b64_tr_b16 v[78:79], v40 offset:16896
  ds_read_b128 a[72:75], v24 offset:32768
  ds_read_b128 a[76:79], v25 offset:32768
  v_mfma_f32_32x32x16_bf16 v[108:123], v[80:83], a[156:159], v[108:123]
  ds_read_b128 a[200:203], v24 offset:36864
  ds_read_b128 a[204:207], v25 offset:36864
  s_waitcnt lgkmcnt(15)
  v_mfma_f32_32x32x16_bf16 v[92:107], v[68:71], a[32:35], v[92:107]
  ds_read_b64_tr_b16 v[80:81], v41 offset:16384
  ds_read_b64_tr_b16 v[82:83], v41 offset:16896
  v_mfma_f32_16x16x32_bf16 v[84:87], v[88:91], v[68:71], v[84:87]
  ds_read_b128 a[88:91], v24 offset:49152
  ds_read_b128 a[92:95], v25 offset:49152
  v_mfma_f32_32x32x16_bf16 v[108:123], v[68:71], a[160:163], v[108:123]
  ds_read_b128 a[216:219], v24 offset:53248
  ds_read_b128 a[220:223], v25 offset:53248
  s_waitcnt lgkmcnt(15)
  v_mfma_f32_32x32x16_bf16 v[92:107], v[72:75], a[36:39], v[92:107]
  ds_read_b64_tr_b16 v[68:69], v38 offset:24576
  ds_read_b64_tr_b16 v[70:71], v38 offset:25088
  v_accvgpr_write_b32 a64, v204
  v_accvgpr_write_b32 a65, v205
  v_accvgpr_write_b32 a66, v206
  v_accvgpr_write_b32 a67, v207
  v_mfma_f32_32x32x16_bf16 v[108:123], v[72:75], a[164:167], v[108:123]
  v_accvgpr_write_b32 a68, v208
  v_accvgpr_write_b32 a69, v209
  v_accvgpr_write_b32 a70, v210
  v_accvgpr_write_b32 a71, v211
  v_lshrrev_b32 v244, 3, v1
  v_mul_u32_u24 v244, 3072, v244
  v_add_u32 v5, v244, v5
  s_waitcnt lgkmcnt(12)
  v_mfma_f32_32x32x16_bf16 v[92:107], v[76:79], a[40:43], v[92:107]
  ds_read_b64_tr_b16 v[72:73], v39 offset:24576
  ds_read_b64_tr_b16 v[74:75], v39 offset:25088
  v_mfma_f32_16x16x32_bf16 v[84:87], v[88:91], v[76:79], v[84:87]
  v_accvgpr_write_b32 a192, v212
  v_accvgpr_write_b32 a193, v213
  v_accvgpr_write_b32 a194, v214
  v_accvgpr_write_b32 a195, v215
  v_mfma_f32_32x32x16_bf16 v[108:123], v[76:79], a[168:171], v[108:123]
  v_accvgpr_write_b32 a196, v216
  v_accvgpr_write_b32 a197, v217
  v_accvgpr_write_b32 a198, v218
  v_accvgpr_write_b32 a199, v219
  v_add_u32 v244, 24576, v244
  v_add_u32 v6, v244, v6
  s_waitcnt lgkmcnt(8)
  v_mfma_f32_32x32x16_bf16 v[92:107], v[80:83], a[44:47], v[92:107]
  ds_read_b64_tr_b16 v[76:77], v40 offset:24576
  ds_read_b64_tr_b16 v[78:79], v40 offset:25088
  v_accvgpr_write_b32 a80, v220
  v_accvgpr_write_b32 a81, v221
  v_accvgpr_write_b32 a82, v222
  v_accvgpr_write_b32 a83, v223
  v_mfma_f32_32x32x16_bf16 v[108:123], v[80:83], a[172:175], v[108:123]
  v_accvgpr_write_b32 a84, v224
  v_accvgpr_write_b32 a85, v225
  v_accvgpr_write_b32 a86, v226
  v_accvgpr_write_b32 a87, v227
  v_add_u32 v244, 24576, v244
  v_add_u32 v7, v244, v7
  s_waitcnt lgkmcnt(4)
  v_mfma_f32_32x32x16_bf16 v[92:107], v[68:71], a[48:51], v[92:107]
  ds_read_b64_tr_b16 v[80:81], v41 offset:24576
  ds_read_b64_tr_b16 v[82:83], v41 offset:25088
  v_mfma_f32_16x16x32_bf16 v[84:87], v[88:91], v[68:71], v[84:87]
  v_accvgpr_write_b32 a208, v228
  v_accvgpr_write_b32 a209, v229
  v_accvgpr_write_b32 a210, v230
  v_accvgpr_write_b32 a211, v231
  v_mfma_f32_32x32x16_bf16 v[108:123], v[68:71], a[176:179], v[108:123]
  v_accvgpr_write_b32 a212, v232
  v_accvgpr_write_b32 a213, v233
  v_accvgpr_write_b32 a214, v234
  v_accvgpr_write_b32 a215, v235
  v_add_u32 v244, 24576, v244
  v_add_u32 v8, v244, v8
  v_dot2c_f32_bf16 v52, v204, v50
  v_dot2c_f32_bf16 v53, v204, v204
  v_dot2c_f32_bf16 v54, v212, v50
  v_dot2c_f32_bf16 v55, v212, v212
  v_dot2c_f32_bf16 v52, v205, v50
  v_dot2c_f32_bf16 v53, v205, v205
  v_dot2c_f32_bf16 v54, v213, v50
  v_dot2c_f32_bf16 v55, v213, v213
  v_dot2c_f32_bf16 v52, v206, v50
  v_dot2c_f32_bf16 v53, v206, v206
  v_dot2c_f32_bf16 v54, v214, v50
  v_dot2c_f32_bf16 v55, v214, v214
  v_dot2c_f32_bf16 v52, v207, v50
  v_dot2c_f32_bf16 v53, v207, v207
  v_dot2c_f32_bf16 v54, v215, v50
  v_dot2c_f32_bf16 v55, v215, v215
  v_dot2c_f32_bf16 v52, v208, v50
  v_dot2c_f32_bf16 v53, v208, v208
  v_dot2c_f32_bf16 v54, v216, v50
  v_dot2c_f32_bf16 v55, v216, v216
  v_dot2c_f32_bf16 v52, v209, v50
  v_dot2c_f32_bf16 v53, v209, v209
  v_dot2c_f32_bf16 v54, v217, v50
  v_dot2c_f32_bf16 v55, v217, v217
  v_dot2c_f32_bf16 v52, v210, v50
  v_dot2c_f32_bf16 v53, v210, v210
  v_dot2c_f32_bf16 v54, v218, v50
  v_dot2c_f32_bf16 v55, v218, v218
  v_dot2c_f32_bf16 v52, v211, v50
  v_dot2c_f32_bf16 v53, v211, v211
  v_dot2c_f32_bf16 v54, v219, v50
  v_dot2c_f32_bf16 v55, v219, v219
  v_dot2c_f32_bf16 v52, v220, v50
  v_dot2c_f32_bf16 v53, v220, v220
  v_dot2c_f32_bf16 v54, v228, v50
  v_dot2c_f32_bf16 v55, v228, v228
  v_dot2c_f32_bf16 v52, v221, v50
  v_dot2c_f32_bf16 v53, v221, v221
  v_dot2c_f32_bf16 v54, v229, v50
  v_dot2c_f32_bf16 v55, v229, v229
  v_dot2c_f32_bf16 v52, v222, v50
  v_dot2c_f32_bf16 v53, v222, v222
  v_dot2c_f32_bf16 v54, v230, v50
  v_dot2c_f32_bf16 v55, v230, v230
  v_dot2c_f32_bf16 v52, v223, v50
  v_dot2c_f32_bf16 v53, v223, v223
  v_dot2c_f32_bf16 v54, v231, v50
  v_dot2c_f32_bf16 v55, v231, v231
  v_dot2c_f32_bf16 v52, v224, v50
  v_dot2c_f32_bf16 v53, v224, v224
  v_dot2c_f32_bf16 v54, v232, v50
  v_dot2c_f32_bf16 v55, v232, v232
  v_dot2c_f32_bf16 v52, v225, v50
  v_dot2c_f32_bf16 v53, v225, v225
  v_dot2c_f32_bf16 v54, v233, v50
  v_dot2c_f32_bf16 v55, v233, v233
  v_dot2c_f32_bf16 v52, v226, v50
  v_dot2c_f32_bf16 v53, v226, v226
  v_dot2c_f32_bf16 v54, v234, v50
  v_dot2c_f32_bf16 v55, v234, v234
  v_dot2c_f32_bf16 v52, v227, v50
  v_dot2c_f32_bf16 v53, v227, v227
  v_dot2c_f32_bf16 v54, v235, v50
  v_dot2c_f32_bf16 v55, v235, v235
  s_waitcnt vmcnt(4)
  s_barrier
  s_waitcnt lgkmcnt(4)
  v_mfma_f32_32x32x16_bf16 v[92:107], v[72:75], a[52:55], v[92:107]
  ds_read_b64_tr_b16 v[68:69], v34 offset:0
  ds_read_b64_tr_b16 v[70:71], v34 offset:512
  ds_read_b128 v[204:207], v18 offset:16384
  ds_read_b128 v[208:211], v19 offset:16384
  s_add_u32 m0, s72, 32768
  s_add_u32 s73, s0, 0
  s_and_b32 s73, s73, 3
  s_mul_i32 s73, s73, 352256
  s_add_u32 s73, s73, s81
  buffer_load_dwordx4 v14, s[28:31], s73 offen offset:0 lds
  buffer_load_dwordx4 v15, s[28:31], s73 offen offset:1024 lds
  buffer_load_dwordx4 v16, s[28:31], s73 offen offset:2048 lds
  buffer_load_dwordx4 v17, s[28:31], s73 offen offset:3072 lds
  v_mfma_f32_32x32x16_bf16 v[108:123], v[72:75], a[180:183], v[108:123]
  ds_read_b128 v[212:215], v18 offset:20480
  ds_read_b128 v[216:219], v19 offset:20480
  s_waitcnt lgkmcnt(8)
  v_mfma_f32_32x32x16_bf16 v[92:107], v[76:79], a[56:59], v[92:107]
  ds_read_b64_tr_b16 v[72:73], v35 offset:0
  ds_read_b64_tr_b16 v[74:75], v35 offset:512
  v_mfma_f32_16x16x32_bf16 v[84:87], v[88:91], v[76:79], v[84:87]
  ds_read_b128 v[220:223], v18 offset:49152
  ds_read_b128 v[224:227], v19 offset:49152
  s_add_u32 m0, s72, 98304
  s_add_u32 s73, s0, 1
  s_and_b32 s73, s73, 3
  s_mul_i32 s73, s73, 352256
  s_add_u32 s73, s73, s81
  buffer_load_dwordx4 v14, s[28:31], s73 offen offset:0 lds
  buffer_load_dwordx4 v15, s[28:31], s73 offen offset:1024 lds
  buffer_load_dwordx4 v16, s[28:31], s73 offen offset:2048 lds
  buffer_load_dwordx4 v17, s[28:31], s73 offen offset:3072 lds
  v_mfma_f32_32x32x16_bf16 v[108:123], v[76:79], a[184:187], v[108:123]
  ds_read_b128 v[228:231], v18 offset:53248
  ds_read_b128 v[232:235], v19 offset:53248
  s_waitcnt lgkmcnt(12)
  v_mfma_f32_32x32x16_bf16 v[92:107], v[80:83], a[60:63], v[92:107]
  ds_read_b64_tr_b16 v[76:77], v36 offset:0
  ds_read_b64_tr_b16 v[78:79], v36 offset:512
  ds_read_b128 a[104:107], v20 offset:16384
  ds_read_b128 a[108:111], v21 offset:16384
  s_add_u32 m0, s72, 114688
  s_add_u32 s73, s0, 2
  s_and_b32 s73, s73, 3
  s_mul_i32 s73, s73, 352256
  s_add_u32 s73, s73, s81
  buffer_load_dwordx4 v14, s[28:31], s73 offen offset:0 lds
  buffer_load_dwordx4 v15, s[28:31], s73 offen offset:1024 lds
  buffer_load_dwordx4 v16, s[28:31], s73 offen offset:2048 lds
  buffer_load_dwordx4 v17, s[28:31], s73 offen offset:3072 lds
  v_mfma_f32_32x32x16_bf16 v[108:123], v[80:83], a[188:191], v[108:123]
  ds_read_b128 a[232:235], v20 offset:20480
  ds_read_b128 a[236:239], v21 offset:20480
  s_waitcnt lgkmcnt(15)
  v_mfma_f32_32x32x16_bf16 v[92:107], v[68:71], a[64:67], v[92:107]
  ds_read_b64_tr_b16 v[80:81], v37 offset:0
  ds_read_b64_tr_b16 v[82:83], v37 offset:512
  v_mfma_f32_16x16x32_bf16 v[84:87], v[88:91], v[68:71], v[84:87]
  ds_read_b128 a[120:123], v20 offset:49152
  ds_read_b128 a[124:127], v21 offset:49152
  v_mfma_f32_32x32x16_bf16 v[108:123], v[68:71], a[192:195], v[108:123]
  ds_read_b128 a[248:251], v20 offset:53248
  ds_read_b128 a[252:255], v21 offset:53248
  s_waitcnt lgkmcnt(15)
  v_mfma_f32_32x32x16_bf16 v[92:107], v[72:75], a[68:71], v[92:107]
  ds_read_b64_tr_b16 v[68:69], v34 offset:8192
  ds_read_b64_tr_b16 v[70:71], v34 offset:8704
  v_accvgpr_write_b32 a96, v204
  v_accvgpr_write_b32 a97, v205
  v_accvgpr_write_b32 a98, v206
  v_accvgpr_write_b32 a99, v207
  v_mfma_f32_32x32x16_bf16 v[108:123], v[72:75], a[196:199], v[108:123]
  v_accvgpr_write_b32 a100, v208
  v_accvgpr_write_b32 a101, v209
  v_accvgpr_write_b32 a102, v210
  v_accvgpr_write_b32 a103, v211
  s_waitcnt lgkmcnt(12)
  v_mfma_f32_32x32x16_bf16 v[92:107], v[76:79], a[72:75], v[92:107]
  ds_read_b64_tr_b16 v[72:73], v35 offset:8192
  ds_read_b64_tr_b16 v[74:75], v35 offset:8704
  v_mfma_f32_16x16x32_bf16 v[84:87], v[88:91], v[76:79], v[84:87]
  v_accvgpr_write_b32 a224, v212
  v_accvgpr_write_b32 a225, v213
  v_accvgpr_write_b32 a226, v214
  v_accvgpr_write_b32 a227, v215
  v_mfma_f32_32x32x16_bf16 v[108:123], v[76:79], a[200:203], v[108:123]
  v_accvgpr_write_b32 a228, v216
  v_accvgpr_write_b32 a229, v217
  v_accvgpr_write_b32 a230, v218
  v_accvgpr_write_b32 a231, v219
  s_waitcnt lgkmcnt(8)
  v_mfma_f32_32x32x16_bf16 v[92:107], v[80:83], a[76:79], v[92:107]
  ds_read_b64_tr_b16 v[76:77], v36 offset:8192
  ds_read_b64_tr_b16 v[78:79], v36 offset:8704
  v_accvgpr_write_b32 a112, v220
  v_accvgpr_write_b32 a113, v221
  v_accvgpr_write_b32 a114, v222
  v_accvgpr_write_b32 a115, v223
  v_mfma_f32_32x32x16_bf16 v[108:123], v[80:83], a[204:207], v[108:123]
  v_accvgpr_write_b32 a116, v224
  v_accvgpr_write_b32 a117, v225
  v_accvgpr_write_b32 a118, v226
  v_accvgpr_write_b32 a119, v227
  s_waitcnt lgkmcnt(4)
  v_mfma_f32_32x32x16_bf16 v[92:107], v[68:71], a[80:83], v[92:107]
  ds_read_b64_tr_b16 v[80:81], v37 offset:8192
  ds_read_b64_tr_b16 v[82:83], v37 offset:8704
  v_mfma_f32_16x16x32_bf16 v[84:87], v[88:91], v[68:71], v[84:87]
  v_accvgpr_write_b32 a240, v228
  v_accvgpr_write_b32 a241, v229
  v_accvgpr_write_b32 a242, v230
  v_accvgpr_write_b32 a243, v231
  v_mfma_f32_32x32x16_bf16 v[108:123], v[68:71], a[208:211], v[108:123]
  v_accvgpr_write_b32 a244, v232
  v_accvgpr_write_b32 a245, v233
  v_accvgpr_write_b32 a246, v234
  v_accvgpr_write_b32 a247, v235
  v_dot2c_f32_bf16 v52, v156, v50
  v_dot2c_f32_bf16 v53, v156, v156
  v_dot2c_f32_bf16 v54, v164, v50
  v_dot2c_f32_bf16 v55, v164, v164
  v_dot2c_f32_bf16 v52, v157, v50
  v_dot2c_f32_bf16 v53, v157, v157
  v_dot2c_f32_bf16 v54, v165, v50
  v_dot2c_f32_bf16 v55, v165, v165
  v_dot2c_f32_bf16 v52, v158, v50
  v_dot2c_f32_bf16 v53, v158, v158
  v_dot2c_f32_bf16 v54, v166, v50
  v_dot2c_f32_bf16 v55, v166, v166
  v_dot2c_f32_bf16 v52, v159, v50
  v_dot2c_f32_bf16 v53, v159, v159
  v_dot2c_f32_bf16 v54, v167, v50
  v_dot2c_f32_bf16 v55, v167, v167
  v_dot2c_f32_bf16 v52, v160, v50
  v_dot2c_f32_bf16 v53, v160, v160
  v_dot2c_f32_bf16 v54, v168, v50
  v_dot2c_f32_bf16 v55, v168, v168
  v_dot2c_f32_bf16 v52, v161, v50
  v_dot2c_f32_bf16 v53, v161, v161
  v_dot2c_f32_bf16 v54, v169, v50
  v_dot2c_f32_bf16 v55, v169, v169
  v_dot2c_f32_bf16 v52, v162, v50
  v_dot2c_f32_bf16 v53, v162, v162
  v_dot2c_f32_bf16 v54, v170, v50
  v_dot2c_f32_bf16 v55, v170, v170
  v_dot2c_f32_bf16 v52, v163, v50
  v_dot2c_f32_bf16 v53, v163, v163
  v_dot2c_f32_bf16 v54, v171, v50
  v_dot2c_f32_bf16 v55, v171, v171
  v_dot2c_f32_bf16 v52, v172, v50
  v_dot2c_f32_bf16 v53, v172, v172
  v_dot2c_f32_bf16 v54, v180, v50
  v_dot2c_f32_bf16 v55, v180, v180
  v_dot2c_f32_bf16 v52, v173, v50
  v_dot2c_f32_bf16 v53, v173, v173
  v_dot2c_f32_bf16 v54, v181, v50
  v_dot2c_f32_bf16 v55, v181, v181
  v_dot2c_f32_bf16 v52, v174, v50
  v_dot2c_f32_bf16 v53, v174, v174
  v_dot2c_f32_bf16 v54, v182, v50
  v_dot2c_f32_bf16 v55, v182, v182
  v_dot2c_f32_bf16 v52, v175, v50
  v_dot2c_f32_bf16 v53, v175, v175
  v_dot2c_f32_bf16 v54, v183, v50
  v_dot2c_f32_bf16 v55, v183, v183
  v_dot2c_f32_bf16 v52, v176, v50
  v_dot2c_f32_bf16 v53, v176, v176
  v_dot2c_f32_bf16 v54, v184, v50
  v_dot2c_f32_bf16 v55, v184, v184
  v_dot2c_f32_bf16 v52, v177, v50
  v_dot2c_f32_bf16 v53, v177, v177
  v_dot2c_f32_bf16 v54, v185, v50
  v_dot2c_f32_bf16 v55, v185, v185
  v_dot2c_f32_bf16 v52, v178, v50
  v_dot2c_f32_bf16 v53, v178, v178
  v_dot2c_f32_bf16 v54, v186, v50
  v_dot2c_f32_bf16 v55, v186, v186
  v_dot2c_f32_bf16 v52, v179, v50
  v_dot2c_f32_bf16 v53, v179, v179
  v_dot2c_f32_bf16 v54, v187, v50
  v_dot2c_f32_bf16 v55, v187, v187
  v_dot2c_f32_bf16 v52, v204, v50
  v_dot2c_f32_bf16 v53, v204, v204
  v_dot2c_f32_bf16 v54, v212, v50
  v_dot2c_f32_bf16 v55, v212, v212
  v_dot2c_f32_bf16 v52, v205, v50
  v_dot2c_f32_bf16 v53, v205, v205
  v_dot2c_f32_bf16 v54, v213, v50
  v_dot2c_f32_bf16 v55, v213, v213
  v_dot2c_f32_bf16 v52, v206, v50
  v_dot2c_f32_bf16 v53, v206, v206
  v_dot2c_f32_bf16 v54, v214, v50
  v_dot2c_f32_bf16 v55, v214, v214
  v_dot2c_f32_bf16 v52, v207, v50
  v_dot2c_f32_bf16 v53, v207, v207
  v_dot2c_f32_bf16 v54, v215, v50
  v_dot2c_f32_bf16 v55, v215, v215
  v_dot2c_f32_bf16 v52, v208, v50
  v_dot2c_f32_bf16 v53, v208, v208
  v_dot2c_f32_bf16 v54, v216, v50
  v_dot2c_f32_bf16 v55, v216, v216
  v_dot2c_f32_bf16 v52, v209, v50
  v_dot2c_f32_bf16 v53, v209, v209
  v_dot2c_f32_bf16 v54, v217, v50
  v_dot2c_f32_bf16 v55, v217, v217
  v_dot2c_f32_bf16 v52, v210, v50
  v_dot2c_f32_bf16 v53, v210, v210
  v_dot2c_f32_bf16 v54, v218, v50
  v_dot2c_f32_bf16 v55, v218, v218
  v_dot2c_f32_bf16 v52, v211, v50
  v_dot2c_f32_bf16 v53, v211, v211
  v_dot2c_f32_bf16 v54, v219, v50
  v_dot2c_f32_bf16 v55, v219, v219
  v_dot2c_f32_bf16 v52, v220, v50
  v_dot2c_f32_bf16 v53, v220, v220
  v_dot2c_f32_bf16 v54, v228, v50
  v_dot2c_f32_bf16 v55, v228, v228
  v_dot2c_f32_bf16 v52, v221, v50
  v_dot2c_f32_bf16 v53, v221, v221
  v_dot2c_f32_bf16 v54, v229, v50
  v_dot2c_f32_bf16 v55, v229, v229
  v_dot2c_f32_bf16 v52, v222, v50
  v_dot2c_f32_bf16 v53, v222, v222
  v_dot2c_f32_bf16 v54, v230, v50
  v_dot2c_f32_bf16 v55, v230, v230
  v_dot2c_f32_bf16 v52, v223, v50
  v_dot2c_f32_bf16 v53, v223, v223
  v_dot2c_f32_bf16 v54, v231, v50
  v_dot2c_f32_bf16 v55, v231, v231
  v_dot2c_f32_bf16 v52, v224, v50
  v_dot2c_f32_bf16 v53, v224, v224
  v_dot2c_f32_bf16 v54, v232, v50
  v_dot2c_f32_bf16 v55, v232, v232
  v_dot2c_f32_bf16 v52, v225, v50
  v_dot2c_f32_bf16 v53, v225, v225
  v_dot2c_f32_bf16 v54, v233, v50
  v_dot2c_f32_bf16 v55, v233, v233
  v_dot2c_f32_bf16 v52, v226, v50
  v_dot2c_f32_bf16 v53, v226, v226
  v_dot2c_f32_bf16 v54, v234, v50
  v_dot2c_f32_bf16 v55, v234, v234
  v_dot2c_f32_bf16 v52, v227, v50
  v_dot2c_f32_bf16 v53, v227, v227
  v_dot2c_f32_bf16 v54, v235, v50
  v_dot2c_f32_bf16 v55, v235, v235
  s_waitcnt vmcnt(12)
  s_barrier
  s_waitcnt lgkmcnt(4)
  v_mfma_f32_32x32x16_bf16 v[92:107], v[72:75], a[84:87], v[92:107]
  ds_read_b64_tr_b16 v[68:69], v38 offset:0
  ds_read_b64_tr_b16 v[70:71], v38 offset:512
  s_add_u32 m0, s72, 81920
  s_add_u32 s73, s0, 3
  s_and_b32 s73, s73, 3
  s_mul_i32 s73, s73, 352256
  s_add_u32 s73, s73, s81
  buffer_load_dwordx4 v14, s[28:31], s73 offen offset:0 lds
  buffer_load_dwordx4 v15, s[28:31], s73 offen offset:1024 lds
  buffer_load_dwordx4 v16, s[28:31], s73 offen offset:2048 lds
  buffer_load_dwordx4 v17, s[28:31], s73 offen offset:3072 lds
  v_mfma_f32_32x32x16_bf16 v[108:123], v[72:75], a[212:215], v[108:123]
  s_waitcnt lgkmcnt(4)
  v_mfma_f32_32x32x16_bf16 v[92:107], v[76:79], a[88:91], v[92:107]
  ds_read_b64_tr_b16 v[72:73], v39 offset:0
  ds_read_b64_tr_b16 v[74:75], v39 offset:512
  v_permlane32_swap_b32 v52, v53
  v_permlane32_swap_b32 v54, v55
  v_mfma_f32_16x16x32_bf16 v[84:87], v[88:91], v[76:79], v[84:87]
  s_add_u32 m0, s72, 16384
  s_add_u32 s73, s1, 0
  s_and_b32 s73, s73, 7
  s_mul_i32 s73, s73, 128
  s_add_u32 s73, s73, s79
  buffer_load_dwordx4 v5, s[32:35], s73 offen offset:0 lds
  buffer_load_dwordx4 v6, s[32:35], s73 offen offset:1024 lds
  buffer_load_dwordx4 v7, s[32:35], s73 offen offset:2048 lds
  buffer_load_dwordx4 v8, s[32:35], s73 offen offset:3072 lds
  v_mfma_f32_32x32x16_bf16 v[108:123], v[76:79], a[216:219], v[108:123]
  v_add_f32 v52, v52, v53
  v_add_f32 v54, v54, v55
  ds_write_b32 v48, v52 offset:0
  ds_write_b32 v48, v54 offset:256
  v_xor_b32 v244, 512, v48
  s_waitcnt lgkmcnt(6)
  v_mfma_f32_32x32x16_bf16 v[92:107], v[80:83], a[92:95], v[92:107]
  ds_read_b64_tr_b16 v[76:77], v40 offset:0
  ds_read_b64_tr_b16 v[78:79], v40 offset:512
  s_add_u32 m0, s72, 49152
  s_add_u32 s73, s1, 0
  s_and_b32 s73, s73, 7
  s_mul_i32 s73, s73, 128
  s_add_u32 s73, s73, s78
  buffer_load_dwordx4 v5, s[32:35], s73 offen offset:0 lds
  buffer_load_dwordx4 v6, s[32:35], s73 offen offset:1024 lds
  buffer_load_dwordx4 v7, s[32:35], s73 offen offset:2048 lds
  buffer_load_dwordx4 v8, s[32:35], s73 offen offset:3072 lds
  v_mfma_f32_32x32x16_bf16 v[108:123], v[80:83], a[220:223], v[108:123]
  s_waitcnt lgkmcnt(6)
  v_mfma_f32_32x32x16_bf16 v[92:107], v[68:71], a[96:99], v[92:107]
  ds_read_b64_tr_b16 v[80:81], v41 offset:0
  ds_read_b64_tr_b16 v[82:83], v41 offset:512
  v_mfma_f32_16x16x32_bf16 v[84:87], v[88:91], v[68:71], v[84:87]
  v_mfma_f32_32x32x16_bf16 v[108:123], v[68:71], a[224:227], v[108:123]
  v_bfe_u32 v248, v1, 1, 4
  v_mul_u32_u24 v248, 2752, v248
  v_and_b32 v249, 1, v1
  v_mul_u32_u24 v249, 124, v249
  v_add_u32_e64 v248, v248, v249
  s_lshl_b32 s74, s3, 2
  s_add_u32 s74, s74, s44
  s_mul_i32 s74, s74, 44032
  s_add_u32 s74, s74, s82
  s_mov_b64 exec, 0xffffffff
  buffer_load_dword v4, v248, s[28:31], s74 offen
  s_mov_b64 exec, -1
  v_lshlrev_b32 v248, 7, v1
  s_and_b32 s74, s2, 63
  s_lshl_b32 s74, s74, 2
  s_add_u32 s74, s74, s44
  s_mul_i32 s76, s74, 2816
  s_lshl_b32 s74, s74, 11
  s_mov_b64 exec, 0xffff
  buffer_load_dword v4, v248, s[12:15], s74 offen
  s_mov_b64 exec, 0x3fffff
  buffer_load_dword v4, v248, s[16:19], s76 offen
  s_mov_b64 exec, -1
  s_waitcnt lgkmcnt(6)
  v_mfma_f32_32x32x16_bf16 v[92:107], v[72:75], a[100:103], v[92:107]
  ds_read_b64_tr_b16 v[68:69], v38 offset:8192
  ds_read_b64_tr_b16 v[70:71], v38 offset:8704
  v_mfma_f32_32x32x16_bf16 v[108:123], v[72:75], a[228:231], v[108:123]
  s_waitcnt lgkmcnt(4)
  v_mfma_f32_32x32x16_bf16 v[92:107], v[76:79], a[104:107], v[92:107]
  ds_read_b64_tr_b16 v[72:73], v39 offset:8192
  ds_read_b64_tr_b16 v[74:75], v39 offset:8704
  v_mfma_f32_16x16x32_bf16 v[84:87], v[88:91], v[76:79], v[84:87]
  v_mfma_f32_32x32x16_bf16 v[108:123], v[76:79], a[232:235], v[108:123]
  s_waitcnt lgkmcnt(4)
  v_mfma_f32_32x32x16_bf16 v[92:107], v[80:83], a[108:111], v[92:107]
  ds_read_b64_tr_b16 v[76:77], v40 offset:8192
  ds_read_b64_tr_b16 v[78:79], v40 offset:8704
  v_mfma_f32_32x32x16_bf16 v[108:123], v[80:83], a[236:239], v[108:123]
  s_waitcnt lgkmcnt(4)
  v_mfma_f32_32x32x16_bf16 v[92:107], v[68:71], a[112:115], v[92:107]
  ds_read_b64_tr_b16 v[80:81], v41 offset:8192
  ds_read_b64_tr_b16 v[82:83], v41 offset:8704
  v_mfma_f32_16x16x32_bf16 v[84:87], v[88:91], v[68:71], v[84:87]
  v_mfma_f32_32x32x16_bf16 v[108:123], v[68:71], a[240:243], v[108:123]
  s_waitcnt vmcnt(23)
  s_barrier
  s_waitcnt lgkmcnt(4)
  v_mfma_f32_32x32x16_bf16 v[92:107], v[72:75], a[116:119], v[92:107]
  ds_read_b64_tr_b16 v[68:69], v34 offset:32768
  ds_read_b64_tr_b16 v[70:71], v34 offset:33280
  ds_read_b32 v53, v244 offset:0
  ds_read_b32 v55, v244 offset:256
  s_waitcnt lgkmcnt(1)
  v_add_f32 v52, v52, v53
  s_waitcnt lgkmcnt(0)
  v_add_f32 v54, v54, v55
  v_mov_b32 v53, v52
  v_mov_b32_e64 v55, v54
  v_mfma_f32_16x16x32_bf16 v[84:87], v[88:91], v[76:79], v[84:87]
  v_permlane32_swap_b32 v52, v53
  v_mfma_f32_32x32x16_bf16 v[108:123], v[72:75], a[244:247], v[108:123]
  v_permlane32_swap_b32 v54, v55
  v_mul_f32 v56, 0xbb000000, v52
  v_mul_f32 v62, 0xbb000000, v54
  v_mul_f32 v245, 0x3b000000, v53
  v_mul_f32 v246, 0x3b000000, v55
  v_fma_f32 v245, -v56, v56, v245
  v_fma_f32 v246, -v62, v62, v246
  v_mfma_f32_32x32x16_bf16 v[92:107], v[76:79], a[120:123], v[92:107]
  ds_read_b64_tr_b16 v[72:73], v35 offset:32768
  ds_read_b64_tr_b16 v[74:75], v35 offset:33280
  v_max_f32 v245, 0, v245
  v_max_f32 v246, 0, v246
  v_add_f32 v245, 0x3727c5ac, v245
  v_add_f32 v246, 0x3727c5ac, v246
  v_rsq_f32_e64 v57, v245
  v_mfma_f32_32x32x16_bf16 v[108:123], v[76:79], a[248:251], v[108:123]
  v_rsq_f32 v63, v246
  v_sqrt_f32 v58, v245
  v_sqrt_f32_e64 v64, v246
  v_mul_f32 v59, 0xc0135761, v57
  v_mul_f32 v65, 0xc0135761, v63
  v_mfma_f32_32x32x16_bf16 v[92:107], v[80:83], a[124:127], v[92:107]
  ds_read_b64_tr_b16 v[76:77], v36 offset:32768
  ds_read_b64_tr_b16 v[78:79], v36 offset:33280
  ds_write_b32 v49, v84 offset:0
  v_mul_f32 v245, v57, v57
  v_mul_f32 v246, v63, v63
  v_mul_f32 v52, 0xbdd2d3e8, v57
  v_mul_f32 v54, 0xbdd2d3e8, v63
  v_mul_f32_e64 v60, v245, v52
  v_mfma_f32_32x32x16_bf16 v[108:123], v[80:83], a[252:255], v[108:123]
  v_mul_f32 v66, v246, v54
  s_waitcnt lgkmcnt(0)
  s_barrier
  s_add_u32 m0, s72, 0
  s_add_u32 s73, s1, 1
  s_and_b32 s73, s73, 7
  s_mul_i32 s73, s73, 128
  s_add_u32 s73, s73, s79
  buffer_load_dwordx4 v5, s[32:35], s73 offen offset:0 lds
  buffer_load_dwordx4 v6, s[32:35], s73 offen offset:1024 lds
  buffer_load_dwordx4 v7, s[32:35], s73 offen offset:2048 lds
  buffer_load_dwordx4 v8, s[32:35], s73 offen offset:3072 lds
  s_andn2_b32 s94, s90, 1
  s_mul_i32 s94, s94, 44032
  s_lshl_b32 s74, s80, 5
  s_add_u32 s94, s94, s74
  s_lshl_b32 s74, s96, 11
  s_add_u32 s94, s94, s74
  s_add_u32 s94, s94, 6291456
  s_add_u32 s101, s94, 44032
  v_mfma_f32_32x32x16_bf16 v[124:139], v[68:71], a[0:3], 0
  ds_read_b64_tr_b16 v[80:81], v37 offset:32768
  ds_read_b64_tr_b16 v[82:83], v37 offset:33280
  ds_read_b128 v[204:207], v44 offset:0
  ds_read_b128 v[220:223], v44 offset:256
  ds_read_b128 v[208:211], v44 offset:32
  ds_read_b128 v[224:227], v44 offset:288
  ds_read_b128 v[212:215], v44 offset:64
  v_mfma_f32_16x16x32_bf16 v[84:87], v[88:91], v[68:71], 0
  ds_read_b128 v[228:231], v44 offset:320
  ds_read_b128 v[216:219], v44 offset:96
  v_mfma_f32_32x32x16_bf16 v[140:155], v[68:71], a[128:131], 0
  ds_read_b128 v[232:235], v44 offset:352
  s_waitcnt lgkmcnt(6)
  v_add_f32 v204, v204, v220
  v_add_f32 v205, v205, v221
  v_add_f32 v206, v206, v222
  v_add_f32 v207, v207, v223
  s_waitcnt lgkmcnt(4)
  v_add_f32 v208, v208, v224
  v_add_f32 v209, v209, v225
  v_mfma_f32_32x32x16_bf16 v[124:139], v[72:75], a[4:7], v[124:139]
  ds_read_b64_tr_b16 v[68:69], v34 offset:40960
  ds_read_b64_tr_b16 v[70:71], v34 offset:41472
  v_add_f32 v210, v210, v226
  v_add_f32 v211, v211, v227
  s_waitcnt lgkmcnt(4)
  v_add_f32 v212, v212, v228
  v_add_f32 v213, v213, v229
  v_add_f32 v214, v214, v230
  v_mfma_f32_32x32x16_bf16 v[140:155], v[72:75], a[132:135], v[140:155]
  v_add_f32 v215, v215, v231
  s_waitcnt lgkmcnt(2)
  v_add_f32 v216, v216, v232
  v_add_f32 v217, v217, v233
  v_add_f32 v218, v218, v234
  v_add_f32 v219, v219, v235
  v_fmac_f32 v92, v204, v56
  v_fmac_f32 v93, v205, v56
  v_mfma_f32_32x32x16_bf16 v[124:139], v[76:79], a[8:11], v[124:139]
  ds_read_b64_tr_b16 v[72:73], v35 offset:40960
  ds_read_b64_tr_b16 v[74:75], v35 offset:41472
  v_fmac_f32 v94, v206, v56
  v_fmac_f32 v95, v207, v56
  v_fmac_f32 v96, v208, v56
  v_fmac_f32 v97, v209, v56
  v_fmac_f32_e64 v98, v210, v56
  v_mfma_f32_16x16x32_bf16 v[84:87], v[88:91], v[76:79], v[84:87]
  v_fmac_f32 v99, v211, v56
  v_mul_f32 v220, v92, v92
  v_mfma_f32_32x32x16_bf16 v[140:155], v[76:79], a[136:139], v[140:155]
  v_mul_f32 v221, v93, v93
  v_mul_f32 v222, v94, v94
  v_mul_f32 v223, v95, v95
  v_mul_f32 v224, v96, v96
  v_mul_f32 v225, v97, v97
  v_mul_f32 v226, v98, v98
  v_mul_f32_e64 v227, v99, v99
  v_mfma_f32_32x32x16_bf16 v[124:139], v[80:83], a[12:15], v[124:139]
  ds_read_b64_tr_b16 v[76:77], v36 offset:40960
  ds_read_b64_tr_b16 v[78:79], v36 offset:41472
  v_fma_f32 v220, v220, v60, v59
  v_fma_f32 v221, v221, v60, v59
  v_fma_f32 v222, v222, v60, v59
  v_fma_f32 v223, v223, v60, v59
  v_fma_f32 v224, v224, v60, v59
  v_mfma_f32_32x32x16_bf16 v[140:155], v[80:83], a[140:143], v[140:155]
  v_fma_f32 v225, v225, v60, v59
  v_fma_f32 v226, v226, v60, v59
  v_fma_f32 v227, v227, v60, v59
  v_mul_f32 v220, v220, v92
  v_mul_f32 v221, v221, v93
  v_mul_f32 v222, v222, v94
  v_mul_f32_e64 v223, v223, v95
  s_waitcnt lgkmcnt(4)
  v_mfma_f32_32x32x16_bf16 v[124:139], v[68:71], a[16:19], v[124:139]
  ds_read_b64_tr_b16 v[80:81], v37 offset:40960
  ds_read_b64_tr_b16 v[82:83], v37 offset:41472
  v_mul_f32 v224, v224, v96
  v_mul_f32 v225, v225, v97
  v_mul_f32 v226, v226, v98
  v_mul_f32 v227, v227, v99
  v_mfma_f32_16x16x32_bf16 v[84:87], v[88:91], v[68:71], v[84:87]
  v_exp_f32_e64 v220, v220
  v_mfma_f32_32x32x16_bf16 v[140:155], v[68:71], a[144:147], v[140:155]
  s_waitcnt vmcnt(23)
  s_barrier
  v_exp_f32 v221, v221
  v_exp_f32 v222, v222
  v_exp_f32 v223, v223
  s_waitcnt lgkmcnt(4)
  v_mfma_f32_32x32x16_bf16 v[124:139], v[72:75], a[20:23], v[124:139]
  ds_read_b64_tr_b16 v[68:69], v38 offset:32768
  ds_read_b64_tr_b16 v[70:71], v38 offset:33280
  s_add_u32 m0, s72, 65536
  s_add_u32 s73, s1, 1
  s_and_b32 s73, s73, 7
  s_mul_i32 s73, s73, 128
  s_add_u32 s73, s73, s78
  buffer_load_dwordx4 v5, s[32:35], s73 offen offset:0 lds
  buffer_load_dwordx4 v6, s[32:35], s73 offen offset:1024 lds
  buffer_load_dwordx4 v7, s[32:35], s73 offen offset:2048 lds
  buffer_load_dwordx4 v8, s[32:35], s73 offen offset:3072 lds
  v_mfma_f32_32x32x16_bf16 v[140:155], v[72:75], a[148:151], v[140:155]
  v_exp_f32 v224, v224
  v_exp_f32 v225, v225
  v_exp_f32_e64 v226, v226
  s_waitcnt lgkmcnt(4)
  v_mfma_f32_32x32x16_bf16 v[124:139], v[76:79], a[24:27], v[124:139]
  ds_read_b64_tr_b16 v[72:73], v39 offset:32768
  ds_read_b64_tr_b16 v[74:75], v39 offset:33280
  v_exp_f32_e64 v227, v227
  v_fma_f32 v220, v220, v58, v58
  v_fma_f32 v221, v221, v58, v58
  v_fma_f32 v222, v222, v58, v58
  v_mfma_f32_16x16x32_bf16 v[84:87], v[88:91], v[76:79], v[84:87]
  v_fma_f32 v223, v223, v58, v58
  v_fma_f32 v224, v224, v58, v58
  v_mfma_f32_32x32x16_bf16 v[140:155], v[76:79], a[152:155], v[140:155]
  v_fma_f32 v225, v225, v58, v58
  v_fma_f32 v226, v226, v58, v58
  v_fma_f32 v227, v227, v58, v58
  v_rcp_f32 v220, v220
  v_rcp_f32_e64 v221, v221
  s_waitcnt lgkmcnt(4)
  v_mfma_f32_32x32x16_bf16 v[124:139], v[80:83], a[28:31], v[124:139]
  ds_read_b64_tr_b16 v[76:77], v40 offset:32768
  ds_read_b64_tr_b16 v[78:79], v40 offset:33280
  v_rcp_f32 v222, v222
  v_rcp_f32 v223, v223
  v_mfma_f32_32x32x16_bf16 v[140:155], v[80:83], a[156:159], v[140:155]
  v_rcp_f32 v224, v224
  v_rcp_f32 v225, v225
  v_rcp_f32 v226, v226
  s_waitcnt lgkmcnt(4)
  v_mfma_f32_32x32x16_bf16 v[124:139], v[68:71], a[32:35], v[124:139]
  ds_read_b64_tr_b16 v[80:81], v41 offset:32768
  ds_read_b64_tr_b16 v[82:83], v41 offset:33280
  v_rcp_f32 v227, v227
  v_mul_f32 v92, v92, v220
  v_mul_f32 v93, v93, v221
  v_mul_f32 v94, v94, v222
  v_mfma_f32_16x16x32_bf16 v[84:87], v[88:91], v[68:71], v[84:87]
  v_mul_f32 v95, v95, v223
  v_mul_f32 v96, v96, v224
  v_mfma_f32_32x32x16_bf16 v[140:155], v[68:71], a[160:163], v[140:155]
  v_mul_f32 v97, v97, v225
  v_mul_f32 v98, v98, v226
  v_mul_f32_e64 v99, v99, v227
  v_cvt_pk_bf16_f32 v188, v92, v93
  v_cvt_pk_bf16_f32 v189, v94, v95
  v_cvt_pk_bf16_f32 v190, v96, v97
  v_cvt_pk_bf16_f32 v191, v98, v99
  s_waitcnt lgkmcnt(4)
  v_mfma_f32_32x32x16_bf16 v[124:139], v[72:75], a[36:39], v[124:139]
  ds_read_b64_tr_b16 v[68:69], v38 offset:40960
  ds_read_b64_tr_b16 v[70:71], v38 offset:41472
  buffer_store_dwordx4 v[188:191], v2, s[8:11], s94 offen offset:0 sc1
  v_fmac_f32 v100, v212, v56
  v_fmac_f32 v101, v213, v56
  v_fmac_f32 v102, v214, v56
  v_fmac_f32_e64 v103, v215, v56
  v_mfma_f32_32x32x16_bf16 v[140:155], v[72:75], a[164:167], v[140:155]
  v_fmac_f32 v104, v216, v56
  v_fmac_f32 v105, v217, v56
  v_fmac_f32 v106, v218, v56
  v_fmac_f32 v107, v219, v56
  v_mul_f32 v228, v100, v100
  v_mul_f32 v229, v101, v101
  v_mul_f32 v230, v102, v102
  s_waitcnt lgkmcnt(4)
  v_mfma_f32_32x32x16_bf16 v[124:139], v[76:79], a[40:43], v[124:139]
  ds_read_b64_tr_b16 v[72:73], v39 offset:40960
  ds_read_b64_tr_b16 v[74:75], v39 offset:41472
  v_mul_f32 v231, v103, v103
  v_mul_f32 v232, v104, v104
  v_mul_f32 v233, v105, v105
  v_mul_f32 v234, v106, v106
  v_mul_f32_e64 v235, v107, v107
  v_mfma_f32_16x16x32_bf16 v[84:87], v[88:91], v[76:79], v[84:87]
  v_fma_f32 v228, v228, v60, v59
  v_fma_f32 v229, v229, v60, v59
  v_mfma_f32_32x32x16_bf16 v[140:155], v[76:79], a[168:171], v[140:155]
  v_fma_f32 v230, v230, v60, v59
  v_fma_f32 v231, v231, v60, v59
  v_fma_f32 v232, v232, v60, v59
  v_fma_f32 v233, v233, v60, v59
  v_fma_f32 v234, v234, v60, v59
  v_fma_f32 v235, v235, v60, v59
  v_mul_f32 v228, v228, v100
  s_waitcnt lgkmcnt(4)
  v_mfma_f32_32x32x16_bf16 v[124:139], v[80:83], a[44:47], v[124:139]
  ds_read_b64_tr_b16 v[76:77], v40 offset:40960
  ds_read_b64_tr_b16 v[78:79], v40 offset:41472
  v_mul_f32 v229, v229, v101
  v_mul_f32 v230, v230, v102
  v_mul_f32 v231, v231, v103
  v_mul_f32 v232, v232, v104
  v_mul_f32_e64 v233, v233, v105
  v_mfma_f32_32x32x16_bf16 v[140:155], v[80:83], a[172:175], v[140:155]
  v_mul_f32 v234, v234, v106
  v_mul_f32 v235, v235, v107
  v_exp_f32 v228, v228
  v_exp_f32_e64 v229, v229
  s_waitcnt lgkmcnt(4)
  v_mfma_f32_32x32x16_bf16 v[124:139], v[68:71], a[48:51], v[124:139]
  ds_read_b64_tr_b16 v[80:81], v41 offset:40960
  ds_read_b64_tr_b16 v[82:83], v41 offset:41472
  v_exp_f32 v230, v230
  v_exp_f32 v231, v231
  v_mfma_f32_16x16x32_bf16 v[84:87], v[88:91], v[68:71], v[84:87]
  v_exp_f32_e64 v232, v232
  v_mfma_f32_32x32x16_bf16 v[140:155], v[68:71], a[176:179], v[140:155]
  s_waitcnt vmcnt(24)
  s_barrier
  v_exp_f32 v233, v233
  v_exp_f32 v234, v234
  v_exp_f32 v235, v235
  s_waitcnt lgkmcnt(4)
  v_mfma_f32_32x32x16_bf16 v[124:139], v[72:75], a[52:55], v[124:139]
  ds_read_b64_tr_b16 v[68:69], v38 offset:49152
  ds_read_b64_tr_b16 v[70:71], v38 offset:49664
  v_fma_f32 v228, v228, v58, v58
  v_fma_f32 v229, v229, v58, v58
  v_fma_f32 v230, v230, v58, v58
  v_fma_f32 v231, v231, v58, v58
  v_fma_f32 v232, v232, v58, v58
  v_mfma_f32_32x32x16_bf16 v[140:155], v[72:75], a[180:183], v[140:155]
  v_fma_f32 v233, v233, v58, v58
  v_fma_f32 v234, v234, v58, v58
  v_fma_f32 v235, v235, v58, v58
  v_rcp_f32 v228, v228
  v_rcp_f32_e64 v229, v229
  s_waitcnt lgkmcnt(4)
  v_mfma_f32_32x32x16_bf16 v[124:139], v[76:79], a[56:59], v[124:139]
  ds_read_b64_tr_b16 v[72:73], v39 offset:49152
  ds_read_b64_tr_b16 v[74:75], v39 offset:49664
  v_rcp_f32 v230, v230
  v_rcp_f32 v231, v231
  v_mfma_f32_16x16x32_bf16 v[84:87], v[88:91], v[76:79], v[84:87]
  v_rcp_f32_e64 v232, v232
  v_mfma_f32_32x32x16_bf16 v[140:155], v[76:79], a[184:187], v[140:155]
  v_rcp_f32 v233, v233
  v_rcp_f32 v234, v234
  v_rcp_f32 v235, v235
  v_mul_f32_e64 v100, v100, v228
  s_waitcnt lgkmcnt(4)
  v_mfma_f32_32x32x16_bf16 v[124:139], v[80:83], a[60:63], v[124:139]
  ds_read_b64_tr_b16 v[76:77], v40 offset:49152
  ds_read_b64_tr_b16 v[78:79], v40 offset:49664
  v_mul_f32 v101, v101, v229
  v_mul_f32 v102, v102, v230
  v_mul_f32 v103, v103, v231
  v_mul_f32 v104, v104, v232
  v_mul_f32_e64 v105, v105, v233
  v_mfma_f32_32x32x16_bf16 v[140:155], v[80:83], a[188:191], v[140:155]
  v_mul_f32 v106, v106, v234
  v_mul_f32 v107, v107, v235
  v_cvt_pk_bf16_f32 v192, v100, v101
  v_cvt_pk_bf16_f32 v193, v102, v103
  v_cvt_pk_bf16_f32 v194, v104, v105
  v_cvt_pk_bf16_f32 v195, v106, v107
  buffer_store_dwordx4 v[192:195], v2, s[8:11], s94 offen offset:1024 sc1
  s_waitcnt lgkmcnt(4)
  v_mfma_f32_32x32x16_bf16 v[124:139], v[68:71], a[64:67], v[124:139]
  ds_read_b64_tr_b16 v[80:81], v41 offset:49152
  ds_read_b64_tr_b16 v[82:83], v41 offset:49664
  v_fmac_f32 v108, v204, v62
  v_fmac_f32 v109, v205, v62
  v_fmac_f32 v110, v206, v62
  v_fmac_f32 v111, v207, v62
  v_fmac_f32 v112, v208, v62
  v_mfma_f32_16x16x32_bf16 v[84:87], v[88:91], v[68:71], v[84:87]
  v_fmac_f32 v113, v209, v62
  v_fmac_f32 v114, v210, v62
  v_mfma_f32_32x32x16_bf16 v[140:155], v[68:71], a[192:195], v[140:155]
  v_fmac_f32 v115, v211, v62
  v_mul_f32 v220, v108, v108
  v_mul_f32 v221, v109, v109
  v_mul_f32 v222, v110, v110
  v_mul_f32 v223, v111, v111
  v_mul_f32 v224, v112, v112
  v_mul_f32 v225, v113, v113
  s_waitcnt lgkmcnt(4)
  v_mfma_f32_32x32x16_bf16 v[124:139], v[72:75], a[68:71], v[124:139]
  ds_read_b64_tr_b16 v[68:69], v38 offset:57344
  ds_read_b64_tr_b16 v[70:71], v38 offset:57856
  v_mul_f32 v226, v114, v114
  v_mul_f32 v227, v115, v115
  v_fma_f32 v220, v220, v66, v65
  v_fma_f32 v221, v221, v66, v65
  v_fma_f32 v222, v222, v66, v65
  v_mfma_f32_32x32x16_bf16 v[140:155], v[72:75], a[196:199], v[140:155]
  v_fma_f32 v223, v223, v66, v65
  v_fma_f32 v224, v224, v66, v65
  v_fma_f32 v225, v225, v66, v65
  v_fma_f32 v226, v226, v66, v65
  v_fma_f32 v227, v227, v66, v65
  v_mul_f32 v220, v220, v108
  v_mul_f32_e64 v221, v221, v109
  s_waitcnt lgkmcnt(4)
  v_mfma_f32_32x32x16_bf16 v[124:139], v[76:79], a[72:75], v[124:139]
  ds_read_b64_tr_b16 v[72:73], v39 offset:57344
  ds_read_b64_tr_b16 v[74:75], v39 offset:57856
  v_mul_f32 v222, v222, v110
  v_mul_f32 v223, v223, v111
  v_mul_f32 v224, v224, v112
  v_mul_f32 v225, v225, v113
  v_mul_f32_e64 v226, v226, v114
  v_mfma_f32_16x16x32_bf16 v[84:87], v[88:91], v[76:79], v[84:87]
  v_mul_f32_e64 v227, v227, v115
  v_mfma_f32_32x32x16_bf16 v[140:155], v[76:79], a[200:203], v[140:155]
  v_exp_f32 v220, v220
  v_exp_f32 v221, v221
  v_exp_f32 v222, v222
  s_waitcnt lgkmcnt(4)
  v_mfma_f32_32x32x16_bf16 v[124:139], v[80:83], a[76:79], v[124:139]
  ds_read_b64_tr_b16 v[76:77], v40 offset:57344
  ds_read_b64_tr_b16 v[78:79], v40 offset:57856
  v_exp_f32 v223, v223
  v_exp_f32 v224, v224
  v_mfma_f32_32x32x16_bf16 v[140:155], v[80:83], a[204:207], v[140:155]
  v_exp_f32 v225, v225
  v_exp_f32 v226, v226
  v_exp_f32_e64 v227, v227
  v_fma_f32 v220, v220, v64, v64
  s_waitcnt lgkmcnt(4)
  v_mfma_f32_32x32x16_bf16 v[124:139], v[68:71], a[80:83], v[124:139]
  ds_read_b64_tr_b16 v[80:81], v41 offset:57344
  ds_read_b64_tr_b16 v[82:83], v41 offset:57856
  v_fma_f32 v221, v221, v64, v64
  v_fma_f32 v222, v222, v64, v64
  v_fma_f32 v223, v223, v64, v64
  v_fma_f32 v224, v224, v64, v64
  v_fma_f32 v225, v225, v64, v64
  v_mfma_f32_16x16x32_bf16 v[84:87], v[88:91], v[68:71], v[84:87]
  s_add_u32 m0, s72, 32768
  s_add_u32 s73, s0, 0
  s_and_b32 s73, s73, 3
  s_mul_i32 s73, s73, 352256
  s_add_u32 s73, s73, s82
  buffer_load_dwordx4 v14, s[28:31], s73 offen offset:0 lds
  buffer_load_dwordx4 v15, s[28:31], s73 offen offset:1024 lds
  buffer_load_dwordx4 v16, s[28:31], s73 offen offset:2048 lds
  buffer_load_dwordx4 v17, s[28:31], s73 offen offset:3072 lds
  v_mfma_f32_32x32x16_bf16 v[140:155], v[68:71], a[208:211], v[140:155]
  s_waitcnt vmcnt(25)
  s_barrier
  v_fma_f32 v226, v226, v64, v64
  v_fma_f32 v227, v227, v64, v64
  v_rcp_f32 v220, v220
  v_rcp_f32_e64 v221, v221
  s_waitcnt lgkmcnt(4)
  v_mfma_f32_32x32x16_bf16 v[124:139], v[72:75], a[84:87], v[124:139]
  ds_read_b64_tr_b16 v[68:69], v38 offset:16384
  ds_read_b64_tr_b16 v[70:71], v38 offset:16896
  v_rcp_f32 v222, v222
  v_rcp_f32 v223, v223
  v_mfma_f32_32x32x16_bf16 v[140:155], v[72:75], a[212:215], v[140:155]
  v_rcp_f32 v224, v224
  v_rcp_f32 v225, v225
  v_rcp_f32 v226, v226
  s_waitcnt lgkmcnt(4)
  v_mfma_f32_32x32x16_bf16 v[124:139], v[76:79], a[88:91], v[124:139]
  ds_read_b64_tr_b16 v[72:73], v39 offset:16384
  ds_read_b64_tr_b16 v[74:75], v39 offset:16896
  v_rcp_f32 v227, v227
  v_mul_f32 v108, v108, v220
  v_mul_f32 v109, v109, v221
  v_mul_f32 v110, v110, v222
  v_mfma_f32_16x16x32_bf16 v[84:87], v[88:91], v[76:79], v[84:87]
  v_mul_f32 v111, v111, v223
  v_mul_f32 v112, v112, v224
  v_mfma_f32_32x32x16_bf16 v[140:155], v[76:79], a[216:219], v[140:155]
  v_mul_f32 v113, v113, v225
  v_mul_f32 v114, v114, v226
  v_mul_f32_e64 v115, v115, v227
  v_cvt_pk_bf16_f32 v196, v108, v109
  v_cvt_pk_bf16_f32 v197, v110, v111
  v_cvt_pk_bf16_f32 v198, v112, v113
  v_cvt_pk_bf16_f32 v199, v114, v115
  s_waitcnt lgkmcnt(4)
  v_mfma_f32_32x32x16_bf16 v[124:139], v[80:83], a[92:95], v[124:139]
  ds_read_b64_tr_b16 v[76:77], v40 offset:16384
  ds_read_b64_tr_b16 v[78:79], v40 offset:16896
  buffer_store_dwordx4 v[196:199], v2, s[8:11], s101 offen offset:0 sc1
  v_fmac_f32 v116, v212, v62
  v_fmac_f32 v117, v213, v62
  v_fmac_f32 v118, v214, v62
  v_fmac_f32_e64 v119, v215, v62
  v_mfma_f32_32x32x16_bf16 v[140:155], v[80:83], a[220:223], v[140:155]
  v_fmac_f32 v120, v216, v62
  v_fmac_f32 v121, v217, v62
  v_fmac_f32 v122, v218, v62
  v_fmac_f32 v123, v219, v62
  v_mul_f32 v228, v116, v116
  v_mul_f32 v229, v117, v117
  v_mul_f32 v230, v118, v118
  s_waitcnt lgkmcnt(4)
  v_mfma_f32_32x32x16_bf16 v[124:139], v[68:71], a[96:99], v[124:139]
  ds_read_b64_tr_b16 v[80:81], v41 offset:16384
  ds_read_b64_tr_b16 v[82:83], v41 offset:16896
  v_mul_f32 v231, v119, v119
  v_mul_f32 v232, v120, v120
  v_mul_f32 v233, v121, v121
  v_mul_f32 v234, v122, v122
  v_mul_f32_e64 v235, v123, v123
  v_mfma_f32_16x16x32_bf16 v[84:87], v[88:91], v[68:71], v[84:87]
  s_add_u32 m0, s72, 98304
  s_add_u32 s73, s0, 1
  s_and_b32 s73, s73, 3
  s_mul_i32 s73, s73, 352256
  s_add_u32 s73, s73, s82
  buffer_load_dwordx4 v14, s[28:31], s73 offen offset:0 lds
  buffer_load_dwordx4 v15, s[28:31], s73 offen offset:1024 lds
  buffer_load_dwordx4 v16, s[28:31], s73 offen offset:2048 lds
  buffer_load_dwordx4 v17, s[28:31], s73 offen offset:3072 lds
  v_mfma_f32_32x32x16_bf16 v[140:155], v[68:71], a[224:227], v[140:155]
  v_fma_f32 v228, v228, v66, v65
  v_fma_f32 v229, v229, v66, v65
  v_fma_f32 v230, v230, v66, v65
  v_fma_f32 v231, v231, v66, v65
  v_fma_f32 v232, v232, v66, v65
  v_fma_f32 v233, v233, v66, v65
  v_fma_f32 v234, v234, v66, v65
  s_waitcnt lgkmcnt(4)
  v_mfma_f32_32x32x16_bf16 v[124:139], v[72:75], a[100:103], v[124:139]
  ds_read_b64_tr_b16 v[68:69], v38 offset:24576
  ds_read_b64_tr_b16 v[70:71], v38 offset:25088
  v_fma_f32 v235, v235, v66, v65
  v_mul_f32 v228, v228, v116
  v_mul_f32 v229, v229, v117
  v_mul_f32 v230, v230, v118
  v_mul_f32 v231, v231, v119
  v_mfma_f32_32x32x16_bf16 v[140:155], v[72:75], a[228:231], v[140:155]
  v_mul_f32 v232, v232, v120
  v_mul_f32 v233, v233, v121
  v_mul_f32 v234, v234, v122
  v_mul_f32 v235, v235, v123
  v_exp_f32 v228, v228
  s_waitcnt lgkmcnt(4)
  v_mfma_f32_32x32x16_bf16 v[124:139], v[76:79], a[104:107], v[124:139]
  ds_read_b64_tr_b16 v[72:73], v39 offset:24576
  ds_read_b64_tr_b16 v[74:75], v39 offset:25088
  v_exp_f32 v229, v229
  v_exp_f32 v230, v230
  v_mfma_f32_16x16x32_bf16 v[84:87], v[88:91], v[76:79], v[84:87]
  v_exp_f32_e64 v231, v231
  v_mfma_f32_32x32x16_bf16 v[140:155], v[76:79], a[232:235], v[140:155]
  v_exp_f32 v232, v232
  v_exp_f32 v233, v233
  v_exp_f32 v234, v234
  s_waitcnt lgkmcnt(4)
  v_mfma_f32_32x32x16_bf16 v[124:139], v[80:83], a[108:111], v[124:139]
  ds_read_b64_tr_b16 v[76:77], v40 offset:24576
  ds_read_b64_tr_b16 v[78:79], v40 offset:25088
  v_exp_f32_e64 v235, v235
  v_fma_f32 v228, v228, v64, v64
  v_fma_f32 v229, v229, v64, v64
  v_fma_f32 v230, v230, v64, v64
  v_mfma_f32_32x32x16_bf16 v[140:155], v[80:83], a[236:239], v[140:155]
  v_fma_f32 v231, v231, v64, v64
  v_fma_f32 v232, v232, v64, v64
  v_fma_f32 v233, v233, v64, v64
  v_fma_f32 v234, v234, v64, v64
  v_fma_f32 v235, v235, v64, v64
  v_rcp_f32 v228, v228
  s_waitcnt lgkmcnt(4)
  v_mfma_f32_32x32x16_bf16 v[124:139], v[68:71], a[112:115], v[124:139]
  ds_read_b64_tr_b16 v[80:81], v41 offset:24576
  ds_read_b64_tr_b16 v[82:83], v41 offset:25088
  v_rcp_f32 v229, v229
  v_rcp_f32 v230, v230
  v_mfma_f32_16x16x32_bf16 v[84:87], v[88:91], v[68:71], v[84:87]
  v_rcp_f32_e64 v231, v231
  v_mfma_f32_32x32x16_bf16 v[140:155], v[68:71], a[240:243], v[140:155]
  s_waitcnt vmcnt(5)
  s_barrier
  v_rcp_f32 v232, v232
  v_rcp_f32 v233, v233
  v_rcp_f32 v234, v234
  s_waitcnt lgkmcnt(4)
  v_mfma_f32_32x32x16_bf16 v[124:139], v[72:75], a[116:119], v[124:139]
  ds_read_b64_tr_b16 v[68:69], v34 offset:32768
  ds_read_b64_tr_b16 v[70:71], v34 offset:33280
  v_rcp_f32 v235, v235
  v_mul_f32 v116, v116, v228
  v_mul_f32 v117, v117, v229
  v_mul_f32_e64 v118, v118, v230
  s_waitcnt lgkmcnt(4)
  v_mfma_f32_16x16x32_bf16 v[84:87], v[88:91], v[76:79], v[84:87]
  s_add_u32 m0, s72, 114688
  s_add_u32 s73, s0, 2
  s_and_b32 s73, s73, 3
  s_mul_i32 s73, s73, 352256
  s_add_u32 s73, s73, s82
  buffer_load_dwordx4 v14, s[28:31], s73 offen offset:0 lds
  buffer_load_dwordx4 v15, s[28:31], s73 offen offset:1024 lds
  buffer_load_dwordx4 v16, s[28:31], s73 offen offset:2048 lds
  buffer_load_dwordx4 v17, s[28:31], s73 offen offset:3072 lds
  v_mfma_f32_32x32x16_bf16 v[140:155], v[72:75], a[244:247], v[140:155]
  v_mul_f32 v119, v119, v231
  v_mul_f32 v120, v120, v232
  v_mul_f32 v121, v121, v233
  v_mul_f32 v122, v122, v234
  v_mul_f32 v123, v123, v235
  v_cvt_pk_bf16_f32 v200, v116, v117
  v_cvt_pk_bf16_f32 v201, v118, v119
  v_mfma_f32_32x32x16_bf16 v[124:139], v[76:79], a[120:123], v[124:139]
  ds_read_b64_tr_b16 v[72:73], v35 offset:32768
  ds_read_b64_tr_b16 v[74:75], v35 offset:33280
  v_cvt_pk_bf16_f32 v202, v120, v121
  v_cvt_pk_bf16_f32 v203, v122, v123
  buffer_store_dwordx4 v[200:203], v2, s[8:11], s101 offen offset:1024 sc1
  v_mfma_f32_32x32x16_bf16 v[140:155], v[76:79], a[248:251], v[140:155]
  s_waitcnt lgkmcnt(4)
  v_mfma_f32_32x32x16_bf16 v[124:139], v[80:83], a[124:127], v[124:139]
  ds_read_b64_tr_b16 v[76:77], v36 offset:32768
  ds_read_b64_tr_b16 v[78:79], v36 offset:33280
  ds_write_b32 v49, v84 offset:512
  v_mfma_f32_32x32x16_bf16 v[140:155], v[80:83], a[252:255], v[140:155]
  s_waitcnt lgkmcnt(0)
  s_barrier
  s_add_u32 s94, s94, 4096
  s_add_u32 s101, s101, 4096
  v_mfma_f32_32x32x16_bf16 v[156:171], v[68:71], a[0:3], 0
  ds_read_b64_tr_b16 v[80:81], v37 offset:32768
  ds_read_b64_tr_b16 v[82:83], v37 offset:33280
  ds_read_b128 v[204:207], v44 offset:512
  ds_read_b128 v[220:223], v44 offset:768
  ds_read_b128 v[208:211], v44 offset:544
  ds_read_b128 v[224:227], v44 offset:800
  ds_read_b128 v[212:215], v44 offset:576
  v_mfma_f32_16x16x32_bf16 v[84:87], v[88:91], v[68:71], 0
  ds_read_b128 v[228:231], v44 offset:832
  ds_read_b128 v[216:219], v44 offset:608
  v_mfma_f32_32x32x16_bf16 v[172:187], v[68:71], a[128:131], 0
  ds_read_b128 v[232:235], v44 offset:864
  s_waitcnt lgkmcnt(6)
  v_add_f32 v204, v204, v220
  v_add_f32 v205, v205, v221
  v_add_f32 v206, v206, v222
  v_add_f32 v207, v207, v223
  s_waitcnt lgkmcnt(4)
  v_add_f32 v208, v208, v224
  v_add_f32_e64 v209, v209, v225
  v_mfma_f32_32x32x16_bf16 v[156:171], v[72:75], a[4:7], v[156:171]
  ds_read_b64_tr_b16 v[68:69], v34 offset:40960
  ds_read_b64_tr_b16 v[70:71], v34 offset:41472
  v_add_f32 v210, v210, v226
  v_add_f32 v211, v211, v227
  s_waitcnt lgkmcnt(4)
  v_add_f32 v212, v212, v228
  v_add_f32 v213, v213, v229
  v_add_f32 v214, v214, v230
  v_mfma_f32_32x32x16_bf16 v[172:187], v[72:75], a[132:135], v[172:187]
  v_add_f32 v215, v215, v231
  s_waitcnt lgkmcnt(2)
  v_add_f32 v216, v216, v232
  v_add_f32 v217, v217, v233
  v_add_f32 v218, v218, v234
  v_add_f32 v219, v219, v235
  v_fmac_f32 v124, v204, v56
  v_fmac_f32 v125, v205, v56
  v_mfma_f32_32x32x16_bf16 v[156:171], v[76:79], a[8:11], v[156:171]
  ds_read_b64_tr_b16 v[72:73], v35 offset:40960
  ds_read_b64_tr_b16 v[74:75], v35 offset:41472
  v_fmac_f32 v126, v206, v56
  v_fmac_f32 v127, v207, v56
  v_fmac_f32 v128, v208, v56
  v_fmac_f32 v129, v209, v56
  v_fmac_f32_e64 v130, v210, v56
  v_mfma_f32_16x16x32_bf16 v[84:87], v[88:91], v[76:79], v[84:87]
  v_fmac_f32 v131, v211, v56
  v_mul_f32 v220, v124, v124
  v_mfma_f32_32x32x16_bf16 v[172:187], v[76:79], a[136:139], v[172:187]
  v_mul_f32 v221, v125, v125
  v_mul_f32 v222, v126, v126
  v_mul_f32 v223, v127, v127
  v_mul_f32 v224, v128, v128
  v_mul_f32 v225, v129, v129
  v_mul_f32 v226, v130, v130
  v_mul_f32_e64 v227, v131, v131
  v_mfma_f32_32x32x16_bf16 v[156:171], v[80:83], a[12:15], v[156:171]
  ds_read_b64_tr_b16 v[76:77], v36 offset:40960
  ds_read_b64_tr_b16 v[78:79], v36 offset:41472
  v_fma_f32 v220, v220, v60, v59
  v_fma_f32 v221, v221, v60, v59
  v_fma_f32 v222, v222, v60, v59
  v_fma_f32 v223, v223, v60, v59
  v_fma_f32 v224, v224, v60, v59
  v_mfma_f32_32x32x16_bf16 v[172:187], v[80:83], a[140:143], v[172:187]
  v_fma_f32 v225, v225, v60, v59
  v_fma_f32 v226, v226, v60, v59
  v_fma_f32 v227, v227, v60, v59
  v_mul_f32 v220, v220, v124
  v_mul_f32 v221, v221, v125
  v_mul_f32 v222, v222, v126
  v_mul_f32_e64 v223, v223, v127
  s_waitcnt lgkmcnt(4)
  v_mfma_f32_32x32x16_bf16 v[156:171], v[68:71], a[16:19], v[156:171]
  ds_read_b64_tr_b16 v[80:81], v37 offset:40960
  ds_read_b64_tr_b16 v[82:83], v37 offset:41472
  v_mul_f32 v224, v224, v128
  v_mul_f32 v225, v225, v129
  v_mul_f32 v226, v226, v130
  v_mul_f32 v227, v227, v131
  v_mfma_f32_16x16x32_bf16 v[84:87], v[88:91], v[68:71], v[84:87]
  v_exp_f32_e64 v220, v220
  v_mfma_f32_32x32x16_bf16 v[172:187], v[68:71], a[144:147], v[172:187]
  ds_read_b128 a[0:3], v26 offset:16384
  ds_read_b128 a[4:7], v27 offset:16384
  ds_read_b128 a[8:11], v28 offset:16384
  ds_read_b128 a[12:15], v29 offset:16384
  s_waitcnt vmcnt(5)
  s_barrier
  v_exp_f32 v221, v221
  s_waitcnt lgkmcnt(8)
  v_mfma_f32_32x32x16_bf16 v[156:171], v[72:75], a[20:23], v[156:171]
  ds_read_b64_tr_b16 v[68:69], v38 offset:32768
  ds_read_b64_tr_b16 v[70:71], v38 offset:33280
  s_add_u32 m0, s72, 81920
  s_add_u32 s73, s0, 3
  s_and_b32 s73, s73, 3
  s_mul_i32 s73, s73, 352256
  s_add_u32 s73, s73, s82
  buffer_load_dwordx4 v14, s[28:31], s73 offen offset:0 lds
  buffer_load_dwordx4 v15, s[28:31], s73 offen offset:1024 lds
  buffer_load_dwordx4 v16, s[28:31], s73 offen offset:2048 lds
  buffer_load_dwordx4 v17, s[28:31], s73 offen offset:3072 lds
  v_mfma_f32_32x32x16_bf16 v[172:187], v[72:75], a[148:151], v[172:187]
  v_exp_f32 v222, v222
  v_exp_f32 v223, v223
  v_exp_f32_e64 v224, v224
  s_waitcnt lgkmcnt(8)
  v_mfma_f32_32x32x16_bf16 v[156:171], v[76:79], a[24:27], v[156:171]
  ds_read_b64_tr_b16 v[72:73], v39 offset:32768
  ds_read_b64_tr_b16 v[74:75], v39 offset:33280
  v_exp_f32 v225, v225
  v_exp_f32 v226, v226
  v_mfma_f32_16x16x32_bf16 v[84:87], v[88:91], v[76:79], v[84:87]
  s_waitcnt lgkmcnt(4)
  s_add_u32 m0, s72, 16384
  s_add_u32 s73, s1, 2
  s_and_b32 s73, s73, 7
  s_mul_i32 s73, s73, 128
  s_add_u32 s73, s73, s79
  buffer_load_dwordx4 v5, s[32:35], s73 offen offset:0 lds
  buffer_load_dwordx4 v6, s[32:35], s73 offen offset:1024 lds
  buffer_load_dwordx4 v7, s[32:35], s73 offen offset:2048 lds
  buffer_load_dwordx4 v8, s[32:35], s73 offen offset:3072 lds
  v_mfma_f32_32x32x16_bf16 v[172:187], v[76:79], a[152:155], v[172:187]
  v_exp_f32_e64 v227, v227
  v_fma_f32 v220, v220, v58, v58
  v_fma_f32 v221, v221, v58, v58
  v_fma_f32 v222, v222, v58, v58
  v_fma_f32 v223, v223, v58, v58
  v_fma_f32 v224, v224, v58, v58
  v_mfma_f32_32x32x16_bf16 v[156:171], v[80:83], a[28:31], v[156:171]
  ds_read_b64_tr_b16 v[76:77], v40 offset:32768
  ds_read_b64_tr_b16 v[78:79], v40 offset:33280
  v_fma_f32 v225, v225, v58, v58
  v_fma_f32 v226, v226, v58, v58
  v_fma_f32 v227, v227, v58, v58
  v_rcp_f32_e64 v220, v220
  v_mfma_f32_32x32x16_bf16 v[172:187], v[80:83], a[156:159], v[172:187]
  v_rcp_f32 v221, v221
  v_rcp_f32 v222, v222
  v_rcp_f32 v223, v223
  s_waitcnt lgkmcnt(4)
  v_mfma_f32_32x32x16_bf16 v[156:171], v[68:71], a[32:35], v[156:171]
  ds_read_b64_tr_b16 v[80:81], v41 offset:32768
  ds_read_b64_tr_b16 v[82:83], v41 offset:33280
  v_rcp_f32 v224, v224
  v_rcp_f32 v225, v225
  v_mfma_f32_16x16x32_bf16 v[84:87], v[88:91], v[68:71], v[84:87]
  v_rcp_f32_e64 v226, v226
  v_mfma_f32_32x32x16_bf16 v[172:187], v[68:71], a[160:163], v[172:187]
  ds_read_b128 a[128:131], v26 offset:49152
  ds_read_b128 a[132:135], v27 offset:49152
  ds_read_b128 a[136:139], v28 offset:49152
  ds_read_b128 a[140:143], v29 offset:49152
  v_rcp_f32 v227, v227
  v_mul_f32_e64 v124, v124, v220
  s_waitcnt lgkmcnt(8)
  v_mfma_f32_32x32x16_bf16 v[156:171], v[72:75], a[36:39], v[156:171]
  ds_read_b64_tr_b16 v[68:69], v38 offset:40960
  ds_read_b64_tr_b16 v[70:71], v38 offset:41472
  v_mul_f32 v125, v125, v221
  v_mul_f32 v126, v126, v222
  v_mul_f32 v127, v127, v223
  v_mul_f32 v128, v128, v224
  v_mul_f32_e64 v129, v129, v225
  v_mfma_f32_32x32x16_bf16 v[172:187], v[72:75], a[164:167], v[172:187]
  v_mul_f32 v130, v130, v226
  v_mul_f32 v131, v131, v227
  v_cvt_pk_bf16_f32 v188, v124, v125
  v_cvt_pk_bf16_f32 v189, v126, v127
  v_cvt_pk_bf16_f32 v190, v128, v129
  v_cvt_pk_bf16_f32 v191, v130, v131
  buffer_store_dwordx4 v[188:191], v2, s[8:11], s94 offen offset:0 sc1
  s_waitcnt lgkmcnt(8)
  v_mfma_f32_32x32x16_bf16 v[156:171], v[76:79], a[40:43], v[156:171]
  ds_read_b64_tr_b16 v[72:73], v39 offset:40960
  ds_read_b64_tr_b16 v[74:75], v39 offset:41472
  v_fmac_f32 v132, v212, v56
  v_fmac_f32 v133, v213, v56
  v_fmac_f32 v134, v214, v56
  v_fmac_f32 v135, v215, v56
  v_fmac_f32 v136, v216, v56
  v_mfma_f32_16x16x32_bf16 v[84:87], v[88:91], v[76:79], v[84:87]
  s_waitcnt lgkmcnt(4)
  s_add_u32 m0, s72, 49152
  s_add_u32 s73, s1, 2
  s_and_b32 s73, s73, 7
  s_mul_i32 s73, s73, 128
  s_add_u32 s73, s73, s78
  buffer_load_dwordx4 v5, s[32:35], s73 offen offset:0 lds
  buffer_load_dwordx4 v6, s[32:35], s73 offen offset:1024 lds
  buffer_load_dwordx4 v7, s[32:35], s73 offen offset:2048 lds
  buffer_load_dwordx4 v8, s[32:35], s73 offen offset:3072 lds
  v_mfma_f32_32x32x16_bf16 v[172:187], v[76:79], a[168:171], v[172:187]
  v_fmac_f32 v137, v217, v56
  v_fmac_f32 v138, v218, v56
  v_fmac_f32 v139, v219, v56
  v_mul_f32 v228, v132, v132
  v_mul_f32 v229, v133, v133
  v_mul_f32 v230, v134, v134
  v_mul_f32_e64 v231, v135, v135
  v_mfma_f32_32x32x16_bf16 v[156:171], v[80:83], a[44:47], v[156:171]
  ds_read_b64_tr_b16 v[76:77], v40 offset:40960
  ds_read_b64_tr_b16 v[78:79], v40 offset:41472
  v_mul_f32 v232, v136, v136
  v_mul_f32 v233, v137, v137
  v_mul_f32 v234, v138, v138
  v_mul_f32 v235, v139, v139
  v_fma_f32 v228, v228, v60, v59
  v_mfma_f32_32x32x16_bf16 v[172:187], v[80:83], a[172:175], v[172:187]
  v_fma_f32 v229, v229, v60, v59
  v_fma_f32 v230, v230, v60, v59
  v_fma_f32 v231, v231, v60, v59
  v_fma_f32 v232, v232, v60, v59
  v_fma_f32 v233, v233, v60, v59
  v_fma_f32 v234, v234, v60, v59
  v_fma_f32 v235, v235, v60, v59
  s_waitcnt lgkmcnt(4)
  v_mfma_f32_32x32x16_bf16 v[156:171], v[68:71], a[48:51], v[156:171]
  ds_read_b64_tr_b16 v[80:81], v41 offset:40960
  ds_read_b64_tr_b16 v[82:83], v41 offset:41472
  v_mul_f32 v228, v228, v132
  v_mul_f32 v229, v229, v133
  v_mul_f32 v230, v230, v134
  v_mul_f32 v231, v231, v135
  v_mul_f32 v232, v232, v136
  v_mfma_f32_16x16x32_bf16 v[84:87], v[88:91], v[68:71], v[84:87]
  v_mul_f32 v233, v233, v137
  v_mul_f32 v234, v234, v138
  v_mfma_f32_32x32x16_bf16 v[172:187], v[68:71], a[176:179], v[172:187]
  s_waitcnt vmcnt(14)
  s_barrier
  v_mul_f32 v235, v235, v139
  v_exp_f32 v228, v228
  v_exp_f32 v229, v229
  s_waitcnt lgkmcnt(4)
  v_mfma_f32_32x32x16_bf16 v[156:171], v[72:75], a[52:55], v[156:171]
  ds_read_b64_tr_b16 v[68:69], v38 offset:49152
  ds_read_b64_tr_b16 v[70:71], v38 offset:49664
  s_add_u32 m0, s72, 32768
  s_add_u32 s73, s1, 4
  s_and_b32 s73, s73, 7
  s_mul_i32 s73, s73, 128
  s_add_u32 s73, s73, s79
  buffer_load_dwordx4 v5, s[32:35], s73 offen offset:0 lds
  buffer_load_dwordx4 v6, s[32:35], s73 offen offset:1024 lds
  buffer_load_dwordx4 v7, s[32:35], s73 offen offset:2048 lds
  buffer_load_dwordx4 v8, s[32:35], s73 offen offset:3072 lds
  v_mfma_f32_32x32x16_bf16 v[172:187], v[72:75], a[180:183], v[172:187]
  v_exp_f32 v230, v230
  v_exp_f32 v231, v231
  v_exp_f32_e64 v232, v232
  s_waitcnt lgkmcnt(4)
  v_mfma_f32_32x32x16_bf16 v[156:171], v[76:79], a[56:59], v[156:171]
  ds_read_b64_tr_b16 v[72:73], v39 offset:49152
  ds_read_b64_tr_b16 v[74:75], v39 offset:49664
  v_exp_f32 v233, v233
  v_exp_f32 v234, v234
  v_mfma_f32_16x16x32_bf16 v[84:87], v[88:91], v[76:79], v[84:87]
  v_exp_f32_e64 v235, v235
  v_mfma_f32_32x32x16_bf16 v[172:187], v[76:79], a[184:187], v[172:187]
  ds_read_b128 a[16:19], v26 offset:0
  ds_read_b128 a[20:23], v27 offset:0
  ds_read_b128 a[24:27], v28 offset:0
  ds_read_b128 a[28:31], v29 offset:0
  v_fma_f32 v228, v228, v58, v58
  v_fma_f32 v229, v229, v58, v58
  v_fma_f32 v230, v230, v58, v58
  s_waitcnt lgkmcnt(8)
  v_mfma_f32_32x32x16_bf16 v[156:171], v[80:83], a[60:63], v[156:171]
  ds_read_b64_tr_b16 v[76:77], v40 offset:49152
  ds_read_b64_tr_b16 v[78:79], v40 offset:49664
  v_fma_f32 v231, v231, v58, v58
  v_fma_f32 v232, v232, v58, v58
  v_fma_f32 v233, v233, v58, v58
  v_fma_f32 v234, v234, v58, v58
  v_fma_f32 v235, v235, v58, v58
  v_mfma_f32_32x32x16_bf16 v[172:187], v[80:83], a[188:191], v[172:187]
  v_rcp_f32 v228, v228
  v_rcp_f32 v229, v229
  v_rcp_f32_e64 v230, v230
  s_waitcnt lgkmcnt(8)
  v_mfma_f32_32x32x16_bf16 v[156:171], v[68:71], a[64:67], v[156:171]
  ds_read_b64_tr_b16 v[80:81], v41 offset:49152
  ds_read_b64_tr_b16 v[82:83], v41 offset:49664
  v_rcp_f32 v231, v231
  v_rcp_f32 v232, v232
  v_mfma_f32_16x16x32_bf16 v[84:87], v[88:91], v[68:71], v[84:87]
  s_waitcnt lgkmcnt(4)
  s_add_u32 m0, s72, 0
  s_add_u32 s73, s1, 3
  s_and_b32 s73, s73, 7
  s_mul_i32 s73, s73, 128
  s_add_u32 s73, s73, s79
  buffer_load_dwordx4 v5, s[32:35], s73 offen offset:0 lds
  buffer_load_dwordx4 v6, s[32:35], s73 offen offset:1024 lds
  buffer_load_dwordx4 v7, s[32:35], s73 offen offset:2048 lds
  buffer_load_dwordx4 v8, s[32:35], s73 offen offset:3072 lds
  v_mfma_f32_32x32x16_bf16 v[172:187], v[68:71], a[192:195], v[172:187]
  v_rcp_f32 v233, v233
  v_rcp_f32 v234, v234
  v_rcp_f32 v235, v235
  v_mul_f32_e64 v132, v132, v228
  v_mfma_f32_32x32x16_bf16 v[156:171], v[72:75], a[68:71], v[156:171]
  ds_read_b64_tr_b16 v[68:69], v38 offset:57344
  ds_read_b64_tr_b16 v[70:71], v38 offset:57856
  v_mul_f32 v133, v133, v229
  v_mul_f32 v134, v134, v230
  v_mul_f32 v135, v135, v231
  v_mul_f32 v136, v136, v232
  v_mul_f32_e64 v137, v137, v233
  v_mfma_f32_32x32x16_bf16 v[172:187], v[72:75], a[196:199], v[172:187]
  v_mul_f32 v138, v138, v234
  v_mul_f32 v139, v139, v235
  v_cvt_pk_bf16_f32 v192, v132, v133
  v_cvt_pk_bf16_f32 v193, v134, v135
  v_cvt_pk_bf16_f32 v194, v136, v137
  v_cvt_pk_bf16_f32 v195, v138, v139
  buffer_store_dwordx4 v[192:195], v2, s[8:11], s94 offen offset:1024 sc1
  s_waitcnt lgkmcnt(4)
  v_mfma_f32_32x32x16_bf16 v[156:171], v[76:79], a[72:75], v[156:171]
  ds_read_b64_tr_b16 v[72:73], v39 offset:57344
  ds_read_b64_tr_b16 v[74:75], v39 offset:57856
  v_fmac_f32 v140, v204, v62
  v_fmac_f32 v141, v205, v62
  v_fmac_f32 v142, v206, v62
  v_fmac_f32 v143, v207, v62
  v_fmac_f32 v144, v208, v62
  v_mfma_f32_16x16x32_bf16 v[84:87], v[88:91], v[76:79], v[84:87]
  v_fmac_f32 v145, v209, v62
  v_fmac_f32 v146, v210, v62
  v_mfma_f32_32x32x16_bf16 v[172:187], v[76:79], a[200:203], v[172:187]
  v_fmac_f32 v147, v211, v62
  v_mul_f32 v220, v140, v140
  v_mul_f32 v221, v141, v141
  v_mul_f32 v222, v142, v142
  v_mul_f32 v223, v143, v143
  v_mul_f32 v224, v144, v144
  v_mul_f32 v225, v145, v145
  s_waitcnt lgkmcnt(4)
  v_mfma_f32_32x32x16_bf16 v[156:171], v[80:83], a[76:79], v[156:171]
  ds_read_b64_tr_b16 v[76:77], v40 offset:57344
  ds_read_b64_tr_b16 v[78:79], v40 offset:57856
  v_mul_f32 v226, v146, v146
  v_mul_f32 v227, v147, v147
  v_fma_f32 v220, v220, v66, v65
  v_fma_f32 v221, v221, v66, v65
  v_fma_f32 v222, v222, v66, v65
  v_mfma_f32_32x32x16_bf16 v[172:187], v[80:83], a[204:207], v[172:187]
  v_fma_f32 v223, v223, v66, v65
  v_fma_f32 v224, v224, v66, v65
  v_fma_f32 v225, v225, v66, v65
  v_fma_f32 v226, v226, v66, v65
  v_fma_f32 v227, v227, v66, v65
  v_mul_f32 v220, v220, v140
  v_mul_f32_e64 v221, v221, v141
  s_waitcnt lgkmcnt(4)
  v_mfma_f32_32x32x16_bf16 v[156:171], v[68:71], a[80:83], v[156:171]
  ds_read_b64_tr_b16 v[80:81], v41 offset:57344
  ds_read_b64_tr_b16 v[82:83], v41 offset:57856
  v_mul_f32 v222, v222, v142
  v_mul_f32 v223, v223, v143
  v_mul_f32 v224, v224, v144
  v_mul_f32 v225, v225, v145
  v_mul_f32_e64 v226, v226, v146
  v_mfma_f32_16x16x32_bf16 v[84:87], v[88:91], v[68:71], v[84:87]
  v_mul_f32_e64 v227, v227, v147
  v_mfma_f32_32x32x16_bf16 v[172:187], v[68:71], a[208:211], v[172:187]
  s_waitcnt vmcnt(18)
  s_barrier
  v_exp_f32 v220, v220
  v_exp_f32 v221, v221
  v_exp_f32 v222, v222
  s_waitcnt lgkmcnt(4)
  v_mfma_f32_32x32x16_bf16 v[156:171], v[72:75], a[84:87], v[156:171]
  ds_read_b64_tr_b16 v[68:69], v38 offset:16384
  ds_read_b64_tr_b16 v[70:71], v38 offset:16896
  s_add_u32 m0, s72, 98304
  s_add_u32 s73, s1, 4
  s_and_b32 s73, s73, 7
  s_mul_i32 s73, s73, 128
  s_add_u32 s73, s73, s78
  buffer_load_dwordx4 v5, s[32:35], s73 offen offset:0 lds
  buffer_load_dwordx4 v6, s[32:35], s73 offen offset:1024 lds
  buffer_load_dwordx4 v7, s[32:35], s73 offen offset:2048 lds
  buffer_load_dwordx4 v8, s[32:35], s73 offen offset:3072 lds
  v_mfma_f32_32x32x16_bf16 v[172:187], v[72:75], a[212:215], v[172:187]
  v_exp_f32 v223, v223
  v_exp_f32 v224, v224
  v_exp_f32_e64 v225, v225
  s_waitcnt lgkmcnt(4)
  v_mfma_f32_32x32x16_bf16 v[156:171], v[76:79], a[88:91], v[156:171]
  ds_read_b64_tr_b16 v[72:73], v39 offset:16384
  ds_read_b64_tr_b16 v[74:75], v39 offset:16896
  v_exp_f32 v226, v226
  v_exp_f32 v227, v227
  v_fma_f32 v220, v220, v64, v64
  v_mfma_f32_16x16x32_bf16 v[84:87], v[88:91], v[76:79], v[84:87]
  v_fma_f32 v221, v221, v64, v64
  v_fma_f32 v222, v222, v64, v64
  v_mfma_f32_32x32x16_bf16 v[172:187], v[76:79], a[216:219], v[172:187]
  ds_read_b128 a[144:147], v30 offset:0
  ds_read_b128 a[148:151], v31 offset:0
  ds_read_b128 a[152:155], v32 offset:0
  ds_read_b128 a[156:159], v33 offset:0
  v_fma_f32 v223, v223, v64, v64
  v_fma_f32 v224, v224, v64, v64
  v_fma_f32 v225, v225, v64, v64
  s_waitcnt lgkmcnt(8)
  v_mfma_f32_32x32x16_bf16 v[156:171], v[80:83], a[92:95], v[156:171]
  ds_read_b64_tr_b16 v[76:77], v40 offset:16384
  ds_read_b64_tr_b16 v[78:79], v40 offset:16896
  v_fma_f32 v226, v226, v64, v64
  v_fma_f32 v227, v227, v64, v64
  v_rcp_f32 v220, v220
  v_mfma_f32_32x32x16_bf16 v[172:187], v[80:83], a[220:223], v[172:187]
  v_rcp_f32 v221, v221
  v_rcp_f32 v222, v222
  v_rcp_f32 v223, v223
  s_waitcnt lgkmcnt(8)
  v_mfma_f32_32x32x16_bf16 v[156:171], v[68:71], a[96:99], v[156:171]
  ds_read_b64_tr_b16 v[80:81], v41 offset:16384
  ds_read_b64_tr_b16 v[82:83], v41 offset:16896
  v_rcp_f32 v224, v224
  v_rcp_f32 v225, v225
  v_mfma_f32_16x16x32_bf16 v[84:87], v[88:91], v[68:71], v[84:87]
  s_waitcnt lgkmcnt(4)
  s_add_u32 m0, s72, 65536
  s_add_u32 s73, s1, 3
  s_and_b32 s73, s73, 7
  s_mul_i32 s73, s73, 128
  s_add_u32 s73, s73, s78
  buffer_load_dwordx4 v5, s[32:35], s73 offen offset:0 lds
  buffer_load_dwordx4 v6, s[32:35], s73 offen offset:1024 lds
  buffer_load_dwordx4 v7, s[32:35], s73 offen offset:2048 lds
  buffer_load_dwordx4 v8, s[32:35], s73 offen offset:3072 lds
  v_mfma_f32_32x32x16_bf16 v[172:187], v[68:71], a[224:227], v[172:187]
  v_rcp_f32 v226, v226
  v_rcp_f32 v227, v227
  v_mul_f32 v140, v140, v220
  v_mul_f32 v141, v141, v221
  v_mul_f32_e64 v142, v142, v222
  v_mfma_f32_32x32x16_bf16 v[156:171], v[72:75], a[100:103], v[156:171]
  ds_read_b64_tr_b16 v[68:69], v38 offset:24576
  ds_read_b64_tr_b16 v[70:71], v38 offset:25088
  v_mul_f32 v143, v143, v223
  v_mul_f32 v144, v144, v224
  v_mul_f32 v145, v145, v225
  v_mul_f32 v146, v146, v226
  v_mul_f32_e64 v147, v147, v227
  v_mfma_f32_32x32x16_bf16 v[172:187], v[72:75], a[228:231], v[172:187]
  v_cvt_pk_bf16_f32 v196, v140, v141
  v_cvt_pk_bf16_f32 v197, v142, v143
  v_cvt_pk_bf16_f32 v198, v144, v145
  v_cvt_pk_bf16_f32 v199, v146, v147
  buffer_store_dwordx4 v[196:199], v2, s[8:11], s101 offen offset:0 sc1
  v_fmac_f32 v148, v212, v62
  v_fmac_f32_e64 v149, v213, v62
  s_waitcnt lgkmcnt(4)
  v_mfma_f32_32x32x16_bf16 v[156:171], v[76:79], a[104:107], v[156:171]
  ds_read_b64_tr_b16 v[72:73], v39 offset:24576
  ds_read_b64_tr_b16 v[74:75], v39 offset:25088
  v_fmac_f32 v150, v214, v62
  v_fmac_f32 v151, v215, v62
  v_fmac_f32 v152, v216, v62
  v_fmac_f32 v153, v217, v62
  v_fmac_f32_e64 v154, v218, v62
  v_mfma_f32_16x16x32_bf16 v[84:87], v[88:91], v[76:79], v[84:87]
  v_fmac_f32 v155, v219, v62
  v_mul_f32 v228, v148, v148
  v_mfma_f32_32x32x16_bf16 v[172:187], v[76:79], a[232:235], v[172:187]
  v_mul_f32 v229, v149, v149
  v_mul_f32 v230, v150, v150
  v_mul_f32 v231, v151, v151
  v_mul_f32 v232, v152, v152
  v_mul_f32 v233, v153, v153
  v_mul_f32 v234, v154, v154
  v_mul_f32 v235, v155, v155
  s_waitcnt lgkmcnt(4)
  v_mfma_f32_32x32x16_bf16 v[156:171], v[80:83], a[108:111], v[156:171]
  ds_read_b64_tr_b16 v[76:77], v40 offset:24576
  ds_read_b64_tr_b16 v[78:79], v40 offset:25088
  v_fma_f32 v228, v228, v66, v65
  v_fma_f32 v229, v229, v66, v65
  v_fma_f32 v230, v230, v66, v65
  v_fma_f32 v231, v231, v66, v65
  v_fma_f32 v232, v232, v66, v65
  v_mfma_f32_32x32x16_bf16 v[172:187], v[80:83], a[236:239], v[172:187]
  v_fma_f32 v233, v233, v66, v65
  v_fma_f32 v234, v234, v66, v65
  v_fma_f32 v235, v235, v66, v65
  v_mul_f32 v228, v228, v148
  v_mul_f32 v229, v229, v149
  v_mul_f32 v230, v230, v150
  v_mul_f32_e64 v231, v231, v151
  s_waitcnt lgkmcnt(4)
  v_mfma_f32_32x32x16_bf16 v[156:171], v[68:71], a[112:115], v[156:171]
  ds_read_b64_tr_b16 v[80:81], v41 offset:24576
  ds_read_b64_tr_b16 v[82:83], v41 offset:25088
  v_mul_f32 v232, v232, v152
  v_mul_f32 v233, v233, v153
  v_mul_f32 v234, v234, v154
  v_mul_f32 v235, v235, v155
  v_mfma_f32_16x16x32_bf16 v[84:87], v[88:91], v[68:71], v[84:87]
  v_exp_f32_e64 v228, v228
  v_mfma_f32_32x32x16_bf16 v[172:187], v[68:71], a[240:243], v[172:187]
  s_barrier
  v_exp_f32 v229, v229
  v_exp_f32 v230, v230
  v_exp_f32_e64 v231, v231
  s_waitcnt lgkmcnt(4)
  v_mfma_f32_32x32x16_bf16 v[156:171], v[72:75], a[116:119], v[156:171]
  v_exp_f32 v232, v232
  v_exp_f32 v233, v233
  v_exp_f32 v234, v234
  s_waitcnt lgkmcnt(2)
  v_mfma_f32_16x16x32_bf16 v[84:87], v[88:91], v[76:79], v[84:87]
  s_add_u32 m0, s72, 114688
  s_add_u32 s73, s1, 5
  s_and_b32 s73, s73, 7
  s_mul_i32 s73, s73, 128
  s_add_u32 s73, s73, s79
  buffer_load_dwordx4 v5, s[32:35], s73 offen offset:0 lds
  buffer_load_dwordx4 v6, s[32:35], s73 offen offset:1024 lds
  buffer_load_dwordx4 v7, s[32:35], s73 offen offset:2048 lds
  buffer_load_dwordx4 v8, s[32:35], s73 offen offset:3072 lds
  v_mfma_f32_32x32x16_bf16 v[172:187], v[72:75], a[244:247], v[172:187]
  v_exp_f32 v235, v235
  v_fma_f32 v228, v228, v64, v64
  v_fma_f32 v229, v229, v64, v64
  v_fma_f32 v230, v230, v64, v64
  v_fma_f32 v231, v231, v64, v64
  v_fma_f32 v232, v232, v64, v64
  v_mfma_f32_32x32x16_bf16 v[156:171], v[76:79], a[120:123], v[156:171]
  v_fma_f32 v233, v233, v64, v64
  v_fma_f32 v234, v234, v64, v64
  v_fma_f32 v235, v235, v64, v64
  v_rcp_f32 v228, v228
  v_rcp_f32 v229, v229
  v_mfma_f32_32x32x16_bf16 v[172:187], v[76:79], a[248:251], v[172:187]
  v_rcp_f32 v230, v230
  v_rcp_f32 v231, v231
  v_rcp_f32 v232, v232
  s_waitcnt lgkmcnt(0)
  v_mfma_f32_32x32x16_bf16 v[156:171], v[80:83], a[124:127], v[156:171]
  ds_write_b32 v49, v84 offset:1024
  v_rcp_f32 v233, v233
  v_rcp_f32 v234, v234
  v_rcp_f32_e64 v235, v235
  v_mfma_f32_32x32x16_bf16 v[172:187], v[80:83], a[252:255], v[172:187]
  v_mul_f32 v148, v148, v228
  v_mul_f32 v149, v149, v229
  v_mul_f32 v150, v150, v230
  v_mul_f32 v151, v151, v231
  v_mul_f32 v152, v152, v232
  v_mul_f32 v153, v153, v233
  v_mul_f32 v154, v154, v234
  v_mul_f32 v155, v155, v235
  v_cvt_pk_bf16_f32 v200, v148, v149
  v_cvt_pk_bf16_f32 v201, v150, v151
  v_cvt_pk_bf16_f32 v202, v152, v153
  v_cvt_pk_bf16_f32 v203, v154, v155
  buffer_store_dwordx4 v[200:203], v2, s[8:11], s101 offen offset:1024 sc1
  s_waitcnt lgkmcnt(0)
  s_barrier
  s_add_u32 m0, s72, 81920
  s_add_u32 s73, s1, 5
  s_and_b32 s73, s73, 7
  s_mul_i32 s73, s73, 128
  s_add_u32 s73, s73, s78
  buffer_load_dwordx4 v5, s[32:35], s73 offen offset:0 lds
  buffer_load_dwordx4 v6, s[32:35], s73 offen offset:1024 lds
  buffer_load_dwordx4 v7, s[32:35], s73 offen offset:2048 lds
  buffer_load_dwordx4 v8, s[32:35], s73 offen offset:3072 lds
  s_add_u32 s94, s94, 4096
  s_add_u32 s101, s101, 4096
  s_buffer_load_dword s71, s[40:43], 0
  ds_read_b128 v[204:207], v44 offset:1024
  ds_read_b128 v[220:223], v44 offset:1280
  ds_read_b128 v[208:211], v44 offset:1056
  ds_read_b128 v[224:227], v44 offset:1312
  ds_read_b128 v[212:215], v44 offset:1088
  ds_read_b128 v[228:231], v44 offset:1344
  ds_read_b128 v[216:219], v44 offset:1120
  ds_read_b128 v[232:235], v44 offset:1376
  s_waitcnt lgkmcnt(6)
  v_pk_add_f32 v[204:205], v[204:205], v[220:221] op_sel:[0,0] op_sel_hi:[1,1]
  v_pk_add_f32 v[206:207], v[206:207], v[222:223] op_sel:[0,0] op_sel_hi:[1,1]
  s_waitcnt lgkmcnt(4)
  v_pk_add_f32 v[208:209], v[208:209], v[224:225] op_sel:[0,0] op_sel_hi:[1,1]
  v_pk_add_f32 v[210:211], v[210:211], v[226:227] op_sel:[0,0] op_sel_hi:[1,1]
  s_waitcnt lgkmcnt(2)
  v_pk_add_f32 v[212:213], v[212:213], v[228:229] op_sel:[0,0] op_sel_hi:[1,1]
  v_pk_add_f32 v[214:215], v[214:215], v[230:231] op_sel:[0,0] op_sel_hi:[1,1]
  s_waitcnt lgkmcnt(0)
  v_pk_add_f32 v[216:217], v[216:217], v[232:233] op_sel:[0,0] op_sel_hi:[1,1]
  v_pk_add_f32 v[218:219], v[218:219], v[234:235] op_sel:[0,0] op_sel_hi:[1,1]
  v_pk_fma_f32 v[156:157], v[204:205], v[56:57], v[156:157] op_sel:[0,0,0] op_sel_hi:[1,0,1]
  v_pk_fma_f32 v[158:159], v[206:207], v[56:57], v[158:159] op_sel:[0,0,0] op_sel_hi:[1,0,1]
  v_pk_fma_f32 v[160:161], v[208:209], v[56:57], v[160:161] op_sel:[0,0,0] op_sel_hi:[1,0,1]
  v_pk_fma_f32 v[162:163], v[210:211], v[56:57], v[162:163] op_sel:[0,0,0] op_sel_hi:[1,0,1]
  v_pk_mul_f32 v[220:221], v[156:157], v[156:157] op_sel:[0,0] op_sel_hi:[1,1]
  v_pk_mul_f32 v[222:223], v[158:159], v[158:159] op_sel:[0,0] op_sel_hi:[1,1]
  v_pk_mul_f32 v[224:225], v[160:161], v[160:161] op_sel:[0,0] op_sel_hi:[1,1]
  v_pk_mul_f32 v[226:227], v[162:163], v[162:163] op_sel:[0,0] op_sel_hi:[1,1]
  v_pk_fma_f32 v[220:221], v[220:221], v[60:61], v[58:59] op_sel:[0,0,1] op_sel_hi:[1,0,1]
  v_pk_fma_f32 v[222:223], v[222:223], v[60:61], v[58:59] op_sel:[0,0,1] op_sel_hi:[1,0,1]
  v_pk_fma_f32 v[224:225], v[224:225], v[60:61], v[58:59] op_sel:[0,0,1] op_sel_hi:[1,0,1]
  v_pk_fma_f32 v[226:227], v[226:227], v[60:61], v[58:59] op_sel:[0,0,1] op_sel_hi:[1,0,1]
  v_pk_mul_f32 v[220:221], v[220:221], v[156:157] op_sel:[0,0] op_sel_hi:[1,1]
  v_pk_mul_f32 v[222:223], v[222:223], v[158:159] op_sel:[0,0] op_sel_hi:[1,1]
  v_pk_mul_f32 v[224:225], v[224:225], v[160:161] op_sel:[0,0] op_sel_hi:[1,1]
  v_pk_mul_f32 v[226:227], v[226:227], v[162:163] op_sel:[0,0] op_sel_hi:[1,1]
  v_exp_f32 v220, v220
  v_exp_f32 v221, v221
  v_exp_f32 v222, v222
  v_exp_f32 v223, v223
  v_exp_f32 v224, v224
  v_exp_f32 v225, v225
  v_exp_f32 v226, v226
  v_exp_f32_e64 v227, v227
  v_pk_fma_f32 v[220:221], v[220:221], v[58:59], v[58:59] op_sel:[0,0,0] op_sel_hi:[1,0,0]
  v_pk_fma_f32 v[222:223], v[222:223], v[58:59], v[58:59] op_sel:[0,0,0] op_sel_hi:[1,0,0]
  v_pk_fma_f32 v[224:225], v[224:225], v[58:59], v[58:59] op_sel:[0,0,0] op_sel_hi:[1,0,0]
  v_pk_fma_f32 v[226:227], v[226:227], v[58:59], v[58:59] op_sel:[0,0,0] op_sel_hi:[1,0,0]
  v_rcp_f32 v220, v220
  v_rcp_f32 v221, v221
  v_rcp_f32 v222, v222
  v_rcp_f32 v223, v223
  v_rcp_f32 v224, v224
  v_rcp_f32 v225, v225
  v_rcp_f32 v226, v226
  v_rcp_f32 v227, v227
  v_pk_mul_f32 v[156:157], v[156:157], v[220:221] op_sel:[0,0] op_sel_hi:[1,1]
  v_pk_mul_f32 v[158:159], v[158:159], v[222:223] op_sel:[0,0] op_sel_hi:[1,1]
  v_pk_mul_f32 v[160:161], v[160:161], v[224:225] op_sel:[0,0] op_sel_hi:[1,1]
  v_pk_mul_f32 v[162:163], v[162:163], v[226:227] op_sel:[0,0] op_sel_hi:[1,1]
  v_cvt_pk_bf16_f32 v188, v156, v157
  v_cvt_pk_bf16_f32 v189, v158, v159
  v_cvt_pk_bf16_f32 v190, v160, v161
  v_cvt_pk_bf16_f32 v191, v162, v163
  buffer_store_dwordx4 v[188:191], v2, s[8:11], s94 offen offset:0 sc1
  v_pk_fma_f32 v[164:165], v[212:213], v[56:57], v[164:165] op_sel:[0,0,0] op_sel_hi:[1,0,1]
  v_pk_fma_f32 v[166:167], v[214:215], v[56:57], v[166:167] op_sel:[0,0,0] op_sel_hi:[1,0,1]
  v_pk_fma_f32 v[168:169], v[216:217], v[56:57], v[168:169] op_sel:[0,0,0] op_sel_hi:[1,0,1]
  v_pk_fma_f32 v[170:171], v[218:219], v[56:57], v[170:171] op_sel:[0,0,0] op_sel_hi:[1,0,1]
  v_pk_mul_f32 v[228:229], v[164:165], v[164:165] op_sel:[0,0] op_sel_hi:[1,1]
  v_pk_mul_f32 v[230:231], v[166:167], v[166:167] op_sel:[0,0] op_sel_hi:[1,1]
  v_pk_mul_f32 v[232:233], v[168:169], v[168:169] op_sel:[0,0] op_sel_hi:[1,1]
  v_pk_mul_f32 v[234:235], v[170:171], v[170:171] op_sel:[0,0] op_sel_hi:[1,1]
  v_pk_fma_f32 v[228:229], v[228:229], v[60:61], v[58:59] op_sel:[0,0,1] op_sel_hi:[1,0,1]
  v_pk_fma_f32 v[230:231], v[230:231], v[60:61], v[58:59] op_sel:[0,0,1] op_sel_hi:[1,0,1]
  v_pk_fma_f32 v[232:233], v[232:233], v[60:61], v[58:59] op_sel:[0,0,1] op_sel_hi:[1,0,1]
  v_pk_fma_f32 v[234:235], v[234:235], v[60:61], v[58:59] op_sel:[0,0,1] op_sel_hi:[1,0,1]
  v_pk_mul_f32 v[228:229], v[228:229], v[164:165] op_sel:[0,0] op_sel_hi:[1,1]
  v_pk_mul_f32 v[230:231], v[230:231], v[166:167] op_sel:[0,0] op_sel_hi:[1,1]
  v_pk_mul_f32 v[232:233], v[232:233], v[168:169] op_sel:[0,0] op_sel_hi:[1,1]
  v_pk_mul_f32 v[234:235], v[234:235], v[170:171] op_sel:[0,0] op_sel_hi:[1,1]
  v_exp_f32 v228, v228
  v_exp_f32 v229, v229
  v_exp_f32 v230, v230
  v_exp_f32 v231, v231
  v_exp_f32 v232, v232
  v_exp_f32 v233, v233
  v_exp_f32 v234, v234
  v_exp_f32 v235, v235
  v_pk_fma_f32 v[228:229], v[228:229], v[58:59], v[58:59] op_sel:[0,0,0] op_sel_hi:[1,0,0]
  v_pk_fma_f32 v[230:231], v[230:231], v[58:59], v[58:59] op_sel:[0,0,0] op_sel_hi:[1,0,0]
  v_pk_fma_f32 v[232:233], v[232:233], v[58:59], v[58:59] op_sel:[0,0,0] op_sel_hi:[1,0,0]
  v_pk_fma_f32 v[234:235], v[234:235], v[58:59], v[58:59] op_sel:[0,0,0] op_sel_hi:[1,0,0]
  v_rcp_f32 v228, v228
  v_rcp_f32 v229, v229
  v_rcp_f32 v230, v230
  v_rcp_f32 v231, v231
  v_rcp_f32 v232, v232
  v_rcp_f32 v233, v233
  v_rcp_f32 v234, v234
  v_rcp_f32 v235, v235
  v_pk_mul_f32 v[164:165], v[164:165], v[228:229] op_sel:[0,0] op_sel_hi:[1,1]
  v_pk_mul_f32 v[166:167], v[166:167], v[230:231] op_sel:[0,0] op_sel_hi:[1,1]
  v_pk_mul_f32 v[168:169], v[168:169], v[232:233] op_sel:[0,0] op_sel_hi:[1,1]
  v_pk_mul_f32 v[170:171], v[170:171], v[234:235] op_sel:[0,0] op_sel_hi:[1,1]
  v_cvt_pk_bf16_f32 v192, v164, v165
  v_cvt_pk_bf16_f32 v193, v166, v167
  v_cvt_pk_bf16_f32 v194, v168, v169
  v_cvt_pk_bf16_f32 v195, v170, v171
  buffer_store_dwordx4 v[192:195], v2, s[8:11], s94 offen offset:1024 sc1
  v_pk_fma_f32 v[172:173], v[204:205], v[62:63], v[172:173] op_sel:[0,0,0] op_sel_hi:[1,0,1]
  v_pk_fma_f32 v[174:175], v[206:207], v[62:63], v[174:175] op_sel:[0,0,0] op_sel_hi:[1,0,1]
  v_pk_fma_f32 v[176:177], v[208:209], v[62:63], v[176:177] op_sel:[0,0,0] op_sel_hi:[1,0,1]
  v_pk_fma_f32 v[178:179], v[210:211], v[62:63], v[178:179] op_sel:[0,0,0] op_sel_hi:[1,0,1]
  v_pk_mul_f32 v[220:221], v[172:173], v[172:173] op_sel:[0,0] op_sel_hi:[1,1]
  v_pk_mul_f32 v[222:223], v[174:175], v[174:175] op_sel:[0,0] op_sel_hi:[1,1]
  v_pk_mul_f32 v[224:225], v[176:177], v[176:177] op_sel:[0,0] op_sel_hi:[1,1]
  v_pk_mul_f32 v[226:227], v[178:179], v[178:179] op_sel:[0,0] op_sel_hi:[1,1]
  v_pk_fma_f32 v[220:221], v[220:221], v[66:67], v[64:65] op_sel:[0,0,1] op_sel_hi:[1,0,1]
  v_pk_fma_f32 v[222:223], v[222:223], v[66:67], v[64:65] op_sel:[0,0,1] op_sel_hi:[1,0,1]
  v_pk_fma_f32 v[224:225], v[224:225], v[66:67], v[64:65] op_sel:[0,0,1] op_sel_hi:[1,0,1]
  v_pk_fma_f32 v[226:227], v[226:227], v[66:67], v[64:65] op_sel:[0,0,1] op_sel_hi:[1,0,1]
  v_pk_mul_f32 v[220:221], v[220:221], v[172:173] op_sel:[0,0] op_sel_hi:[1,1]
  v_pk_mul_f32 v[222:223], v[222:223], v[174:175] op_sel:[0,0] op_sel_hi:[1,1]
  v_pk_mul_f32 v[224:225], v[224:225], v[176:177] op_sel:[0,0] op_sel_hi:[1,1]
  v_pk_mul_f32 v[226:227], v[226:227], v[178:179] op_sel:[0,0] op_sel_hi:[1,1]
  v_exp_f32 v220, v220
  v_exp_f32 v221, v221
  v_exp_f32 v222, v222
  v_exp_f32 v223, v223
  v_exp_f32 v224, v224
  v_exp_f32 v225, v225
  v_exp_f32 v226, v226
  v_exp_f32 v227, v227
  v_pk_fma_f32 v[220:221], v[220:221], v[64:65], v[64:65] op_sel:[0,0,0] op_sel_hi:[1,0,0]
  v_pk_fma_f32 v[222:223], v[222:223], v[64:65], v[64:65] op_sel:[0,0,0] op_sel_hi:[1,0,0]
  v_pk_fma_f32 v[224:225], v[224:225], v[64:65], v[64:65] op_sel:[0,0,0] op_sel_hi:[1,0,0]
  v_pk_fma_f32 v[226:227], v[226:227], v[64:65], v[64:65] op_sel:[0,0,0] op_sel_hi:[1,0,0]
  v_rcp_f32 v220, v220
  v_rcp_f32 v221, v221
  v_rcp_f32 v222, v222
  v_rcp_f32 v223, v223
  v_rcp_f32 v224, v224
  v_rcp_f32 v225, v225
  v_rcp_f32 v226, v226
  v_rcp_f32 v227, v227
  v_pk_mul_f32 v[172:173], v[172:173], v[220:221] op_sel:[0,0] op_sel_hi:[1,1]
  v_pk_mul_f32 v[174:175], v[174:175], v[222:223] op_sel:[0,0] op_sel_hi:[1,1]
  v_pk_mul_f32 v[176:177], v[176:177], v[224:225] op_sel:[0,0] op_sel_hi:[1,1]
  v_pk_mul_f32 v[178:179], v[178:179], v[226:227] op_sel:[0,0] op_sel_hi:[1,1]
  v_cvt_pk_bf16_f32 v196, v172, v173
  v_cvt_pk_bf16_f32 v197, v174, v175
  v_cvt_pk_bf16_f32 v198, v176, v177
  v_cvt_pk_bf16_f32 v199, v178, v179
  buffer_store_dwordx4 v[196:199], v2, s[8:11], s101 offen offset:0 sc1
  v_pk_fma_f32 v[180:181], v[212:213], v[62:63], v[180:181] op_sel:[0,0,0] op_sel_hi:[1,0,1]
  v_pk_fma_f32 v[182:183], v[214:215], v[62:63], v[182:183] op_sel:[0,0,0] op_sel_hi:[1,0,1]
  v_pk_fma_f32 v[184:185], v[216:217], v[62:63], v[184:185] op_sel:[0,0,0] op_sel_hi:[1,0,1]
  v_pk_fma_f32 v[186:187], v[218:219], v[62:63], v[186:187] op_sel:[0,0,0] op_sel_hi:[1,0,1]
  v_pk_mul_f32 v[228:229], v[180:181], v[180:181] op_sel:[0,0] op_sel_hi:[1,1]
  v_pk_mul_f32 v[230:231], v[182:183], v[182:183] op_sel:[0,0] op_sel_hi:[1,1]
  v_pk_mul_f32 v[232:233], v[184:185], v[184:185] op_sel:[0,0] op_sel_hi:[1,1]
  v_pk_mul_f32 v[234:235], v[186:187], v[186:187] op_sel:[0,0] op_sel_hi:[1,1]
  v_pk_fma_f32 v[228:229], v[228:229], v[66:67], v[64:65] op_sel:[0,0,1] op_sel_hi:[1,0,1]
  v_pk_fma_f32 v[230:231], v[230:231], v[66:67], v[64:65] op_sel:[0,0,1] op_sel_hi:[1,0,1]
  v_pk_fma_f32 v[232:233], v[232:233], v[66:67], v[64:65] op_sel:[0,0,1] op_sel_hi:[1,0,1]
  v_pk_fma_f32 v[234:235], v[234:235], v[66:67], v[64:65] op_sel:[0,0,1] op_sel_hi:[1,0,1]
  v_pk_mul_f32 v[228:229], v[228:229], v[180:181] op_sel:[0,0] op_sel_hi:[1,1]
  v_pk_mul_f32 v[230:231], v[230:231], v[182:183] op_sel:[0,0] op_sel_hi:[1,1]
  v_pk_mul_f32 v[232:233], v[232:233], v[184:185] op_sel:[0,0] op_sel_hi:[1,1]
  v_pk_mul_f32 v[234:235], v[234:235], v[186:187] op_sel:[0,0] op_sel_hi:[1,1]
  v_exp_f32 v228, v228
  v_exp_f32 v229, v229
  v_exp_f32 v230, v230
  v_exp_f32 v231, v231
  v_exp_f32 v232, v232
  v_exp_f32 v233, v233
  v_exp_f32 v234, v234
  v_exp_f32 v235, v235
  v_pk_fma_f32 v[228:229], v[228:229], v[64:65], v[64:65] op_sel:[0,0,0] op_sel_hi:[1,0,0]
  v_pk_fma_f32 v[230:231], v[230:231], v[64:65], v[64:65] op_sel:[0,0,0] op_sel_hi:[1,0,0]
  v_pk_fma_f32 v[232:233], v[232:233], v[64:65], v[64:65] op_sel:[0,0,0] op_sel_hi:[1,0,0]
  v_pk_fma_f32 v[234:235], v[234:235], v[64:65], v[64:65] op_sel:[0,0,0] op_sel_hi:[1,0,0]
  v_rcp_f32 v228, v228
  v_rcp_f32 v229, v229
  v_rcp_f32 v230, v230
  v_rcp_f32 v231, v231
  v_rcp_f32 v232, v232
  v_rcp_f32 v233, v233
  v_rcp_f32 v234, v234
  v_rcp_f32 v235, v235
  v_pk_mul_f32 v[180:181], v[180:181], v[228:229] op_sel:[0,0] op_sel_hi:[1,1]
  v_pk_mul_f32 v[182:183], v[182:183], v[230:231] op_sel:[0,0] op_sel_hi:[1,1]
  v_pk_mul_f32 v[184:185], v[184:185], v[232:233] op_sel:[0,0] op_sel_hi:[1,1]
  v_pk_mul_f32 v[186:187], v[186:187], v[234:235] op_sel:[0,0] op_sel_hi:[1,1]
  v_cvt_pk_bf16_f32 v200, v180, v181
  v_cvt_pk_bf16_f32 v201, v182, v183
  v_cvt_pk_bf16_f32 v202, v184, v185
  v_cvt_pk_bf16_f32 v203, v186, v187
  buffer_store_dwordx4 v[200:203], v2, s[8:11], s101 offen offset:1024 sc1
  s_cmp_eq_u32 s71, 0
  s_cbranch_scc1 SLOW_TGC
RET_TGC:
  s_mov_b32 s70, s71
  s_barrier
  s_waitcnt vmcnt(36)
  ds_read_b128 a[32:35], v26 offset:16384
  ds_read_b128 a[36:39], v27 offset:16384
  ds_read_b128 a[40:43], v28 offset:16384
  ds_read_b128 a[44:47], v29 offset:16384
  s_waitcnt vmcnt(31)
  ds_read_b128 a[160:163], v26 offset:49152
  ds_read_b128 a[164:167], v27 offset:49152
  ds_read_b128 a[168:171], v28 offset:49152
  ds_read_b128 a[172:175], v29 offset:49152
  s_waitcnt vmcnt(23)
  ds_read_b128 a[48:51], v26 offset:0
  ds_read_b128 a[52:55], v27 offset:0
  ds_read_b128 a[56:59], v28 offset:0
  ds_read_b128 a[60:63], v29 offset:0
  s_waitcnt vmcnt(14)
  ds_read_b128 a[176:179], v30 offset:0
  ds_read_b128 a[180:183], v31 offset:0
  ds_read_b128 a[184:187], v32 offset:0
  ds_read_b128 a[188:191], v33 offset:0
  s_waitcnt lgkmcnt(12)
  s_add_u32 m0, s72, 16384
  s_add_u32 s73, s1, 6
  s_and_b32 s73, s73, 7
  s_mul_i32 s73, s73, 128
  s_add_u32 s73, s73, s79
  buffer_load_dwordx4 v5, s[32:35], s73 offen offset:0 lds
  buffer_load_dwordx4 v6, s[32:35], s73 offen offset:1024 lds
  buffer_load_dwordx4 v7, s[32:35], s73 offen offset:2048 lds
  buffer_load_dwordx4 v8, s[32:35], s73 offen offset:3072 lds
  s_waitcnt lgkmcnt(8)
  s_add_u32 m0, s72, 49152
  s_add_u32 s73, s1, 6
  s_and_b32 s73, s73, 7
  s_mul_i32 s73, s73, 128
  s_add_u32 s73, s73, s78
  buffer_load_dwordx4 v5, s[32:35], s73 offen offset:0 lds
  buffer_load_dwordx4 v6, s[32:35], s73 offen offset:1024 lds
  buffer_load_dwordx4 v7, s[32:35], s73 offen offset:2048 lds
  buffer_load_dwordx4 v8, s[32:35], s73 offen offset:3072 lds
  s_waitcnt lgkmcnt(4)
  s_add_u32 m0, s72, 0
  s_add_u32 s73, s1, 7
  s_and_b32 s73, s73, 7
  s_mul_i32 s73, s73, 128
  s_add_u32 s73, s73, s79
  buffer_load_dwordx4 v5, s[32:35], s73 offen offset:0 lds
  buffer_load_dwordx4 v6, s[32:35], s73 offen offset:1024 lds
  buffer_load_dwordx4 v7, s[32:35], s73 offen offset:2048 lds
  buffer_load_dwordx4 v8, s[32:35], s73 offen offset:3072 lds
  s_waitcnt lgkmcnt(0)
  s_add_u32 m0, s72, 65536
  s_add_u32 s73, s1, 7
  s_and_b32 s73, s73, 7
  s_mul_i32 s73, s73, 128
  s_add_u32 s73, s73, s78
  buffer_load_dwordx4 v5, s[32:35], s73 offen offset:0 lds
  buffer_load_dwordx4 v6, s[32:35], s73 offen offset:1024 lds
  buffer_load_dwordx4 v7, s[32:35], s73 offen offset:2048 lds
  buffer_load_dwordx4 v8, s[32:35], s73 offen offset:3072 lds
  s_mul_i32 s91, s83, 3
  s_add_u32 s91, s91, 1
  s_cmp_eq_u32 s83, 7
  s_cselect_b32 s91, 0, s91
  s_cselect_b32 s75, 0, 128
  s_lshl_b32 s74, s91, 7
  s_lshl_b32 s73, s44, 5
  s_add_u32 s74, s74, s73
  s_add_u32 s40, s74, 4224
  s_add_u32 s41, s40, s75
  s_add_u32 s42, s41, s75
  s_buffer_load_dwordx8 s[48:55], s[8:11], s40
  s_buffer_load_dwordx8 s[56:63], s[8:11], s41
  s_buffer_load_dwordx8 s[24:31], s[8:11], s42
  s_waitcnt lgkmcnt(0)
  s_cmp_eq_u32 s83, 7
  s_cbranch_scc1 LIGHT
PHASE2:
  s_xor_b64 s[48:49], s[48:49], s[70:71]
  s_xor_b64 s[50:51], s[50:51], s[70:71]
  s_xor_b64 s[52:53], s[52:53], s[70:71]
  s_xor_b64 s[54:55], s[54:55], s[70:71]
  s_xor_b64 s[56:57], s[56:57], s[70:71]
  s_xor_b64 s[58:59], s[58:59], s[70:71]
  s_xor_b64 s[60:61], s[60:61], s[70:71]
  s_xor_b64 s[62:63], s[62:63], s[70:71]
  s_xor_b64 s[24:25], s[24:25], s[70:71]
  s_xor_b64 s[26:27], s[26:27], s[70:71]
  s_xor_b64 s[28:29], s[28:29], s[70:71]
  s_xor_b64 s[30:31], s[30:31], s[70:71]
  s_or_b64 s[48:49], s[48:49], s[50:51]
  s_or_b64 s[52:53], s[52:53], s[54:55]
  s_or_b64 s[56:57], s[56:57], s[58:59]
  s_or_b64 s[60:61], s[60:61], s[62:63]
  s_or_b64 s[24:25], s[24:25], s[26:27]
  s_or_b64 s[28:29], s[28:29], s[30:31]
  s_or_b64 s[48:49], s[48:49], s[52:53]
  s_or_b64 s[56:57], s[56:57], s[60:61]
  s_or_b64 s[24:25], s[24:25], s[28:29]
  s_or_b64 s[48:49], s[48:49], s[56:57]
  s_or_b64 s[48:49], s[48:49], s[24:25]
  s_cbranch_scc1 SLOW_F1
RET_F1:
  s_mov_b32 s73, s91
  s_lshl_b32 s91, s73, 17
  s_lshl_b32 s74, s44, 15
  s_add_u32 s91, s91, s74
  s_add_u32 s91, s91, 12582912
  s_lshl_b32 s75, s96, 8
  v_xor_b32_e64 v5, s75, v2
  s_add_u32 s75, s1, 0
  s_and_b32 s75, s75, 7
  s_mul_i32 s75, s75, 4096
  s_add_u32 s75, s75, s91
  buffer_load_dwordx4 v[128:131], v5, s[8:11], s75 offen offset:0 sc1
  buffer_load_dwordx4 v[132:135], v5, s[8:11], s75 offen offset:1024 sc1
  buffer_load_dwordx4 v[136:139], v5, s[8:11], s75 offen offset:2048 sc1
  buffer_load_dwordx4 v[140:143], v5, s[8:11], s75 offen offset:3072 sc1
  s_lshl_b32 s73, s73, 1
  s_add_u32 s73, s73, s96
  s_lshl_b32 s74, s47, 1
  s_add_u32 s74, s74, s95
  s_mul_i32 s76, s74, 43
  s_add_u32 s75, s76, s73
  s_lshl_b32 s75, s75, 10
  s_add_u32 s92, s75, 9436160
  s_add_u32 s93, s75, 6290432
  s_cmp_eq_u32 s73, 0
  s_cselect_b32 s92, 2130706432, s92
  s_cselect_b32 s93, 2130706432, s93
  s_lshl_b32 s75, s74, 6
  v_and_b32 v44, 31, v1
  v_lshlrev_b32 v44, 1, v44
  buffer_load_ushort v6, v44, s[36:39], s75 offen
  s_lshl_b32 s76, s76, 10
  s_add_u32 s77, s76, 9437184
  s_mul_i32 s75, s96, 24576
  s_add_u32 s75, s75, s77
  s_add_u32 s64, s75, 1024
  s_add_u32 s65, s64, 6144
  s_add_u32 s66, s64, 12288
  s_add_u32 s67, s64, 18432
  s_cmp_eq_u32 s96, 1
  s_cselect_b32 s77, s77, s67
  s_cselect_b32 s67, 2130706432, s67
  s_lshl_b32 s74, s74, 15
  s_lshl_b32 s75, s96, 14
  s_add_u32 s74, s74, s75
  s_add_u32 s78, s74, 4194304
  s_add_u32 s79, s78, 4096
  s_add_u32 s80, s78, 8192
  s_add_u32 s81, s78, 12288
  s_lshl_b32 s94, s83, 7
  s_lshl_b32 s97, s47, 16
  s_add_u32 s82, s97, s94
  s_lshl_b32 s73, s47, 7
  s_add_u32 s40, s73, 16384
  s_lshl_b32 s74, s96, 6
  s_add_u32 s74, s74, s73
  s_add_u32 s41, s74, 24576
  s_lshl_b32 s74, s95, 6
  s_add_u32 s73, s73, s74
  s_add_u32 s42, s73, 32768
  s_xor_b32 s73, s44, 1
  s_mul_i32 s73, s73, 6144
  s_add_u32 s73, s73, 139264
  v_add_u32 v7, s73, v2
  s_xor_b32 s73, s44, 2
  s_mul_i32 s73, s73, 6144
  s_add_u32 s73, s73, 141312
  v_add_u32 v8, s73, v2
  s_xor_b32 s73, s44, 3
  s_mul_i32 s73, s73, 6144
  s_add_u32 s73, s73, 143360
  v_add_u32_e64 v9, s73, v2
  s_mul_i32 s73, s44, 6144
  s_add_u32 s73, s73, 139264
  v_add_u32 v10, s73, v2
  v_lshrrev_b32 v44, 3, v1
  v_bfe_u32 v45, v1, 4, 1
  v_lshlrev_b32 v45, 2, v45
  v_and_b32 v46, 7, v1
  v_xor_b32 v45, v45, v46
  v_lshlrev_b32 v45, 4, v45
  v_lshl_add_u32 v13, v44, 10, v45
  v_add_u32 v14, 7168, v13
  v_add_u32 v15, 14336, v13
  v_add_u32 v16, 21504, v13
  s_add_u32 s75, s1, 1
  s_and_b32 s75, s75, 7
  s_mul_i32 s75, s75, 4096
  s_add_u32 s75, s75, s91
  buffer_load_dwordx4 v[144:147], v5, s[8:11], s75 offen offset:0 sc1
  buffer_load_dwordx4 v[148:151], v5, s[8:11], s75 offen offset:1024 sc1
  buffer_load_dwordx4 v[152:155], v5, s[8:11], s75 offen offset:2048 sc1
  buffer_load_dwordx4 v[156:159], v5, s[8:11], s75 offen offset:3072 sc1
  s_waitcnt vmcnt(25)
  s_lshr_b32 s74, s90, 1
  s_lshl_b32 s74, s74, 7
  s_lshl_b32 s73, s46, 3
  s_add_u32 s74, s74, s73
  s_lshl_b32 s73, s96, 2
  s_add_u32 s74, s74, s73
  s_add_u32 s74, s74, 16384
  v_mov_b32 v3, s71
  s_mov_b64 exec, 1
  buffer_store_dword v3, off, s[8:11], s74 sc1
  s_mov_b64 exec, -1
  s_add_u32 s75, s1, 2
  s_and_b32 s75, s75, 7
  s_mul_i32 s75, s75, 4096
  s_add_u32 s75, s75, s91
  buffer_load_dwordx4 v[160:163], v5, s[8:11], s75 offen offset:0 sc1
  buffer_load_dwordx4 v[164:167], v5, s[8:11], s75 offen offset:1024 sc1
  buffer_load_dwordx4 v[168:171], v5, s[8:11], s75 offen offset:2048 sc1
  buffer_load_dwordx4 v[172:175], v5, s[8:11], s75 offen offset:3072 sc1
  s_add_u32 s75, s1, 3
  s_and_b32 s75, s75, 7
  s_mul_i32 s75, s75, 4096
  s_add_u32 s75, s75, s91
  buffer_load_dwordx4 v[176:179], v5, s[8:11], s75 offen offset:0 sc1
  buffer_load_dwordx4 v[180:183], v5, s[8:11], s75 offen offset:1024 sc1
  s_waitcnt vmcnt(15)
  v_mfma_f32_32x32x16_bf16 v[64:79], v[128:131], a[0:3], 0
  v_mfma_f32_32x32x16_bf16 v[80:95], v[128:131], a[128:131], 0
  buffer_load_dwordx4 v[128:131], v5, s[8:11], s75 offen offset:2048 sc1
  s_waitcnt vmcnt(15)
  v_mfma_f32_32x32x16_bf16 v[64:79], v[132:135], a[4:7], v[64:79]
  v_mfma_f32_32x32x16_bf16 v[80:95], v[132:135], a[132:135], v[80:95]
  buffer_load_dwordx4 v[132:135], v5, s[8:11], s75 offen offset:3072 sc1
  s_waitcnt vmcnt(15)
  v_mfma_f32_32x32x16_bf16 v[64:79], v[136:139], a[8:11], v[64:79]
  v_mfma_f32_32x32x16_bf16 v[80:95], v[136:139], a[136:139], v[80:95]
  s_add_u32 s75, s1, 4
  s_and_b32 s75, s75, 7
  s_mul_i32 s75, s75, 4096
  s_add_u32 s75, s75, s91
  buffer_load_dwordx4 v[136:139], v5, s[8:11], s75 offen offset:0 sc1
  ds_read_b128 a[64:67], v26 offset:32768
  ds_read_b128 a[68:71], v27 offset:32768
  ds_read_b128 a[72:75], v28 offset:32768
  ds_read_b128 a[76:79], v29 offset:32768
  s_waitcnt vmcnt(15)
  v_mfma_f32_32x32x16_bf16 v[64:79], v[140:143], a[12:15], v[64:79]
  v_mfma_f32_32x32x16_bf16 v[80:95], v[140:143], a[140:143], v[80:95]
  buffer_load_dwordx4 v[140:143], v5, s[8:11], s75 offen offset:1024 sc1
  ds_read_b128 a[192:195], v30 offset:32768
  ds_read_b128 a[196:199], v31 offset:32768
  ds_read_b128 a[200:203], v32 offset:32768
  ds_read_b128 a[204:207], v33 offset:32768
  s_waitcnt vmcnt(14)
  v_mfma_f32_32x32x16_bf16 v[64:79], v[144:147], a[16:19], v[64:79]
  v_mfma_f32_32x32x16_bf16 v[80:95], v[144:147], a[144:147], v[80:95]
  buffer_load_dwordx4 v[144:147], v5, s[8:11], s75 offen offset:2048 sc1
  ds_read_b128 a[80:83], v30 offset:49152
  ds_read_b128 a[84:87], v31 offset:49152
  ds_read_b128 a[88:91], v32 offset:49152
  ds_read_b128 a[92:95], v33 offset:49152
  s_waitcnt vmcnt(14)
  v_mfma_f32_32x32x16_bf16 v[64:79], v[148:151], a[20:23], v[64:79]
  v_mfma_f32_32x32x16_bf16 v[80:95], v[148:151], a[148:151], v[80:95]
  buffer_load_dwordx4 v[148:151], v5, s[8:11], s75 offen offset:3072 sc1
  ds_read_b128 a[208:211], v30 offset:16384
  ds_read_b128 a[212:215], v31 offset:16384
  ds_read_b128 a[216:219], v32 offset:16384
  ds_read_b128 a[220:223], v33 offset:16384
  s_waitcnt vmcnt(14)
  v_mfma_f32_32x32x16_bf16 v[64:79], v[152:155], a[24:27], v[64:79]
  v_mfma_f32_32x32x16_bf16 v[80:95], v[152:155], a[152:155], v[80:95]
  s_add_u32 s75, s1, 5
  s_and_b32 s75, s75, 7
  s_mul_i32 s75, s75, 4096
  s_add_u32 s75, s75, s91
  buffer_load_dwordx4 v[152:155], v5, s[8:11], s75 offen offset:0 sc1
  s_waitcnt vmcnt(14)
  v_mfma_f32_32x32x16_bf16 v[64:79], v[156:159], a[28:31], v[64:79]
  v_mfma_f32_32x32x16_bf16 v[80:95], v[156:159], a[156:159], v[80:95]
  buffer_load_dwordx4 v[156:159], v5, s[8:11], s75 offen offset:1024 sc1
  s_waitcnt vmcnt(13)
  v_mfma_f32_32x32x16_bf16 v[64:79], v[160:163], a[32:35], v[64:79]
  v_mfma_f32_32x32x16_bf16 v[80:95], v[160:163], a[160:163], v[80:95]
  buffer_load_dwordx4 v[160:163], v5, s[8:11], s75 offen offset:2048 sc1
  s_waitcnt vmcnt(13)
  v_mfma_f32_32x32x16_bf16 v[64:79], v[164:167], a[36:39], v[64:79]
  v_mfma_f32_32x32x16_bf16 v[80:95], v[164:167], a[164:167], v[80:95]
  buffer_load_dwordx4 v[164:167], v5, s[8:11], s75 offen offset:3072 sc1
  s_waitcnt vmcnt(13)
  v_mfma_f32_32x32x16_bf16 v[64:79], v[168:171], a[40:43], v[64:79]
  v_mfma_f32_32x32x16_bf16 v[80:95], v[168:171], a[168:171], v[80:95]
  s_add_u32 s75, s1, 6
  s_and_b32 s75, s75, 7
  s_mul_i32 s75, s75, 4096
  s_add_u32 s75, s75, s91
  buffer_load_dwordx4 v[168:171], v5, s[8:11], s75 offen offset:0 sc1
  s_waitcnt vmcnt(13)
  v_mfma_f32_32x32x16_bf16 v[64:79], v[172:175], a[44:47], v[64:79]
  v_mfma_f32_32x32x16_bf16 v[80:95], v[172:175], a[172:175], v[80:95]
  buffer_load_dwordx4 v[172:175], v5, s[8:11], s75 offen offset:1024 sc1
  s_waitcnt vmcnt(13)
  v_mfma_f32_32x32x16_bf16 v[64:79], v[176:179], a[48:51], v[64:79]
  v_mfma_f32_32x32x16_bf16 v[80:95], v[176:179], a[176:179], v[80:95]
  buffer_load_dwordx4 v[176:179], v5, s[8:11], s75 offen offset:2048 sc1
  s_waitcnt vmcnt(13)
  v_mfma_f32_32x32x16_bf16 v[64:79], v[180:183], a[52:55], v[64:79]
  v_mfma_f32_32x32x16_bf16 v[80:95], v[180:183], a[180:183], v[80:95]
  buffer_load_dwordx4 v[180:183], v5, s[8:11], s75 offen offset:3072 sc1
  s_waitcnt vmcnt(13)
  v_mfma_f32_32x32x16_bf16 v[64:79], v[128:131], a[56:59], v[64:79]
  v_mfma_f32_32x32x16_bf16 v[80:95], v[128:131], a[184:187], v[80:95]
  s_add_u32 s75, s1, 7
  s_and_b32 s75, s75, 7
  s_mul_i32 s75, s75, 4096
  s_add_u32 s75, s75, s91
  buffer_load_dwordx4 v[128:131], v5, s[8:11], s75 offen offset:0 sc1
  ds_read_b128 a[96:99], v26 offset:16384
  ds_read_b128 a[100:103], v27 offset:16384
  ds_read_b128 a[104:107], v28 offset:16384
  ds_read_b128 a[108:111], v29 offset:16384
  s_waitcnt vmcnt(13)
  v_mfma_f32_32x32x16_bf16 v[64:79], v[132:135], a[60:63], v[64:79]
  v_mfma_f32_32x32x16_bf16 v[80:95], v[132:135], a[188:191], v[80:95]
  buffer_load_dwordx4 v[132:135], v5, s[8:11], s75 offen offset:1024 sc1
  ds_read_b128 a[224:227], v26 offset:49152
  ds_read_b128 a[228:231], v27 offset:49152
  ds_read_b128 a[232:235], v28 offset:49152
  ds_read_b128 a[236:239], v29 offset:49152
  s_waitcnt vmcnt(13) lgkmcnt(15)
  v_mfma_f32_32x32x16_bf16 v[64:79], v[136:139], a[64:67], v[64:79]
  v_mfma_f32_32x32x16_bf16 v[80:95], v[136:139], a[192:195], v[80:95]
  buffer_load_dwordx4 v[136:139], v5, s[8:11], s75 offen offset:2048 sc1
  ds_read_b128 a[112:115], v26 offset:0
  ds_read_b128 a[116:119], v27 offset:0
  ds_read_b128 a[120:123], v28 offset:0
  ds_read_b128 a[124:127], v29 offset:0
  s_waitcnt vmcnt(13)
  v_mfma_f32_32x32x16_bf16 v[64:79], v[140:143], a[68:71], v[64:79]
  v_mfma_f32_32x32x16_bf16 v[80:95], v[140:143], a[196:199], v[80:95]
  buffer_load_dwordx4 v[140:143], v5, s[8:11], s75 offen offset:3072 sc1
  ds_read_b128 a[240:243], v30 offset:0
  ds_read_b128 a[244:247], v31 offset:0
  ds_read_b128 a[248:251], v32 offset:0
  ds_read_b128 a[252:255], v33 offset:0
  s_waitcnt vmcnt(13)
  v_mfma_f32_32x32x16_bf16 v[64:79], v[144:147], a[72:75], v[64:79]
  v_mfma_f32_32x32x16_bf16 v[80:95], v[144:147], a[200:203], v[80:95]
  s_add_u32 s75, s1, 0
  s_and_b32 s75, s75, 7
  s_mul_i32 s75, s75, 4096
  s_add_u32 s75, s75, s91
  s_add_u32 s75, s75, 131072
  buffer_load_dwordx4 v[144:147], v5, s[8:11], s75 offen offset:0 sc1
  s_waitcnt vmcnt(13)
  v_mfma_f32_32x32x16_bf16 v[64:79], v[148:151], a[76:79], v[64:79]
  v_mfma_f32_32x32x16_bf16 v[80:95], v[148:151], a[204:207], v[80:95]
  buffer_load_dwordx4 v[148:151], v5, s[8:11], s75 offen offset:1024 sc1
  s_waitcnt vmcnt(13)
  v_mfma_f32_32x32x16_bf16 v[64:79], v[152:155], a[80:83], v[64:79]
  s_waitcnt lgkmcnt(15)
  v_mfma_f32_32x32x16_bf16 v[80:95], v[152:155], a[208:211], v[80:95]
  buffer_load_dwordx4 v[152:155], v5, s[8:11], s75 offen offset:2048 sc1
  s_waitcnt vmcnt(13)
  v_mfma_f32_32x32x16_bf16 v[64:79], v[156:159], a[84:87], v[64:79]
  v_mfma_f32_32x32x16_bf16 v[80:95], v[156:159], a[212:215], v[80:95]
  buffer_load_dwordx4 v[156:159], v5, s[8:11], s75 offen offset:3072 sc1
  s_waitcnt vmcnt(13)
  v_mfma_f32_32x32x16_bf16 v[64:79], v[160:163], a[88:91], v[64:79]
  v_mfma_f32_32x32x16_bf16 v[80:95], v[160:163], a[216:219], v[80:95]
  s_add_u32 s75, s1, 1
  s_and_b32 s75, s75, 7
  s_mul_i32 s75, s75, 4096
  s_add_u32 s75, s75, s91
  s_add_u32 s75, s75, 131072
  buffer_load_dwordx4 v[160:163], v5, s[8:11], s75 offen offset:0 sc1
  s_waitcnt vmcnt(13)
  v_mfma_f32_32x32x16_bf16 v[64:79], v[164:167], a[92:95], v[64:79]
  v_mfma_f32_32x32x16_bf16 v[80:95], v[164:167], a[220:223], v[80:95]
  buffer_load_dwordx4 v[164:167], v5, s[8:11], s75 offen offset:1024 sc1
  s_waitcnt vmcnt(13)
  v_mfma_f32_32x32x16_bf16 v[64:79], v[168:171], a[96:99], v[64:79]
  s_waitcnt lgkmcnt(11)
  v_mfma_f32_32x32x16_bf16 v[80:95], v[168:171], a[224:227], v[80:95]
  buffer_load_dwordx4 v[168:171], v5, s[8:11], s75 offen offset:2048 sc1
  s_waitcnt vmcnt(13)
  v_mfma_f32_32x32x16_bf16 v[64:79], v[172:175], a[100:103], v[64:79]
  s_waitcnt lgkmcnt(10)
  v_mfma_f32_32x32x16_bf16 v[80:95], v[172:175], a[228:231], v[80:95]
  buffer_load_dwordx4 v[172:175], v5, s[8:11], s75 offen offset:3072 sc1
  s_waitcnt vmcnt(13)
  v_mfma_f32_32x32x16_bf16 v[64:79], v[176:179], a[104:107], v[64:79]
  s_waitcnt lgkmcnt(9)
  v_mfma_f32_32x32x16_bf16 v[80:95], v[176:179], a[232:235], v[80:95]
  s_add_u32 s75, s1, 2
  s_and_b32 s75, s75, 7
  s_mul_i32 s75, s75, 4096
  s_add_u32 s75, s75, s91
  s_add_u32 s75, s75, 131072
  buffer_load_dwordx4 v[176:179], v5, s[8:11], s75 offen offset:0 sc1
  s_waitcnt vmcnt(13)
  v_mfma_f32_32x32x16_bf16 v[64:79], v[180:183], a[108:111], v[64:79]
  s_waitcnt lgkmcnt(8)
  v_mfma_f32_32x32x16_bf16 v[80:95], v[180:183], a[236:239], v[80:95]
  buffer_load_dwordx4 v[180:183], v5, s[8:11], s75 offen offset:1024 sc1
  s_waitcnt vmcnt(13) lgkmcnt(7)
  v_mfma_f32_32x32x16_bf16 v[64:79], v[128:131], a[112:115], v[64:79]
  s_waitcnt lgkmcnt(3)
  v_mfma_f32_32x32x16_bf16 v[80:95], v[128:131], a[240:243], v[80:95]
  buffer_load_dwordx4 v[128:131], v5, s[8:11], s75 offen offset:2048 sc1
  s_waitcnt vmcnt(13)
  v_mfma_f32_32x32x16_bf16 v[64:79], v[132:135], a[116:119], v[64:79]
  s_waitcnt lgkmcnt(2)
  v_mfma_f32_32x32x16_bf16 v[80:95], v[132:135], a[244:247], v[80:95]
  buffer_load_dwordx4 v[132:135], v5, s[8:11], s75 offen offset:3072 sc1
  s_waitcnt vmcnt(13)
  v_mfma_f32_32x32x16_bf16 v[64:79], v[136:139], a[120:123], v[64:79]
  s_waitcnt lgkmcnt(1)
  v_mfma_f32_32x32x16_bf16 v[80:95], v[136:139], a[248:251], v[80:95]
  s_add_u32 s75, s1, 3
  s_and_b32 s75, s75, 7
  s_mul_i32 s75, s75, 4096
  s_add_u32 s75, s75, s91
  s_add_u32 s75, s75, 131072
  buffer_load_dwordx4 v[136:139], v5, s[8:11], s75 offen offset:0 sc1
  s_barrier
  v_lshlrev_b32_e64 v6, 16, v6
  s_waitcnt vmcnt(13)
  v_mfma_f32_32x32x16_bf16 v[64:79], v[140:143], a[124:127], v[64:79]
  s_waitcnt lgkmcnt(0)
  v_mfma_f32_32x32x16_bf16 v[80:95], v[140:143], a[252:255], v[80:95]
  buffer_load_dwordx4 v[140:143], v5, s[8:11], s75 offen offset:1024 sc1
  s_waitcnt vmcnt(13)
  v_mfma_f32_32x32x16_bf16 v[96:111], v[144:147], a[0:3], 0
  v_mfma_f32_32x32x16_bf16 v[112:127], v[144:147], a[128:131], 0
  buffer_load_dwordx4 v[144:147], v5, s[8:11], s75 offen offset:2048 sc1
  s_waitcnt vmcnt(13)
  v_mfma_f32_32x32x16_bf16 v[96:111], v[148:151], a[4:7], v[96:111]
  v_mfma_f32_32x32x16_bf16 v[112:127], v[148:151], a[132:135], v[112:127]
  buffer_load_dwordx4 v[148:151], v5, s[8:11], s75 offen offset:3072 sc1
  s_buffer_load_dwordx16 s[48:63], s[8:11], s40
  s_buffer_load_dwordx16 s[24:39], s[8:11], s40 offset:64
  ds_write_b128 v7, v[72:75] offset:0
  ds_write_b128 v7, v[76:79] offset:1024
  ds_write_b128 v8, v[80:83] offset:0
  ds_write_b128 v8, v[84:87] offset:1024
  ds_write_b128 v9, v[88:91] offset:0
  ds_write_b128 v9, v[92:95] offset:1024
  s_waitcnt vmcnt(13)
  v_mfma_f32_32x32x16_bf16 v[96:111], v[152:155], a[8:11], v[96:111]
  v_mfma_f32_32x32x16_bf16 v[112:127], v[152:155], a[136:139], v[112:127]
  s_add_u32 s75, s1, 4
  s_and_b32 s75, s75, 7
  s_mul_i32 s75, s75, 4096
  s_add_u32 s75, s75, s91
  s_add_u32 s75, s75, 131072
  buffer_load_dwordx4 v[152:155], v5, s[8:11], s75 offen offset:0 sc1
  s_waitcnt vmcnt(13)
  v_mfma_f32_32x32x16_bf16 v[96:111], v[156:159], a[12:15], v[96:111]
  v_mfma_f32_32x32x16_bf16 v[112:127], v[156:159], a[140:143], v[112:127]
  buffer_load_dwordx4 v[156:159], v5, s[8:11], s75 offen offset:1024 sc1
  s_waitcnt vmcnt(13)
  v_mfma_f32_32x32x16_bf16 v[96:111], v[160:163], a[16:19], v[96:111]
  v_mfma_f32_32x32x16_bf16 v[112:127], v[160:163], a[144:147], v[112:127]
  buffer_load_dwordx4 v[160:163], v5, s[8:11], s75 offen offset:2048 sc1
  s_waitcnt vmcnt(13)
  v_mfma_f32_32x32x16_bf16 v[96:111], v[164:167], a[20:23], v[96:111]
  v_mfma_f32_32x32x16_bf16 v[112:127], v[164:167], a[148:151], v[112:127]
  buffer_load_dwordx4 v[164:167], v5, s[8:11], s75 offen offset:3072 sc1
  s_waitcnt vmcnt(13)
  v_mfma_f32_32x32x16_bf16 v[96:111], v[168:171], a[24:27], v[96:111]
  v_mfma_f32_32x32x16_bf16 v[112:127], v[168:171], a[152:155], v[112:127]
  s_add_u32 s75, s1, 5
  s_and_b32 s75, s75, 7
  s_mul_i32 s75, s75, 4096
  s_add_u32 s75, s75, s91
  s_add_u32 s75, s75, 131072
  buffer_load_dwordx4 v[168:171], v5, s[8:11], s75 offen offset:0 sc1
  s_waitcnt vmcnt(13)
  v_mfma_f32_32x32x16_bf16 v[96:111], v[172:175], a[28:31], v[96:111]
  v_mfma_f32_32x32x16_bf16 v[112:127], v[172:175], a[156:159], v[112:127]
  buffer_load_dwordx4 v[172:175], v5, s[8:11], s75 offen offset:1024 sc1
  s_waitcnt vmcnt(13)
  v_mfma_f32_32x32x16_bf16 v[96:111], v[176:179], a[32:35], v[96:111]
  v_mfma_f32_32x32x16_bf16 v[112:127], v[176:179], a[160:163], v[112:127]
  buffer_load_dwordx4 v[176:179], v5, s[8:11], s75 offen offset:2048 sc1
  s_waitcnt lgkmcnt(0)
  s_barrier
  ds_read_b128 v[32:35], v10 offset:0
  ds_read_b128 v[36:39], v10 offset:1024
  ds_read_b128 v[40:43], v10 offset:2048
  ds_read_b128 v[44:47], v10 offset:3072
  ds_read_b128 v[48:51], v10 offset:4096
  ds_read_b128 v[52:55], v10 offset:5120
  s_waitcnt vmcnt(13)
  v_mfma_f32_32x32x16_bf16 v[96:111], v[180:183], a[36:39], v[96:111]
  v_mfma_f32_32x32x16_bf16 v[112:127], v[180:183], a[164:167], v[112:127]
  buffer_load_dwordx4 v[180:183], v5, s[8:11], s75 offen offset:3072 sc1
  s_waitcnt vmcnt(13)
  v_mfma_f32_32x32x16_bf16 v[96:111], v[128:131], a[40:43], v[96:111]
  v_add_f32 v56, v64, v6
  v_add_f32 v57, v65, v6
  v_add_f32 v58, v66, v6
  v_add_f32 v59, v67, v6
  v_mfma_f32_32x32x16_bf16 v[112:127], v[128:131], a[168:171], v[112:127]
  s_add_u32 s75, s1, 6
  s_and_b32 s75, s75, 7
  s_mul_i32 s75, s75, 4096
  s_add_u32 s75, s75, s91
  s_add_u32 s75, s75, 131072
  buffer_load_dwordx4 v[128:131], v5, s[8:11], s75 offen offset:0 sc1
  s_waitcnt vmcnt(13)
  v_mfma_f32_32x32x16_bf16 v[96:111], v[132:135], a[44:47], v[96:111]
  v_add_f32 v60, v68, v6
  v_add_f32 v61, v69, v6
  v_add_f32 v62, v70, v6
  v_add_f32 v63, v71, v6
  v_mfma_f32_32x32x16_bf16 v[112:127], v[132:135], a[172:175], v[112:127]
  buffer_load_dwordx4 v[132:135], v5, s[8:11], s75 offen offset:1024 sc1
  s_waitcnt lgkmcnt(3)
  v_add_f32 v32, v32, v40
  v_add_f32 v33, v33, v41
  v_add_f32_e64 v34, v34, v42
  s_waitcnt vmcnt(13)
  v_mfma_f32_32x32x16_bf16 v[96:111], v[136:139], a[48:51], v[96:111]
  v_add_f32 v35, v35, v43
  s_waitcnt lgkmcnt(2)
  v_add_f32 v36, v36, v44
  v_add_f32 v37, v37, v45
  v_add_f32_e64 v38, v38, v46
  v_mfma_f32_32x32x16_bf16 v[112:127], v[136:139], a[176:179], v[112:127]
  buffer_load_dwordx4 v[136:139], v5, s[8:11], s75 offen offset:2048 sc1
  v_add_f32 v39, v39, v47
  s_waitcnt lgkmcnt(1)
  v_add_f32 v56, v56, v48
  v_add_f32_e64 v57, v57, v49
  s_waitcnt vmcnt(13)
  v_mfma_f32_32x32x16_bf16 v[96:111], v[140:143], a[52:55], v[96:111]
  v_add_f32 v58, v58, v50
  v_add_f32 v59, v59, v51
  s_waitcnt lgkmcnt(0)
  v_add_f32 v60, v60, v52
  v_add_f32_e64 v61, v61, v53
  v_mfma_f32_32x32x16_bf16 v[112:127], v[140:143], a[180:183], v[112:127]
  buffer_load_dwordx4 v[140:143], v5, s[8:11], s75 offen offset:3072 sc1
  s_xor_b64 s[48:49], s[48:49], s[70:71]
  s_xor_b64 s[50:51], s[50:51], s[70:71]
  s_xor_b64 s[52:53], s[52:53], s[70:71]
  s_xor_b64 s[54:55], s[54:55], s[70:71]
  s_xor_b64 s[56:57], s[56:57], s[70:71]
  s_xor_b64 s[58:59], s[58:59], s[70:71]
  s_xor_b64 s[60:61], s[60:61], s[70:71]
  s_xor_b64 s[62:63], s[62:63], s[70:71]
  s_xor_b64 s[24:25], s[24:25], s[70:71]
  s_xor_b64 s[26:27], s[26:27], s[70:71]
  s_xor_b64 s[28:29], s[28:29], s[70:71]
  s_xor_b64 s[30:31], s[30:31], s[70:71]
  s_xor_b64 s[32:33], s[32:33], s[70:71]
  s_xor_b64 s[34:35], s[34:35], s[70:71]
  s_xor_b64 s[36:37], s[36:37], s[70:71]
  s_xor_b64 s[38:39], s[38:39], s[70:71]
  s_or_b64 s[48:49], s[48:49], s[50:51]
  s_or_b64 s[52:53], s[52:53], s[54:55]
  s_or_b64 s[56:57], s[56:57], s[58:59]
  s_or_b64 s[60:61], s[60:61], s[62:63]
  s_or_b64 s[24:25], s[24:25], s[26:27]
  s_or_b64 s[28:29], s[28:29], s[30:31]
  s_or_b64 s[32:33], s[32:33], s[34:35]
  s_or_b64 s[36:37], s[36:37], s[38:39]
  s_or_b64 s[48:49], s[48:49], s[52:53]
  s_or_b64 s[56:57], s[56:57], s[60:61]
  s_or_b64 s[24:25], s[24:25], s[28:29]
  s_or_b64 s[32:33], s[32:33], s[36:37]
  s_or_b64 s[48:49], s[48:49], s[56:57]
  s_or_b64 s[24:25], s[24:25], s[32:33]
  s_or_b64 s[48:49], s[48:49], s[24:25]
  s_cbranch_scc1 SLOW_F2
RET_F2:
  s_lshl_b32 s73, s83, 2
  s_add_u32 s73, s73, s44
  s_lshl_b32 s98, s73, 11
  s_add_u32 s98, s98, 524288
  buffer_load_dwordx4 v[200:203], v2, s[8:11], s98 offen offset:0 sc1
  buffer_load_dwordx4 v[204:207], v2, s[8:11], s98 offen offset:1024 sc1
  s_lshl_b32 s73, s73, 10
  s_add_u32 s73, s73, s97
  s_add_u32 s100, s73, 4194304
  s_add_u32 s73, s73, 2097152
  buffer_load_dwordx4 v[192:195], v2, s[8:11], s73 offen sc1
  s_add_u32 s73, s73, 0x8000
  buffer_load_dwordx4 v[196:199], v2, s[8:11], s73 offen sc1
  buffer_load_dwordx4 v[20:23], v2, s[8:11], s93 offen offset:0 sc1
  buffer_load_dwordx4 v[24:27], v2, s[8:11], s93 offen offset:2048 sc1
  s_add_u32 s93, s93, 4096
  buffer_load_dwordx4 v[28:31], v2, s[8:11], s93 offen offset:0 sc1
  s_waitcnt vmcnt(20)
  v_mfma_f32_32x32x16_bf16 v[96:111], v[144:147], a[56:59], v[96:111]
  v_add_f32 v62, v62, v54
  v_add_f32 v63, v63, v55
  v_add_f32 v56, v56, v32
  v_add_f32 v57, v57, v33
  v_mfma_f32_32x32x16_bf16 v[112:127], v[144:147], a[184:187], v[112:127]
  s_add_u32 s75, s1, 7
  s_and_b32 s75, s75, 7
  s_mul_i32 s75, s75, 4096
  s_add_u32 s75, s75, s91
  s_add_u32 s75, s75, 131072
  buffer_load_dwordx4 v[144:147], v5, s[8:11], s75 offen offset:0 sc1
  s_waitcnt vmcnt(20)
  v_mfma_f32_32x32x16_bf16 v[96:111], v[148:151], a[60:63], v[96:111]
  v_add_f32 v58, v58, v34
  v_add_f32 v59, v59, v35
  v_add_f32 v60, v60, v36
  v_add_f32 v61, v61, v37
  v_mfma_f32_32x32x16_bf16 v[112:127], v[148:151], a[188:191], v[112:127]
  buffer_load_dwordx4 v[148:151], v5, s[8:11], s75 offen offset:1024 sc1
  v_add_f32 v62, v62, v38
  v_add_f32_e64 v63, v63, v39
  s_waitcnt vmcnt(20)
  v_mfma_f32_32x32x16_bf16 v[96:111], v[152:155], a[64:67], v[96:111]
  v_mfma_f32_32x32x16_bf16 v[112:127], v[152:155], a[192:195], v[112:127]
  buffer_load_dwordx4 v[152:155], v5, s[8:11], s75 offen offset:2048 sc1
  s_waitcnt vmcnt(20)
  v_mfma_f32_32x32x16_bf16 v[96:111], v[156:159], a[68:71], v[96:111]
  v_mfma_f32_32x32x16_bf16 v[112:127], v[156:159], a[196:199], v[112:127]
  buffer_load_dwordx4 v[156:159], v5, s[8:11], s75 offen offset:3072 sc1
  s_waitcnt vmcnt(20)
  v_mfma_f32_32x32x16_bf16 v[96:111], v[160:163], a[72:75], v[96:111]
  v_mfma_f32_32x32x16_bf16 v[112:127], v[160:163], a[200:203], v[112:127]
  s_add_u32 s75, s1, 0
  s_and_b32 s75, s75, 7
  s_mul_i32 s75, s75, 4096
  s_add_u32 s75, s75, s91
  s_add_u32 s75, s75, 262144
  buffer_load_dwordx4 v[160:163], v5, s[8:11], s75 offen offset:0 sc1
  s_waitcnt vmcnt(20)
  v_mfma_f32_32x32x16_bf16 v[96:111], v[164:167], a[76:79], v[96:111]
  v_mfma_f32_32x32x16_bf16 v[112:127], v[164:167], a[204:207], v[112:127]
  buffer_load_dwordx4 v[164:167], v5, s[8:11], s75 offen offset:1024 sc1
  s_waitcnt vmcnt(20)
  v_mfma_f32_32x32x16_bf16 v[96:111], v[168:171], a[80:83], v[96:111]
  v_mfma_f32_32x32x16_bf16 v[112:127], v[168:171], a[208:211], v[112:127]
  buffer_load_dwordx4 v[168:171], v5, s[8:11], s75 offen offset:2048 sc1
  s_waitcnt vmcnt(20)
  v_mfma_f32_32x32x16_bf16 v[96:111], v[172:175], a[84:87], v[96:111]
  v_mfma_f32_32x32x16_bf16 v[112:127], v[172:175], a[212:215], v[112:127]
  buffer_load_dwordx4 v[172:175], v5, s[8:11], s75 offen offset:3072 sc1
  s_waitcnt vmcnt(20)
  v_mfma_f32_32x32x16_bf16 v[96:111], v[176:179], a[88:91], v[96:111]
  v_mfma_f32_32x32x16_bf16 v[112:127], v[176:179], a[216:219], v[112:127]
  s_add_u32 s75, s1, 1
  s_and_b32 s75, s75, 7
  s_mul_i32 s75, s75, 4096
  s_add_u32 s75, s75, s91
  s_add_u32 s75, s75, 262144
  buffer_load_dwordx4 v[176:179], v5, s[8:11], s75 offen offset:0 sc1
  s_waitcnt vmcnt(20)
  v_mfma_f32_32x32x16_bf16 v[96:111], v[180:183], a[92:95], v[96:111]
  v_mfma_f32_32x32x16_bf16 v[112:127], v[180:183], a[220:223], v[112:127]
  buffer_load_dwordx4 v[180:183], v5, s[8:11], s75 offen offset:1024 sc1
  s_waitcnt vmcnt(20)
  v_mfma_f32_32x32x16_bf16 v[96:111], v[128:131], a[96:99], v[96:111]
  v_mfma_f32_32x32x16_bf16 v[112:127], v[128:131], a[224:227], v[112:127]
  buffer_load_dwordx4 v[128:131], v5, s[8:11], s75 offen offset:2048 sc1
  s_waitcnt vmcnt(20)
  v_mfma_f32_32x32x16_bf16 v[96:111], v[132:135], a[100:103], v[96:111]
  v_mfma_f32_32x32x16_bf16 v[112:127], v[132:135], a[228:231], v[112:127]
  buffer_load_dwordx4 v[132:135], v5, s[8:11], s75 offen offset:3072 sc1
  s_waitcnt vmcnt(20)
  v_mfma_f32_32x32x16_bf16 v[96:111], v[136:139], a[104:107], v[96:111]
  v_mfma_f32_32x32x16_bf16 v[112:127], v[136:139], a[232:235], v[112:127]
  s_add_u32 s75, s1, 2
  s_and_b32 s75, s75, 7
  s_mul_i32 s75, s75, 4096
  s_add_u32 s75, s75, s91
  s_add_u32 s75, s75, 262144
  buffer_load_dwordx4 v[136:139], v5, s[8:11], s75 offen offset:0 sc1
  s_waitcnt vmcnt(20)
  v_mfma_f32_32x32x16_bf16 v[96:111], v[140:143], a[108:111], v[96:111]
  v_mfma_f32_32x32x16_bf16 v[112:127], v[140:143], a[236:239], v[112:127]
  buffer_load_dwordx4 v[140:143], v5, s[8:11], s75 offen offset:1024 sc1
  s_waitcnt vmcnt(13)
  v_mfma_f32_32x32x16_bf16 v[96:111], v[144:147], a[112:115], v[96:111]
  v_mfma_f32_32x32x16_bf16 v[112:127], v[144:147], a[240:243], v[112:127]
  buffer_load_dwordx4 v[144:147], v5, s[8:11], s75 offen offset:2048 sc1
  v_xor_b32 v201, s71, v201
  v_xor_b32 v203, s71, v203
  v_xor_b32 v205, s71, v205
  v_xor_b32_e64 v207, s71, v207
  v_or3_b32 v201, v201, v203, v205
  v_or_b32 v201, v201, v207
  v_cmp_ne_u32 vcc, 0, v201
  s_nop 0
  s_cbranch_vccnz SLOW_KVF
RET_KVF:
  v_mov_b32 v208, v200
  v_mov_b32 v209, v202
  v_mov_b32 v210, v204
  v_mov_b32_e64 v211, v206
  s_nop 1
  v_mfma_f32_32x32x16_bf16 v[212:227], v[208:211], v[192:195], 0
  v_mfma_f32_32x32x16_bf16 v[228:243], v[208:211], v[196:199], 0
  s_waitcnt vmcnt(13)
  v_mfma_f32_32x32x16_bf16 v[96:111], v[148:151], a[116:119], v[96:111]
  v_mfma_f32_32x32x16_bf16 v[112:127], v[148:151], a[244:247], v[112:127]
  buffer_load_dwordx4 v[148:151], v5, s[8:11], s75 offen offset:3072 sc1
  s_waitcnt vmcnt(13)
  v_mfma_f32_32x32x16_bf16 v[96:111], v[152:155], a[120:123], v[96:111]
  s_nop 4
  v_add_f32 v220, s84, v220
  v_rcp_f32 v220, v220
  v_add_f32 v236, s84, v236
  v_mfma_f32_32x32x16_bf16 v[112:127], v[152:155], a[248:251], v[112:127]
  s_add_u32 s75, s1, 3
  s_and_b32 s75, s75, 7
  s_mul_i32 s75, s75, 4096
  s_add_u32 s75, s75, s91
  s_add_u32 s75, s75, 262144
  buffer_load_dwordx4 v[152:155], v5, s[8:11], s75 offen offset:0 sc1
  s_barrier
  s_waitcnt vmcnt(13)
  v_mfma_f32_32x32x16_bf16 v[96:111], v[156:159], a[124:127], v[96:111]
  v_rcp_f32 v236, v236
  v_mul_f32 v212, v212, v220
  v_mul_f32 v213, v213, v220
  v_mul_f32_e64 v214, v214, v220
  v_mfma_f32_32x32x16_bf16 v[112:127], v[156:159], a[252:255], v[112:127]
  buffer_load_dwordx4 v[156:159], v5, s[8:11], s75 offen offset:1024 sc1
  v_mul_f32 v215, v215, v220
  v_mul_f32 v216, v216, v220
  v_mul_f32 v217, v217, v220
  v_mul_f32_e64 v218, v218, v220
  s_waitcnt vmcnt(13)
  v_mfma_f32_32x32x16_bf16 v[64:79], v[160:163], a[0:3], 0
  v_mul_f32_e64 v219, v219, v220
  v_cvt_pk_bf16_f32 v224, v212, v213
  v_cvt_pk_bf16_f32 v225, v214, v215
  v_cvt_pk_bf16_f32 v226, v216, v217
  v_cvt_pk_bf16_f32 v227, v218, v219
  v_mfma_f32_32x32x16_bf16 v[80:95], v[160:163], a[128:131], 0
  buffer_load_dwordx4 v[160:163], v5, s[8:11], s75 offen offset:2048 sc1
  buffer_store_dwordx4 v[224:227], v2, s[8:11], s100 offen sc1
  v_mul_f32 v228, v228, v236
  v_mul_f32 v229, v229, v236
  v_mul_f32 v230, v230, v236
  s_waitcnt vmcnt(14)
  v_mfma_f32_32x32x16_bf16 v[64:79], v[164:167], a[4:7], v[64:79]
  v_mul_f32 v231, v231, v236
  v_mul_f32 v232, v232, v236
  v_mul_f32 v233, v233, v236
  v_mul_f32 v234, v234, v236
  v_mul_f32_e64 v235, v235, v236
  v_mfma_f32_32x32x16_bf16 v[80:95], v[164:167], a[132:135], v[80:95]
  buffer_load_dwordx4 v[164:167], v5, s[8:11], s75 offen offset:3072 sc1
  ds_write_b128 v7, v[104:107] offset:0
  ds_write_b128 v7, v[108:111] offset:1024
  ds_write_b128 v8, v[112:115] offset:0
  ds_write_b128 v8, v[116:119] offset:1024
  ds_write_b128 v9, v[120:123] offset:0
  ds_write_b128 v9, v[124:127] offset:1024
  s_waitcnt vmcnt(14)
  v_mfma_f32_32x32x16_bf16 v[64:79], v[168:171], a[8:11], v[64:79]
  v_cvt_pk_bf16_f32 v240, v228, v229
  v_cvt_pk_bf16_f32 v241, v230, v231
  v_cvt_pk_bf16_f32 v242, v232, v233
  v_cvt_pk_bf16_f32 v243, v234, v235
  s_add_u32 s100, s100, 0x8000
  v_mfma_f32_32x32x16_bf16 v[80:95], v[168:171], a[136:139], v[80:95]
  s_add_u32 s75, s1, 4
  s_and_b32 s75, s75, 7
  s_mul_i32 s75, s75, 4096
  s_add_u32 s75, s75, s91
  s_add_u32 s75, s75, 262144
  buffer_load_dwordx4 v[168:171], v5, s[8:11], s75 offen offset:0 sc1
  s_waitcnt vmcnt(14)
  v_mfma_f32_32x32x16_bf16 v[64:79], v[172:175], a[12:15], v[64:79]
  buffer_store_dwordx4 v[240:243], v2, s[8:11], s100 offen sc1
  v_lshlrev_b32 v244, 16, v20
  v_and_b32 v245, 0xffff0000, v20
  v_lshlrev_b32_e64 v246, 16, v21
  v_and_b32 v247, 0xffff0000, v21
  v_mfma_f32_32x32x16_bf16 v[80:95], v[172:175], a[140:143], v[80:95]
  buffer_load_dwordx4 v[172:175], v5, s[8:11], s75 offen offset:1024 sc1
  v_lshlrev_b32_e64 v248, 16, v22
  v_and_b32 v249, 0xffff0000, v22
  v_lshlrev_b32_e64 v250, 16, v23
  v_and_b32 v251, 0xffff0000, v23
  s_waitcnt vmcnt(15)
  v_mfma_f32_32x32x16_bf16 v[64:79], v[176:179], a[16:19], v[64:79]
  v_mul_f32 v56, v56, v244
  v_mul_f32 v57, v57, v245
  v_mul_f32 v58, v58, v246
  v_mul_f32 v59, v59, v247
  v_mul_f32 v60, v60, v248
  v_mfma_f32_32x32x16_bf16 v[80:95], v[176:179], a[144:147], v[80:95]
  buffer_load_dwordx4 v[176:179], v5, s[8:11], s75 offen offset:2048 sc1
  v_mul_f32 v61, v61, v249
  v_mul_f32 v62, v62, v250
  v_mul_f32_e64 v63, v63, v251
  v_cvt_pk_bf16_f32 v20, v56, v57
  s_waitcnt vmcnt(15)
  v_mfma_f32_32x32x16_bf16 v[64:79], v[180:183], a[20:23], v[64:79]
  v_cvt_pk_bf16_f32 v21, v58, v59
  v_cvt_pk_bf16_f32 v22, v60, v61
  v_cvt_pk_bf16_f32 v23, v62, v63
  buffer_store_dwordx4 v[20:23], v2, s[8:11], s92 offen offset:0 sc1
  v_mfma_f32_32x32x16_bf16 v[80:95], v[180:183], a[148:151], v[80:95]
  buffer_load_dwordx4 v[180:183], v5, s[8:11], s75 offen offset:3072 sc1
  s_waitcnt vmcnt(16)
  v_mfma_f32_32x32x16_bf16 v[64:79], v[128:131], a[24:27], v[64:79]
  v_mfma_f32_32x32x16_bf16 v[80:95], v[128:131], a[152:155], v[80:95]
  s_add_u32 s75, s1, 5
  s_and_b32 s75, s75, 7
  s_mul_i32 s75, s75, 4096
  s_add_u32 s75, s75, s91
  s_add_u32 s75, s75, 262144
  buffer_load_dwordx4 v[128:131], v5, s[8:11], s75 offen offset:0 sc1
  s_waitcnt vmcnt(16)
  v_mfma_f32_32x32x16_bf16 v[64:79], v[132:135], a[28:31], v[64:79]
  v_mfma_f32_32x32x16_bf16 v[80:95], v[132:135], a[156:159], v[80:95]
  buffer_load_dwordx4 v[132:135], v5, s[8:11], s75 offen offset:1024 sc1
  s_waitcnt vmcnt(16)
  v_mfma_f32_32x32x16_bf16 v[64:79], v[136:139], a[32:35], v[64:79]
  v_mfma_f32_32x32x16_bf16 v[80:95], v[136:139], a[160:163], v[80:95]
  buffer_load_dwordx4 v[136:139], v5, s[8:11], s75 offen offset:2048 sc1
  s_waitcnt lgkmcnt(0)
  s_barrier
  ds_read_b128 v[32:35], v10 offset:0
  ds_read_b128 v[36:39], v10 offset:1024
  ds_read_b128 v[40:43], v10 offset:2048
  ds_read_b128 v[44:47], v10 offset:3072
  ds_read_b128 v[48:51], v10 offset:4096
  ds_read_b128 v[52:55], v10 offset:5120
  s_waitcnt vmcnt(16)
  v_mfma_f32_32x32x16_bf16 v[64:79], v[140:143], a[36:39], v[64:79]
  v_mfma_f32_32x32x16_bf16 v[80:95], v[140:143], a[164:167], v[80:95]
  buffer_load_dwordx4 v[140:143], v5, s[8:11], s75 offen offset:3072 sc1
  s_waitcnt vmcnt(16)
  v_mfma_f32_32x32x16_bf16 v[64:79], v[144:147], a[40:43], v[64:79]
  v_lshlrev_b32 v244, 16, v24
  v_and_b32 v245, 0xffff0000, v24
  v_lshlrev_b32_e64 v246, 16, v25
  v_and_b32 v247, 0xffff0000, v25
  v_lshlrev_b32_e64 v248, 16, v26
  v_and_b32 v249, 0xffff0000, v26
  v_mfma_f32_32x32x16_bf16 v[80:95], v[144:147], a[168:171], v[80:95]
  s_add_u32 s75, s1, 6
  s_and_b32 s75, s75, 7
  s_mul_i32 s75, s75, 4096
  s_add_u32 s75, s75, s91
  s_add_u32 s75, s75, 262144
  buffer_load_dwordx4 v[144:147], v5, s[8:11], s75 offen offset:0 sc1
  s_waitcnt vmcnt(16)
  v_mfma_f32_32x32x16_bf16 v[64:79], v[148:151], a[44:47], v[64:79]
  v_lshlrev_b32_e64 v250, 16, v27
  v_and_b32 v251, 0xffff0000, v27
  v_add_f32 v96, v96, v6
  v_add_f32 v97, v97, v6
  v_add_f32 v98, v98, v6
  v_add_f32 v99, v99, v6
  v_mfma_f32_32x32x16_bf16 v[80:95], v[148:151], a[172:175], v[80:95]
  buffer_load_dwordx4 v[148:151], v5, s[8:11], s75 offen offset:1024 sc1
  v_add_f32 v100, v100, v6
  v_add_f32 v101, v101, v6
  v_add_f32 v102, v102, v6
  v_add_f32 v103, v103, v6
  s_waitcnt lgkmcnt(3)
  v_add_f32_e64 v32, v32, v40
  s_waitcnt vmcnt(16)
  v_mfma_f32_32x32x16_bf16 v[64:79], v[152:155], a[48:51], v[64:79]
  v_add_f32 v33, v33, v41
  v_add_f32 v34, v34, v42
  v_add_f32 v35, v35, v43
  s_waitcnt lgkmcnt(2)
  v_add_f32 v36, v36, v44
  v_add_f32 v37, v37, v45
  v_add_f32_e64 v38, v38, v46
  v_mfma_f32_32x32x16_bf16 v[80:95], v[152:155], a[176:179], v[80:95]
  buffer_load_dwordx4 v[152:155], v5, s[8:11], s75 offen offset:2048 sc1
  v_add_f32 v39, v39, v47
  s_waitcnt lgkmcnt(1)
  v_add_f32 v96, v96, v48
  v_add_f32 v97, v97, v49
  v_add_f32 v98, v98, v50
  v_add_f32_e64 v99, v99, v51
  s_waitcnt vmcnt(16)
  v_mfma_f32_32x32x16_bf16 v[64:79], v[156:159], a[52:55], v[64:79]
  s_waitcnt lgkmcnt(0)
  v_add_f32 v100, v100, v52
  v_add_f32 v101, v101, v53
  v_add_f32 v102, v102, v54
  v_add_f32 v103, v103, v55
  v_add_f32 v96, v96, v32
  v_add_f32_e64 v97, v97, v33
  v_mfma_f32_32x32x16_bf16 v[80:95], v[156:159], a[180:183], v[80:95]
  buffer_load_dwordx4 v[156:159], v5, s[8:11], s75 offen offset:3072 sc1
  v_add_f32 v98, v98, v34
  v_add_f32 v99, v99, v35
  v_add_f32 v100, v100, v36
  v_add_f32 v101, v101, v37
  v_add_f32 v102, v102, v38
  s_waitcnt vmcnt(16)
  v_mfma_f32_32x32x16_bf16 v[64:79], v[160:163], a[56:59], v[64:79]
  v_add_f32 v103, v103, v39
  v_mul_f32 v96, v96, v244
  v_mul_f32 v97, v97, v245
  v_mul_f32 v98, v98, v246
  v_mul_f32 v99, v99, v247
  v_mul_f32 v100, v100, v248
  v_mfma_f32_32x32x16_bf16 v[80:95], v[160:163], a[184:187], v[80:95]
  s_add_u32 s75, s1, 7
  s_and_b32 s75, s75, 7
  s_mul_i32 s75, s75, 4096
  s_add_u32 s75, s75, s91
  s_add_u32 s75, s75, 262144
  buffer_load_dwordx4 v[160:163], v5, s[8:11], s75 offen offset:0 sc1
  s_waitcnt vmcnt(15)
  v_mfma_f32_32x32x16_bf16 v[64:79], v[164:167], a[60:63], v[64:79]
  v_mul_f32 v101, v101, v249
  v_mul_f32 v102, v102, v250
  v_mul_f32_e64 v103, v103, v251
  v_cvt_pk_bf16_f32 v24, v96, v97
  v_cvt_pk_bf16_f32 v25, v98, v99
  v_cvt_pk_bf16_f32 v26, v100, v101
  v_mfma_f32_32x32x16_bf16 v[80:95], v[164:167], a[188:191], v[80:95]
  buffer_load_dwordx4 v[164:167], v5, s[8:11], s75 offen offset:1024 sc1
  v_cvt_pk_bf16_f32 v27, v102, v103
  buffer_store_dwordx4 v[24:27], v2, s[8:11], s92 offen offset:2048 sc1
  v_lshlrev_b32_e64 v56, 16, v28
  v_and_b32 v57, 0xffff0000, v28
  v_lshlrev_b32 v58, 16, v29
  s_waitcnt vmcnt(16)
  v_mfma_f32_32x32x16_bf16 v[64:79], v[168:171], a[64:67], v[64:79]
  v_and_b32 v59, 0xffff0000, v29
  v_lshlrev_b32_e64 v60, 16, v30
  v_and_b32 v61, 0xffff0000, v30
  v_lshlrev_b32_e64 v62, 16, v31
  v_and_b32 v63, 0xffff0000, v31
  s_lshl_b32 s99, s44, 3
  v_mfma_f32_32x32x16_bf16 v[80:95], v[168:171], a[192:195], v[80:95]
  buffer_load_dwordx4 v[168:171], v5, s[8:11], s75 offen offset:2048 sc1
  v_lshrrev_b32 v249, 3, v1
  v_add_u32 v249, s99, v249
  v_and_b32 v250, 7, v1
  v_lshlrev_b32_e64 v251, 4, v250
  v_lshl_add_u32 v27, v249, 10, v251
  s_waitcnt vmcnt(15)
  v_mfma_f32_32x32x16_bf16 v[64:79], v[172:175], a[68:71], v[64:79]
  v_lshlrev_b32 v250, 1, v250
  v_and_b32 v251, 15, v249
  v_xor_b32 v250, v250, v251
  v_lshlrev_b32_e64 v250, 4, v250
  v_lshl_add_u32 v25, v249, 8, v250
  v_xor_b32_e64 v26, 16, v25
  v_mfma_f32_32x32x16_bf16 v[80:95], v[172:175], a[196:199], v[80:95]
  buffer_load_dwordx4 v[172:175], v5, s[8:11], s75 offen offset:3072 sc1
  v_lshrrev_b32_e64 v244, 5, v1
  v_bfe_u32 v245, v1, 2, 2
  v_and_b32_e64 v246, 3, v1
  v_bfe_u32 v247, v1, 4, 1
  v_lshlrev_b32 v246, 3, v246
  s_waitcnt vmcnt(15)
  v_mfma_f32_32x32x16_bf16 v[64:79], v[176:179], a[72:75], v[64:79]
  v_lshl_add_u32 v246, v247, 5, v246
  v_lshl_add_u32 v248, v244, 2, v245
  v_lshl_add_u32 v248, v248, 7, v246
  v_bfe_u32 v249, v1, 3, 1
  v_lshl_add_u32 v248, v249, 6, v248
  s_lshl_b32 s99, s96, 15
  v_mfma_f32_32x32x16_bf16 v[80:95], v[176:179], a[200:203], v[80:95]
  s_lshl_b32 s73, s83, 4
  s_lshl_b32 s74, s44, 2
  s_add_u32 s73, s73, s74
  s_lshl_b32 s74, s47, 7
  s_add_u32 s73, s73, s74
  s_add_u32 s73, s73, 24576
  v_mov_b32 v3, s71
  s_mov_b64 exec, 1
  buffer_store_dword v3, off, s[8:11], s73 sc1
  s_mov_b64 exec, -1
  s_waitcnt vmcnt(14)
  v_mfma_f32_32x32x16_bf16 v[64:79], v[180:183], a[76:79], v[64:79]
  v_add_u32 v20, s99, v248
  v_xor_b32 v21, 64, v20
  s_mul_i32 s99, s96, 49152
  s_add_u32 s99, s99, 67584
  v_add_u32 v22, s99, v248
  v_xor_b32 v23, 64, v22
  v_mfma_f32_32x32x16_bf16 v[80:95], v[180:183], a[204:207], v[80:95]
  s_cmp_eq_u32 s96, 1
  s_cselect_b32 s99, 28672, s99
  v_add_u32 v17, s99, v248
  v_xor_b32 v18, 64, v17
  v_and_b32 v249, 15, v1
  v_xor_b32 v249, v249, v244
  s_waitcnt vmcnt(13)
  v_mfma_f32_32x32x16_bf16 v[64:79], v[128:131], a[80:83], v[64:79]
  v_lshlrev_b32 v249, 4, v249
  v_and_b32 v250, 31, v1
  v_lshl_add_u32 v249, v250, 8, v249
  s_lshl_b32 s99, s96, 14
  s_lshl_b32 s101, s95, 13
  s_add_u32 s99, s99, s101
  v_mfma_f32_32x32x16_bf16 v[80:95], v[128:131], a[208:211], v[80:95]
  s_lshl_b32 s74, s44, 14
  s_add_u32 m0, s74, 0
  s_lshl_b32 s73, s44, 17
  s_add_u32 s73, s73, s94
  s_add_u32 s73, s73, 0
  buffer_load_dwordx4 v13, s[12:15], s73 offen offset:0 lds
  buffer_load_dwordx4 v14, s[12:15], s73 offen offset:1024 lds
  buffer_load_dwordx4 v15, s[12:15], s73 offen offset:2048 lds
  buffer_load_dwordx4 v16, s[12:15], s73 offen offset:3072 lds
  s_waitcnt vmcnt(16)
  v_mfma_f32_32x32x16_bf16 v[64:79], v[132:135], a[84:87], v[64:79]
  v_add_u32 v24, s99, v249
  v_mfma_f32_32x32x16_bf16 v[80:95], v[132:135], a[212:215], v[80:95]
  s_waitcnt vmcnt(15)
  v_mfma_f32_32x32x16_bf16 v[64:79], v[136:139], a[88:91], v[64:79]
  v_mfma_f32_32x32x16_bf16 v[80:95], v[136:139], a[216:219], v[80:95]
  s_waitcnt vmcnt(14)
  v_mfma_f32_32x32x16_bf16 v[64:79], v[140:143], a[92:95], v[64:79]
  v_mfma_f32_32x32x16_bf16 v[80:95], v[140:143], a[220:223], v[80:95]
  s_waitcnt vmcnt(13)
  v_mfma_f32_32x32x16_bf16 v[64:79], v[144:147], a[96:99], v[64:79]
  v_mfma_f32_32x32x16_bf16 v[80:95], v[144:147], a[224:227], v[80:95]
  s_lshl_b32 s74, s44, 14
  s_add_u32 m0, s74, 4096
  s_lshl_b32 s73, s44, 17
  s_add_u32 s73, s73, s94
  s_add_u32 s73, s73, 32768
  buffer_load_dwordx4 v13, s[12:15], s73 offen offset:0 lds
  buffer_load_dwordx4 v14, s[12:15], s73 offen offset:1024 lds
  buffer_load_dwordx4 v15, s[12:15], s73 offen offset:2048 lds
  buffer_load_dwordx4 v16, s[12:15], s73 offen offset:3072 lds
  s_waitcnt vmcnt(16)
  v_mfma_f32_32x32x16_bf16 v[64:79], v[148:151], a[100:103], v[64:79]
  v_mfma_f32_32x32x16_bf16 v[80:95], v[148:151], a[228:231], v[80:95]
  s_waitcnt vmcnt(15)
  v_mfma_f32_32x32x16_bf16 v[64:79], v[152:155], a[104:107], v[64:79]
  v_mfma_f32_32x32x16_bf16 v[80:95], v[152:155], a[232:235], v[80:95]
  s_waitcnt vmcnt(14)
  v_mfma_f32_32x32x16_bf16 v[64:79], v[156:159], a[108:111], v[64:79]
  v_mfma_f32_32x32x16_bf16 v[80:95], v[156:159], a[236:239], v[80:95]
  s_waitcnt vmcnt(13)
  v_mfma_f32_32x32x16_bf16 v[64:79], v[160:163], a[112:115], v[64:79]
  v_mfma_f32_32x32x16_bf16 v[80:95], v[160:163], a[240:243], v[80:95]
  s_lshl_b32 s74, s44, 14
  s_add_u32 m0, s74, 8192
  s_lshl_b32 s73, s44, 17
  s_add_u32 s73, s73, s94
  s_add_u32 s73, s73, 65536
  buffer_load_dwordx4 v13, s[12:15], s73 offen offset:0 lds
  buffer_load_dwordx4 v14, s[12:15], s73 offen offset:1024 lds
  buffer_load_dwordx4 v15, s[12:15], s73 offen offset:2048 lds
  buffer_load_dwordx4 v16, s[12:15], s73 offen offset:3072 lds
  s_barrier
  s_waitcnt vmcnt(16)
  v_mfma_f32_32x32x16_bf16 v[64:79], v[164:167], a[116:119], v[64:79]
  v_mfma_f32_32x32x16_bf16 v[80:95], v[164:167], a[244:247], v[80:95]
  s_waitcnt vmcnt(14)
  v_mfma_f32_32x32x16_bf16 v[64:79], v[168:171], a[120:123], v[64:79]
  v_mfma_f32_32x32x16_bf16 v[80:95], v[168:171], a[248:251], v[80:95]
  s_waitcnt vmcnt(13)
  v_mfma_f32_32x32x16_bf16 v[64:79], v[172:175], a[124:127], v[64:79]
  v_mfma_f32_32x32x16_bf16 v[80:95], v[172:175], a[252:255], v[80:95]
  s_lshl_b32 s73, s83, 3
  s_lshl_b32 s74, s96, 2
  s_add_u32 s73, s73, s74
  s_add_u32 s73, s73, s42
  s_add_u32 s73, s73, 8192
  v_mov_b32_e64 v3, s71
  s_mov_b64 exec, 1
  buffer_store_dword v3, off, s[8:11], s73 sc1
  s_mov_b64 exec, -1
  s_nop 1
  ds_write_b128 v7, v[72:75] offset:0
  ds_write_b128 v7, v[76:79] offset:1024
  ds_write_b128 v8, v[80:83] offset:0
  ds_write_b128 v8, v[84:87] offset:1024
  ds_write_b128 v9, v[88:91] offset:0
  ds_write_b128 v9, v[92:95] offset:1024
  s_lshl_b32 s74, s44, 14
  s_add_u32 m0, s74, 12288
  s_lshl_b32 s73, s44, 17
  s_add_u32 s73, s73, s94
  s_add_u32 s73, s73, 98304
  buffer_load_dwordx4 v13, s[12:15], s73 offen offset:0 lds
  buffer_load_dwordx4 v14, s[12:15], s73 offen offset:1024 lds
  buffer_load_dwordx4 v15, s[12:15], s73 offen offset:2048 lds
  buffer_load_dwordx4 v16, s[12:15], s73 offen offset:3072 lds
  s_waitcnt lgkmcnt(0)
  s_barrier
  ds_read_b128 v[32:35], v10 offset:0
  ds_read_b128 v[36:39], v10 offset:1024
  ds_read_b128 v[40:43], v10 offset:2048
  ds_read_b128 v[44:47], v10 offset:3072
  ds_read_b128 v[48:51], v10 offset:4096
  ds_read_b128 v[52:55], v10 offset:5120
  v_pk_add_f32 v[64:65], v[64:65], v[6:7] op_sel:[0,0] op_sel_hi:[1,0]
  v_pk_add_f32 v[66:67], v[66:67], v[6:7] op_sel:[0,0] op_sel_hi:[1,0]
  v_pk_add_f32 v[68:69], v[68:69], v[6:7] op_sel:[0,0] op_sel_hi:[1,0]
  v_pk_add_f32 v[70:71], v[70:71], v[6:7] op_sel:[0,0] op_sel_hi:[1,0]
  s_waitcnt lgkmcnt(3)
  v_pk_add_f32 v[32:33], v[32:33], v[40:41] op_sel:[0,0] op_sel_hi:[1,1]
  v_pk_add_f32 v[34:35], v[34:35], v[42:43] op_sel:[0,0] op_sel_hi:[1,1]
  s_waitcnt lgkmcnt(2)
  v_pk_add_f32 v[36:37], v[36:37], v[44:45] op_sel:[0,0] op_sel_hi:[1,1]
  v_pk_add_f32 v[38:39], v[38:39], v[46:47] op_sel:[0,0] op_sel_hi:[1,1]
  s_waitcnt lgkmcnt(1)
  v_pk_add_f32 v[64:65], v[64:65], v[48:49] op_sel:[0,0] op_sel_hi:[1,1]
  v_pk_add_f32 v[66:67], v[66:67], v[50:51] op_sel:[0,0] op_sel_hi:[1,1]
  s_waitcnt lgkmcnt(0)
  v_pk_add_f32 v[68:69], v[68:69], v[52:53] op_sel:[0,0] op_sel_hi:[1,1]
  v_pk_add_f32 v[70:71], v[70:71], v[54:55] op_sel:[0,0] op_sel_hi:[1,1]
  v_pk_add_f32 v[64:65], v[64:65], v[32:33] op_sel:[0,0] op_sel_hi:[1,1]
  v_pk_add_f32 v[66:67], v[66:67], v[34:35] op_sel:[0,0] op_sel_hi:[1,1]
  v_pk_add_f32 v[68:69], v[68:69], v[36:37] op_sel:[0,0] op_sel_hi:[1,1]
  v_pk_add_f32 v[70:71], v[70:71], v[38:39] op_sel:[0,0] op_sel_hi:[1,1]
  v_pk_mul_f32 v[64:65], v[64:65], v[56:57] op_sel:[0,0] op_sel_hi:[1,1]
  v_pk_mul_f32 v[66:67], v[66:67], v[58:59] op_sel:[0,0] op_sel_hi:[1,1]
  v_pk_mul_f32 v[68:69], v[68:69], v[60:61] op_sel:[0,0] op_sel_hi:[1,1]
  v_pk_mul_f32 v[70:71], v[70:71], v[62:63] op_sel:[0,0] op_sel_hi:[1,1]
  v_cvt_pk_bf16_f32 v28, v64, v65
  v_cvt_pk_bf16_f32 v29, v66, v67
  v_cvt_pk_bf16_f32 v30, v68, v69
  v_cvt_pk_bf16_f32 v31, v70, v71
  s_add_u32 s92, s92, 4096
  buffer_store_dwordx4 v[28:31], v2, s[8:11], s92 offen offset:0 sc1
  s_mul_i32 s74, s44, 18432
  s_add_u32 m0, s74, 65536
  s_mul_i32 s73, s44, 147456
  s_add_u32 s73, s73, s94
  s_add_u32 s73, s73, 0
  buffer_load_dwordx4 v13, s[16:19], s73 offen offset:0 lds
  buffer_load_dwordx4 v14, s[16:19], s73 offen offset:1024 lds
  buffer_load_dwordx4 v15, s[16:19], s73 offen offset:2048 lds
  buffer_load_dwordx4 v16, s[16:19], s73 offen offset:3072 lds
  s_mul_i32 s74, s44, 18432
  s_add_u32 m0, s74, 69632
  s_mul_i32 s73, s44, 147456
  s_add_u32 s73, s73, s94
  s_add_u32 s73, s73, 32768
  buffer_load_dwordx4 v13, s[16:19], s73 offen offset:0 lds
  buffer_load_dwordx4 v14, s[16:19], s73 offen offset:1024 lds
  buffer_load_dwordx4 v15, s[16:19], s73 offen offset:2048 lds
  buffer_load_dwordx4 v16, s[16:19], s73 offen offset:3072 lds
  s_waitcnt vmcnt(8)
  s_lshl_b32 s73, s83, 3
  s_lshl_b32 s74, s96, 2
  s_add_u32 s73, s73, s74
  s_add_u32 s73, s73, s42
  v_mov_b32_e64 v3, s71
  s_mov_b64 exec, 1
  buffer_store_dword v3, off, s[8:11], s73 sc1
  s_mov_b64 exec, -1
  s_mul_i32 s74, s44, 18432
  s_add_u32 m0, s74, 73728
  s_mul_i32 s73, s44, 147456
  s_add_u32 s73, s73, s94
  s_add_u32 s73, s73, 65536
  buffer_load_dwordx4 v13, s[16:19], s73 offen offset:0 lds
  buffer_load_dwordx4 v14, s[16:19], s73 offen offset:1024 lds
  buffer_load_dwordx4 v15, s[16:19], s73 offen offset:2048 lds
  buffer_load_dwordx4 v16, s[16:19], s73 offen offset:3072 lds
  s_buffer_load_dwordx16 s[24:39], s[8:11], s41
  s_buffer_load_dwordx16 s[48:63], s[8:11], s42 offset:8192
  s_mul_i32 s74, s44, 18432
  s_add_u32 m0, s74, 77824
  s_mul_i32 s73, s44, 147456
  s_add_u32 s73, s73, s94
  s_add_u32 s73, s73, 98304
  buffer_load_dwordx4 v13, s[16:19], s73 offen offset:0 lds
  buffer_load_dwordx4 v14, s[16:19], s73 offen offset:1024 lds
  buffer_load_dwordx4 v15, s[16:19], s73 offen offset:2048 lds
  buffer_load_dwordx4 v16, s[16:19], s73 offen offset:3072 lds
  s_mul_i32 s74, s44, 18432
  s_add_u32 m0, s74, 81920
  s_mul_i32 s73, s44, 147456
  s_add_u32 s73, s73, s94
  s_add_u32 s73, s73, 131072
  buffer_load_dwordx4 v13, s[16:19], s73 offen offset:0 lds
  buffer_load_dwordx4 v14, s[16:19], s73 offen offset:1024 lds
  s_waitcnt lgkmcnt(0)
  s_xor_b64 s[24:25], s[24:25], s[70:71]
  s_xor_b64 s[26:27], s[26:27], s[70:71]
  s_xor_b64 s[28:29], s[28:29], s[70:71]
  s_xor_b64 s[30:31], s[30:31], s[70:71]
  s_xor_b64 s[32:33], s[32:33], s[70:71]
  s_xor_b64 s[34:35], s[34:35], s[70:71]
  s_xor_b64 s[36:37], s[36:37], s[70:71]
  s_xor_b64 s[38:39], s[38:39], s[70:71]
  s_or_b64 s[24:25], s[24:25], s[26:27]
  s_or_b64 s[28:29], s[28:29], s[30:31]
  s_or_b64 s[32:33], s[32:33], s[34:35]
  s_or_b64 s[36:37], s[36:37], s[38:39]
  s_or_b64 s[24:25], s[24:25], s[28:29]
  s_or_b64 s[32:33], s[32:33], s[36:37]
  s_or_b64 s[24:25], s[24:25], s[32:33]
  s_cbranch_scc1 SLOW_F4
RET_F4:
  buffer_load_dwordx4 v[192:195], v2, s[8:11], s78 offen offset:0 sc1
  buffer_load_dwordx4 v[196:199], v2, s[8:11], s78 offen offset:1024 sc1
  buffer_load_dwordx4 v[200:203], v2, s[8:11], s78 offen offset:2048 sc1
  buffer_load_dwordx4 v[204:207], v2, s[8:11], s78 offen offset:3072 sc1
  buffer_load_dwordx4 v[208:211], v2, s[8:11], s79 offen offset:0 sc1
  buffer_load_dwordx4 v[212:215], v2, s[8:11], s79 offen offset:1024 sc1
  buffer_load_dwordx4 v[216:219], v2, s[8:11], s79 offen offset:2048 sc1
  buffer_load_dwordx4 v[220:223], v2, s[8:11], s79 offen offset:3072 sc1
  buffer_load_dwordx4 v[224:227], v2, s[8:11], s80 offen offset:0 sc1
  buffer_load_dwordx4 v[228:231], v2, s[8:11], s80 offen offset:1024 sc1
  buffer_load_dwordx4 v[232:235], v2, s[8:11], s80 offen offset:2048 sc1
  buffer_load_dwordx4 v[236:239], v2, s[8:11], s80 offen offset:3072 sc1
  buffer_load_dwordx4 v[240:243], v2, s[8:11], s81 offen offset:0 sc1
  buffer_load_dwordx4 v[244:247], v2, s[8:11], s81 offen offset:1024 sc1
  buffer_load_dwordx4 v[248:251], v2, s[8:11], s81 offen offset:2048 sc1
  buffer_load_dwordx4 v[252:255], v2, s[8:11], s81 offen offset:3072 sc1
PHASE3:
  s_barrier
  s_lshl_b32 s74, s44, 12
  s_add_u32 m0, s74, 139264
  s_lshl_b32 s73, s44, 15
  s_add_u32 s73, s73, s94
  s_add_u32 s73, s73, 589824
  buffer_load_dwordx4 v13, s[16:19], s73 offen offset:0 lds
  buffer_load_dwordx4 v14, s[16:19], s73 offen offset:1024 lds
  buffer_load_dwordx4 v15, s[16:19], s73 offen offset:2048 lds
  buffer_load_dwordx4 v16, s[16:19], s73 offen offset:3072 lds
  buffer_load_dwordx4 v[56:59], v27, s[4:7], s82 offen
  s_add_u32 s91, s82, 0x8000
  buffer_load_dwordx4 v[60:63], v27, s[4:7], s91 offen
  s_xor_b64 s[48:49], s[48:49], s[70:71]
  s_xor_b64 s[50:51], s[50:51], s[70:71]
  s_xor_b64 s[52:53], s[52:53], s[70:71]
  s_xor_b64 s[54:55], s[54:55], s[70:71]
  s_xor_b64 s[56:57], s[56:57], s[70:71]
  s_xor_b64 s[58:59], s[58:59], s[70:71]
  s_xor_b64 s[60:61], s[60:61], s[70:71]
  s_xor_b64 s[62:63], s[62:63], s[70:71]
  s_or_b64 s[48:49], s[48:49], s[50:51]
  s_or_b64 s[52:53], s[52:53], s[54:55]
  s_or_b64 s[56:57], s[56:57], s[58:59]
  s_or_b64 s[60:61], s[60:61], s[62:63]
  s_or_b64 s[48:49], s[48:49], s[52:53]
  s_or_b64 s[56:57], s[56:57], s[60:61]
  s_or_b64 s[48:49], s[48:49], s[56:57]
  s_cbranch_scc1 SLOW_F5A
RET_F5A:
  buffer_load_dwordx4 v[128:131], v2, s[8:11], s64 offen offset:0 sc1
  buffer_load_dwordx4 v[132:135], v2, s[8:11], s64 offen offset:1024 sc1
  ds_read_b64_tr_b16 v[32:33], v20 offset:0
  ds_read_b64_tr_b16 v[34:35], v20 offset:1024
  ds_read_b64_tr_b16 v[36:37], v21 offset:0
  ds_read_b64_tr_b16 v[38:39], v21 offset:1024
  ds_read_b64_tr_b16 v[40:41], v20 offset:2048
  ds_read_b64_tr_b16 v[42:43], v20 offset:3072
  ds_read_b64_tr_b16 v[44:45], v21 offset:2048
  ds_read_b64_tr_b16 v[46:47], v21 offset:3072
  s_waitcnt vmcnt(23) lgkmcnt(6)
  v_mfma_f32_32x32x16_bf16 a[0:15], v[32:35], v[192:195], 0
  ds_read_b64_tr_b16 v[48:49], v20 offset:4096
  ds_read_b64_tr_b16 v[50:51], v20 offset:5120
  v_xor_b32 v120, 0, v24
  v_xor_b32 v121, 32, v24
  v_xor_b32 v122, 64, v24
  s_waitcnt lgkmcnt(6)
  v_mfma_f32_32x32x16_bf16 a[16:31], v[36:39], v[192:195], 0
  ds_read_b64_tr_b16 v[52:53], v21 offset:4096
  ds_read_b64_tr_b16 v[54:55], v21 offset:5120
  buffer_load_dwordx4 v[136:139], v2, s[8:11], s64 offen offset:2048 sc1
  v_xor_b32 v123, 96, v24
  v_xor_b32 v124, 128, v24
  s_waitcnt vmcnt(23) lgkmcnt(6)
  v_mfma_f32_32x32x16_bf16 a[0:15], v[40:43], v[196:199], a[0:15]
  ds_read_b64_tr_b16 v[32:33], v20 offset:6144
  ds_read_b64_tr_b16 v[34:35], v20 offset:7168
  v_xor_b32 v125, 160, v24
  v_xor_b32 v126, 192, v24
  v_xor_b32 v127, 224, v24
  s_waitcnt lgkmcnt(6)
  v_mfma_f32_32x32x16_bf16 a[16:31], v[44:47], v[196:199], a[16:31]
  ds_read_b64_tr_b16 v[36:37], v21 offset:6144
  ds_read_b64_tr_b16 v[38:39], v21 offset:7168
  buffer_load_dwordx4 v[140:143], v2, s[8:11], s64 offen offset:3072 sc1
  s_waitcnt vmcnt(23) lgkmcnt(6)
  v_mfma_f32_32x32x16_bf16 a[0:15], v[48:51], v[200:203], a[0:15]
  ds_read_b64_tr_b16 v[40:41], v20 offset:8192
  ds_read_b64_tr_b16 v[42:43], v20 offset:9216
  s_waitcnt lgkmcnt(6)
  v_mfma_f32_32x32x16_bf16 a[16:31], v[52:55], v[200:203], a[16:31]
  ds_read_b64_tr_b16 v[44:45], v21 offset:8192
  ds_read_b64_tr_b16 v[46:47], v21 offset:9216
  buffer_load_dwordx4 v[144:147], v2, s[8:11], s65 offen offset:0 sc1
  s_waitcnt vmcnt(23) lgkmcnt(6)
  v_mfma_f32_32x32x16_bf16 a[0:15], v[32:35], v[204:207], a[0:15]
  ds_read_b64_tr_b16 v[48:49], v20 offset:10240
  ds_read_b64_tr_b16 v[50:51], v20 offset:11264
  s_waitcnt lgkmcnt(6)
  v_mfma_f32_32x32x16_bf16 a[16:31], v[36:39], v[204:207], a[16:31]
  ds_read_b64_tr_b16 v[52:53], v21 offset:10240
  ds_read_b64_tr_b16 v[54:55], v21 offset:11264
  buffer_load_dwordx4 v[148:151], v2, s[8:11], s65 offen offset:1024 sc1
  s_waitcnt vmcnt(23) lgkmcnt(6)
  v_mfma_f32_32x32x16_bf16 a[0:15], v[40:43], v[208:211], a[0:15]
  ds_read_b64_tr_b16 v[32:33], v20 offset:12288
  ds_read_b64_tr_b16 v[34:35], v20 offset:13312
  s_waitcnt lgkmcnt(6)
  v_mfma_f32_32x32x16_bf16 a[16:31], v[44:47], v[208:211], a[16:31]
  ds_read_b64_tr_b16 v[36:37], v21 offset:12288
  ds_read_b64_tr_b16 v[38:39], v21 offset:13312
  buffer_load_dwordx4 v[152:155], v2, s[8:11], s65 offen offset:2048 sc1
  s_waitcnt vmcnt(23) lgkmcnt(6)
  v_mfma_f32_32x32x16_bf16 a[0:15], v[48:51], v[212:215], a[0:15]
  ds_read_b64_tr_b16 v[40:41], v20 offset:14336
  ds_read_b64_tr_b16 v[42:43], v20 offset:15360
  s_waitcnt lgkmcnt(6)
  v_mfma_f32_32x32x16_bf16 a[16:31], v[52:55], v[212:215], a[16:31]
  ds_read_b64_tr_b16 v[44:45], v21 offset:14336
  ds_read_b64_tr_b16 v[46:47], v21 offset:15360
  buffer_load_dwordx4 v[156:159], v2, s[8:11], s65 offen offset:3072 sc1
  s_waitcnt vmcnt(23) lgkmcnt(6)
  v_mfma_f32_32x32x16_bf16 a[0:15], v[32:35], v[216:219], a[0:15]
  ds_read_b64_tr_b16 v[48:49], v20 offset:16384
  ds_read_b64_tr_b16 v[50:51], v20 offset:17408
  s_waitcnt lgkmcnt(6)
  v_mfma_f32_32x32x16_bf16 a[16:31], v[36:39], v[216:219], a[16:31]
  ds_read_b64_tr_b16 v[52:53], v21 offset:16384
  ds_read_b64_tr_b16 v[54:55], v21 offset:17408
  buffer_load_dwordx4 v[160:163], v2, s[8:11], s66 offen offset:0 sc1
  s_waitcnt vmcnt(23) lgkmcnt(6)
  v_mfma_f32_32x32x16_bf16 a[0:15], v[40:43], v[220:223], a[0:15]
  ds_read_b64_tr_b16 v[32:33], v20 offset:18432
  ds_read_b64_tr_b16 v[34:35], v20 offset:19456
  s_waitcnt lgkmcnt(6)
  v_mfma_f32_32x32x16_bf16 a[16:31], v[44:47], v[220:223], a[16:31]
  ds_read_b64_tr_b16 v[36:37], v21 offset:18432
  ds_read_b64_tr_b16 v[38:39], v21 offset:19456
  buffer_load_dwordx4 v[164:167], v2, s[8:11], s66 offen offset:1024 sc1
  s_waitcnt vmcnt(23) lgkmcnt(6)
  v_mfma_f32_32x32x16_bf16 a[0:15], v[48:51], v[224:227], a[0:15]
  ds_read_b64_tr_b16 v[40:41], v20 offset:20480
  ds_read_b64_tr_b16 v[42:43], v20 offset:21504
  s_waitcnt lgkmcnt(6)
  v_mfma_f32_32x32x16_bf16 a[16:31], v[52:55], v[224:227], a[16:31]
  ds_read_b64_tr_b16 v[44:45], v21 offset:20480
  ds_read_b64_tr_b16 v[46:47], v21 offset:21504
  buffer_load_dwordx4 v[168:171], v2, s[8:11], s66 offen offset:2048 sc1
  s_waitcnt vmcnt(23) lgkmcnt(6)
  v_mfma_f32_32x32x16_bf16 a[0:15], v[32:35], v[228:231], a[0:15]
  ds_read_b64_tr_b16 v[48:49], v20 offset:22528
  ds_read_b64_tr_b16 v[50:51], v20 offset:23552
  s_waitcnt lgkmcnt(6)
  v_mfma_f32_32x32x16_bf16 a[16:31], v[36:39], v[228:231], a[16:31]
  ds_read_b64_tr_b16 v[52:53], v21 offset:22528
  ds_read_b64_tr_b16 v[54:55], v21 offset:23552
  buffer_load_dwordx4 v[172:175], v2, s[8:11], s66 offen offset:3072 sc1
  s_waitcnt vmcnt(23) lgkmcnt(6)
  v_mfma_f32_32x32x16_bf16 a[0:15], v[40:43], v[232:235], a[0:15]
  ds_read_b64_tr_b16 v[32:33], v20 offset:24576
  ds_read_b64_tr_b16 v[34:35], v20 offset:25600
  s_waitcnt lgkmcnt(6)
  v_mfma_f32_32x32x16_bf16 a[16:31], v[44:47], v[232:235], a[16:31]
  ds_read_b64_tr_b16 v[36:37], v21 offset:24576
  ds_read_b64_tr_b16 v[38:39], v21 offset:25600
  buffer_load_dwordx4 v[176:179], v2, s[8:11], s77 offen offset:0 sc1
  s_waitcnt vmcnt(23) lgkmcnt(6)
  v_mfma_f32_32x32x16_bf16 a[0:15], v[48:51], v[236:239], a[0:15]
  ds_read_b64_tr_b16 v[40:41], v20 offset:26624
  ds_read_b64_tr_b16 v[42:43], v20 offset:27648
  s_waitcnt lgkmcnt(6)
  v_mfma_f32_32x32x16_bf16 a[16:31], v[52:55], v[236:239], a[16:31]
  ds_read_b64_tr_b16 v[44:45], v21 offset:26624
  ds_read_b64_tr_b16 v[46:47], v21 offset:27648
  buffer_load_dwordx4 v[180:183], v2, s[8:11], s67 offen offset:1024 sc1
  s_buffer_load_dwordx16 s[48:63], s[8:11], s42
  s_waitcnt vmcnt(23) lgkmcnt(6)
  v_mfma_f32_32x32x16_bf16 a[0:15], v[32:35], v[240:243], a[0:15]
  ds_read_b64_tr_b16 v[48:49], v20 offset:28672
  ds_read_b64_tr_b16 v[50:51], v20 offset:29696
  s_waitcnt lgkmcnt(6)
  v_mfma_f32_32x32x16_bf16 a[16:31], v[36:39], v[240:243], a[16:31]
  ds_read_b64_tr_b16 v[52:53], v21 offset:28672
  ds_read_b64_tr_b16 v[54:55], v21 offset:29696
  buffer_load_dwordx4 v[184:187], v2, s[8:11], s67 offen offset:2048 sc1
  s_waitcnt vmcnt(23) lgkmcnt(6)
  v_mfma_f32_32x32x16_bf16 a[0:15], v[40:43], v[244:247], a[0:15]
  ds_read_b64_tr_b16 v[32:33], v20 offset:30720
  ds_read_b64_tr_b16 v[34:35], v20 offset:31744
  s_waitcnt lgkmcnt(6)
  v_mfma_f32_32x32x16_bf16 a[16:31], v[44:47], v[244:247], a[16:31]
  ds_read_b64_tr_b16 v[36:37], v21 offset:30720
  ds_read_b64_tr_b16 v[38:39], v21 offset:31744
  buffer_load_dwordx4 v[188:191], v2, s[8:11], s67 offen offset:3072 sc1
  s_waitcnt vmcnt(23) lgkmcnt(6)
  v_mfma_f32_32x32x16_bf16 a[0:15], v[48:51], v[248:251], a[0:15]
  s_waitcnt lgkmcnt(4)
  v_mfma_f32_32x32x16_bf16 a[16:31], v[52:55], v[248:251], a[16:31]
  s_waitcnt vmcnt(22) lgkmcnt(2)
  v_mfma_f32_32x32x16_bf16 a[0:15], v[32:35], v[252:255], a[0:15]
  s_waitcnt lgkmcnt(0)
  v_mfma_f32_32x32x16_bf16 a[16:31], v[36:39], v[252:255], a[16:31]
  s_xor_b64 s[48:49], s[48:49], s[70:71]
  s_xor_b64 s[50:51], s[50:51], s[70:71]
  s_xor_b64 s[52:53], s[52:53], s[70:71]
  s_xor_b64 s[54:55], s[54:55], s[70:71]
  s_xor_b64 s[56:57], s[56:57], s[70:71]
  s_xor_b64 s[58:59], s[58:59], s[70:71]
  s_xor_b64 s[60:61], s[60:61], s[70:71]
  s_xor_b64 s[62:63], s[62:63], s[70:71]
  s_or_b64 s[48:49], s[48:49], s[50:51]
  s_or_b64 s[52:53], s[52:53], s[54:55]
  s_or_b64 s[56:57], s[56:57], s[58:59]
  s_or_b64 s[60:61], s[60:61], s[62:63]
  s_or_b64 s[48:49], s[48:49], s[52:53]
  s_or_b64 s[56:57], s[56:57], s[60:61]
  s_or_b64 s[48:49], s[48:49], s[56:57]
  s_cbranch_scc1 SLOW_F5
RET_F5:
  s_add_u32 s73, s64, 4096
  buffer_load_dwordx4 v[96:99], v2, s[8:11], s73 offen offset:0 sc1
  buffer_load_dwordx4 v[100:103], v2, s[8:11], s73 offen offset:1024 sc1
  s_add_u32 s73, s65, 4096
  buffer_load_dwordx4 v[104:107], v2, s[8:11], s73 offen offset:0 sc1
  buffer_load_dwordx4 v[108:111], v2, s[8:11], s73 offen offset:1024 sc1
  s_waitcnt vmcnt(22)
  s_barrier
  ds_read_b64_tr_b16 v[32:33], v22 offset:0
  ds_read_b64_tr_b16 v[34:35], v22 offset:1024
  ds_read_b64_tr_b16 v[36:37], v23 offset:0
  ds_read_b64_tr_b16 v[38:39], v23 offset:1024
  ds_read_b64_tr_b16 v[40:41], v22 offset:2048
  ds_read_b64_tr_b16 v[42:43], v22 offset:3072
  ds_read_b64_tr_b16 v[44:45], v23 offset:2048
  ds_read_b64_tr_b16 v[46:47], v23 offset:3072
  s_waitcnt vmcnt(19) lgkmcnt(6)
  v_mfma_f32_32x32x16_bf16 a[32:47], v[32:35], v[128:131], 0
  ds_read_b64_tr_b16 v[48:49], v22 offset:4096
  ds_read_b64_tr_b16 v[50:51], v22 offset:5120
  ds_write_b128 v120, a[0:3] offset:0
  ds_write_b128 v121, a[4:7] offset:0
  ds_write_b128 v122, a[8:11] offset:0
  s_waitcnt lgkmcnt(9)
  v_mfma_f32_32x32x16_bf16 a[48:63], v[36:39], v[128:131], 0
  ds_read_b64_tr_b16 v[52:53], v23 offset:4096
  ds_read_b64_tr_b16 v[54:55], v23 offset:5120
  s_add_u32 s73, s66, 4096
  buffer_load_dwordx4 v[112:115], v2, s[8:11], s73 offen offset:0 sc1
  ds_write_b128 v123, a[12:15] offset:0
  s_waitcnt vmcnt(19) lgkmcnt(10)
  v_mfma_f32_32x32x16_bf16 a[32:47], v[40:43], v[132:135], a[32:47]
  ds_read_b64_tr_b16 v[32:33], v22 offset:6144
  ds_read_b64_tr_b16 v[34:35], v22 offset:7168
  ds_write_b128 v124, a[16:19] offset:0
  ds_write_b128 v125, a[20:23] offset:0
  ds_write_b128 v126, a[24:27] offset:0
  s_waitcnt lgkmcnt(13)
  v_mfma_f32_32x32x16_bf16 a[48:63], v[44:47], v[132:135], a[48:63]
  ds_read_b64_tr_b16 v[36:37], v23 offset:6144
  ds_read_b64_tr_b16 v[38:39], v23 offset:7168
  buffer_load_dwordx4 v[116:119], v2, s[8:11], s73 offen offset:1024 sc1
  ds_write_b128 v127, a[28:31] offset:0
  s_waitcnt vmcnt(19) lgkmcnt(14)
  v_mfma_f32_32x32x16_bf16 a[32:47], v[48:51], v[136:139], a[32:47]
  ds_read_b64_tr_b16 v[40:41], v22 offset:12288
  ds_read_b64_tr_b16 v[42:43], v22 offset:13312
  s_waitcnt lgkmcnt(11)
  v_mfma_f32_32x32x16_bf16 a[48:63], v[52:55], v[136:139], a[48:63]
  ds_read_b64_tr_b16 v[44:45], v23 offset:12288
  ds_read_b64_tr_b16 v[46:47], v23 offset:13312
  s_add_u32 s73, s67, 4096
  buffer_load_dwordx4 v[80:83], v2, s[8:11], s73 offen offset:0 sc1
  s_waitcnt vmcnt(19) lgkmcnt(10)
  v_mfma_f32_32x32x16_bf16 a[32:47], v[32:35], v[140:143], a[32:47]
  ds_read_b64_tr_b16 v[48:49], v22 offset:14336
  ds_read_b64_tr_b16 v[50:51], v22 offset:15360
  s_waitcnt lgkmcnt(7)
  v_mfma_f32_32x32x16_bf16 a[48:63], v[36:39], v[140:143], a[48:63]
  ds_read_b64_tr_b16 v[52:53], v23 offset:14336
  ds_read_b64_tr_b16 v[54:55], v23 offset:15360
  buffer_load_dwordx4 v[84:87], v2, s[8:11], s73 offen offset:1024 sc1
  s_waitcnt vmcnt(19) lgkmcnt(6)
  v_mfma_f32_32x32x16_bf16 a[32:47], v[40:43], v[144:147], a[32:47]
  ds_read_b64_tr_b16 v[32:33], v22 offset:16384
  ds_read_b64_tr_b16 v[34:35], v22 offset:17408
  s_waitcnt lgkmcnt(6)
  v_mfma_f32_32x32x16_bf16 a[48:63], v[44:47], v[144:147], a[48:63]
  ds_read_b64_tr_b16 v[36:37], v23 offset:16384
  ds_read_b64_tr_b16 v[38:39], v23 offset:17408
  s_waitcnt vmcnt(18) lgkmcnt(6)
  v_mfma_f32_32x32x16_bf16 a[32:47], v[48:51], v[148:151], a[32:47]
  ds_read_b64_tr_b16 v[40:41], v22 offset:18432
  ds_read_b64_tr_b16 v[42:43], v22 offset:19456
  s_waitcnt lgkmcnt(6)
  v_mfma_f32_32x32x16_bf16 a[48:63], v[52:55], v[148:151], a[48:63]
  ds_read_b64_tr_b16 v[44:45], v23 offset:18432
  ds_read_b64_tr_b16 v[46:47], v23 offset:19456
  s_waitcnt vmcnt(17) lgkmcnt(6)
  v_mfma_f32_32x32x16_bf16 a[32:47], v[32:35], v[152:155], a[32:47]
  ds_read_b64_tr_b16 v[48:49], v22 offset:24576
  ds_read_b64_tr_b16 v[50:51], v22 offset:25600
  s_waitcnt lgkmcnt(6)
  v_mfma_f32_32x32x16_bf16 a[48:63], v[36:39], v[152:155], a[48:63]
  ds_read_b64_tr_b16 v[52:53], v23 offset:24576
  ds_read_b64_tr_b16 v[54:55], v23 offset:25600
  s_waitcnt vmcnt(16) lgkmcnt(6)
  v_mfma_f32_32x32x16_bf16 a[32:47], v[40:43], v[156:159], a[32:47]
  ds_read_b64_tr_b16 v[32:33], v22 offset:26624
  ds_read_b64_tr_b16 v[34:35], v22 offset:27648
  s_waitcnt lgkmcnt(6)
  v_mfma_f32_32x32x16_bf16 a[48:63], v[44:47], v[156:159], a[48:63]
  ds_read_b64_tr_b16 v[36:37], v23 offset:26624
  ds_read_b64_tr_b16 v[38:39], v23 offset:27648
  s_waitcnt vmcnt(15) lgkmcnt(6)
  v_mfma_f32_32x32x16_bf16 a[32:47], v[48:51], v[160:163], a[32:47]
  ds_read_b64_tr_b16 v[40:41], v22 offset:28672
  ds_read_b64_tr_b16 v[42:43], v22 offset:29696
  s_waitcnt lgkmcnt(6)
  v_mfma_f32_32x32x16_bf16 a[48:63], v[52:55], v[160:163], a[48:63]
  ds_read_b64_tr_b16 v[44:45], v23 offset:28672
  ds_read_b64_tr_b16 v[46:47], v23 offset:29696
  s_waitcnt vmcnt(14) lgkmcnt(6)
  v_mfma_f32_32x32x16_bf16 a[32:47], v[32:35], v[164:167], a[32:47]
  ds_read_b64_tr_b16 v[48:49], v22 offset:30720
  ds_read_b64_tr_b16 v[50:51], v22 offset:31744
  s_waitcnt lgkmcnt(6)
  v_mfma_f32_32x32x16_bf16 a[48:63], v[36:39], v[164:167], a[48:63]
  ds_read_b64_tr_b16 v[52:53], v23 offset:30720
  ds_read_b64_tr_b16 v[54:55], v23 offset:31744
  s_barrier
  s_waitcnt vmcnt(13) lgkmcnt(6)
  v_mfma_f32_32x32x16_bf16 a[32:47], v[40:43], v[168:171], a[32:47]
  ds_read_b64_tr_b16 v[32:33], v17 offset:36864
  ds_read_b64_tr_b16 v[34:35], v17 offset:37888
  ds_read_b128 v[192:195], v25 offset:0
  ds_read_b128 v[208:211], v25 offset:16384
  ds_read_b128 v[196:199], v26 offset:0
  s_waitcnt lgkmcnt(9)
  v_mfma_f32_32x32x16_bf16 a[48:63], v[44:47], v[168:171], a[48:63]
  ds_read_b64_tr_b16 v[36:37], v18 offset:36864
  ds_read_b64_tr_b16 v[38:39], v18 offset:37888
  ds_read_b128 v[212:215], v26 offset:16384
  ds_read_b128 v[200:203], v25 offset:8192
  ds_read_b128 v[216:219], v25 offset:24576
  s_waitcnt vmcnt(12) lgkmcnt(12)
  v_mfma_f32_32x32x16_bf16 a[32:47], v[48:51], v[172:175], a[32:47]
  ds_read_b64_tr_b16 v[40:41], v17 offset:38912
  ds_read_b64_tr_b16 v[42:43], v17 offset:39936
  ds_read_b128 v[204:207], v26 offset:8192
  ds_read_b128 v[220:223], v26 offset:24576
  v_lshlrev_b32 v64, 16, v56
  s_waitcnt lgkmcnt(14)
  v_mfma_f32_32x32x16_bf16 a[48:63], v[52:55], v[172:175], a[48:63]
  ds_read_b64_tr_b16 v[44:45], v18 offset:38912
  ds_read_b64_tr_b16 v[46:47], v18 offset:39936
  v_and_b32 v65, 0xffff0000, v56
  v_lshlrev_b32_e64 v66, 16, v57
  v_and_b32 v67, 0xffff0000, v57
  s_waitcnt vmcnt(11) lgkmcnt(14)
  v_mfma_f32_32x32x16_bf16 a[32:47], v[32:35], v[176:179], a[32:47]
  ds_read_b64_tr_b16 v[48:49], v17 offset:40960
  ds_read_b64_tr_b16 v[50:51], v17 offset:41984
  v_lshlrev_b32 v68, 16, v58
  v_and_b32 v69, 0xffff0000, v58
  v_lshlrev_b32 v70, 16, v59
  s_waitcnt lgkmcnt(11)
  v_mfma_f32_32x32x16_bf16 a[48:63], v[36:39], v[176:179], a[48:63]
  ds_read_b64_tr_b16 v[52:53], v18 offset:40960
  ds_read_b64_tr_b16 v[54:55], v18 offset:41984
  v_and_b32 v71, 0xffff0000, v59
  v_lshlrev_b32_e64 v72, 16, v60
  v_and_b32 v73, 0xffff0000, v60
  s_waitcnt vmcnt(10) lgkmcnt(8)
  v_mfma_f32_32x32x16_bf16 a[32:47], v[40:43], v[180:183], a[32:47]
  ds_read_b64_tr_b16 v[32:33], v17 offset:43008
  ds_read_b64_tr_b16 v[34:35], v17 offset:44032
  v_lshlrev_b32 v74, 16, v61
  v_and_b32 v75, 0xffff0000, v61
  v_lshlrev_b32 v76, 16, v62
  s_waitcnt lgkmcnt(6)
  v_mfma_f32_32x32x16_bf16 a[48:63], v[44:47], v[180:183], a[48:63]
  ds_read_b64_tr_b16 v[36:37], v18 offset:43008
  ds_read_b64_tr_b16 v[38:39], v18 offset:44032
  v_and_b32 v77, 0xffff0000, v62
  v_lshlrev_b32_e64 v78, 16, v63
  v_and_b32 v79, 0xffff0000, v63
  s_waitcnt vmcnt(9) lgkmcnt(6)
  v_mfma_f32_32x32x16_bf16 a[32:47], v[48:51], v[184:187], a[32:47]
  ds_read_b64_tr_b16 v[40:41], v22 offset:8192
  ds_read_b64_tr_b16 v[42:43], v22 offset:9216
  v_add_f32 v192, v192, v208
  v_add_f32 v193, v193, v209
  v_add_f32_e64 v194, v194, v210
  s_waitcnt lgkmcnt(6)
  v_mfma_f32_32x32x16_bf16 a[48:63], v[52:55], v[184:187], a[48:63]
  ds_read_b64_tr_b16 v[44:45], v23 offset:8192
  ds_read_b64_tr_b16 v[46:47], v23 offset:9216
  v_add_f32 v195, v195, v211
  v_add_f32 v196, v196, v212
  v_add_f32 v197, v197, v213
  s_waitcnt vmcnt(8) lgkmcnt(6)
  v_mfma_f32_32x32x16_bf16 a[32:47], v[32:35], v[188:191], a[32:47]
  ds_read_b64_tr_b16 v[48:49], v22 offset:10240
  ds_read_b64_tr_b16 v[50:51], v22 offset:11264
  v_add_f32 v198, v198, v214
  v_add_f32 v199, v199, v215
  v_add_f32 v200, v200, v216
  s_waitcnt lgkmcnt(6)
  v_mfma_f32_32x32x16_bf16 a[48:63], v[36:39], v[188:191], a[48:63]
  ds_read_b64_tr_b16 v[52:53], v23 offset:10240
  ds_read_b64_tr_b16 v[54:55], v23 offset:11264
  v_add_f32 v201, v201, v217
  v_add_f32 v202, v202, v218
  v_add_f32 v203, v203, v219
  s_waitcnt vmcnt(7) lgkmcnt(6)
  v_mfma_f32_32x32x16_bf16 a[32:47], v[40:43], v[96:99], a[32:47]
  ds_read_b64_tr_b16 v[32:33], v22 offset:20480
  ds_read_b64_tr_b16 v[34:35], v22 offset:21504
  v_add_f32 v204, v204, v220
  v_add_f32 v205, v205, v221
  v_add_f32 v206, v206, v222
  s_waitcnt lgkmcnt(6)
  v_mfma_f32_32x32x16_bf16 a[48:63], v[44:47], v[96:99], a[48:63]
  ds_read_b64_tr_b16 v[36:37], v23 offset:20480
  ds_read_b64_tr_b16 v[38:39], v23 offset:21504
  v_add_f32 v207, v207, v223
  s_waitcnt vmcnt(6) lgkmcnt(6)
  v_mfma_f32_32x32x16_bf16 a[32:47], v[48:51], v[100:103], a[32:47]
  ds_read_b64_tr_b16 v[40:41], v22 offset:22528
  ds_read_b64_tr_b16 v[42:43], v22 offset:23552
  s_waitcnt lgkmcnt(6)
  v_mfma_f32_32x32x16_bf16 a[48:63], v[52:55], v[100:103], a[48:63]
  ds_read_b64_tr_b16 v[44:45], v23 offset:22528
  ds_read_b64_tr_b16 v[46:47], v23 offset:23552
  s_waitcnt vmcnt(5) lgkmcnt(6)
  v_mfma_f32_32x32x16_bf16 a[32:47], v[32:35], v[104:107], a[32:47]
  ds_read_b64_tr_b16 v[48:49], v22 offset:32768
  ds_read_b64_tr_b16 v[50:51], v22 offset:33792
  s_waitcnt lgkmcnt(6)
  v_mfma_f32_32x32x16_bf16 a[48:63], v[36:39], v[104:107], a[48:63]
  ds_read_b64_tr_b16 v[52:53], v23 offset:32768
  ds_read_b64_tr_b16 v[54:55], v23 offset:33792
  s_waitcnt vmcnt(4) lgkmcnt(6)
  v_mfma_f32_32x32x16_bf16 a[32:47], v[40:43], v[108:111], a[32:47]
  ds_read_b64_tr_b16 v[32:33], v22 offset:34816
  ds_read_b64_tr_b16 v[34:35], v22 offset:35840
  s_waitcnt lgkmcnt(6)
  v_mfma_f32_32x32x16_bf16 a[48:63], v[44:47], v[108:111], a[48:63]
  ds_read_b64_tr_b16 v[36:37], v23 offset:34816
  ds_read_b64_tr_b16 v[38:39], v23 offset:35840
  s_waitcnt vmcnt(3) lgkmcnt(6)
  v_mfma_f32_32x32x16_bf16 a[32:47], v[48:51], v[112:115], a[32:47]
  ds_read_b64_tr_b16 v[40:41], v17 offset:45056
  ds_read_b64_tr_b16 v[42:43], v17 offset:46080
  s_waitcnt lgkmcnt(6)
  v_mfma_f32_32x32x16_bf16 a[48:63], v[52:55], v[112:115], a[48:63]
  ds_read_b64_tr_b16 v[44:45], v18 offset:45056
  ds_read_b64_tr_b16 v[46:47], v18 offset:46080
  s_waitcnt vmcnt(2) lgkmcnt(6)
  v_mfma_f32_32x32x16_bf16 a[32:47], v[32:35], v[116:119], a[32:47]
  ds_read_b64_tr_b16 v[48:49], v17 offset:47104
  ds_read_b64_tr_b16 v[50:51], v17 offset:48128
  s_waitcnt lgkmcnt(6)
  v_mfma_f32_32x32x16_bf16 a[48:63], v[36:39], v[116:119], a[48:63]
  ds_read_b64_tr_b16 v[52:53], v18 offset:47104
  ds_read_b64_tr_b16 v[54:55], v18 offset:48128
  s_waitcnt vmcnt(1) lgkmcnt(6)
  v_mfma_f32_32x32x16_bf16 a[32:47], v[40:43], v[80:83], a[32:47]
  s_waitcnt lgkmcnt(4)
  v_mfma_f32_32x32x16_bf16 a[48:63], v[44:47], v[80:83], a[48:63]
  s_waitcnt vmcnt(0) lgkmcnt(2)
  v_mfma_f32_32x32x16_bf16 a[32:47], v[48:51], v[84:87], a[32:47]
  s_waitcnt lgkmcnt(0)
  v_mfma_f32_32x32x16_bf16 a[48:63], v[52:55], v[84:87], a[48:63]
  s_nop 9
  ds_write_b128 v120, a[32:35] offset:32768
  ds_write_b128 v121, a[36:39] offset:32768
  ds_write_b128 v122, a[40:43] offset:32768
  ds_write_b128 v123, a[44:47] offset:32768
  ds_write_b128 v124, a[48:51] offset:32768
  ds_write_b128 v125, a[52:55] offset:32768
  ds_write_b128 v126, a[56:59] offset:32768
  ds_write_b128 v127, a[60:63] offset:32768
  s_waitcnt lgkmcnt(0)
  s_barrier
  ds_read_b128 v[128:131], v25 offset:32768
  ds_read_b128 v[144:147], v25 offset:49152
  ds_read_b128 v[132:135], v26 offset:32768
  ds_read_b128 v[148:151], v26 offset:49152
  ds_read_b128 v[136:139], v25 offset:40960
  ds_read_b128 v[152:155], v25 offset:57344
  ds_read_b128 v[140:143], v26 offset:40960
  ds_read_b128 v[156:159], v26 offset:57344
  s_waitcnt lgkmcnt(6)
  v_pk_add_f32 v[128:129], v[128:129], v[144:145] op_sel:[0,0] op_sel_hi:[1,1]
  v_pk_add_f32 v[130:131], v[130:131], v[146:147] op_sel:[0,0] op_sel_hi:[1,1]
  s_waitcnt lgkmcnt(4)
  v_pk_add_f32 v[132:133], v[132:133], v[148:149] op_sel:[0,0] op_sel_hi:[1,1]
  v_pk_add_f32 v[134:135], v[134:135], v[150:151] op_sel:[0,0] op_sel_hi:[1,1]
  s_waitcnt lgkmcnt(2)
  v_pk_add_f32 v[136:137], v[136:137], v[152:153] op_sel:[0,0] op_sel_hi:[1,1]
  v_pk_add_f32 v[138:139], v[138:139], v[154:155] op_sel:[0,0] op_sel_hi:[1,1]
  s_waitcnt lgkmcnt(0)
  v_pk_add_f32 v[140:141], v[140:141], v[156:157] op_sel:[0,0] op_sel_hi:[1,1]
  v_pk_add_f32 v[142:143], v[142:143], v[158:159] op_sel:[0,0] op_sel_hi:[1,1]
  v_pk_mul_f32 v[144:145], v[128:129], s[86:87] op_sel:[0,0] op_sel_hi:[1,1]
  v_pk_mul_f32 v[146:147], v[130:131], s[86:87] op_sel:[0,0] op_sel_hi:[1,1]
  v_pk_mul_f32 v[148:149], v[132:133], s[86:87] op_sel:[0,0] op_sel_hi:[1,1]
  v_pk_mul_f32 v[150:151], v[134:135], s[86:87] op_sel:[0,0] op_sel_hi:[1,1]
  v_pk_mul_f32 v[152:153], v[136:137], s[86:87] op_sel:[0,0] op_sel_hi:[1,1]
  v_pk_mul_f32 v[154:155], v[138:139], s[86:87] op_sel:[0,0] op_sel_hi:[1,1]
  v_pk_mul_f32 v[156:157], v[140:141], s[86:87] op_sel:[0,0] op_sel_hi:[1,1]
  v_pk_mul_f32 v[158:159], v[142:143], s[86:87] op_sel:[0,0] op_sel_hi:[1,1]
  v_exp_f32 v144, -v144
  v_exp_f32 v145, -v145
  v_exp_f32 v146, -v146
  v_exp_f32 v147, -v147
  v_exp_f32 v148, -v148
  v_exp_f32 v149, -v149
  v_exp_f32 v150, -v150
  v_exp_f32 v151, -v151
  v_exp_f32 v152, -v152
  v_exp_f32 v153, -v153
  v_exp_f32 v154, -v154
  v_exp_f32 v155, -v155
  v_exp_f32 v156, -v156
  v_exp_f32 v157, -v157
  v_exp_f32 v158, -v158
  v_exp_f32 v159, -v159
  v_pk_mul_f32 v[128:129], v[128:129], v[192:193] op_sel:[0,0] op_sel_hi:[1,1]
  v_pk_mul_f32 v[130:131], v[130:131], v[194:195] op_sel:[0,0] op_sel_hi:[1,1]
  v_pk_mul_f32 v[132:133], v[132:133], v[196:197] op_sel:[0,0] op_sel_hi:[1,1]
  v_pk_mul_f32 v[134:135], v[134:135], v[198:199] op_sel:[0,0] op_sel_hi:[1,1]
  v_pk_mul_f32 v[136:137], v[136:137], v[200:201] op_sel:[0,0] op_sel_hi:[1,1]
  v_pk_mul_f32 v[138:139], v[138:139], v[202:203] op_sel:[0,0] op_sel_hi:[1,1]
  v_pk_mul_f32 v[140:141], v[140:141], v[204:205] op_sel:[0,0] op_sel_hi:[1,1]
  v_pk_mul_f32 v[142:143], v[142:143], v[206:207] op_sel:[0,0] op_sel_hi:[1,1]
  v_add_f32 v144, 1.0, v144
  v_add_f32 v145, 1.0, v145
  v_add_f32 v146, 1.0, v146
  v_add_f32 v147, 1.0, v147
  v_add_f32 v148, 1.0, v148
  v_add_f32 v149, 1.0, v149
  v_add_f32 v150, 1.0, v150
  v_add_f32 v151, 1.0, v151
  v_add_f32 v152, 1.0, v152
  v_add_f32 v153, 1.0, v153
  v_add_f32 v154, 1.0, v154
  v_add_f32 v155, 1.0, v155
  v_add_f32 v156, 1.0, v156
  v_add_f32 v157, 1.0, v157
  v_add_f32 v158, 1.0, v158
  v_add_f32 v159, 1.0, v159
  v_rcp_f32 v144, v144
  v_rcp_f32 v145, v145
  v_rcp_f32 v146, v146
  v_rcp_f32 v147, v147
  v_rcp_f32 v148, v148
  v_rcp_f32 v149, v149
  v_rcp_f32 v150, v150
  v_rcp_f32 v151, v151
  v_pk_fma_f32 v[128:129], v[128:129], v[144:145], v[64:65] op_sel:[0,0,0] op_sel_hi:[1,1,1]
  v_pk_fma_f32 v[130:131], v[130:131], v[146:147], v[66:67] op_sel:[0,0,0] op_sel_hi:[1,1,1]
  v_pk_fma_f32 v[132:133], v[132:133], v[148:149], v[68:69] op_sel:[0,0,0] op_sel_hi:[1,1,1]
  v_pk_fma_f32 v[134:135], v[134:135], v[150:151], v[70:71] op_sel:[0,0,0] op_sel_hi:[1,1,1]
  v_cvt_pk_bf16_f32 v144, v128, v129
  v_cvt_pk_bf16_f32 v145, v130, v131
  v_cvt_pk_bf16_f32 v146, v132, v133
  v_cvt_pk_bf16_f32 v147, v134, v135
  buffer_store_dwordx4 v[144:147], v27, s[20:23], s82 offen sc1
  v_rcp_f32 v152, v152
  v_rcp_f32 v153, v153
  v_rcp_f32 v154, v154
  v_rcp_f32 v155, v155
  v_rcp_f32 v156, v156
  v_rcp_f32 v157, v157
  v_rcp_f32 v158, v158
  v_rcp_f32 v159, v159
  v_pk_fma_f32 v[136:137], v[136:137], v[152:153], v[72:73] op_sel:[0,0,0] op_sel_hi:[1,1,1]
  v_pk_fma_f32 v[138:139], v[138:139], v[154:155], v[74:75] op_sel:[0,0,0] op_sel_hi:[1,1,1]
  v_pk_fma_f32 v[140:141], v[140:141], v[156:157], v[76:77] op_sel:[0,0,0] op_sel_hi:[1,1,1]
  v_pk_fma_f32 v[142:143], v[142:143], v[158:159], v[78:79] op_sel:[0,0,0] op_sel_hi:[1,1,1]
  v_cvt_pk_bf16_f32 v152, v136, v137
  v_cvt_pk_bf16_f32 v153, v138, v139
  v_cvt_pk_bf16_f32 v154, v140, v141
  v_cvt_pk_bf16_f32 v155, v142, v143
  buffer_store_dwordx4 v[152:155], v27, s[20:23], s91 offen sc1
END:
  s_endpgm
LIGHT:
  s_waitcnt vmcnt(16)
  s_lshr_b32 s74, s90, 1
  s_lshl_b32 s74, s74, 7
  s_lshl_b32 s73, s46, 3
  s_add_u32 s74, s74, s73
  s_lshl_b32 s73, s96, 2
  s_add_u32 s74, s74, s73
  s_add_u32 s74, s74, 16384
  v_mov_b32 v3, s71
  s_mov_b64 exec, 1
  buffer_store_dword v3, off, s[8:11], s74 sc1
  s_mov_b64 exec, -1
  ds_read_b128 a[64:67], v26 offset:32768
  ds_read_b128 a[68:71], v27 offset:32768
  ds_read_b128 a[72:75], v28 offset:32768
  ds_read_b128 a[76:79], v29 offset:32768
  ds_read_b128 a[192:195], v30 offset:32768
  ds_read_b128 a[196:199], v31 offset:32768
  ds_read_b128 a[200:203], v32 offset:32768
  ds_read_b128 a[204:207], v33 offset:32768
  ds_read_b128 a[80:83], v30 offset:49152
  ds_read_b128 a[84:87], v31 offset:49152
  ds_read_b128 a[88:91], v32 offset:49152
  ds_read_b128 a[92:95], v33 offset:49152
  ds_read_b128 a[208:211], v30 offset:16384
  ds_read_b128 a[212:215], v31 offset:16384
  ds_read_b128 a[216:219], v32 offset:16384
  ds_read_b128 a[220:223], v33 offset:16384
  s_waitcnt vmcnt(13)
  ds_read_b128 a[96:99], v26 offset:16384
  ds_read_b128 a[100:103], v27 offset:16384
  ds_read_b128 a[104:107], v28 offset:16384
  ds_read_b128 a[108:111], v29 offset:16384
  s_waitcnt vmcnt(9)
  ds_read_b128 a[224:227], v26 offset:49152
  ds_read_b128 a[228:231], v27 offset:49152
  ds_read_b128 a[232:235], v28 offset:49152
  ds_read_b128 a[236:239], v29 offset:49152
  s_waitcnt vmcnt(5)
  ds_read_b128 a[112:115], v26 offset:0
  ds_read_b128 a[116:119], v27 offset:0
  ds_read_b128 a[120:123], v28 offset:0
  ds_read_b128 a[124:127], v29 offset:0
  s_waitcnt vmcnt(1)
  ds_read_b128 a[240:243], v30 offset:0
  ds_read_b128 a[244:247], v31 offset:0
  ds_read_b128 a[248:251], v32 offset:0
  ds_read_b128 a[252:255], v33 offset:0
  s_xor_b64 s[48:49], s[48:49], s[70:71]
  s_xor_b64 s[50:51], s[50:51], s[70:71]
  s_xor_b64 s[52:53], s[52:53], s[70:71]
  s_xor_b64 s[54:55], s[54:55], s[70:71]
  s_xor_b64 s[56:57], s[56:57], s[70:71]
  s_xor_b64 s[58:59], s[58:59], s[70:71]
  s_xor_b64 s[60:61], s[60:61], s[70:71]
  s_xor_b64 s[62:63], s[62:63], s[70:71]
  s_xor_b64 s[24:25], s[24:25], s[70:71]
  s_xor_b64 s[26:27], s[26:27], s[70:71]
  s_xor_b64 s[28:29], s[28:29], s[70:71]
  s_xor_b64 s[30:31], s[30:31], s[70:71]
  s_or_b64 s[48:49], s[48:49], s[50:51]
  s_or_b64 s[52:53], s[52:53], s[54:55]
  s_or_b64 s[56:57], s[56:57], s[58:59]
  s_or_b64 s[60:61], s[60:61], s[62:63]
  s_or_b64 s[24:25], s[24:25], s[26:27]
  s_or_b64 s[28:29], s[28:29], s[30:31]
  s_or_b64 s[48:49], s[48:49], s[52:53]
  s_or_b64 s[56:57], s[56:57], s[60:61]
  s_or_b64 s[24:25], s[24:25], s[28:29]
  s_or_b64 s[48:49], s[48:49], s[56:57]
  s_or_b64 s[48:49], s[48:49], s[24:25]
  s_cbranch_scc1 SLOW_F1L
RET_F1L:
  s_mov_b32 s73, s91
  s_lshl_b32 s91, s73, 17
  s_lshl_b32 s74, s44, 15
  s_add_u32 s91, s91, s74
  s_add_u32 s91, s91, 12582912
  s_lshl_b32 s75, s96, 8
  v_xor_b32 v5, s75, v2
  s_lshl_b32 s73, s73, 1
  s_add_u32 s73, s73, s96
  s_lshl_b32 s74, s47, 1
  s_add_u32 s74, s74, s95
  s_mul_i32 s76, s74, 43
  s_add_u32 s75, s76, s73
  s_lshl_b32 s75, s75, 10
  s_add_u32 s92, s75, 9436160
  s_add_u32 s93, s75, 6290432
  s_cmp_eq_u32 s73, 0
  s_cselect_b32 s92, 2130706432, s92
  s_cselect_b32 s93, 2130706432, s93
  s_lshl_b32 s75, s74, 6
  v_and_b32 v44, 31, v1
  v_lshlrev_b32 v44, 1, v44
  buffer_load_ushort v6, v44, s[36:39], s75 offen
  s_lshl_b32 s76, s76, 10
  s_add_u32 s77, s76, 9437184
  s_mul_i32 s75, s96, 24576
  s_add_u32 s75, s75, s77
  s_add_u32 s64, s75, 1024
  s_add_u32 s65, s64, 6144
  s_add_u32 s66, s64, 12288
  s_add_u32 s67, s64, 18432
  s_cmp_eq_u32 s96, 1
  s_cselect_b32 s77, s77, s67
  s_cselect_b32 s67, 2130706432, s67
  s_lshl_b32 s74, s74, 15
  s_lshl_b32 s75, s96, 14
  s_add_u32 s74, s74, s75
  s_add_u32 s78, s74, 4194304
  s_add_u32 s79, s78, 4096
  s_add_u32 s80, s78, 8192
  s_add_u32 s81, s78, 12288
  s_lshl_b32 s94, s83, 7
  s_lshl_b32 s97, s47, 16
  s_add_u32 s82, s97, s94
  s_lshl_b32 s73, s47, 7
  s_add_u32 s40, s73, 16384
  s_lshl_b32 s74, s96, 6
  s_add_u32 s74, s74, s73
  s_add_u32 s41, s74, 24576
  s_lshl_b32 s74, s95, 6
  s_add_u32 s73, s73, s74
  s_add_u32 s42, s73, 32768
  s_xor_b32 s73, s44, 1
  s_mul_i32 s73, s73, 6144
  s_add_u32 s73, s73, 139264
  v_add_u32 v7, s73, v2
  s_xor_b32 s73, s44, 2
  s_mul_i32 s73, s73, 6144
  s_add_u32 s73, s73, 141312
  v_add_u32 v8, s73, v2
  s_xor_b32 s73, s44, 3
  s_mul_i32 s73, s73, 6144
  s_add_u32 s73, s73, 143360
  v_add_u32_e64 v9, s73, v2
  s_mul_i32 s73, s44, 6144
  s_add_u32 s73, s73, 139264
  v_add_u32 v10, s73, v2
  v_lshrrev_b32 v44, 3, v1
  v_bfe_u32 v45, v1, 4, 1
  v_lshlrev_b32 v45, 2, v45
  v_and_b32 v46, 7, v1
  v_xor_b32 v45, v45, v46
  v_lshlrev_b32 v45, 4, v45
  v_lshl_add_u32 v13, v44, 10, v45
  v_add_u32 v14, 7168, v13
  v_add_u32 v15, 14336, v13
  v_add_u32 v16, 21504, v13
  s_add_u32 s75, s1, 0
  s_and_b32 s75, s75, 7
  s_mul_i32 s75, s75, 4096
  s_add_u32 s75, s75, s91
  buffer_load_dwordx4 v[128:131], v5, s[8:11], s75 offen offset:0 sc1
  buffer_load_dwordx4 v[132:135], v5, s[8:11], s75 offen offset:1024 sc1
  buffer_load_dwordx4 v[136:139], v5, s[8:11], s75 offen offset:2048 sc1
  buffer_load_dwordx4 v[140:143], v5, s[8:11], s75 offen offset:3072 sc1
  s_add_u32 s75, s1, 1
  s_and_b32 s75, s75, 7
  s_mul_i32 s75, s75, 4096
  s_add_u32 s75, s75, s91
  buffer_load_dwordx4 v[144:147], v5, s[8:11], s75 offen offset:0 sc1
  buffer_load_dwordx4 v[148:151], v5, s[8:11], s75 offen offset:1024 sc1
  buffer_load_dwordx4 v[152:155], v5, s[8:11], s75 offen offset:2048 sc1
  buffer_load_dwordx4 v[156:159], v5, s[8:11], s75 offen offset:3072 sc1
  s_add_u32 s75, s1, 2
  s_and_b32 s75, s75, 7
  s_mul_i32 s75, s75, 4096
  s_add_u32 s75, s75, s91
  buffer_load_dwordx4 v[160:163], v5, s[8:11], s75 offen offset:0 sc1
  buffer_load_dwordx4 v[164:167], v5, s[8:11], s75 offen offset:1024 sc1
  buffer_load_dwordx4 v[168:171], v5, s[8:11], s75 offen offset:2048 sc1
  buffer_load_dwordx4 v[172:175], v5, s[8:11], s75 offen offset:3072 sc1
  s_add_u32 s75, s1, 3
  s_and_b32 s75, s75, 7
  s_mul_i32 s75, s75, 4096
  s_add_u32 s75, s75, s91
  buffer_load_dwordx4 v[176:179], v5, s[8:11], s75 offen offset:0 sc1
  buffer_load_dwordx4 v[180:183], v5, s[8:11], s75 offen offset:1024 sc1
  s_waitcnt vmcnt(14)
  v_lshlrev_b32_e64 v6, 16, v6
  s_lshl_b32 s73, s44, 19
  s_lshl_b32 s74, s47, 12
  s_add_u32 s73, s73, s74
  s_add_u32 s98, s73, 16777216
  s_add_u32 s99, s98, 131072
  s_add_u32 s100, s98, 262144
  s_add_u32 s101, s98, 393216
  v_and_b32 v12, 31, v1
  s_and_b32 s73, s47, 1
  s_mul_i32 s74, s73, 15
  s_mul_i32 s73, s73, 15
  s_add_u32 s73, s73, 16
  v_max_u32 v12, s74, v12
  v_min_u32 v12, s73, v12
  v_and_b32 v11, 32, v1
  v_add_u32 v12, v12, v11
  v_lshlrev_b32 v12, 4, v12
  buffer_load_dwordx4 v[192:195], v12, s[8:11], s98 offen offset:0 sc1
  buffer_load_dwordx4 v[196:199], v12, s[8:11], s98 offen offset:1024 sc1
  buffer_load_dwordx4 v[200:203], v12, s[8:11], s98 offen offset:2048 sc1
  buffer_load_dwordx4 v[204:207], v12, s[8:11], s98 offen offset:3072 sc1
  buffer_load_dwordx4 v[208:211], v12, s[8:11], s99 offen offset:0 sc1
  buffer_load_dwordx4 v[212:215], v12, s[8:11], s99 offen offset:1024 sc1
  buffer_load_dwordx4 v[216:219], v12, s[8:11], s99 offen offset:2048 sc1
  buffer_load_dwordx4 v[220:223], v12, s[8:11], s99 offen offset:3072 sc1
  buffer_load_dwordx4 v[224:227], v12, s[8:11], s100 offen offset:0 sc1
  buffer_load_dwordx4 v[228:231], v12, s[8:11], s100 offen offset:1024 sc1
  buffer_load_dwordx4 v[232:235], v12, s[8:11], s100 offen offset:2048 sc1
  buffer_load_dwordx4 v[236:239], v12, s[8:11], s100 offen offset:3072 sc1
  buffer_load_dwordx4 v[240:243], v12, s[8:11], s101 offen offset:0 sc1
  buffer_load_dwordx4 v[244:247], v12, s[8:11], s101 offen offset:1024 sc1
  buffer_load_dwordx4 v[248:251], v12, s[8:11], s101 offen offset:2048 sc1
  buffer_load_dwordx4 v[252:255], v12, s[8:11], s101 offen offset:3072 sc1
  s_lshl_b32 s73, s44, 11
  s_add_u32 s73, s73, 139264
  v_add_u32 v52, s73, v2
  v_add_u32 v53, 139264, v2
  s_waitcnt vmcnt(15)
  v_xor_b32 v193, s71, v193
  v_xor_b32 v195, s71, v195
  s_waitcnt vmcnt(14)
  v_xor_b32 v197, s71, v197
  v_xor_b32 v199, s71, v199
  s_waitcnt vmcnt(13)
  v_xor_b32 v201, s71, v201
  v_xor_b32 v203, s71, v203
  s_waitcnt vmcnt(12)
  v_xor_b32 v205, s71, v205
  v_xor_b32 v207, s71, v207
  s_waitcnt vmcnt(11)
  v_xor_b32 v209, s71, v209
  v_xor_b32 v211, s71, v211
  s_waitcnt vmcnt(10)
  v_xor_b32 v213, s71, v213
  v_xor_b32 v215, s71, v215
  s_waitcnt vmcnt(9)
  v_xor_b32 v217, s71, v217
  v_xor_b32 v219, s71, v219
  s_waitcnt vmcnt(8)
  v_xor_b32 v221, s71, v221
  v_xor_b32 v223, s71, v223
  s_waitcnt vmcnt(7)
  v_xor_b32 v225, s71, v225
  v_xor_b32 v227, s71, v227
  s_waitcnt vmcnt(6)
  v_xor_b32 v229, s71, v229
  v_xor_b32 v231, s71, v231
  s_waitcnt vmcnt(5)
  v_xor_b32 v233, s71, v233
  v_xor_b32 v235, s71, v235
  s_waitcnt vmcnt(4)
  v_xor_b32 v237, s71, v237
  v_xor_b32 v239, s71, v239
  s_waitcnt vmcnt(3)
  v_xor_b32 v241, s71, v241
  v_xor_b32 v243, s71, v243
  s_waitcnt vmcnt(2)
  v_xor_b32 v245, s71, v245
  v_xor_b32 v247, s71, v247
  s_waitcnt vmcnt(1)
  v_xor_b32 v249, s71, v249
  v_xor_b32 v251, s71, v251
  s_waitcnt vmcnt(0)
  v_xor_b32 v253, s71, v253
  v_xor_b32 v255, s71, v255
  v_or3_b32 v48, v193, v195, v197
  v_or_b32_e64 v49, v199, v201
  v_or3_b32 v48, v48, v203, v205
  v_or3_b32 v49, v49, v207, v209
  v_or3_b32 v48, v48, v211, v213
  v_or3_b32 v49, v49, v215, v217
  v_or3_b32 v48, v48, v219, v221
  v_or3_b32 v49, v49, v223, v225
  v_or3_b32 v48, v48, v227, v229
  v_or3_b32 v49, v49, v231, v233
  v_or3_b32 v48, v48, v235, v237
  v_or3_b32 v49, v49, v239, v241
  v_or3_b32 v48, v48, v243, v245
  v_or3_b32 v49, v49, v247, v249
  v_or3_b32 v48, v48, v251, v253
  v_or3_b32 v48, v48, v49, v255
  v_cmp_ne_u32_e64 vcc, 0, v48
  s_nop 0
  s_cbranch_vccnz SLOW_KVP
RET_KVP:
  s_buffer_load_dwordx16 s[48:63], s[8:11], s40
  s_buffer_load_dwordx16 s[24:39], s[8:11], s40 offset:64
  v_add_f32 v32, v192, v208
  v_add_f32 v40, v224, v240
  v_add_f32 v33, v194, v210
  v_add_f32 v41, v226, v242
  v_add_f32 v34, v196, v212
  v_add_f32 v42, v228, v244
  v_add_f32 v35, v198, v214
  v_add_f32 v43, v230, v246
  v_add_f32 v36, v200, v216
  v_add_f32 v44, v232, v248
  v_add_f32 v37, v202, v218
  v_add_f32 v45, v234, v250
  v_add_f32 v38, v204, v220
  v_add_f32 v46, v236, v252
  v_add_f32 v39, v206, v222
  v_add_f32 v47, v238, v254
  v_pk_add_f32 v[32:33], v[32:33], v[40:41] op_sel:[0,0] op_sel_hi:[1,1]
  v_pk_add_f32 v[34:35], v[34:35], v[42:43] op_sel:[0,0] op_sel_hi:[1,1]
  v_pk_add_f32 v[36:37], v[36:37], v[44:45] op_sel:[0,0] op_sel_hi:[1,1]
  v_pk_add_f32 v[38:39], v[38:39], v[46:47] op_sel:[0,0] op_sel_hi:[1,1]
  ds_write_b128 v52, v[32:35] offset:0
  ds_write_b128 v52, v[36:39] offset:1024
  s_waitcnt lgkmcnt(0)
  s_barrier
  ds_read_b128 v[96:99], v53 offset:0
  ds_read_b128 v[100:103], v53 offset:1024
  ds_read_b128 v[104:107], v53 offset:2048
  ds_read_b128 v[108:111], v53 offset:3072
  ds_read_b128 v[112:115], v53 offset:4096
  ds_read_b128 v[116:119], v53 offset:5120
  ds_read_b128 v[120:123], v53 offset:6144
  ds_read_b128 v[124:127], v53 offset:7168
  s_waitcnt lgkmcnt(5)
  v_pk_add_f32 v[96:97], v[96:97], v[104:105] op_sel:[0,0] op_sel_hi:[1,1]
  v_pk_add_f32 v[98:99], v[98:99], v[106:107] op_sel:[0,0] op_sel_hi:[1,1]
  s_waitcnt lgkmcnt(4)
  v_pk_add_f32 v[100:101], v[100:101], v[108:109] op_sel:[0,0] op_sel_hi:[1,1]
  v_pk_add_f32 v[102:103], v[102:103], v[110:111] op_sel:[0,0] op_sel_hi:[1,1]
  s_waitcnt lgkmcnt(1)
  v_pk_add_f32 v[112:113], v[112:113], v[120:121] op_sel:[0,0] op_sel_hi:[1,1]
  v_pk_add_f32 v[114:115], v[114:115], v[122:123] op_sel:[0,0] op_sel_hi:[1,1]
  s_waitcnt lgkmcnt(0)
  v_pk_add_f32 v[116:117], v[116:117], v[124:125] op_sel:[0,0] op_sel_hi:[1,1]
  v_pk_add_f32 v[118:119], v[118:119], v[126:127] op_sel:[0,0] op_sel_hi:[1,1]
  v_pk_add_f32 v[96:97], v[96:97], v[112:113] op_sel:[0,0] op_sel_hi:[1,1]
  v_pk_add_f32 v[98:99], v[98:99], v[114:115] op_sel:[0,0] op_sel_hi:[1,1]
  v_pk_add_f32 v[100:101], v[100:101], v[116:117] op_sel:[0,0] op_sel_hi:[1,1]
  v_pk_add_f32 v[102:103], v[102:103], v[118:119] op_sel:[0,0] op_sel_hi:[1,1]
  v_cvt_pk_bf16_f32 v32, v96, v97
  v_cvt_pk_bf16_f32 v34, v98, v99
  v_cvt_pk_bf16_f32 v36, v100, v101
  v_cvt_pk_bf16_f32 v38, v102, v103
  v_mov_b32 v33, s71
  v_mov_b32 v35, s71
  v_mov_b32 v37, s71
  v_mov_b32 v39, s71
  s_and_b32 s74, s47, 1
  s_lshl_b32 s74, s74, 8
  v_xor_b32 v40, s74, v2
  s_lshl_b32 s74, s47, 11
  s_add_u32 s74, s74, 524288
  s_cmp_eq_u32 s44, 0
  s_cselect_b32 s74, s74, 2130706432
  buffer_store_dwordx4 v[32:35], v40, s[8:11], s74 offen offset:0 sc1
  buffer_store_dwordx4 v[36:39], v40, s[8:11], s74 offen offset:1024 sc1
  v_mfma_f32_32x32x16_bf16 v[64:79], v[128:131], a[0:3], 0
  v_mfma_f32_32x32x16_bf16 v[80:95], v[128:131], a[128:131], 0
  buffer_load_dwordx4 v[128:131], v5, s[8:11], s75 offen offset:2048 sc1
  v_mfma_f32_32x32x16_bf16 v[64:79], v[132:135], a[4:7], v[64:79]
  v_mfma_f32_32x32x16_bf16 v[80:95], v[132:135], a[132:135], v[80:95]
  buffer_load_dwordx4 v[132:135], v5, s[8:11], s75 offen offset:3072 sc1
  v_mfma_f32_32x32x16_bf16 v[64:79], v[136:139], a[8:11], v[64:79]
  v_mfma_f32_32x32x16_bf16 v[80:95], v[136:139], a[136:139], v[80:95]
  s_add_u32 s75, s1, 4
  s_and_b32 s75, s75, 7
  s_mul_i32 s75, s75, 4096
  s_add_u32 s75, s75, s91
  buffer_load_dwordx4 v[136:139], v5, s[8:11], s75 offen offset:0 sc1
  v_mfma_f32_32x32x16_bf16 v[64:79], v[140:143], a[12:15], v[64:79]
  v_mfma_f32_32x32x16_bf16 v[80:95], v[140:143], a[140:143], v[80:95]
  buffer_load_dwordx4 v[140:143], v5, s[8:11], s75 offen offset:1024 sc1
  v_mfma_f32_32x32x16_bf16 v[64:79], v[144:147], a[16:19], v[64:79]
  v_mfma_f32_32x32x16_bf16 v[80:95], v[144:147], a[144:147], v[80:95]
  buffer_load_dwordx4 v[144:147], v5, s[8:11], s75 offen offset:2048 sc1
  v_mfma_f32_32x32x16_bf16 v[64:79], v[148:151], a[20:23], v[64:79]
  v_mfma_f32_32x32x16_bf16 v[80:95], v[148:151], a[148:151], v[80:95]
  buffer_load_dwordx4 v[148:151], v5, s[8:11], s75 offen offset:3072 sc1
  v_mfma_f32_32x32x16_bf16 v[64:79], v[152:155], a[24:27], v[64:79]
  v_mfma_f32_32x32x16_bf16 v[80:95], v[152:155], a[152:155], v[80:95]
  s_add_u32 s75, s1, 5
  s_and_b32 s75, s75, 7
  s_mul_i32 s75, s75, 4096
  s_add_u32 s75, s75, s91
  buffer_load_dwordx4 v[152:155], v5, s[8:11], s75 offen offset:0 sc1
  v_mfma_f32_32x32x16_bf16 v[64:79], v[156:159], a[28:31], v[64:79]
  v_mfma_f32_32x32x16_bf16 v[80:95], v[156:159], a[156:159], v[80:95]
  buffer_load_dwordx4 v[156:159], v5, s[8:11], s75 offen offset:1024 sc1
  v_mfma_f32_32x32x16_bf16 v[64:79], v[160:163], a[32:35], v[64:79]
  v_mfma_f32_32x32x16_bf16 v[80:95], v[160:163], a[160:163], v[80:95]
  buffer_load_dwordx4 v[160:163], v5, s[8:11], s75 offen offset:2048 sc1
  v_mfma_f32_32x32x16_bf16 v[64:79], v[164:167], a[36:39], v[64:79]
  v_mfma_f32_32x32x16_bf16 v[80:95], v[164:167], a[164:167], v[80:95]
  buffer_load_dwordx4 v[164:167], v5, s[8:11], s75 offen offset:3072 sc1
  v_mfma_f32_32x32x16_bf16 v[64:79], v[168:171], a[40:43], v[64:79]
  v_mfma_f32_32x32x16_bf16 v[80:95], v[168:171], a[168:171], v[80:95]
  s_add_u32 s75, s1, 6
  s_and_b32 s75, s75, 7
  s_mul_i32 s75, s75, 4096
  s_add_u32 s75, s75, s91
  buffer_load_dwordx4 v[168:171], v5, s[8:11], s75 offen offset:0 sc1
  v_mfma_f32_32x32x16_bf16 v[64:79], v[172:175], a[44:47], v[64:79]
  v_mfma_f32_32x32x16_bf16 v[80:95], v[172:175], a[172:175], v[80:95]
  buffer_load_dwordx4 v[172:175], v5, s[8:11], s75 offen offset:1024 sc1
  v_mfma_f32_32x32x16_bf16 v[64:79], v[176:179], a[48:51], v[64:79]
  v_mfma_f32_32x32x16_bf16 v[80:95], v[176:179], a[176:179], v[80:95]
  buffer_load_dwordx4 v[176:179], v5, s[8:11], s75 offen offset:2048 sc1
  v_mfma_f32_32x32x16_bf16 v[64:79], v[180:183], a[52:55], v[64:79]
  v_mfma_f32_32x32x16_bf16 v[80:95], v[180:183], a[180:183], v[80:95]
  buffer_load_dwordx4 v[180:183], v5, s[8:11], s75 offen offset:3072 sc1
  s_waitcnt vmcnt(13)
  v_mfma_f32_32x32x16_bf16 v[64:79], v[128:131], a[56:59], v[64:79]
  v_mfma_f32_32x32x16_bf16 v[80:95], v[128:131], a[184:187], v[80:95]
  s_add_u32 s75, s1, 7
  s_and_b32 s75, s75, 7
  s_mul_i32 s75, s75, 4096
  s_add_u32 s75, s75, s91
  buffer_load_dwordx4 v[128:131], v5, s[8:11], s75 offen offset:0 sc1
  s_waitcnt vmcnt(13)
  v_mfma_f32_32x32x16_bf16 v[64:79], v[132:135], a[60:63], v[64:79]
  v_mfma_f32_32x32x16_bf16 v[80:95], v[132:135], a[188:191], v[80:95]
  buffer_load_dwordx4 v[132:135], v5, s[8:11], s75 offen offset:1024 sc1
  s_waitcnt vmcnt(13)
  v_mfma_f32_32x32x16_bf16 v[64:79], v[136:139], a[64:67], v[64:79]
  v_mfma_f32_32x32x16_bf16 v[80:95], v[136:139], a[192:195], v[80:95]
  buffer_load_dwordx4 v[136:139], v5, s[8:11], s75 offen offset:2048 sc1
  s_waitcnt vmcnt(13)
  v_mfma_f32_32x32x16_bf16 v[64:79], v[140:143], a[68:71], v[64:79]
  v_mfma_f32_32x32x16_bf16 v[80:95], v[140:143], a[196:199], v[80:95]
  buffer_load_dwordx4 v[140:143], v5, s[8:11], s75 offen offset:3072 sc1
  s_waitcnt vmcnt(13)
  v_mfma_f32_32x32x16_bf16 v[64:79], v[144:147], a[72:75], v[64:79]
  v_mfma_f32_32x32x16_bf16 v[80:95], v[144:147], a[200:203], v[80:95]
  s_waitcnt vmcnt(12)
  v_mfma_f32_32x32x16_bf16 v[64:79], v[148:151], a[76:79], v[64:79]
  v_mfma_f32_32x32x16_bf16 v[80:95], v[148:151], a[204:207], v[80:95]
  s_waitcnt vmcnt(11)
  v_mfma_f32_32x32x16_bf16 v[64:79], v[152:155], a[80:83], v[64:79]
  v_mfma_f32_32x32x16_bf16 v[80:95], v[152:155], a[208:211], v[80:95]
  s_xor_b64 s[48:49], s[48:49], s[70:71]
  s_xor_b64 s[50:51], s[50:51], s[70:71]
  s_xor_b64 s[52:53], s[52:53], s[70:71]
  s_xor_b64 s[54:55], s[54:55], s[70:71]
  s_xor_b64 s[56:57], s[56:57], s[70:71]
  s_xor_b64 s[58:59], s[58:59], s[70:71]
  s_xor_b64 s[60:61], s[60:61], s[70:71]
  s_xor_b64 s[62:63], s[62:63], s[70:71]
  s_xor_b64 s[24:25], s[24:25], s[70:71]
  s_xor_b64 s[26:27], s[26:27], s[70:71]
  s_xor_b64 s[28:29], s[28:29], s[70:71]
  s_xor_b64 s[30:31], s[30:31], s[70:71]
  s_xor_b64 s[32:33], s[32:33], s[70:71]
  s_xor_b64 s[34:35], s[34:35], s[70:71]
  s_xor_b64 s[36:37], s[36:37], s[70:71]
  s_xor_b64 s[38:39], s[38:39], s[70:71]
  s_or_b64 s[48:49], s[48:49], s[50:51]
  s_or_b64 s[52:53], s[52:53], s[54:55]
  s_or_b64 s[56:57], s[56:57], s[58:59]
  s_or_b64 s[60:61], s[60:61], s[62:63]
  s_or_b64 s[24:25], s[24:25], s[26:27]
  s_or_b64 s[28:29], s[28:29], s[30:31]
  s_or_b64 s[32:33], s[32:33], s[34:35]
  s_or_b64 s[36:37], s[36:37], s[38:39]
  s_or_b64 s[48:49], s[48:49], s[52:53]
  s_or_b64 s[56:57], s[56:57], s[60:61]
  s_or_b64 s[24:25], s[24:25], s[28:29]
  s_or_b64 s[32:33], s[32:33], s[36:37]
  s_or_b64 s[48:49], s[48:49], s[56:57]
  s_or_b64 s[24:25], s[24:25], s[32:33]
  s_or_b64 s[48:49], s[48:49], s[24:25]
  s_cbranch_scc1 SLOW_F2L
RET_F2L:
  buffer_load_dwordx4 v[20:23], v2, s[8:11], s93 offen offset:0 sc1
  s_lshl_b32 s73, s83, 2
  s_add_u32 s73, s73, s44
  s_lshl_b32 s98, s73, 11
  s_add_u32 s98, s98, 524288
  buffer_load_dwordx4 v[200:203], v2, s[8:11], s98 offen offset:0 sc1
  buffer_load_dwordx4 v[204:207], v2, s[8:11], s98 offen offset:1024 sc1
  s_lshl_b32 s73, s73, 10
  s_add_u32 s73, s73, s97
  s_add_u32 s100, s73, 4194304
  s_add_u32 s73, s73, 2097152
  buffer_load_dwordx4 v[192:195], v2, s[8:11], s73 offen sc1
  s_add_u32 s73, s73, 0x8000
  buffer_load_dwordx4 v[196:199], v2, s[8:11], s73 offen sc1
  s_waitcnt vmcnt(15)
  v_mfma_f32_32x32x16_bf16 v[64:79], v[156:159], a[84:87], v[64:79]
  v_mfma_f32_32x32x16_bf16 v[80:95], v[156:159], a[212:215], v[80:95]
  s_waitcnt vmcnt(14)
  v_mfma_f32_32x32x16_bf16 v[64:79], v[160:163], a[88:91], v[64:79]
  v_mfma_f32_32x32x16_bf16 v[80:95], v[160:163], a[216:219], v[80:95]
  s_waitcnt vmcnt(13)
  v_mfma_f32_32x32x16_bf16 v[64:79], v[164:167], a[92:95], v[64:79]
  v_mfma_f32_32x32x16_bf16 v[80:95], v[164:167], a[220:223], v[80:95]
  s_waitcnt vmcnt(12)
  v_mfma_f32_32x32x16_bf16 v[64:79], v[168:171], a[96:99], v[64:79]
  v_mfma_f32_32x32x16_bf16 v[80:95], v[168:171], a[224:227], v[80:95]
  s_waitcnt vmcnt(11)
  v_mfma_f32_32x32x16_bf16 v[64:79], v[172:175], a[100:103], v[64:79]
  v_mfma_f32_32x32x16_bf16 v[80:95], v[172:175], a[228:231], v[80:95]
  s_waitcnt vmcnt(10)
  v_mfma_f32_32x32x16_bf16 v[64:79], v[176:179], a[104:107], v[64:79]
  v_mfma_f32_32x32x16_bf16 v[80:95], v[176:179], a[232:235], v[80:95]
  s_waitcnt vmcnt(9)
  v_mfma_f32_32x32x16_bf16 v[64:79], v[180:183], a[108:111], v[64:79]
  v_mfma_f32_32x32x16_bf16 v[80:95], v[180:183], a[236:239], v[80:95]
  s_waitcnt vmcnt(8)
  v_mfma_f32_32x32x16_bf16 v[64:79], v[128:131], a[112:115], v[64:79]
  v_mfma_f32_32x32x16_bf16 v[80:95], v[128:131], a[240:243], v[80:95]
  s_waitcnt vmcnt(7)
  v_mfma_f32_32x32x16_bf16 v[64:79], v[132:135], a[116:119], v[64:79]
  v_mfma_f32_32x32x16_bf16 v[80:95], v[132:135], a[244:247], v[80:95]
  s_waitcnt vmcnt(6)
  v_mfma_f32_32x32x16_bf16 v[64:79], v[136:139], a[120:123], v[64:79]
  v_mfma_f32_32x32x16_bf16 v[80:95], v[136:139], a[248:251], v[80:95]
  s_waitcnt vmcnt(5)
  v_mfma_f32_32x32x16_bf16 v[64:79], v[140:143], a[124:127], v[64:79]
  v_mfma_f32_32x32x16_bf16 v[80:95], v[140:143], a[252:255], v[80:95]
  s_barrier
  s_nop 9
  ds_write_b128 v7, v[72:75] offset:0
  ds_write_b128 v7, v[76:79] offset:1024
  ds_write_b128 v8, v[80:83] offset:0
  ds_write_b128 v8, v[84:87] offset:1024
  ds_write_b128 v9, v[88:91] offset:0
  ds_write_b128 v9, v[92:95] offset:1024
  s_waitcnt lgkmcnt(0)
  s_barrier
  ds_read_b128 v[32:35], v10 offset:0
  ds_read_b128 v[36:39], v10 offset:1024
  ds_read_b128 v[40:43], v10 offset:2048
  ds_read_b128 v[44:47], v10 offset:3072
  ds_read_b128 v[48:51], v10 offset:4096
  ds_read_b128 v[52:55], v10 offset:5120
  v_pk_add_f32 v[64:65], v[64:65], v[6:7] op_sel:[0,0] op_sel_hi:[1,0]
  v_pk_add_f32 v[66:67], v[66:67], v[6:7] op_sel:[0,0] op_sel_hi:[1,0]
  v_pk_add_f32 v[68:69], v[68:69], v[6:7] op_sel:[0,0] op_sel_hi:[1,0]
  v_pk_add_f32 v[70:71], v[70:71], v[6:7] op_sel:[0,0] op_sel_hi:[1,0]
  s_waitcnt lgkmcnt(3)
  v_pk_add_f32 v[32:33], v[32:33], v[40:41] op_sel:[0,0] op_sel_hi:[1,1]
  v_pk_add_f32 v[34:35], v[34:35], v[42:43] op_sel:[0,0] op_sel_hi:[1,1]
  s_waitcnt lgkmcnt(2)
  v_pk_add_f32 v[36:37], v[36:37], v[44:45] op_sel:[0,0] op_sel_hi:[1,1]
  v_pk_add_f32 v[38:39], v[38:39], v[46:47] op_sel:[0,0] op_sel_hi:[1,1]
  s_waitcnt lgkmcnt(1)
  v_pk_add_f32 v[64:65], v[64:65], v[48:49] op_sel:[0,0] op_sel_hi:[1,1]
  v_pk_add_f32 v[66:67], v[66:67], v[50:51] op_sel:[0,0] op_sel_hi:[1,1]
  s_waitcnt lgkmcnt(0)
  v_pk_add_f32 v[68:69], v[68:69], v[52:53] op_sel:[0,0] op_sel_hi:[1,1]
  v_pk_add_f32 v[70:71], v[70:71], v[54:55] op_sel:[0,0] op_sel_hi:[1,1]
  v_pk_add_f32 v[64:65], v[64:65], v[32:33] op_sel:[0,0] op_sel_hi:[1,1]
  v_pk_add_f32 v[66:67], v[66:67], v[34:35] op_sel:[0,0] op_sel_hi:[1,1]
  v_pk_add_f32 v[68:69], v[68:69], v[36:37] op_sel:[0,0] op_sel_hi:[1,1]
  v_pk_add_f32 v[70:71], v[70:71], v[38:39] op_sel:[0,0] op_sel_hi:[1,1]
  s_waitcnt vmcnt(4)
  v_lshlrev_b32 v56, 16, v20
  v_and_b32 v57, 0xffff0000, v20
  v_lshlrev_b32_e64 v58, 16, v21
  v_and_b32 v59, 0xffff0000, v21
  v_lshlrev_b32_e64 v60, 16, v22
  v_and_b32 v61, 0xffff0000, v22
  v_lshlrev_b32_e64 v62, 16, v23
  v_and_b32 v63, 0xffff0000, v23
  v_pk_mul_f32 v[64:65], v[64:65], v[56:57] op_sel:[0,0] op_sel_hi:[1,1]
  v_pk_mul_f32 v[66:67], v[66:67], v[58:59] op_sel:[0,0] op_sel_hi:[1,1]
  v_pk_mul_f32 v[68:69], v[68:69], v[60:61] op_sel:[0,0] op_sel_hi:[1,1]
  v_pk_mul_f32 v[70:71], v[70:71], v[62:63] op_sel:[0,0] op_sel_hi:[1,1]
  v_cvt_pk_bf16_f32 v20, v64, v65
  v_cvt_pk_bf16_f32 v21, v66, v67
  v_cvt_pk_bf16_f32 v22, v68, v69
  v_cvt_pk_bf16_f32 v23, v70, v71
  buffer_store_dwordx4 v[20:23], v2, s[8:11], s92 offen offset:0 sc1
  s_waitcnt vmcnt(4)
  v_xor_b32 v201, s71, v201
  v_xor_b32 v203, s71, v203
  s_waitcnt vmcnt(3)
  v_xor_b32 v205, s71, v205
  v_xor_b32 v207, s71, v207
  v_or3_b32 v201, v201, v203, v205
  v_or_b32 v201, v201, v207
  v_cmp_ne_u32 vcc, 0, v201
  s_nop 0
  s_cbranch_vccnz SLOW_KVFL
RET_KVFL:
  v_mov_b32 v208, v200
  v_mov_b32 v209, v202
  v_mov_b32 v210, v204
  v_mov_b32 v211, v206
  s_waitcnt vmcnt(2)
  s_nop 0
  v_mfma_f32_32x32x16_bf16 v[212:227], v[208:211], v[192:195], 0
  s_waitcnt vmcnt(1)
  v_mfma_f32_32x32x16_bf16 v[228:243], v[208:211], v[196:199], 0
  s_nop 9
  v_add_f32 v220, s84, v220
  v_rcp_f32 v220, v220
  v_add_f32 v236, s84, v236
  v_rcp_f32 v236, v236
  v_mul_f32 v212, v212, v220
  v_mul_f32 v213, v213, v220
  v_mul_f32 v214, v214, v220
  v_mul_f32 v215, v215, v220
  v_mul_f32 v216, v216, v220
  v_mul_f32 v217, v217, v220
  v_mul_f32 v218, v218, v220
  v_mul_f32 v219, v219, v220
  v_cvt_pk_bf16_f32 v224, v212, v213
  v_cvt_pk_bf16_f32 v225, v214, v215
  v_cvt_pk_bf16_f32 v226, v216, v217
  v_cvt_pk_bf16_f32 v227, v218, v219
  buffer_store_dwordx4 v[224:227], v2, s[8:11], s100 offen sc1
  v_mul_f32 v228, v228, v236
  v_mul_f32 v229, v229, v236
  v_mul_f32 v230, v230, v236
  v_mul_f32 v231, v231, v236
  v_mul_f32 v232, v232, v236
  v_mul_f32 v233, v233, v236
  v_mul_f32 v234, v234, v236
  v_mul_f32 v235, v235, v236
  v_cvt_pk_bf16_f32 v240, v228, v229
  v_cvt_pk_bf16_f32 v241, v230, v231
  v_cvt_pk_bf16_f32 v242, v232, v233
  v_cvt_pk_bf16_f32 v243, v234, v235
  s_add_u32 s100, s100, 0x8000
  buffer_store_dwordx4 v[240:243], v2, s[8:11], s100 offen sc1
  s_lshl_b32 s74, s44, 14
  s_add_u32 m0, s74, 0
  s_lshl_b32 s73, s44, 17
  s_add_u32 s73, s73, s94
  s_add_u32 s73, s73, 0
  buffer_load_dwordx4 v13, s[12:15], s73 offen offset:0 lds
  buffer_load_dwordx4 v14, s[12:15], s73 offen offset:1024 lds
  buffer_load_dwordx4 v15, s[12:15], s73 offen offset:2048 lds
  buffer_load_dwordx4 v16, s[12:15], s73 offen offset:3072 lds
  s_lshl_b32 s74, s44, 14
  s_add_u32 m0, s74, 4096
  s_lshl_b32 s73, s44, 17
  s_add_u32 s73, s73, s94
  s_add_u32 s73, s73, 32768
  buffer_load_dwordx4 v13, s[12:15], s73 offen offset:0 lds
  buffer_load_dwordx4 v14, s[12:15], s73 offen offset:1024 lds
  buffer_load_dwordx4 v15, s[12:15], s73 offen offset:2048 lds
  buffer_load_dwordx4 v16, s[12:15], s73 offen offset:3072 lds
  s_waitcnt vmcnt(10)
  s_lshl_b32 s73, s83, 3
  s_lshl_b32 s74, s96, 2
  s_add_u32 s73, s73, s74
  s_add_u32 s73, s73, s42
  v_mov_b32_e64 v3, s71
  s_mov_b64 exec, 1
  buffer_store_dword v3, off, s[8:11], s73 sc1
  s_mov_b64 exec, -1
  s_lshl_b32 s73, s83, 3
  s_lshl_b32 s74, s96, 2
  s_add_u32 s73, s73, s74
  s_add_u32 s73, s73, s42
  s_add_u32 s73, s73, 8192
  v_mov_b32_e64 v3, s71
  s_mov_b64 exec, 1
  buffer_store_dword v3, off, s[8:11], s73 sc1
  s_mov_b64 exec, -1
  s_waitcnt vmcnt(10)
  s_lshl_b32 s73, s83, 4
  s_lshl_b32 s74, s44, 2
  s_add_u32 s73, s73, s74
  s_lshl_b32 s74, s47, 7
  s_add_u32 s73, s73, s74
  s_add_u32 s73, s73, 24576
  v_mov_b32_e64 v3, s71
  s_mov_b64 exec, 1
  buffer_store_dword v3, off, s[8:11], s73 sc1
  s_mov_b64 exec, -1
  s_lshl_b32 s74, s44, 14
  s_add_u32 m0, s74, 8192
  s_lshl_b32 s73, s44, 17
  s_add_u32 s73, s73, s94
  s_add_u32 s73, s73, 65536
  buffer_load_dwordx4 v13, s[12:15], s73 offen offset:0 lds
  buffer_load_dwordx4 v14, s[12:15], s73 offen offset:1024 lds
  buffer_load_dwordx4 v15, s[12:15], s73 offen offset:2048 lds
  buffer_load_dwordx4 v16, s[12:15], s73 offen offset:3072 lds
  s_lshl_b32 s74, s44, 14
  s_add_u32 m0, s74, 12288
  s_lshl_b32 s73, s44, 17
  s_add_u32 s73, s73, s94
  s_add_u32 s73, s73, 98304
  buffer_load_dwordx4 v13, s[12:15], s73 offen offset:0 lds
  buffer_load_dwordx4 v14, s[12:15], s73 offen offset:1024 lds
  buffer_load_dwordx4 v15, s[12:15], s73 offen offset:2048 lds
  buffer_load_dwordx4 v16, s[12:15], s73 offen offset:3072 lds
  s_mul_i32 s74, s44, 18432
  s_add_u32 m0, s74, 65536
  s_mul_i32 s73, s44, 147456
  s_add_u32 s73, s73, s94
  s_add_u32 s73, s73, 0
  buffer_load_dwordx4 v13, s[16:19], s73 offen offset:0 lds
  buffer_load_dwordx4 v14, s[16:19], s73 offen offset:1024 lds
  buffer_load_dwordx4 v15, s[16:19], s73 offen offset:2048 lds
  buffer_load_dwordx4 v16, s[16:19], s73 offen offset:3072 lds
  s_mul_i32 s74, s44, 18432
  s_add_u32 m0, s74, 69632
  s_mul_i32 s73, s44, 147456
  s_add_u32 s73, s73, s94
  s_add_u32 s73, s73, 32768
  buffer_load_dwordx4 v13, s[16:19], s73 offen offset:0 lds
  buffer_load_dwordx4 v14, s[16:19], s73 offen offset:1024 lds
  buffer_load_dwordx4 v15, s[16:19], s73 offen offset:2048 lds
  buffer_load_dwordx4 v16, s[16:19], s73 offen offset:3072 lds
  s_mul_i32 s74, s44, 18432
  s_add_u32 m0, s74, 73728
  s_mul_i32 s73, s44, 147456
  s_add_u32 s73, s73, s94
  s_add_u32 s73, s73, 65536
  buffer_load_dwordx4 v13, s[16:19], s73 offen offset:0 lds
  buffer_load_dwordx4 v14, s[16:19], s73 offen offset:1024 lds
  buffer_load_dwordx4 v15, s[16:19], s73 offen offset:2048 lds
  buffer_load_dwordx4 v16, s[16:19], s73 offen offset:3072 lds
  s_mul_i32 s74, s44, 18432
  s_add_u32 m0, s74, 77824
  s_mul_i32 s73, s44, 147456
  s_add_u32 s73, s73, s94
  s_add_u32 s73, s73, 98304
  buffer_load_dwordx4 v13, s[16:19], s73 offen offset:0 lds
  buffer_load_dwordx4 v14, s[16:19], s73 offen offset:1024 lds
  buffer_load_dwordx4 v15, s[16:19], s73 offen offset:2048 lds
  buffer_load_dwordx4 v16, s[16:19], s73 offen offset:3072 lds
  s_mul_i32 s74, s44, 18432
  s_add_u32 m0, s74, 81920
  s_mul_i32 s73, s44, 147456
  s_add_u32 s73, s73, s94
  s_add_u32 s73, s73, 131072
  buffer_load_dwordx4 v13, s[16:19], s73 offen offset:0 lds
  buffer_load_dwordx4 v14, s[16:19], s73 offen offset:1024 lds
  s_buffer_load_dwordx16 s[24:39], s[8:11], s41
  s_buffer_load_dwordx16 s[48:63], s[8:11], s42 offset:8192
  s_lshl_b32 s99, s44, 3
  v_lshrrev_b32 v249, 3, v1
  v_add_u32 v249, s99, v249
  v_and_b32 v250, 7, v1
  v_lshlrev_b32 v251, 4, v250
  v_lshl_add_u32 v27, v249, 10, v251
  v_lshlrev_b32 v250, 1, v250
  v_and_b32 v251, 15, v249
  v_xor_b32 v250, v250, v251
  v_lshlrev_b32 v250, 4, v250
  v_lshl_add_u32 v25, v249, 8, v250
  v_xor_b32 v26, 16, v25
  v_lshrrev_b32 v244, 5, v1
  v_bfe_u32 v245, v1, 2, 2
  v_and_b32_e64 v246, 3, v1
  v_bfe_u32 v247, v1, 4, 1
  v_lshlrev_b32_e64 v246, 3, v246
  v_lshl_add_u32 v246, v247, 5, v246
  v_lshl_add_u32 v248, v244, 2, v245
  v_lshl_add_u32 v248, v248, 7, v246
  v_bfe_u32 v249, v1, 3, 1
  v_lshl_add_u32 v248, v249, 6, v248
  s_lshl_b32 s99, s96, 15
  v_add_u32 v20, s99, v248
  v_xor_b32_e64 v21, 64, v20
  s_mul_i32 s99, s96, 49152
  s_add_u32 s99, s99, 67584
  v_add_u32 v22, s99, v248
  v_xor_b32_e64 v23, 64, v22
  s_cmp_eq_u32 s96, 1
  s_cselect_b32 s99, 28672, s99
  v_add_u32 v17, s99, v248
  v_xor_b32 v18, 64, v17
  v_and_b32 v249, 15, v1
  v_xor_b32 v249, v249, v244
  v_lshlrev_b32 v249, 4, v249
  v_and_b32 v250, 31, v1
  v_lshl_add_u32 v249, v250, 8, v249
  s_lshl_b32 s99, s96, 14
  s_lshl_b32 s101, s95, 13
  s_add_u32 s99, s99, s101
  v_add_u32_e64 v24, s99, v249
  s_waitcnt lgkmcnt(0)
  s_xor_b64 s[24:25], s[24:25], s[70:71]
  s_xor_b64 s[26:27], s[26:27], s[70:71]
  s_xor_b64 s[28:29], s[28:29], s[70:71]
  s_xor_b64 s[30:31], s[30:31], s[70:71]
  s_xor_b64 s[32:33], s[32:33], s[70:71]
  s_xor_b64 s[34:35], s[34:35], s[70:71]
  s_xor_b64 s[36:37], s[36:37], s[70:71]
  s_xor_b64 s[38:39], s[38:39], s[70:71]
  s_or_b64 s[24:25], s[24:25], s[26:27]
  s_or_b64 s[28:29], s[28:29], s[30:31]
  s_or_b64 s[32:33], s[32:33], s[34:35]
  s_or_b64 s[36:37], s[36:37], s[38:39]
  s_or_b64 s[24:25], s[24:25], s[28:29]
  s_or_b64 s[32:33], s[32:33], s[36:37]
  s_or_b64 s[24:25], s[24:25], s[32:33]
  s_cbranch_scc1 SLOW_F4L
RET_F4L:
  buffer_load_dwordx4 v[192:195], v2, s[8:11], s78 offen offset:0 sc1
  buffer_load_dwordx4 v[196:199], v2, s[8:11], s78 offen offset:1024 sc1
  buffer_load_dwordx4 v[200:203], v2, s[8:11], s78 offen offset:2048 sc1
  buffer_load_dwordx4 v[204:207], v2, s[8:11], s78 offen offset:3072 sc1
  buffer_load_dwordx4 v[208:211], v2, s[8:11], s79 offen offset:0 sc1
  buffer_load_dwordx4 v[212:215], v2, s[8:11], s79 offen offset:1024 sc1
  buffer_load_dwordx4 v[216:219], v2, s[8:11], s79 offen offset:2048 sc1
  buffer_load_dwordx4 v[220:223], v2, s[8:11], s79 offen offset:3072 sc1
  buffer_load_dwordx4 v[224:227], v2, s[8:11], s80 offen offset:0 sc1
  buffer_load_dwordx4 v[228:231], v2, s[8:11], s80 offen offset:1024 sc1
  buffer_load_dwordx4 v[232:235], v2, s[8:11], s80 offen offset:2048 sc1
  buffer_load_dwordx4 v[236:239], v2, s[8:11], s80 offen offset:3072 sc1
  buffer_load_dwordx4 v[240:243], v2, s[8:11], s81 offen offset:0 sc1
  buffer_load_dwordx4 v[244:247], v2, s[8:11], s81 offen offset:1024 sc1
  buffer_load_dwordx4 v[248:251], v2, s[8:11], s81 offen offset:2048 sc1
  buffer_load_dwordx4 v[252:255], v2, s[8:11], s81 offen offset:3072 sc1
  s_waitcnt vmcnt(0) lgkmcnt(0)
  s_branch PHASE3
EPOCH_A:
  v_add_u32 v3, 1, v3
  v_max_u32_e64 v3, 1, v3
  s_mov_b64 exec, 1
  buffer_store_dword v3, off, s[8:11], 0 sc1
  buffer_store_dword v3, off, s[40:43], 0 sc1
  s_mov_b64 exec, -1
  s_nop 1
  s_branch EPOCHR_A
SLOW_TGA:
  s_mov_b32 s76, 200000
SLOWL_TGA:
  buffer_load_dword v3, off, s[40:43], 0 sc1
  s_waitcnt vmcnt(0)
  v_readfirstlane_b32 s71, v3
  s_nop 0
  s_cmp_lg_u32 s71, 0
  s_cbranch_scc1 RET_TGA
  s_sub_u32 s76, s76, 1
  s_cmp_lg_u32 s76, 0
  s_cbranch_scc1 SLOWL_TGA
  s_branch RET_TGA
SLOW_STA:
  s_mov_b32 s76, 200000
SLOWL_STA:
  buffer_load_dwordx4 v[14:17], v47, s[8:11], 0 offen offset:0 sc1
  buffer_load_dwordx4 v[18:21], v47, s[8:11], 0 offen offset:1024 sc1
  buffer_load_dwordx4 v[22:25], v47, s[8:11], 0 offen offset:2048 sc1
  buffer_load_dwordx4 v[52:55], v47, s[8:11], 0 offen offset:3072 sc1
  buffer_load_dwordx4 v[248:251], v47, s[8:11], s93 offen offset:0 sc1
  buffer_load_dwordx4 v[252:255], v47, s[8:11], s93 offen offset:1024 sc1
  s_waitcnt vmcnt(0)
  v_xor_b32 v15, s71, v15
  v_xor_b32 v17, s71, v17
  v_xor_b32 v19, s71, v19
  v_xor_b32 v21, s71, v21
  v_xor_b32 v23, s71, v23
  v_xor_b32 v25, s71, v25
  v_xor_b32 v53, s71, v53
  v_xor_b32 v55, s71, v55
  v_xor_b32 v249, s71, v249
  v_xor_b32 v251, s71, v251
  v_xor_b32 v253, s71, v253
  v_xor_b32_e64 v255, s71, v255
  v_or3_b32 v15, v15, v17, v19
  v_or3_b32 v21, v21, v23, v25
  v_or3_b32 v53, v53, v55, v249
  v_or3_b32 v251, v251, v253, v255
  v_or3_b32 v15, v15, v21, v53
  v_or_b32 v15, v15, v251
  v_cmp_ne_u32 vcc, 0, v15
  s_nop 1
  s_cbranch_vccz RET_STA
  s_sub_u32 s76, s76, 1
  s_cmp_lg_u32 s76, 0
  s_cbranch_scc1 SLOWL_STA
  s_branch RET_STA
EPOCH_B:
  v_add_u32 v3, 1, v3
  v_max_u32_e64 v3, 1, v3
  s_mov_b64 exec, 1
  buffer_store_dword v3, off, s[8:11], 0 sc1
  buffer_store_dword v3, off, s[40:43], 0 sc1
  s_mov_b64 exec, -1
  s_nop 1
  s_branch EPOCHR_B
SLOW_TGB:
  s_mov_b32 s76, 200000
SLOWL_TGB:
  buffer_load_dword v3, off, s[40:43], 0 sc1
  s_waitcnt vmcnt(0)
  v_readfirstlane_b32 s71, v3
  s_nop 0
  s_cmp_lg_u32 s71, 0
  s_cbranch_scc1 RET_TGB
  s_sub_u32 s76, s76, 1
  s_cmp_lg_u32 s76, 0
  s_cbranch_scc1 SLOWL_TGB
  s_branch RET_TGB
SLOW_STB:
  s_mov_b32 s76, 200000
SLOWL_STB:
  buffer_load_dwordx4 v[14:17], v47, s[8:11], 0 offen offset:0 sc1
  buffer_load_dwordx4 v[18:21], v47, s[8:11], 0 offen offset:1024 sc1
  buffer_load_dwordx4 v[22:25], v47, s[8:11], 0 offen offset:2048 sc1
  buffer_load_dwordx4 v[52:55], v47, s[8:11], 0 offen offset:3072 sc1
  buffer_load_dwordx4 v[248:251], v47, s[8:11], s93 offen offset:0 sc1
  buffer_load_dwordx4 v[252:255], v47, s[8:11], s93 offen offset:1024 sc1
  s_waitcnt vmcnt(0)
  v_xor_b32 v15, s71, v15
  v_xor_b32 v17, s71, v17
  v_xor_b32 v19, s71, v19
  v_xor_b32 v21, s71, v21
  v_xor_b32 v23, s71, v23
  v_xor_b32 v25, s71, v25
  v_xor_b32 v53, s71, v53
  v_xor_b32 v55, s71, v55
  v_xor_b32 v249, s71, v249
  v_xor_b32 v251, s71, v251
  v_xor_b32 v253, s71, v253
  v_xor_b32_e64 v255, s71, v255
  v_or3_b32 v15, v15, v17, v19
  v_or3_b32 v21, v21, v23, v25
  v_or3_b32 v53, v53, v55, v249
  v_or3_b32 v251, v251, v253, v255
  v_or3_b32 v15, v15, v21, v53
  v_or_b32 v15, v15, v251
  v_cmp_ne_u32 vcc, 0, v15
  s_nop 1
  s_cbranch_vccz RET_STB
  s_sub_u32 s76, s76, 1
  s_cmp_lg_u32 s76, 0
  s_cbranch_scc1 SLOWL_STB
  s_branch RET_STB
EPOCH_D:
  v_add_u32 v3, 1, v3
  v_max_u32_e64 v3, 1, v3
  s_mov_b64 exec, 1
  buffer_store_dword v3, off, s[8:11], 0 sc1
  buffer_store_dword v3, off, s[40:43], 0 sc1
  s_mov_b64 exec, -1
  s_nop 1
  s_branch EPOCHR_D
SLOW_TGD:
  s_mov_b32 s76, 200000
SLOWL_TGD:
  buffer_load_dword v3, off, s[40:43], 0 sc1
  s_waitcnt vmcnt(0)
  v_readfirstlane_b32 s71, v3
  s_nop 0
  s_cmp_lg_u32 s71, 0
  s_cbranch_scc1 RET_TGD
  s_sub_u32 s76, s76, 1
  s_cmp_lg_u32 s76, 0
  s_cbranch_scc1 SLOWL_TGD
  s_branch RET_TGD
EPOCH_C:
  v_add_u32 v3, 1, v3
  v_max_u32_e64 v3, 1, v3
  s_mov_b64 exec, 1
  buffer_store_dword v3, off, s[8:11], 0 sc1
  buffer_store_dword v3, off, s[40:43], 0 sc1
  s_mov_b64 exec, -1
  s_nop 1
  s_branch EPOCHR_C
SLOW_TGC:
  s_mov_b32 s76, 200000
SLOWL_TGC:
  buffer_load_dword v3, off, s[40:43], 0 sc1
  s_waitcnt vmcnt(0)
  v_readfirstlane_b32 s71, v3
  s_nop 0
  s_cmp_lg_u32 s71, 0
  s_cbranch_scc1 RET_TGC
  s_sub_u32 s76, s76, 1
  s_cmp_lg_u32 s76, 0
  s_cbranch_scc1 SLOWL_TGC
  s_branch RET_TGC
SLOW_F1:
  s_waitcnt vmcnt(0)
  s_lshr_b32 s74, s90, 1
  s_lshl_b32 s74, s74, 7
  s_lshl_b32 s73, s46, 3
  s_add_u32 s74, s74, s73
  s_lshl_b32 s73, s96, 2
  s_add_u32 s74, s74, s73
  s_add_u32 s74, s74, 16384
  v_mov_b32_e64 v3, s71
  s_mov_b64 exec, 1
  buffer_store_dword v3, off, s[8:11], s74 sc1
  s_mov_b64 exec, -1
  v_lshrrev_b32 v11, 3, v1
  v_min_u32 v11, 2, v11
  s_sub_u32 s74, s41, s40
  v_mul_u32_u24 v11, s74, v11
  v_and_b32 v12, 7, v1
  v_lshl_add_u32 v12, v12, 2, s40
  v_add_u32_e64 v12, v12, v11
  s_mov_b32 s76, 200000
SLOWL_F1:
  buffer_load_dword v11, v12, s[8:11], 0 offen sc1
  s_waitcnt vmcnt(0)
  v_cmp_ne_u32 vcc, s71, v11
  s_nop 1
  s_cbranch_vccz RET_F1
  s_sub_u32 s76, s76, 1
  s_cmp_lg_u32 s76, 0
  s_cbranch_scc1 SLOWL_F1
  s_branch RET_F1
SLOW_F2:
  v_and_b32_e64 v12, 31, v1
  v_lshl_add_u32 v12, v12, 2, s40
  s_mov_b32 s76, 200000
SLOWL_F2:
  buffer_load_dword v11, v12, s[8:11], 0 offen sc1
  s_waitcnt vmcnt(0)
  v_cmp_ne_u32 vcc, s71, v11
  s_nop 1
  s_cbranch_vccz RET_F2
  s_sub_u32 s76, s76, 1
  s_cmp_lg_u32 s76, 0
  s_cbranch_scc1 SLOWL_F2
  s_branch RET_F2
SLOW_KVF:
  s_mov_b32 s76, 200000
SLOWL_KVF:
  buffer_load_dwordx4 v[200:203], v2, s[8:11], s98 offen offset:0 sc1
  buffer_load_dwordx4 v[204:207], v2, s[8:11], s98 offen offset:1024 sc1
  s_waitcnt vmcnt(0)
  v_xor_b32 v201, s71, v201
  v_xor_b32 v203, s71, v203
  v_xor_b32 v205, s71, v205
  v_xor_b32_e64 v207, s71, v207
  v_or3_b32 v201, v201, v203, v205
  v_or_b32 v201, v201, v207
  v_cmp_ne_u32 vcc, 0, v201
  s_nop 1
  s_cbranch_vccz RET_KVF
  s_sub_u32 s76, s76, 1
  s_cmp_lg_u32 s76, 0
  s_cbranch_scc1 SLOWL_KVF
  s_branch RET_KVF
SLOW_F4:
  v_and_b32_e64 v12, 15, v1
  v_lshl_add_u32 v12, v12, 2, s41
  s_mov_b32 s76, 200000
SLOWL_F4:
  buffer_load_dword v11, v12, s[8:11], 0 offen sc1
  s_waitcnt vmcnt(0)
  v_cmp_ne_u32_e64 vcc, s71, v11
  s_nop 1
  s_cbranch_vccz RET_F4
  s_sub_u32 s76, s76, 1
  s_cmp_lg_u32 s76, 0
  s_cbranch_scc1 SLOWL_F4
  s_branch RET_F4
SLOW_F1L:
  s_waitcnt vmcnt(0)
  s_lshr_b32 s74, s90, 1
  s_lshl_b32 s74, s74, 7
  s_lshl_b32 s73, s46, 3
  s_add_u32 s74, s74, s73
  s_lshl_b32 s73, s96, 2
  s_add_u32 s74, s74, s73
  s_add_u32 s74, s74, 16384
  v_mov_b32 v3, s71
  s_mov_b64 exec, 1
  buffer_store_dword v3, off, s[8:11], s74 sc1
  s_mov_b64 exec, -1
  v_lshrrev_b32 v11, 3, v1
  v_min_u32 v11, 2, v11
  s_sub_u32 s74, s41, s40
  v_mul_u32_u24 v11, s74, v11
  v_and_b32 v12, 7, v1
  v_lshl_add_u32 v12, v12, 2, s40
  v_add_u32_e64 v12, v12, v11
  s_mov_b32 s76, 200000
SLOWL_F1L:
  buffer_load_dword v11, v12, s[8:11], 0 offen sc1
  s_waitcnt vmcnt(0)
  v_cmp_ne_u32 vcc, s71, v11
  s_nop 1
  s_cbranch_vccz RET_F1L
  s_sub_u32 s76, s76, 1
  s_cmp_lg_u32 s76, 0
  s_cbranch_scc1 SLOWL_F1L
  s_branch RET_F1L
SLOW_KVP:
  s_mov_b32 s76, 200000
SLOWL_KVP:
  buffer_load_dwordx4 v[192:195], v12, s[8:11], s98 offen offset:0 sc1
  buffer_load_dwordx4 v[196:199], v12, s[8:11], s98 offen offset:1024 sc1
  buffer_load_dwordx4 v[200:203], v12, s[8:11], s98 offen offset:2048 sc1
  buffer_load_dwordx4 v[204:207], v12, s[8:11], s98 offen offset:3072 sc1
  buffer_load_dwordx4 v[208:211], v12, s[8:11], s99 offen offset:0 sc1
  buffer_load_dwordx4 v[212:215], v12, s[8:11], s99 offen offset:1024 sc1
  buffer_load_dwordx4 v[216:219], v12, s[8:11], s99 offen offset:2048 sc1
  buffer_load_dwordx4 v[220:223], v12, s[8:11], s99 offen offset:3072 sc1
  buffer_load_dwordx4 v[224:227], v12, s[8:11], s100 offen offset:0 sc1
  buffer_load_dwordx4 v[228:231], v12, s[8:11], s100 offen offset:1024 sc1
  buffer_load_dwordx4 v[232:235], v12, s[8:11], s100 offen offset:2048 sc1
  buffer_load_dwordx4 v[236:239], v12, s[8:11], s100 offen offset:3072 sc1
  buffer_load_dwordx4 v[240:243], v12, s[8:11], s101 offen offset:0 sc1
  buffer_load_dwordx4 v[244:247], v12, s[8:11], s101 offen offset:1024 sc1
  buffer_load_dwordx4 v[248:251], v12, s[8:11], s101 offen offset:2048 sc1
  buffer_load_dwordx4 v[252:255], v12, s[8:11], s101 offen offset:3072 sc1
  s_waitcnt vmcnt(0)
  v_xor_b32 v193, s71, v193
  v_xor_b32 v195, s71, v195
  v_xor_b32 v197, s71, v197
  v_xor_b32 v199, s71, v199
  v_xor_b32 v201, s71, v201
  v_xor_b32 v203, s71, v203
  v_xor_b32 v205, s71, v205
  v_xor_b32 v207, s71, v207
  v_xor_b32 v209, s71, v209
  v_xor_b32 v211, s71, v211
  v_xor_b32 v213, s71, v213
  v_xor_b32 v215, s71, v215
  v_xor_b32 v217, s71, v217
  v_xor_b32 v219, s71, v219
  v_xor_b32 v221, s71, v221
  v_xor_b32 v223, s71, v223
  v_xor_b32 v225, s71, v225
  v_xor_b32 v227, s71, v227
  v_xor_b32 v229, s71, v229
  v_xor_b32 v231, s71, v231
  v_xor_b32 v233, s71, v233
  v_xor_b32 v235, s71, v235
  v_xor_b32 v237, s71, v237
  v_xor_b32 v239, s71, v239
  v_xor_b32 v241, s71, v241
  v_xor_b32 v243, s71, v243
  v_xor_b32 v245, s71, v245
  v_xor_b32 v247, s71, v247
  v_xor_b32 v249, s71, v249
  v_xor_b32 v251, s71, v251
  v_xor_b32 v253, s71, v253
  v_xor_b32_e64 v255, s71, v255
  v_or3_b32 v48, v193, v195, v197
  v_or_b32_e64 v49, v199, v201
  v_or3_b32 v48, v48, v203, v205
  v_or3_b32 v49, v49, v207, v209
  v_or3_b32 v48, v48, v211, v213
  v_or3_b32 v49, v49, v215, v217
  v_or3_b32 v48, v48, v219, v221
  v_or3_b32 v49, v49, v223, v225
  v_or3_b32 v48, v48, v227, v229
  v_or3_b32 v49, v49, v231, v233
  v_or3_b32 v48, v48, v235, v237
  v_or3_b32 v49, v49, v239, v241
  v_or3_b32 v48, v48, v243, v245
  v_or3_b32 v49, v49, v247, v249
  v_or3_b32 v48, v48, v251, v253
  v_or3_b32 v48, v48, v49, v255
  v_cmp_ne_u32 vcc, 0, v48
  s_nop 1
  s_cbranch_vccz RET_KVP
  s_sub_u32 s76, s76, 1
  s_cmp_lg_u32 s76, 0
  s_cbranch_scc1 SLOWL_KVP
  s_branch RET_KVP
SLOW_F2L:
  v_and_b32 v12, 31, v1
  v_lshl_add_u32 v12, v12, 2, s40
  s_mov_b32 s76, 200000
SLOWL_F2L:
  buffer_load_dword v11, v12, s[8:11], 0 offen sc1
  s_waitcnt vmcnt(0)
  v_cmp_ne_u32 vcc, s71, v11
  s_nop 1
  s_cbranch_vccz RET_F2L
  s_sub_u32 s76, s76, 1
  s_cmp_lg_u32 s76, 0
  s_cbranch_scc1 SLOWL_F2L
  s_branch RET_F2L
SLOW_KVFL:
  s_mov_b32 s76, 200000
SLOWL_KVFL:
  buffer_load_dwordx4 v[200:203], v2, s[8:11], s98 offen offset:0 sc1
  buffer_load_dwordx4 v[204:207], v2, s[8:11], s98 offen offset:1024 sc1
  s_waitcnt vmcnt(0)
  v_xor_b32 v201, s71, v201
  v_xor_b32 v203, s71, v203
  v_xor_b32 v205, s71, v205
  v_xor_b32_e64 v207, s71, v207
  v_or3_b32 v201, v201, v203, v205
  v_or_b32 v201, v201, v207
  v_cmp_ne_u32 vcc, 0, v201
  s_nop 1
  s_cbranch_vccz RET_KVFL
  s_sub_u32 s76, s76, 1
  s_cmp_lg_u32 s76, 0
  s_cbranch_scc1 SLOWL_KVFL
  s_branch RET_KVFL
SLOW_F4L:
  v_and_b32_e64 v12, 15, v1
  v_lshl_add_u32 v12, v12, 2, s41
  s_mov_b32 s76, 200000
SLOWL_F4L:
  buffer_load_dword v11, v12, s[8:11], 0 offen sc1
  s_waitcnt vmcnt(0)
  v_cmp_ne_u32 vcc, s71, v11
  s_nop 1
  s_cbranch_vccz RET_F4L
  s_sub_u32 s76, s76, 1
  s_cmp_lg_u32 s76, 0
  s_cbranch_scc1 SLOWL_F4L
  s_branch RET_F4L
SLOW_F5A:
  v_and_b32_e64 v12, 15, v1
  v_lshl_add_u32 v12, v12, 2, s42
  v_add_u32 v12, 8192, v12
  s_mov_b32 s76, 200000
SLOWL_F5A:
  buffer_load_dword v11, v12, s[8:11], 0 offen sc1
  s_waitcnt vmcnt(0)
  v_cmp_ne_u32 vcc, s71, v11
  s_nop 1
  s_cbranch_vccz RET_F5A
  s_sub_u32 s76, s76, 1
  s_cmp_lg_u32 s76, 0
  s_cbranch_scc1 SLOWL_F5A
  s_branch RET_F5A
SLOW_F5:
  v_and_b32_e64 v12, 15, v1
  v_lshl_add_u32 v12, v12, 2, s42
  s_mov_b32 s76, 200000
SLOWL_F5:
  buffer_load_dword v11, v12, s[8:11], 0 offen sc1
  s_waitcnt vmcnt(0)
  v_cmp_ne_u32 vcc, s71, v11
  s_nop 1
  s_cbranch_vccz RET_F5
  s_sub_u32 s76, s76, 1
  s_cmp_lg_u32 s76, 0
  s_cbranch_scc1 SLOWL_F5
  s_branch RET_F5
  s_endpgm
CODE_END:
.section .rodata,"a"
.p2align 6
.amdhsa_kernel recurrent_scan__linear_attn_block__mixer_gmlp__prompt_kernel
  .amdhsa_next_free_vgpr 512
  .amdhsa_next_free_sgpr 102
  .amdhsa_accum_offset 256
  .amdhsa_group_segment_fixed_size 0
  .amdhsa_kernarg_size 88
  .amdhsa_user_sgpr_count 2
  .amdhsa_user_sgpr_kernarg_segment_ptr 1
  .amdhsa_system_sgpr_workgroup_id_x 1
.end_amdhsa_kernel
```
